```python
import torch

def _softmax(x, axis=-1):
    return torch.softmax(x, dim=axis)
def _gelu(x):
    return torch.nn.functional.gelu(x, approximate="tanh")
def _silu(x):
    return torch.nn.functional.silu(x)
def _sigmoid(x):
    return torch.sigmoid(x)
def _layernorm(x, axis=-1, eps=1e-5):
    m = x.mean(dim=axis, keepdim=True)
    v = x.var(dim=axis, keepdim=True, unbiased=False)
    return (x - m) / torch.sqrt(v + eps)
def _scatter_add(tgt, idx, src, axis=0):
    return tgt.clone().index_add_(axis, idx, src)
def _segment_sum(src, seg, n):
    out = torch.zeros((n,) + src.shape[1:], dtype=src.dtype)
    return out.index_add_(0, seg, src)
def _pad(x, pw):
    flat = tuple(v for pair in reversed(pw) for v in pair)
    return torch.nn.functional.pad(x, flat)

kernel_name = 'sequential_preLN__compressed_kv_cla__moe_arch_mod__prompt'

def setup_inputs():

    _w = (lambda a: (lambda t: t.to(torch.bfloat16) if t.is_floating_point() else t)(torch.as_tensor(a)))
    def _A_setup():
        B, H, Sq, Sk, D, M = 1, 32, 2048, 2048, 128, 640
        Dc = 4 * D
        return {
            "x": _w((lambda *s: torch.randn(*s, dtype=torch.bfloat16) * 0.05)(B, Sq, M)),
            "c_kv": _w((lambda *s: torch.randn(*s, dtype=torch.bfloat16) * 0.4)(B, Sk, Dc)),
            "w_q": _w((lambda *s: torch.randn(*s, dtype=torch.bfloat16) * 3.2)(M, H, D) * (M ** -0.5)),
            "w_uk": _w((lambda *s: torch.randn(*s, dtype=torch.bfloat16) * 3.2)(Dc, H, D) * (Dc ** -0.5)),
            "w_uv": _w((lambda *s: torch.randn(*s, dtype=torch.bfloat16) * 0.4)(Dc, H, D) * (Dc ** -0.5)),
            "w_o": _w((lambda *s: torch.randn(*s, dtype=torch.bfloat16) * 0.4)(H, D, M) * ((H * D) ** -0.5)),
        }
    _A_in = _A_setup()

    def _B_setup():
        B, S, D, F, C = 1, 2048, 640, 1728, 2
        return {
            "x": _w((lambda *s: torch.randn(*s, dtype=torch.bfloat16) * 0.05)(B, S, D)),
            "w_r": _w((lambda *s: torch.randn(*s, dtype=torch.bfloat16) * 0.05)(D)),
            "w_gate": _w((lambda *s: torch.randn(*s, dtype=torch.bfloat16) * 0.05)(D, F)),
            "w_up": _w((lambda *s: torch.randn(*s, dtype=torch.bfloat16) * 0.05)(D, F)),
            "w_down": _w((lambda *s: torch.randn(*s, dtype=torch.bfloat16) * 0.05)(F, D)),
        }
    _B_in = _B_setup()

    return {
        "A_x": _A_in["x"],
        "A_c_kv": _A_in["c_kv"],
        "A_w_q": _A_in["w_q"],
        "A_w_uk": _A_in["w_uk"],
        "A_w_uv": _A_in["w_uv"],
        "A_w_o": _A_in["w_o"],
        "B_x": _B_in["x"],
        "B_w_r": _B_in["w_r"],
        "B_w_gate": _B_in["w_gate"],
        "B_w_up": _B_in["w_up"],
        "B_w_down": _B_in["w_down"],
    }

def reference(A_x, A_c_kv, A_w_q, A_w_uk, A_w_uv, A_w_o, B_x, B_w_r, B_w_gate, B_w_up, B_w_down):
    def _A_ref(x, c_kv, w_q, w_uk, w_uv, w_o):
        B, Sq, M = x.shape[0], x.shape[1], x.shape[2]
        Sk = c_kv.shape[1]
        H, D = w_q.shape[1], w_q.shape[2]
        q = torch.einsum("bqm,mhd->bhqd", x, w_q)
        k = torch.einsum("bkc,chd->bhkd", c_kv, w_uk)
        v = torch.einsum("bkc,chd->bhkd", c_kv, w_uv)
        scores = torch.einsum("bhqd,bhkd->bhqk", q, k) * (D ** -0.5)
        off = Sk - Sq
        qi = torch.arange(Sq)[:, None]
        kj = torch.arange(Sk)[None, :]
        cmask = kj <= (qi + off)
        scores = torch.where(cmask[None, None], scores, -1e9)
        p = _softmax(scores, axis=-1)
        ctx = torch.einsum("bhqk,bhkd->bhqd", p, v)
        return torch.einsum("bhqd,hdm->bqm", ctx, w_o)

    def _B_ref(x, w_r, w_gate, w_up, w_down):
        B, S, D = x.shape
        C = 2
        r = x @ w_r
        idx = torch.argsort(-r, axis=-1)[:, :C]
        idx_e = (lambda x, n, axis: torch.repeat_interleave(x, n, dim=axis))(idx.reshape(B, C, 1), D, axis=2)
        x_sel = (lambda x, i, axis: torch.take_along_dim(x, i, dim=axis))(x, idx_e, axis=1)
        g = _silu(x_sel @ w_gate)
        u = x_sel @ w_up
        y = (g * u) @ w_down
        r_sel = _sigmoid((lambda x, i, axis: torch.take_along_dim(x, i, dim=axis))(r, idx, axis=1))
        y = y * r_sel.reshape(B, C, 1)
        b_off = (torch.arange(B) * S).reshape(B, 1)
        flat_idx = (idx + b_off).reshape(B * C)
        zero = (x * 0.0).reshape(B * S, D)
        upd = _scatter_add(zero, flat_idx, y.reshape(B * C, D), axis=0)
        return x + upd.reshape(B, S, D)

    x = A_x
    h = x + _A_ref(_layernorm(x, axis=-1), A_c_kv, A_w_q, A_w_uk, A_w_uv, A_w_o)
    h2 = h + _B_ref(_layernorm(h, axis=-1), B_w_r, B_w_gate, B_w_up, B_w_down)
    return h2
```

```asm
; @launch kernel=k12_kernel grid=(256,1,1) block=(256,1,1) lds=163840
.amdgcn_target "amdgcn-amd-amdhsa--gfx950"
.text
.globl k12_kernel
.p2align 8
.type k12_kernel,@function
k12_kernel:
    s_cmp_ge_u32 s2, 256
    s_cbranch_scc1 Lk12_end
    s_getpc_b64 s[64:65]
Lk12_pc:
    s_sub_u32 s64, s64, Lk12_pc-k12_kernel
    s_subb_u32 s65, s65, 0
    s_mov_b32 s66, Lcode_end-k12_kernel
    s_mov_b32 s67, 0x20000
    s_lshr_b32 s45, s2, 3
    s_mul_i32 s45, s45, 3072
    v_lshlrev_b32 v10, 7, v0
    v_mov_b32 v11, 0x2000000
    v_cmp_gt_u32 vcc, 24, v0
    s_nop 1
    v_cndmask_b32 v10, v11, v10, vcc
    buffer_load_dword v21, v10, s[64:67], s45 offen
    s_load_dwordx4 s[4:7], s[0:1], 0
    s_load_dwordx4 s[8:11], s[0:1], 24
    s_load_dwordx2 s[14:15], s[0:1], 104
    s_load_dwordx2 s[56:57], s[0:1], 16
    s_load_dwordx2 s[12:13], s[0:1], 96
    v_lshrrev_b32 v1, 6, v0
    v_and_b32 v2, 63, v0
    v_readfirstlane_b32 s40, v1
    s_and_b32 s43, s2, 7
    s_lshr_b32 s44, s2, 3
    s_and_b32 s41, s44, 3
    s_lshl_b32 s43, s43, 2
    s_add_u32 s41, s41, s43
    s_lshr_b32 s42, s44, 2
    s_waitcnt lgkmcnt(0)
    s_mov_b32 s20, s6
    s_mov_b32 s21, s7
    s_mov_b32 s22, 2097152
    s_mov_b32 s23, 0x20000
    s_mov_b32 s24, s8
    s_mov_b32 s25, s9
    s_mov_b32 s26, 4194304
    s_mov_b32 s27, 0x20000
    s_mov_b32 s28, s10
    s_mov_b32 s29, s11
    s_mov_b32 s30, 4194304
    s_mov_b32 s31, 0x20000
    v_lshrrev_b32 v52, 3, v2
    v_lshlrev_b32 v36, 10, v52
    v_lshrrev_b32 v52, 4, v2
    v_and_b32 v53, 7, v2
    v_xor_b32 v52, v52, v53
    v_lshl_add_u32 v36, v52, 4, v36
    v_xor_b32 v37, 64, v36
    s_lshl_b32 s48, s42, 8
    s_lshl_b32 s53, s40, 6
    s_add_u32 s48, s48, s53
    s_lshl_b32 s48, s48, 10
    s_lshl_b32 s49, s40, 13
    v_lshrrev_b32 v52, 4, v2
    v_lshlrev_b32 v4, 13, v52
    v_lshlrev_b32 v52, 2, v52
    v_and_b32 v53, 15, v2
    v_xor_b32 v52, v52, v53
    v_lshl_add_u32 v4, v52, 4, v4
    s_lshl_b32 s88, s40, 17
    s_lshl_b32 s53, s41, 8
    s_add_u32 s88, s88, s53
    s_lshl_b32 s51, s40, 12
    s_mov_b32 s96, 0
    s_add_u32 s97, s96, 0
    s_and_b32 s97, s97, 7
    s_lshl_b32 s97, s97, 7
    s_add_u32 s97, s97, s48
    s_add_u32 m0, s49, 0
    s_add_u32 s53, s97, 0
    buffer_load_dwordx4 v36, s[20:23], s53 offen lds
    s_add_u32 m0, s49, 1024
    s_add_u32 s53, s97, 8192
    buffer_load_dwordx4 v37, s[20:23], s53 offen lds
    s_add_u32 m0, s49, 2048
    s_add_u32 s53, s97, 16384
    buffer_load_dwordx4 v36, s[20:23], s53 offen lds
    s_add_u32 m0, s49, 3072
    s_add_u32 s53, s97, 24576
    buffer_load_dwordx4 v37, s[20:23], s53 offen lds
    s_add_u32 s55, s96, 0
    s_and_b32 s55, s55, 7
    s_lshl_b32 s55, s55, 19
    s_add_u32 s55, s55, s88
    s_add_u32 m0, s51, 98304
    s_add_u32 s53, s55, 0
    buffer_load_dwordx4 v4, s[24:27], s53 offen nt lds
    s_add_u32 m0, s51, 99328
    s_add_u32 s53, s55, 32768
    buffer_load_dwordx4 v4, s[24:27], s53 offen nt lds
    s_add_u32 m0, s51, 100352
    s_add_u32 s53, s55, 65536
    buffer_load_dwordx4 v4, s[24:27], s53 offen nt lds
    s_add_u32 m0, s51, 101376
    s_add_u32 s53, s55, 98304
    buffer_load_dwordx4 v4, s[24:27], s53 offen nt lds
    s_add_u32 m0, s49, 4096
    s_add_u32 s53, s97, 32768
    buffer_load_dwordx4 v36, s[20:23], s53 offen lds
    s_add_u32 m0, s49, 5120
    s_add_u32 s53, s97, 40960
    buffer_load_dwordx4 v37, s[20:23], s53 offen lds
    s_add_u32 m0, s49, 6144
    s_add_u32 s53, s97, 49152
    buffer_load_dwordx4 v36, s[20:23], s53 offen lds
    s_add_u32 m0, s49, 7168
    s_add_u32 s53, s97, 57344
    buffer_load_dwordx4 v37, s[20:23], s53 offen lds
    s_add_u32 m0, s51, 114688
    s_add_u32 s53, s55, 0
    buffer_load_dwordx4 v4, s[28:31], s53 offen nt lds
    s_add_u32 m0, s51, 115712
    s_add_u32 s53, s55, 32768
    buffer_load_dwordx4 v4, s[28:31], s53 offen nt lds
    s_add_u32 m0, s51, 116736
    s_add_u32 s53, s55, 65536
    buffer_load_dwordx4 v4, s[28:31], s53 offen nt lds
    s_add_u32 m0, s51, 117760
    s_add_u32 s53, s55, 98304
    buffer_load_dwordx4 v4, s[28:31], s53 offen nt lds
    s_add_u32 s97, s96, 1
    s_and_b32 s97, s97, 7
    s_lshl_b32 s97, s97, 7
    s_add_u32 s97, s97, s48
    s_add_u32 m0, s49, 32768
    s_add_u32 s53, s97, 0
    buffer_load_dwordx4 v36, s[20:23], s53 offen lds
    s_add_u32 m0, s49, 33792
    s_add_u32 s53, s97, 8192
    buffer_load_dwordx4 v37, s[20:23], s53 offen lds
    s_add_u32 m0, s49, 34816
    s_add_u32 s53, s97, 16384
    buffer_load_dwordx4 v36, s[20:23], s53 offen lds
    s_add_u32 m0, s49, 35840
    s_add_u32 s53, s97, 24576
    buffer_load_dwordx4 v37, s[20:23], s53 offen lds
    s_add_u32 m0, s49, 36864
    s_add_u32 s53, s97, 32768
    buffer_load_dwordx4 v36, s[20:23], s53 offen lds
    s_add_u32 m0, s49, 37888
    s_add_u32 s53, s97, 40960
    buffer_load_dwordx4 v37, s[20:23], s53 offen lds
    s_add_u32 m0, s49, 38912
    s_add_u32 s53, s97, 49152
    buffer_load_dwordx4 v36, s[20:23], s53 offen lds
    s_add_u32 m0, s49, 39936
    s_add_u32 s53, s97, 57344
    buffer_load_dwordx4 v37, s[20:23], s53 offen lds
    s_add_u32 s55, s96, 1
    s_and_b32 s55, s55, 7
    s_lshl_b32 s55, s55, 19
    s_add_u32 s55, s55, s88
    s_add_u32 m0, s51, 131072
    s_add_u32 s53, s55, 0
    buffer_load_dwordx4 v4, s[24:27], s53 offen nt lds
    s_add_u32 m0, s51, 132096
    s_add_u32 s53, s55, 32768
    buffer_load_dwordx4 v4, s[24:27], s53 offen nt lds
    s_add_u32 m0, s51, 133120
    s_add_u32 s53, s55, 65536
    buffer_load_dwordx4 v4, s[24:27], s53 offen nt lds
    s_add_u32 m0, s51, 134144
    s_add_u32 s53, s55, 98304
    buffer_load_dwordx4 v4, s[24:27], s53 offen nt lds
    s_add_u32 m0, s51, 147456
    s_add_u32 s53, s55, 0
    buffer_load_dwordx4 v4, s[28:31], s53 offen nt lds
    s_add_u32 m0, s51, 148480
    s_add_u32 s53, s55, 32768
    buffer_load_dwordx4 v4, s[28:31], s53 offen nt lds
    s_add_u32 m0, s51, 149504
    s_add_u32 s53, s55, 65536
    buffer_load_dwordx4 v4, s[28:31], s53 offen nt lds
    s_add_u32 m0, s51, 150528
    s_add_u32 s53, s55, 98304
    buffer_load_dwordx4 v4, s[28:31], s53 offen nt lds
    s_mov_b32 s16, s4
    s_mov_b32 s17, s5
    s_mov_b32 s18, 2621440
    s_mov_b32 s19, 0x20000
    s_add_u32 s32, s14, 4194304
    s_addc_u32 s33, s15, 0
    s_mov_b32 s34, 33554432
    s_mov_b32 s35, 0x20000
    s_mov_b32 s36, s14
    s_mov_b32 s37, s15
    s_mov_b32 s38, 2621440
    s_mov_b32 s39, 0x20000
    s_mov_b32 s84, s12
    s_mov_b32 s85, s13
    s_mov_b32 s86, 256
    s_mov_b32 s87, 0x20000
    v_bfe_u32 v52, v2, 4, 1
    s_lshl_b32 s45, s2, 3
    s_lshl_b32 s46, s40, 1
    s_add_u32 s45, s45, s46
    v_add_u32 v52, s45, v52
    v_and_b32 v53, 15, v2
    v_mul_u32_u24 v45, 1280, v52
    v_lshl_add_u32 v45, v53, 4, v45
    v_lshrrev_b32 v46, 5, v52
    v_mul_u32_u24 v46, 40960, v46
    v_and_b32 v52, 31, v52
    v_lshl_add_u32 v46, v52, 4, v46
    v_lshrrev_b32 v52, 1, v53
    v_lshl_add_u32 v46, v52, 10, v46
    v_and_b32 v52, 1, v53
    v_lshl_add_u32 v46, v52, 9, v46
    v_mov_b32 v52, 0x1000000
    v_cmp_gt_u32 vcc, 32, v2
    s_nop 1
    v_cndmask_b32 v46, v52, v46, vcc
    v_mov_b32 v55, 0
    v_mov_b32 v57, 1
    v_mov_b32 v53, 0x100000
    v_cmp_eq_u32 vcc, 0, v0
    s_nop 1
    v_cndmask_b32 v56, v53, v55, vcc
    s_memrealtime s[46:47]
    s_waitcnt lgkmcnt(0)
    s_or_b32 s47, s46, 1
    v_mov_b32 v54, s47
    buffer_atomic_cmpswap v[54:55], v56, s[84:87], 0 offen sc0 sc1
    v_lshrrev_b32 v53, 5, v2
    v_bfe_u32 v52, v2, 1, 3
    v_xor_b32 v52, v52, v53
    v_lshlrev_b32 v52, 4, v52
    v_and_b32 v48, 31, v2
    v_lshl_add_u32 v48, v48, 7, v52
    v_xor_b32 v49, 32, v48
    v_add_u32 v49, s49, v49
    v_xor_b32 v50, 64, v48
    v_add_u32 v50, s49, v50
    v_xor_b32 v51, 96, v48
    v_add_u32 v51, s49, v51
    v_add_u32 v48, s49, v48
    v_add_u32 v40, 0x10000, v48
    v_add_u32 v41, 0x10000, v49
    v_add_u32 v42, 0x10000, v50
    v_add_u32 v43, 0x10000, v51
    v_lshrrev_b32 v53, 5, v2
    v_bfe_u32 v52, v2, 2, 2
    v_lshl_add_u32 v53, v53, 3, v52
    v_lshlrev_b32 v53, 8, v53
    v_bfe_u32 v62, v2, 4, 1
    v_lshl_add_u32 v53, v62, 5, v53
    v_and_b32 v62, 3, v2
    v_lshl_add_u32 v53, v62, 3, v53
    v_xor_b32 v62, 0, v52
    v_lshl_add_u32 v6, v62, 6, v53
    v_add_u32 v32, 0x10000, v6
    v_add_u32 v58, 0x20000, v6
    v_xor_b32 v62, 1, v52
    v_lshl_add_u32 v7, v62, 6, v53
    v_add_u32 v33, 0x10000, v7
    v_add_u32 v59, 0x20000, v7
    v_xor_b32 v62, 2, v52
    v_lshl_add_u32 v8, v62, 6, v53
    v_add_u32 v34, 0x10000, v8
    v_add_u32 v60, 0x20000, v8
    v_xor_b32 v62, 3, v52
    v_lshl_add_u32 v9, v62, 6, v53
    v_add_u32 v35, 0x10000, v9
    v_add_u32 v61, 0x20000, v9
    v_lshlrev_b32 v3, 4, v2
    v_mov_b32 v5, 0xff800000
    s_lshl_b32 s52, s41, 6
    s_lshl_b32 s53, s42, 3
    s_add_u32 s52, s52, s53
    s_lshl_b32 s53, s40, 1
    s_add_u32 s52, s52, s53
    s_lshl_b32 s52, s52, 14
    s_mov_b32 s54, 0x3727c5ac
    s_waitcnt vmcnt(17)
    s_barrier
    ds_read_b128 v[128:131], v48 offset:0
    ds_read_b128 v[132:135], v48 offset:4096
    ds_read_b64_tr_b16 v[64:65], v32 offset:32768
    ds_read_b64_tr_b16 v[66:67], v32 offset:33792
    ds_read_b64_tr_b16 v[80:81], v32 offset:49152
    ds_read_b64_tr_b16 v[82:83], v32 offset:50176
    ds_read_b64_tr_b16 v[68:69], v33 offset:32768
    ds_read_b64_tr_b16 v[70:71], v33 offset:33792
    ds_read_b64_tr_b16 v[84:85], v33 offset:49152
    ds_read_b64_tr_b16 v[86:87], v33 offset:50176
    ds_read_b64_tr_b16 v[72:73], v34 offset:32768
    ds_read_b64_tr_b16 v[74:75], v34 offset:33792
    ds_read_b64_tr_b16 v[88:89], v34 offset:49152
    ds_read_b64_tr_b16 v[90:91], v34 offset:50176
    ds_read_b64_tr_b16 v[76:77], v35 offset:32768
    ds_read_b64_tr_b16 v[78:79], v35 offset:33792
    ds_read_b64_tr_b16 v[92:93], v35 offset:49152
    ds_read_b64_tr_b16 v[94:95], v35 offset:50176
    s_waitcnt lgkmcnt(14)
    v_mfma_f32_32x32x16_bf16 a[0:15], v[64:67], v[128:131], 0
    ds_read_b128 v[136:139], v49 offset:0
    ds_read_b128 v[140:143], v49 offset:4096
    s_add_u32 s97, s96, 2
    s_and_b32 s97, s97, 7
    s_lshl_b32 s97, s97, 7
    s_add_u32 s97, s97, s48
    s_add_u32 m0, s49, 65536
    s_add_u32 s53, s97, 0
    buffer_load_dwordx4 v36, s[20:23], s53 offen lds
    v_mfma_f32_32x32x16_bf16 a[16:31], v[64:67], v[132:135], 0
    ds_read_b64_tr_b16 v[96:97], v32 offset:36864
    ds_read_b64_tr_b16 v[98:99], v32 offset:37888
    s_add_u32 m0, s49, 66560
    s_add_u32 s53, s97, 8192
    buffer_load_dwordx4 v37, s[20:23], s53 offen lds
    s_waitcnt lgkmcnt(15)
    v_mfma_f32_32x32x16_bf16 a[128:143], v[128:131], v[80:83], 0
    ds_read_b64_tr_b16 v[112:113], v32 offset:53248
    ds_read_b64_tr_b16 v[114:115], v32 offset:54272
    s_add_u32 m0, s49, 67584
    s_add_u32 s53, s97, 16384
    buffer_load_dwordx4 v36, s[20:23], s53 offen lds
    v_mfma_f32_32x32x16_bf16 a[144:159], v[132:135], v[80:83], 0
    ds_read_b64_tr_b16 v[100:101], v33 offset:36864
    ds_read_b64_tr_b16 v[102:103], v33 offset:37888
    s_add_u32 m0, s49, 68608
    s_add_u32 s53, s97, 24576
    buffer_load_dwordx4 v37, s[20:23], s53 offen lds
    s_waitcnt lgkmcnt(8)
    v_mfma_f32_32x32x16_bf16 a[32:47], v[68:71], v[128:131], 0
    ds_read_b64_tr_b16 v[116:117], v33 offset:53248
    ds_read_b64_tr_b16 v[118:119], v33 offset:54272
    s_add_u32 m0, s49, 69632
    s_add_u32 s53, s97, 32768
    buffer_load_dwordx4 v36, s[20:23], s53 offen lds
    v_mfma_f32_32x32x16_bf16 a[48:63], v[68:71], v[132:135], 0
    ds_read_b64_tr_b16 v[104:105], v34 offset:36864
    ds_read_b64_tr_b16 v[106:107], v34 offset:37888
    s_add_u32 m0, s49, 70656
    s_add_u32 s53, s97, 40960
    buffer_load_dwordx4 v37, s[20:23], s53 offen lds
    v_mfma_f32_32x32x16_bf16 a[160:175], v[128:131], v[84:87], 0
    ds_read_b64_tr_b16 v[120:121], v34 offset:53248
    ds_read_b64_tr_b16 v[122:123], v34 offset:54272
    s_add_u32 m0, s49, 71680
    s_add_u32 s53, s97, 49152
    buffer_load_dwordx4 v36, s[20:23], s53 offen lds
    v_mfma_f32_32x32x16_bf16 a[176:191], v[132:135], v[84:87], 0
    ds_read_b64_tr_b16 v[108:109], v35 offset:36864
    ds_read_b64_tr_b16 v[110:111], v35 offset:37888
    s_add_u32 m0, s49, 72704
    s_add_u32 s53, s97, 57344
    buffer_load_dwordx4 v37, s[20:23], s53 offen lds
    v_mfma_f32_32x32x16_bf16 a[64:79], v[72:75], v[128:131], 0
    ds_read_b64_tr_b16 v[124:125], v35 offset:53248
    ds_read_b64_tr_b16 v[126:127], v35 offset:54272
    buffer_load_dwordx4 v[192:195], v45, s[16:19], 0 offen offset:0
    v_mfma_f32_32x32x16_bf16 a[80:95], v[72:75], v[132:135], 0
    buffer_load_dwordx4 v[196:199], v45, s[16:19], 0 offen offset:256
    v_mfma_f32_32x32x16_bf16 a[192:207], v[128:131], v[88:91], 0
    buffer_load_dwordx4 v[200:203], v45, s[16:19], 0 offen offset:512
    v_mfma_f32_32x32x16_bf16 a[208:223], v[132:135], v[88:91], 0
    buffer_load_dwordx4 v[204:207], v45, s[16:19], 0 offen offset:768
    v_mfma_f32_32x32x16_bf16 a[96:111], v[76:79], v[128:131], 0
    buffer_load_dwordx4 v[208:211], v45, s[16:19], 0 offen offset:1024
    v_mfma_f32_32x32x16_bf16 a[112:127], v[76:79], v[132:135], 0
    v_mfma_f32_32x32x16_bf16 a[224:239], v[128:131], v[92:95], 0
    v_mfma_f32_32x32x16_bf16 a[240:255], v[132:135], v[92:95], 0
    s_waitcnt lgkmcnt(0)
    v_mfma_f32_32x32x16_bf16 a[0:15], v[96:99], v[136:139], a[0:15]
    ds_read_b128 v[128:131], v50 offset:0
    ds_read_b128 v[132:135], v50 offset:4096
    v_mfma_f32_32x32x16_bf16 a[16:31], v[96:99], v[140:143], a[16:31]
    ds_read_b64_tr_b16 v[64:65], v32 offset:40960
    ds_read_b64_tr_b16 v[66:67], v32 offset:41984
    v_mfma_f32_32x32x16_bf16 a[128:143], v[136:139], v[112:115], a[128:143]
    ds_read_b64_tr_b16 v[80:81], v32 offset:57344
    ds_read_b64_tr_b16 v[82:83], v32 offset:58368
    v_mfma_f32_32x32x16_bf16 a[144:159], v[140:143], v[112:115], a[144:159]
    ds_read_b64_tr_b16 v[68:69], v33 offset:40960
    ds_read_b64_tr_b16 v[70:71], v33 offset:41984
    v_mfma_f32_32x32x16_bf16 a[32:47], v[100:103], v[136:139], a[32:47]
    ds_read_b64_tr_b16 v[84:85], v33 offset:57344
    ds_read_b64_tr_b16 v[86:87], v33 offset:58368
    v_mfma_f32_32x32x16_bf16 a[48:63], v[100:103], v[140:143], a[48:63]
    ds_read_b64_tr_b16 v[72:73], v34 offset:40960
    ds_read_b64_tr_b16 v[74:75], v34 offset:41984
    v_mfma_f32_32x32x16_bf16 a[160:175], v[136:139], v[116:119], a[160:175]
    ds_read_b64_tr_b16 v[88:89], v34 offset:57344
    ds_read_b64_tr_b16 v[90:91], v34 offset:58368
    v_mfma_f32_32x32x16_bf16 a[176:191], v[140:143], v[116:119], a[176:191]
    ds_read_b64_tr_b16 v[76:77], v35 offset:40960
    ds_read_b64_tr_b16 v[78:79], v35 offset:41984
    v_mfma_f32_32x32x16_bf16 a[64:79], v[104:107], v[136:139], a[64:79]
    ds_read_b64_tr_b16 v[92:93], v35 offset:57344
    ds_read_b64_tr_b16 v[94:95], v35 offset:58368
    v_mfma_f32_32x32x16_bf16 a[80:95], v[104:107], v[140:143], a[80:95]
    v_mfma_f32_32x32x16_bf16 a[192:207], v[136:139], v[120:123], a[192:207]
    v_mfma_f32_32x32x16_bf16 a[208:223], v[140:143], v[120:123], a[208:223]
    v_mfma_f32_32x32x16_bf16 a[96:111], v[108:111], v[136:139], a[96:111]
    v_mfma_f32_32x32x16_bf16 a[112:127], v[108:111], v[140:143], a[112:127]
    v_mfma_f32_32x32x16_bf16 a[224:239], v[136:139], v[124:127], a[224:239]
    v_mfma_f32_32x32x16_bf16 a[240:255], v[140:143], v[124:127], a[240:255]
    s_waitcnt lgkmcnt(0)
    v_mfma_f32_32x32x16_bf16 a[0:15], v[64:67], v[128:131], a[0:15]
    ds_read_b128 v[136:139], v51 offset:0
    ds_read_b128 v[140:143], v51 offset:4096
    v_mfma_f32_32x32x16_bf16 a[16:31], v[64:67], v[132:135], a[16:31]
    ds_read_b64_tr_b16 v[96:97], v32 offset:45056
    ds_read_b64_tr_b16 v[98:99], v32 offset:46080
    v_mfma_f32_32x32x16_bf16 a[128:143], v[128:131], v[80:83], a[128:143]
    ds_read_b64_tr_b16 v[112:113], v32 offset:61440
    ds_read_b64_tr_b16 v[114:115], v32 offset:62464
    v_mfma_f32_32x32x16_bf16 a[144:159], v[132:135], v[80:83], a[144:159]
    ds_read_b64_tr_b16 v[100:101], v33 offset:45056
    ds_read_b64_tr_b16 v[102:103], v33 offset:46080
    v_mfma_f32_32x32x16_bf16 a[32:47], v[68:71], v[128:131], a[32:47]
    ds_read_b64_tr_b16 v[116:117], v33 offset:61440
    ds_read_b64_tr_b16 v[118:119], v33 offset:62464
    v_mfma_f32_32x32x16_bf16 a[48:63], v[68:71], v[132:135], a[48:63]
    ds_read_b64_tr_b16 v[104:105], v34 offset:45056
    ds_read_b64_tr_b16 v[106:107], v34 offset:46080
    v_mfma_f32_32x32x16_bf16 a[160:175], v[128:131], v[84:87], a[160:175]
    ds_read_b64_tr_b16 v[120:121], v34 offset:61440
    ds_read_b64_tr_b16 v[122:123], v34 offset:62464
    v_mfma_f32_32x32x16_bf16 a[176:191], v[132:135], v[84:87], a[176:191]
    ds_read_b64_tr_b16 v[108:109], v35 offset:45056
    ds_read_b64_tr_b16 v[110:111], v35 offset:46080
    v_mfma_f32_32x32x16_bf16 a[64:79], v[72:75], v[128:131], a[64:79]
    ds_read_b64_tr_b16 v[124:125], v35 offset:61440
    ds_read_b64_tr_b16 v[126:127], v35 offset:62464
    v_mfma_f32_32x32x16_bf16 a[80:95], v[72:75], v[132:135], a[80:95]
    v_mfma_f32_32x32x16_bf16 a[192:207], v[128:131], v[88:91], a[192:207]
    v_mfma_f32_32x32x16_bf16 a[208:223], v[132:135], v[88:91], a[208:223]
    v_mfma_f32_32x32x16_bf16 a[96:111], v[76:79], v[128:131], a[96:111]
    v_mfma_f32_32x32x16_bf16 a[112:127], v[76:79], v[132:135], a[112:127]
    v_mfma_f32_32x32x16_bf16 a[224:239], v[128:131], v[92:95], a[224:239]
    v_mfma_f32_32x32x16_bf16 a[240:255], v[132:135], v[92:95], a[240:255]
    s_waitcnt lgkmcnt(0)
    s_waitcnt vmcnt(14)
    s_barrier
    v_mfma_f32_32x32x16_bf16 a[0:15], v[96:99], v[136:139], a[0:15]
    ds_read_b128 v[128:131], v48 offset:32768
    ds_read_b128 v[132:135], v48 offset:36864
    s_add_u32 s55, s96, 2
    s_and_b32 s55, s55, 7
    s_lshl_b32 s55, s55, 19
    s_add_u32 s55, s55, s88
    s_add_u32 m0, s51, 98304
    s_add_u32 s53, s55, 0
    buffer_load_dwordx4 v4, s[24:27], s53 offen nt lds
    v_mfma_f32_32x32x16_bf16 a[16:31], v[96:99], v[140:143], a[16:31]
    ds_read_b64_tr_b16 v[64:65], v58 offset:0
    ds_read_b64_tr_b16 v[66:67], v58 offset:1024
    s_add_u32 m0, s51, 99328
    s_add_u32 s53, s55, 32768
    buffer_load_dwordx4 v4, s[24:27], s53 offen nt lds
    v_mfma_f32_32x32x16_bf16 a[128:143], v[136:139], v[112:115], a[128:143]
    ds_read_b64_tr_b16 v[80:81], v58 offset:16384
    ds_read_b64_tr_b16 v[82:83], v58 offset:17408
    s_add_u32 m0, s51, 100352
    s_add_u32 s53, s55, 65536
    buffer_load_dwordx4 v4, s[24:27], s53 offen nt lds
    v_mfma_f32_32x32x16_bf16 a[144:159], v[140:143], v[112:115], a[144:159]
    ds_read_b64_tr_b16 v[68:69], v59 offset:0
    ds_read_b64_tr_b16 v[70:71], v59 offset:1024
    s_add_u32 m0, s51, 101376
    s_add_u32 s53, s55, 98304
    buffer_load_dwordx4 v4, s[24:27], s53 offen nt lds
    v_mfma_f32_32x32x16_bf16 a[32:47], v[100:103], v[136:139], a[32:47]
    ds_read_b64_tr_b16 v[84:85], v59 offset:16384
    ds_read_b64_tr_b16 v[86:87], v59 offset:17408
    s_add_u32 m0, s51, 114688
    s_add_u32 s53, s55, 0
    buffer_load_dwordx4 v4, s[28:31], s53 offen nt lds
    v_mfma_f32_32x32x16_bf16 a[48:63], v[100:103], v[140:143], a[48:63]
    ds_read_b64_tr_b16 v[72:73], v60 offset:0
    ds_read_b64_tr_b16 v[74:75], v60 offset:1024
    s_add_u32 m0, s51, 115712
    s_add_u32 s53, s55, 32768
    buffer_load_dwordx4 v4, s[28:31], s53 offen nt lds
    v_mfma_f32_32x32x16_bf16 a[160:175], v[136:139], v[116:119], a[160:175]
    ds_read_b64_tr_b16 v[88:89], v60 offset:16384
    ds_read_b64_tr_b16 v[90:91], v60 offset:17408
    s_add_u32 m0, s51, 116736
    s_add_u32 s53, s55, 65536
    buffer_load_dwordx4 v4, s[28:31], s53 offen nt lds
    v_mfma_f32_32x32x16_bf16 a[176:191], v[140:143], v[116:119], a[176:191]
    ds_read_b64_tr_b16 v[76:77], v61 offset:0
    ds_read_b64_tr_b16 v[78:79], v61 offset:1024
    s_add_u32 m0, s51, 117760
    s_add_u32 s53, s55, 98304
    buffer_load_dwordx4 v4, s[28:31], s53 offen nt lds
    v_mfma_f32_32x32x16_bf16 a[64:79], v[104:107], v[136:139], a[64:79]
    ds_read_b64_tr_b16 v[92:93], v61 offset:16384
    ds_read_b64_tr_b16 v[94:95], v61 offset:17408
    s_add_u32 s97, s96, 3
    s_and_b32 s97, s97, 7
    s_lshl_b32 s97, s97, 7
    s_add_u32 s97, s97, s48
    s_add_u32 m0, s49, 0
    s_add_u32 s53, s97, 0
    buffer_load_dwordx4 v36, s[20:23], s53 offen lds
    v_mfma_f32_32x32x16_bf16 a[80:95], v[104:107], v[140:143], a[80:95]
    s_add_u32 m0, s49, 1024
    s_add_u32 s53, s97, 8192
    buffer_load_dwordx4 v37, s[20:23], s53 offen lds
    v_mfma_f32_32x32x16_bf16 a[192:207], v[136:139], v[120:123], a[192:207]
    s_add_u32 m0, s49, 2048
    s_add_u32 s53, s97, 16384
    buffer_load_dwordx4 v36, s[20:23], s53 offen lds
    v_mfma_f32_32x32x16_bf16 a[208:223], v[140:143], v[120:123], a[208:223]
    s_add_u32 m0, s49, 3072
    s_add_u32 s53, s97, 24576
    buffer_load_dwordx4 v37, s[20:23], s53 offen lds
    v_mfma_f32_32x32x16_bf16 a[96:111], v[108:111], v[136:139], a[96:111]
    s_add_u32 m0, s49, 4096
    s_add_u32 s53, s97, 32768
    buffer_load_dwordx4 v36, s[20:23], s53 offen lds
    v_mfma_f32_32x32x16_bf16 a[112:127], v[108:111], v[140:143], a[112:127]
    s_add_u32 m0, s49, 5120
    s_add_u32 s53, s97, 40960
    buffer_load_dwordx4 v37, s[20:23], s53 offen lds
    v_mfma_f32_32x32x16_bf16 a[224:239], v[136:139], v[124:127], a[224:239]
    s_add_u32 m0, s49, 6144
    s_add_u32 s53, s97, 49152
    buffer_load_dwordx4 v36, s[20:23], s53 offen lds
    v_mfma_f32_32x32x16_bf16 a[240:255], v[140:143], v[124:127], a[240:255]
    s_add_u32 m0, s49, 7168
    s_add_u32 s53, s97, 57344
    buffer_load_dwordx4 v37, s[20:23], s53 offen lds
    s_waitcnt lgkmcnt(0)
    v_mfma_f32_32x32x16_bf16 a[0:15], v[64:67], v[128:131], a[0:15]
    ds_read_b128 v[136:139], v49 offset:32768
    ds_read_b128 v[140:143], v49 offset:36864
    v_mfma_f32_32x32x16_bf16 a[16:31], v[64:67], v[132:135], a[16:31]
    ds_read_b64_tr_b16 v[96:97], v58 offset:4096
    ds_read_b64_tr_b16 v[98:99], v58 offset:5120
    v_mfma_f32_32x32x16_bf16 a[128:143], v[128:131], v[80:83], a[128:143]
    ds_read_b64_tr_b16 v[112:113], v58 offset:20480
    ds_read_b64_tr_b16 v[114:115], v58 offset:21504
    v_mfma_f32_32x32x16_bf16 a[144:159], v[132:135], v[80:83], a[144:159]
    ds_read_b64_tr_b16 v[100:101], v59 offset:4096
    ds_read_b64_tr_b16 v[102:103], v59 offset:5120
    v_mfma_f32_32x32x16_bf16 a[32:47], v[68:71], v[128:131], a[32:47]
    ds_read_b64_tr_b16 v[116:117], v59 offset:20480
    ds_read_b64_tr_b16 v[118:119], v59 offset:21504
    v_mfma_f32_32x32x16_bf16 a[48:63], v[68:71], v[132:135], a[48:63]
    ds_read_b64_tr_b16 v[104:105], v60 offset:4096
    ds_read_b64_tr_b16 v[106:107], v60 offset:5120
    v_mfma_f32_32x32x16_bf16 a[160:175], v[128:131], v[84:87], a[160:175]
    ds_read_b64_tr_b16 v[120:121], v60 offset:20480
    ds_read_b64_tr_b16 v[122:123], v60 offset:21504
    v_mfma_f32_32x32x16_bf16 a[176:191], v[132:135], v[84:87], a[176:191]
    ds_read_b64_tr_b16 v[108:109], v61 offset:4096
    ds_read_b64_tr_b16 v[110:111], v61 offset:5120
    v_mfma_f32_32x32x16_bf16 a[64:79], v[72:75], v[128:131], a[64:79]
    ds_read_b64_tr_b16 v[124:125], v61 offset:20480
    ds_read_b64_tr_b16 v[126:127], v61 offset:21504
    v_mfma_f32_32x32x16_bf16 a[80:95], v[72:75], v[132:135], a[80:95]
    v_mfma_f32_32x32x16_bf16 a[192:207], v[128:131], v[88:91], a[192:207]
    v_mfma_f32_32x32x16_bf16 a[208:223], v[132:135], v[88:91], a[208:223]
    v_mfma_f32_32x32x16_bf16 a[96:111], v[76:79], v[128:131], a[96:111]
    v_mfma_f32_32x32x16_bf16 a[112:127], v[76:79], v[132:135], a[112:127]
    v_mfma_f32_32x32x16_bf16 a[224:239], v[128:131], v[92:95], a[224:239]
    v_mfma_f32_32x32x16_bf16 a[240:255], v[132:135], v[92:95], a[240:255]
    s_waitcnt lgkmcnt(0)
    v_mfma_f32_32x32x16_bf16 a[0:15], v[96:99], v[136:139], a[0:15]
    ds_read_b128 v[128:131], v50 offset:32768
    ds_read_b128 v[132:135], v50 offset:36864
    s_waitcnt vmcnt(16)
    v_lshlrev_b32 v212, 16, v192
    v_and_b32 v213, 0xffff0000, v192
    v_lshlrev_b32 v214, 16, v193
    v_mfma_f32_32x32x16_bf16 a[16:31], v[96:99], v[140:143], a[16:31]
    ds_read_b64_tr_b16 v[64:65], v58 offset:8192
    ds_read_b64_tr_b16 v[66:67], v58 offset:9216
    v_and_b32 v215, 0xffff0000, v193
    v_lshlrev_b32 v216, 16, v194
    v_and_b32 v217, 0xffff0000, v194
    v_mfma_f32_32x32x16_bf16 a[128:143], v[136:139], v[112:115], a[128:143]
    ds_read_b64_tr_b16 v[80:81], v58 offset:24576
    ds_read_b64_tr_b16 v[82:83], v58 offset:25600
    v_lshlrev_b32 v218, 16, v195
    v_and_b32 v219, 0xffff0000, v195
    v_lshlrev_b32 v220, 16, v196
    v_mfma_f32_32x32x16_bf16 a[144:159], v[140:143], v[112:115], a[144:159]
    ds_read_b64_tr_b16 v[68:69], v59 offset:8192
    ds_read_b64_tr_b16 v[70:71], v59 offset:9216
    v_and_b32 v221, 0xffff0000, v196
    v_lshlrev_b32 v222, 16, v197
    v_and_b32 v223, 0xffff0000, v197
    v_mfma_f32_32x32x16_bf16 a[32:47], v[100:103], v[136:139], a[32:47]
    ds_read_b64_tr_b16 v[84:85], v59 offset:24576
    ds_read_b64_tr_b16 v[86:87], v59 offset:25600
    v_lshlrev_b32 v224, 16, v198
    v_and_b32 v225, 0xffff0000, v198
    v_lshlrev_b32 v226, 16, v199
    v_mfma_f32_32x32x16_bf16 a[48:63], v[100:103], v[140:143], a[48:63]
    ds_read_b64_tr_b16 v[72:73], v60 offset:8192
    ds_read_b64_tr_b16 v[74:75], v60 offset:9216
    v_and_b32 v227, 0xffff0000, v199
    v_lshlrev_b32 v228, 16, v200
    v_and_b32 v229, 0xffff0000, v200
    v_mfma_f32_32x32x16_bf16 a[160:175], v[136:139], v[116:119], a[160:175]
    ds_read_b64_tr_b16 v[88:89], v60 offset:24576
    ds_read_b64_tr_b16 v[90:91], v60 offset:25600
    v_lshlrev_b32 v230, 16, v201
    v_and_b32 v231, 0xffff0000, v201
    v_lshlrev_b32 v232, 16, v202
    v_mfma_f32_32x32x16_bf16 a[176:191], v[140:143], v[116:119], a[176:191]
    ds_read_b64_tr_b16 v[76:77], v61 offset:8192
    ds_read_b64_tr_b16 v[78:79], v61 offset:9216
    v_and_b32 v233, 0xffff0000, v202
    v_lshlrev_b32 v234, 16, v203
    v_and_b32 v235, 0xffff0000, v203
    v_mfma_f32_32x32x16_bf16 a[64:79], v[104:107], v[136:139], a[64:79]
    ds_read_b64_tr_b16 v[92:93], v61 offset:24576
    ds_read_b64_tr_b16 v[94:95], v61 offset:25600
    v_lshlrev_b32 v236, 16, v204
    v_and_b32 v237, 0xffff0000, v204
    v_lshlrev_b32 v238, 16, v205
    v_mfma_f32_32x32x16_bf16 a[80:95], v[104:107], v[140:143], a[80:95]
    v_and_b32 v239, 0xffff0000, v205
    v_lshlrev_b32 v240, 16, v206
    v_and_b32 v241, 0xffff0000, v206
    v_mfma_f32_32x32x16_bf16 a[192:207], v[136:139], v[120:123], a[192:207]
    v_lshlrev_b32 v242, 16, v207
    v_and_b32 v243, 0xffff0000, v207
    v_lshlrev_b32 v244, 16, v208
    v_and_b32 v245, 0xffff0000, v208
    v_mfma_f32_32x32x16_bf16 a[208:223], v[140:143], v[120:123], a[208:223]
    v_lshlrev_b32 v246, 16, v209
    v_and_b32 v247, 0xffff0000, v209
    v_lshlrev_b32 v248, 16, v210
    v_and_b32 v249, 0xffff0000, v210
    v_mfma_f32_32x32x16_bf16 a[96:111], v[108:111], v[136:139], a[96:111]
    v_lshlrev_b32 v250, 16, v211
    v_and_b32 v251, 0xffff0000, v211
    v_add_f32 v24, v212, v216
    v_add_f32 v25, v213, v217
    v_mfma_f32_32x32x16_bf16 a[112:127], v[108:111], v[140:143], a[112:127]
    v_add_f32 v26, v214, v218
    v_add_f32 v27, v215, v219
    v_add_f32 v24, v24, v220
    v_add_f32 v25, v25, v221
    v_mfma_f32_32x32x16_bf16 a[224:239], v[136:139], v[124:127], a[224:239]
    v_add_f32 v26, v26, v222
    v_add_f32 v27, v27, v223
    v_add_f32 v24, v24, v224
    v_add_f32 v25, v25, v225
    v_mfma_f32_32x32x16_bf16 a[240:255], v[140:143], v[124:127], a[240:255]
    v_add_f32 v26, v26, v226
    v_add_f32 v27, v27, v227
    v_add_f32 v24, v24, v228
    v_add_f32 v25, v25, v229
    s_waitcnt lgkmcnt(0)
    v_mfma_f32_32x32x16_bf16 a[0:15], v[64:67], v[128:131], a[0:15]
    ds_read_b128 v[136:139], v51 offset:32768
    ds_read_b128 v[140:143], v51 offset:36864
    v_add_f32 v26, v26, v230
    v_add_f32 v27, v27, v231
    v_add_f32 v24, v24, v232
    v_mfma_f32_32x32x16_bf16 a[16:31], v[64:67], v[132:135], a[16:31]
    ds_read_b64_tr_b16 v[96:97], v58 offset:12288
    ds_read_b64_tr_b16 v[98:99], v58 offset:13312
    v_add_f32 v25, v25, v233
    v_add_f32 v26, v26, v234
    v_add_f32 v27, v27, v235
    v_mfma_f32_32x32x16_bf16 a[128:143], v[128:131], v[80:83], a[128:143]
    ds_read_b64_tr_b16 v[112:113], v58 offset:28672
    ds_read_b64_tr_b16 v[114:115], v58 offset:29696
    v_add_f32 v24, v24, v236
    v_add_f32 v25, v25, v237
    v_add_f32 v26, v26, v238
    v_mfma_f32_32x32x16_bf16 a[144:159], v[132:135], v[80:83], a[144:159]
    ds_read_b64_tr_b16 v[100:101], v59 offset:12288
    ds_read_b64_tr_b16 v[102:103], v59 offset:13312
    v_add_f32 v27, v27, v239
    v_add_f32 v24, v24, v240
    v_add_f32 v25, v25, v241
    v_mfma_f32_32x32x16_bf16 a[32:47], v[68:71], v[128:131], a[32:47]
    ds_read_b64_tr_b16 v[116:117], v59 offset:28672
    ds_read_b64_tr_b16 v[118:119], v59 offset:29696
    v_add_f32 v26, v26, v242
    v_add_f32 v27, v27, v243
    v_add_f32 v24, v24, v244
    v_mfma_f32_32x32x16_bf16 a[48:63], v[68:71], v[132:135], a[48:63]
    ds_read_b64_tr_b16 v[104:105], v60 offset:12288
    ds_read_b64_tr_b16 v[106:107], v60 offset:13312
    v_add_f32 v25, v25, v245
    v_add_f32 v26, v26, v246
    v_add_f32 v27, v27, v247
    v_mfma_f32_32x32x16_bf16 a[160:175], v[128:131], v[84:87], a[160:175]
    ds_read_b64_tr_b16 v[120:121], v60 offset:28672
    ds_read_b64_tr_b16 v[122:123], v60 offset:29696
    v_add_f32 v24, v24, v248
    v_add_f32 v25, v25, v249
    v_add_f32 v26, v26, v250
    v_mfma_f32_32x32x16_bf16 a[176:191], v[132:135], v[84:87], a[176:191]
    ds_read_b64_tr_b16 v[108:109], v61 offset:12288
    ds_read_b64_tr_b16 v[110:111], v61 offset:13312
    v_add_f32 v27, v27, v251
    v_add_f32 v24, v24, v25
    v_add_f32 v26, v26, v27
    v_mfma_f32_32x32x16_bf16 a[64:79], v[72:75], v[128:131], a[64:79]
    ds_read_b64_tr_b16 v[124:125], v61 offset:28672
    ds_read_b64_tr_b16 v[126:127], v61 offset:29696
    v_add_f32 v24, v24, v26
    s_nop 1
    v_add_f32 v24, v24, v24 row_ror:8
    s_nop 1
    v_add_f32 v24, v24, v24 row_ror:4
    v_mfma_f32_32x32x16_bf16 a[80:95], v[72:75], v[132:135], a[80:95]
    s_nop 0
    v_add_f32 v24, v24, v24 row_ror:2
    s_nop 1
    v_add_f32 v24, v24, v24 row_ror:1
    v_mul_f32 v28, 0x3acccccd, v24
    v_mfma_f32_32x32x16_bf16 a[192:207], v[128:131], v[88:91], a[192:207]
    v_sub_f32 v29, v212, v28
    v_mul_f32 v24, v29, v29
    v_sub_f32 v29, v213, v28
    v_mul_f32 v25, v29, v29
    v_mfma_f32_32x32x16_bf16 a[208:223], v[132:135], v[88:91], a[208:223]
    v_sub_f32 v29, v214, v28
    v_mul_f32 v26, v29, v29
    v_sub_f32 v29, v215, v28
    v_mul_f32 v27, v29, v29
    v_mfma_f32_32x32x16_bf16 a[96:111], v[76:79], v[128:131], a[96:111]
    v_sub_f32 v29, v216, v28
    v_fmac_f32 v24, v29, v29
    v_sub_f32 v30, v217, v28
    v_fmac_f32 v25, v30, v30
    v_mfma_f32_32x32x16_bf16 a[112:127], v[76:79], v[132:135], a[112:127]
    v_sub_f32 v29, v218, v28
    v_fmac_f32 v26, v29, v29
    v_sub_f32 v30, v219, v28
    v_fmac_f32 v27, v30, v30
    v_mfma_f32_32x32x16_bf16 a[224:239], v[128:131], v[92:95], a[224:239]
    v_sub_f32 v29, v220, v28
    v_fmac_f32 v24, v29, v29
    v_sub_f32 v30, v221, v28
    v_fmac_f32 v25, v30, v30
    v_mfma_f32_32x32x16_bf16 a[240:255], v[132:135], v[92:95], a[240:255]
    v_sub_f32 v29, v222, v28
    v_fmac_f32 v26, v29, v29
    v_sub_f32 v30, v223, v28
    v_fmac_f32 v27, v30, v30
    s_waitcnt lgkmcnt(0)
    s_waitcnt vmcnt(8)
    s_barrier
    v_mfma_f32_32x32x16_bf16 a[0:15], v[96:99], v[136:139], a[0:15]
    ds_read_b128 v[128:131], v40 offset:0
    ds_read_b128 v[132:135], v40 offset:4096
    s_add_u32 s55, s96, 3
    s_and_b32 s55, s55, 7
    s_lshl_b32 s55, s55, 19
    s_add_u32 s55, s55, s88
    s_add_u32 m0, s51, 131072
    s_add_u32 s53, s55, 0
    buffer_load_dwordx4 v4, s[24:27], s53 offen nt lds
    v_sub_f32 v29, v224, v28
    v_fmac_f32 v24, v29, v29
    v_sub_f32 v30, v225, v28
    v_mfma_f32_32x32x16_bf16 a[16:31], v[96:99], v[140:143], a[16:31]
    ds_read_b64_tr_b16 v[64:65], v32 offset:32768
    ds_read_b64_tr_b16 v[66:67], v32 offset:33792
    s_add_u32 m0, s51, 132096
    s_add_u32 s53, s55, 32768
    buffer_load_dwordx4 v4, s[24:27], s53 offen nt lds
    v_fmac_f32 v25, v30, v30
    v_sub_f32 v29, v226, v28
    v_fmac_f32 v26, v29, v29
    v_mfma_f32_32x32x16_bf16 a[128:143], v[136:139], v[112:115], a[128:143]
    ds_read_b64_tr_b16 v[80:81], v32 offset:49152
    ds_read_b64_tr_b16 v[82:83], v32 offset:50176
    s_add_u32 m0, s51, 133120
    s_add_u32 s53, s55, 65536
    buffer_load_dwordx4 v4, s[24:27], s53 offen nt lds
    v_sub_f32 v30, v227, v28
    v_fmac_f32 v27, v30, v30
    v_sub_f32 v29, v228, v28
    v_mfma_f32_32x32x16_bf16 a[144:159], v[140:143], v[112:115], a[144:159]
    ds_read_b64_tr_b16 v[68:69], v33 offset:32768
    ds_read_b64_tr_b16 v[70:71], v33 offset:33792
    s_add_u32 m0, s51, 134144
    s_add_u32 s53, s55, 98304
    buffer_load_dwordx4 v4, s[24:27], s53 offen nt lds
    v_fmac_f32 v24, v29, v29
    v_sub_f32 v30, v229, v28
    v_fmac_f32 v25, v30, v30
    v_mfma_f32_32x32x16_bf16 a[32:47], v[100:103], v[136:139], a[32:47]
    ds_read_b64_tr_b16 v[84:85], v33 offset:49152
    ds_read_b64_tr_b16 v[86:87], v33 offset:50176
    s_add_u32 m0, s51, 147456
    s_add_u32 s53, s55, 0
    buffer_load_dwordx4 v4, s[28:31], s53 offen nt lds
    v_sub_f32 v29, v230, v28
    v_fmac_f32 v26, v29, v29
    v_sub_f32 v30, v231, v28
    v_mfma_f32_32x32x16_bf16 a[48:63], v[100:103], v[140:143], a[48:63]
    ds_read_b64_tr_b16 v[72:73], v34 offset:32768
    ds_read_b64_tr_b16 v[74:75], v34 offset:33792
    s_add_u32 m0, s51, 148480
    s_add_u32 s53, s55, 32768
    buffer_load_dwordx4 v4, s[28:31], s53 offen nt lds
    v_fmac_f32 v27, v30, v30
    v_sub_f32 v29, v232, v28
    v_fmac_f32 v24, v29, v29
    v_mfma_f32_32x32x16_bf16 a[160:175], v[136:139], v[116:119], a[160:175]
    ds_read_b64_tr_b16 v[88:89], v34 offset:49152
    ds_read_b64_tr_b16 v[90:91], v34 offset:50176
    s_add_u32 m0, s51, 149504
    s_add_u32 s53, s55, 65536
    buffer_load_dwordx4 v4, s[28:31], s53 offen nt lds
    v_sub_f32 v30, v233, v28
    v_fmac_f32 v25, v30, v30
    v_sub_f32 v29, v234, v28
    v_mfma_f32_32x32x16_bf16 a[176:191], v[140:143], v[116:119], a[176:191]
    ds_read_b64_tr_b16 v[76:77], v35 offset:32768
    ds_read_b64_tr_b16 v[78:79], v35 offset:33792
    s_add_u32 m0, s51, 150528
    s_add_u32 s53, s55, 98304
    buffer_load_dwordx4 v4, s[28:31], s53 offen nt lds
    v_fmac_f32 v26, v29, v29
    v_sub_f32 v30, v235, v28
    v_fmac_f32 v27, v30, v30
    v_mfma_f32_32x32x16_bf16 a[64:79], v[104:107], v[136:139], a[64:79]
    ds_read_b64_tr_b16 v[92:93], v35 offset:49152
    ds_read_b64_tr_b16 v[94:95], v35 offset:50176
    s_add_u32 s97, s96, 4
    s_and_b32 s97, s97, 7
    s_lshl_b32 s97, s97, 7
    s_add_u32 s97, s97, s48
    s_add_u32 m0, s49, 32768
    s_add_u32 s53, s97, 0
    buffer_load_dwordx4 v36, s[20:23], s53 offen lds
    v_sub_f32 v29, v236, v28
    v_fmac_f32 v24, v29, v29
    v_sub_f32 v30, v237, v28
    v_mfma_f32_32x32x16_bf16 a[80:95], v[104:107], v[140:143], a[80:95]
    s_add_u32 m0, s49, 33792
    s_add_u32 s53, s97, 8192
    buffer_load_dwordx4 v37, s[20:23], s53 offen lds
    v_fmac_f32 v25, v30, v30
    v_sub_f32 v29, v238, v28
    v_fmac_f32 v26, v29, v29
    v_mfma_f32_32x32x16_bf16 a[192:207], v[136:139], v[120:123], a[192:207]
    s_add_u32 m0, s49, 34816
    s_add_u32 s53, s97, 16384
    buffer_load_dwordx4 v36, s[20:23], s53 offen lds
    v_sub_f32 v30, v239, v28
    v_fmac_f32 v27, v30, v30
    v_sub_f32 v29, v240, v28
    v_fmac_f32 v24, v29, v29
    v_mfma_f32_32x32x16_bf16 a[208:223], v[140:143], v[120:123], a[208:223]
    s_add_u32 m0, s49, 35840
    s_add_u32 s53, s97, 24576
    buffer_load_dwordx4 v37, s[20:23], s53 offen lds
    v_sub_f32 v30, v241, v28
    v_fmac_f32 v25, v30, v30
    v_sub_f32 v29, v242, v28
    v_fmac_f32 v26, v29, v29
    v_mfma_f32_32x32x16_bf16 a[96:111], v[108:111], v[136:139], a[96:111]
    s_add_u32 m0, s49, 36864
    s_add_u32 s53, s97, 32768
    buffer_load_dwordx4 v36, s[20:23], s53 offen lds
    v_sub_f32 v30, v243, v28
    v_fmac_f32 v27, v30, v30
    v_sub_f32 v29, v244, v28
    v_fmac_f32 v24, v29, v29
    v_mfma_f32_32x32x16_bf16 a[112:127], v[108:111], v[140:143], a[112:127]
    s_add_u32 m0, s49, 37888
    s_add_u32 s53, s97, 40960
    buffer_load_dwordx4 v37, s[20:23], s53 offen lds
    v_sub_f32 v30, v245, v28
    v_fmac_f32 v25, v30, v30
    v_sub_f32 v29, v246, v28
    v_fmac_f32 v26, v29, v29
    v_mfma_f32_32x32x16_bf16 a[224:239], v[136:139], v[124:127], a[224:239]
    s_add_u32 m0, s49, 38912
    s_add_u32 s53, s97, 49152
    buffer_load_dwordx4 v36, s[20:23], s53 offen lds
    v_sub_f32 v30, v247, v28
    v_fmac_f32 v27, v30, v30
    v_sub_f32 v29, v248, v28
    v_fmac_f32 v24, v29, v29
    v_mfma_f32_32x32x16_bf16 a[240:255], v[140:143], v[124:127], a[240:255]
    s_add_u32 m0, s49, 39936
    s_add_u32 s53, s97, 57344
    buffer_load_dwordx4 v37, s[20:23], s53 offen lds
    v_sub_f32 v30, v249, v28
    v_fmac_f32 v25, v30, v30
    v_sub_f32 v29, v250, v28
    v_fmac_f32 v26, v29, v29
    s_waitcnt lgkmcnt(0)
    v_mfma_f32_32x32x16_bf16 a[0:15], v[64:67], v[128:131], a[0:15]
    ds_read_b128 v[136:139], v41 offset:0
    ds_read_b128 v[140:143], v41 offset:4096
    v_sub_f32 v30, v251, v28
    v_fmac_f32 v27, v30, v30
    v_add_f32 v24, v24, v25
    v_mfma_f32_32x32x16_bf16 a[16:31], v[64:67], v[132:135], a[16:31]
    ds_read_b64_tr_b16 v[96:97], v32 offset:36864
    ds_read_b64_tr_b16 v[98:99], v32 offset:37888
    v_add_f32 v26, v26, v27
    v_add_f32 v24, v24, v26
    s_nop 1
    v_add_f32 v24, v24, v24 row_ror:8
    v_mfma_f32_32x32x16_bf16 a[128:143], v[128:131], v[80:83], a[128:143]
    ds_read_b64_tr_b16 v[112:113], v32 offset:53248
    ds_read_b64_tr_b16 v[114:115], v32 offset:54272
    v_add_f32 v24, v24, v24 row_ror:4
    s_nop 1
    v_add_f32 v24, v24, v24 row_ror:2
    s_nop 1
    v_add_f32 v24, v24, v24 row_ror:1
    v_mfma_f32_32x32x16_bf16 a[144:159], v[132:135], v[80:83], a[144:159]
    ds_read_b64_tr_b16 v[100:101], v33 offset:36864
    ds_read_b64_tr_b16 v[102:103], v33 offset:37888
    v_mul_f32 v24, 0x3acccccd, v24
    v_cvt_pk_bf16_f32 v28, v28, v28
    v_and_b32 v28, 0xffff0000, v28
    v_mfma_f32_32x32x16_bf16 a[32:47], v[68:71], v[128:131], a[32:47]
    ds_read_b64_tr_b16 v[116:117], v33 offset:53248
    ds_read_b64_tr_b16 v[118:119], v33 offset:54272
    v_cvt_pk_bf16_f32 v24, v24, v24
    v_and_b32 v24, 0xffff0000, v24
    v_add_f32 v24, s54, v24
    v_mfma_f32_32x32x16_bf16 a[48:63], v[68:71], v[132:135], a[48:63]
    ds_read_b64_tr_b16 v[104:105], v34 offset:36864
    ds_read_b64_tr_b16 v[106:107], v34 offset:37888
    v_cvt_pk_bf16_f32 v24, v24, v24
    v_and_b32 v24, 0xffff0000, v24
    v_sqrt_f32 v24, v24
    v_mfma_f32_32x32x16_bf16 a[160:175], v[128:131], v[84:87], a[160:175]
    ds_read_b64_tr_b16 v[120:121], v34 offset:53248
    ds_read_b64_tr_b16 v[122:123], v34 offset:54272
    v_cvt_pk_bf16_f32 v24, v24, v24
    v_and_b32 v24, 0xffff0000, v24
    v_rcp_f32 v24, v24
    v_mfma_f32_32x32x16_bf16 a[176:191], v[132:135], v[84:87], a[176:191]
    ds_read_b64_tr_b16 v[108:109], v35 offset:36864
    ds_read_b64_tr_b16 v[110:111], v35 offset:37888
    v_sub_f32 v212, v212, v28
    v_sub_f32 v213, v213, v28
    v_cvt_pk_bf16_f32 v29, v212, v213
    v_mfma_f32_32x32x16_bf16 a[64:79], v[72:75], v[128:131], a[64:79]
    ds_read_b64_tr_b16 v[124:125], v35 offset:53248
    ds_read_b64_tr_b16 v[126:127], v35 offset:54272
    v_lshlrev_b32 v212, 16, v29
    v_and_b32 v213, 0xffff0000, v29
    v_mul_f32 v212, v212, v24
    v_mfma_f32_32x32x16_bf16 a[80:95], v[72:75], v[132:135], a[80:95]
    v_mul_f32 v213, v213, v24
    v_cvt_pk_bf16_f32 v144, v212, v213
    v_sub_f32 v214, v214, v28
    v_mfma_f32_32x32x16_bf16 a[192:207], v[128:131], v[88:91], a[192:207]
    v_sub_f32 v215, v215, v28
    v_cvt_pk_bf16_f32 v29, v214, v215
    v_lshlrev_b32 v214, 16, v29
    v_and_b32 v215, 0xffff0000, v29
    v_mfma_f32_32x32x16_bf16 a[208:223], v[132:135], v[88:91], a[208:223]
    v_mul_f32 v214, v214, v24
    v_mul_f32 v215, v215, v24
    v_cvt_pk_bf16_f32 v145, v214, v215
    v_sub_f32 v216, v216, v28
    v_mfma_f32_32x32x16_bf16 a[96:111], v[76:79], v[128:131], a[96:111]
    v_sub_f32 v217, v217, v28
    v_cvt_pk_bf16_f32 v29, v216, v217
    v_lshlrev_b32 v216, 16, v29
    v_and_b32 v217, 0xffff0000, v29
    v_mfma_f32_32x32x16_bf16 a[112:127], v[76:79], v[132:135], a[112:127]
    v_mul_f32 v216, v216, v24
    v_mul_f32 v217, v217, v24
    v_cvt_pk_bf16_f32 v146, v216, v217
    v_sub_f32 v218, v218, v28
    v_mfma_f32_32x32x16_bf16 a[224:239], v[128:131], v[92:95], a[224:239]
    v_sub_f32 v219, v219, v28
    v_cvt_pk_bf16_f32 v29, v218, v219
    v_lshlrev_b32 v218, 16, v29
    v_and_b32 v219, 0xffff0000, v29
    v_mfma_f32_32x32x16_bf16 a[240:255], v[132:135], v[92:95], a[240:255]
    v_mul_f32 v218, v218, v24
    v_mul_f32 v219, v219, v24
    v_cvt_pk_bf16_f32 v147, v218, v219
    v_sub_f32 v220, v220, v28
    s_waitcnt lgkmcnt(0)
    v_mfma_f32_32x32x16_bf16 a[0:15], v[96:99], v[136:139], a[0:15]
    ds_read_b128 v[128:131], v42 offset:0
    ds_read_b128 v[132:135], v42 offset:4096
    v_sub_f32 v221, v221, v28
    v_cvt_pk_bf16_f32 v29, v220, v221
    v_lshlrev_b32 v220, 16, v29
    v_mfma_f32_32x32x16_bf16 a[16:31], v[96:99], v[140:143], a[16:31]
    ds_read_b64_tr_b16 v[64:65], v32 offset:40960
    ds_read_b64_tr_b16 v[66:67], v32 offset:41984
    v_and_b32 v221, 0xffff0000, v29
    v_mul_f32 v220, v220, v24
    v_mul_f32 v221, v221, v24
    v_mfma_f32_32x32x16_bf16 a[128:143], v[136:139], v[112:115], a[128:143]
    ds_read_b64_tr_b16 v[80:81], v32 offset:57344
    ds_read_b64_tr_b16 v[82:83], v32 offset:58368
    v_cvt_pk_bf16_f32 v148, v220, v221
    v_sub_f32 v222, v222, v28
    v_sub_f32 v223, v223, v28
    v_mfma_f32_32x32x16_bf16 a[144:159], v[140:143], v[112:115], a[144:159]
    ds_read_b64_tr_b16 v[68:69], v33 offset:40960
    ds_read_b64_tr_b16 v[70:71], v33 offset:41984
    v_cvt_pk_bf16_f32 v29, v222, v223
    v_lshlrev_b32 v222, 16, v29
    v_and_b32 v223, 0xffff0000, v29
    v_mfma_f32_32x32x16_bf16 a[32:47], v[100:103], v[136:139], a[32:47]
    ds_read_b64_tr_b16 v[84:85], v33 offset:57344
    ds_read_b64_tr_b16 v[86:87], v33 offset:58368
    v_mul_f32 v222, v222, v24
    v_mul_f32 v223, v223, v24
    v_cvt_pk_bf16_f32 v149, v222, v223
    v_mfma_f32_32x32x16_bf16 a[48:63], v[100:103], v[140:143], a[48:63]
    ds_read_b64_tr_b16 v[72:73], v34 offset:40960
    ds_read_b64_tr_b16 v[74:75], v34 offset:41984
    v_sub_f32 v224, v224, v28
    v_sub_f32 v225, v225, v28
    v_cvt_pk_bf16_f32 v29, v224, v225
    v_mfma_f32_32x32x16_bf16 a[160:175], v[136:139], v[116:119], a[160:175]
    ds_read_b64_tr_b16 v[88:89], v34 offset:57344
    ds_read_b64_tr_b16 v[90:91], v34 offset:58368
    v_lshlrev_b32 v224, 16, v29
    v_and_b32 v225, 0xffff0000, v29
    v_mul_f32 v224, v224, v24
    v_mfma_f32_32x32x16_bf16 a[176:191], v[140:143], v[116:119], a[176:191]
    ds_read_b64_tr_b16 v[76:77], v35 offset:40960
    ds_read_b64_tr_b16 v[78:79], v35 offset:41984
    v_mul_f32 v225, v225, v24
    v_cvt_pk_bf16_f32 v150, v224, v225
    v_sub_f32 v226, v226, v28
    v_mfma_f32_32x32x16_bf16 a[64:79], v[104:107], v[136:139], a[64:79]
    ds_read_b64_tr_b16 v[92:93], v35 offset:57344
    ds_read_b64_tr_b16 v[94:95], v35 offset:58368
    v_sub_f32 v227, v227, v28
    v_cvt_pk_bf16_f32 v29, v226, v227
    v_lshlrev_b32 v226, 16, v29
    v_mfma_f32_32x32x16_bf16 a[80:95], v[104:107], v[140:143], a[80:95]
    v_and_b32 v227, 0xffff0000, v29
    v_mul_f32 v226, v226, v24
    v_mul_f32 v227, v227, v24
    v_mfma_f32_32x32x16_bf16 a[192:207], v[136:139], v[120:123], a[192:207]
    v_cvt_pk_bf16_f32 v151, v226, v227
    v_sub_f32 v228, v228, v28
    v_sub_f32 v229, v229, v28
    v_cvt_pk_bf16_f32 v29, v228, v229
    v_mfma_f32_32x32x16_bf16 a[208:223], v[140:143], v[120:123], a[208:223]
    v_lshlrev_b32 v228, 16, v29
    v_and_b32 v229, 0xffff0000, v29
    v_mul_f32 v228, v228, v24
    v_mul_f32 v229, v229, v24
    v_mfma_f32_32x32x16_bf16 a[96:111], v[108:111], v[136:139], a[96:111]
    v_cvt_pk_bf16_f32 v152, v228, v229
    v_sub_f32 v230, v230, v28
    v_sub_f32 v231, v231, v28
    v_cvt_pk_bf16_f32 v29, v230, v231
    v_mfma_f32_32x32x16_bf16 a[112:127], v[108:111], v[140:143], a[112:127]
    v_lshlrev_b32 v230, 16, v29
    v_and_b32 v231, 0xffff0000, v29
    v_mul_f32 v230, v230, v24
    v_mul_f32 v231, v231, v24
    v_mfma_f32_32x32x16_bf16 a[224:239], v[136:139], v[124:127], a[224:239]
    v_cvt_pk_bf16_f32 v153, v230, v231
    v_sub_f32 v232, v232, v28
    v_sub_f32 v233, v233, v28
    v_cvt_pk_bf16_f32 v29, v232, v233
    v_mfma_f32_32x32x16_bf16 a[240:255], v[140:143], v[124:127], a[240:255]
    v_lshlrev_b32 v232, 16, v29
    v_and_b32 v233, 0xffff0000, v29
    v_mul_f32 v232, v232, v24
    v_mul_f32 v233, v233, v24
    s_waitcnt lgkmcnt(0)
    v_mfma_f32_32x32x16_bf16 a[0:15], v[64:67], v[128:131], a[0:15]
    ds_read_b128 v[136:139], v43 offset:0
    ds_read_b128 v[140:143], v43 offset:4096
    v_cvt_pk_bf16_f32 v154, v232, v233
    v_sub_f32 v234, v234, v28
    v_sub_f32 v235, v235, v28
    v_mfma_f32_32x32x16_bf16 a[16:31], v[64:67], v[132:135], a[16:31]
    ds_read_b64_tr_b16 v[96:97], v32 offset:45056
    ds_read_b64_tr_b16 v[98:99], v32 offset:46080
    v_cvt_pk_bf16_f32 v29, v234, v235
    v_lshlrev_b32 v234, 16, v29
    v_and_b32 v235, 0xffff0000, v29
    v_mfma_f32_32x32x16_bf16 a[128:143], v[128:131], v[80:83], a[128:143]
    ds_read_b64_tr_b16 v[112:113], v32 offset:61440
    ds_read_b64_tr_b16 v[114:115], v32 offset:62464
    v_mul_f32 v234, v234, v24
    v_mul_f32 v235, v235, v24
    v_cvt_pk_bf16_f32 v155, v234, v235
    v_mfma_f32_32x32x16_bf16 a[144:159], v[132:135], v[80:83], a[144:159]
    ds_read_b64_tr_b16 v[100:101], v33 offset:45056
    ds_read_b64_tr_b16 v[102:103], v33 offset:46080
    v_sub_f32 v236, v236, v28
    v_sub_f32 v237, v237, v28
    v_cvt_pk_bf16_f32 v29, v236, v237
    v_mfma_f32_32x32x16_bf16 a[32:47], v[68:71], v[128:131], a[32:47]
    ds_read_b64_tr_b16 v[116:117], v33 offset:61440
    ds_read_b64_tr_b16 v[118:119], v33 offset:62464
    v_lshlrev_b32 v236, 16, v29
    v_and_b32 v237, 0xffff0000, v29
    v_mul_f32 v236, v236, v24
    v_mfma_f32_32x32x16_bf16 a[48:63], v[68:71], v[132:135], a[48:63]
    ds_read_b64_tr_b16 v[104:105], v34 offset:45056
    ds_read_b64_tr_b16 v[106:107], v34 offset:46080
    v_mul_f32 v237, v237, v24
    v_cvt_pk_bf16_f32 v156, v236, v237
    v_sub_f32 v238, v238, v28
    v_mfma_f32_32x32x16_bf16 a[160:175], v[128:131], v[84:87], a[160:175]
    ds_read_b64_tr_b16 v[120:121], v34 offset:61440
    ds_read_b64_tr_b16 v[122:123], v34 offset:62464
    v_sub_f32 v239, v239, v28
    v_cvt_pk_bf16_f32 v29, v238, v239
    v_lshlrev_b32 v238, 16, v29
    v_mfma_f32_32x32x16_bf16 a[176:191], v[132:135], v[84:87], a[176:191]
    ds_read_b64_tr_b16 v[108:109], v35 offset:45056
    ds_read_b64_tr_b16 v[110:111], v35 offset:46080
    v_and_b32 v239, 0xffff0000, v29
    v_mul_f32 v238, v238, v24
    v_mul_f32 v239, v239, v24
    v_mfma_f32_32x32x16_bf16 a[64:79], v[72:75], v[128:131], a[64:79]
    ds_read_b64_tr_b16 v[124:125], v35 offset:61440
    ds_read_b64_tr_b16 v[126:127], v35 offset:62464
    v_cvt_pk_bf16_f32 v157, v238, v239
    v_sub_f32 v240, v240, v28
    v_sub_f32 v241, v241, v28
    v_mfma_f32_32x32x16_bf16 a[80:95], v[72:75], v[132:135], a[80:95]
    v_cvt_pk_bf16_f32 v29, v240, v241
    v_lshlrev_b32 v240, 16, v29
    v_and_b32 v241, 0xffff0000, v29
    v_mfma_f32_32x32x16_bf16 a[192:207], v[128:131], v[88:91], a[192:207]
    v_mul_f32 v240, v240, v24
    v_mul_f32 v241, v241, v24
    v_cvt_pk_bf16_f32 v158, v240, v241
    v_sub_f32 v242, v242, v28
    v_mfma_f32_32x32x16_bf16 a[208:223], v[132:135], v[88:91], a[208:223]
    v_sub_f32 v243, v243, v28
    v_cvt_pk_bf16_f32 v29, v242, v243
    v_lshlrev_b32 v242, 16, v29
    v_and_b32 v243, 0xffff0000, v29
    v_mfma_f32_32x32x16_bf16 a[96:111], v[76:79], v[128:131], a[96:111]
    v_mul_f32 v242, v242, v24
    v_mul_f32 v243, v243, v24
    v_cvt_pk_bf16_f32 v159, v242, v243
    v_sub_f32 v244, v244, v28
    v_mfma_f32_32x32x16_bf16 a[112:127], v[76:79], v[132:135], a[112:127]
    v_sub_f32 v245, v245, v28
    v_cvt_pk_bf16_f32 v29, v244, v245
    v_lshlrev_b32 v244, 16, v29
    v_and_b32 v245, 0xffff0000, v29
    v_mfma_f32_32x32x16_bf16 a[224:239], v[128:131], v[92:95], a[224:239]
    v_mul_f32 v244, v244, v24
    v_mul_f32 v245, v245, v24
    v_cvt_pk_bf16_f32 v160, v244, v245
    v_sub_f32 v246, v246, v28
    v_mfma_f32_32x32x16_bf16 a[240:255], v[132:135], v[92:95], a[240:255]
    v_sub_f32 v247, v247, v28
    v_cvt_pk_bf16_f32 v29, v246, v247
    v_lshlrev_b32 v246, 16, v29
    v_and_b32 v247, 0xffff0000, v29
    s_waitcnt lgkmcnt(0)
    s_waitcnt vmcnt(8)
    s_barrier
    v_mfma_f32_32x32x16_bf16 a[0:15], v[96:99], v[136:139], a[0:15]
    ds_read_b128 v[128:131], v48 offset:0
    ds_read_b128 v[132:135], v48 offset:4096
    s_add_u32 s55, s96, 4
    s_and_b32 s55, s55, 7
    s_lshl_b32 s55, s55, 19
    s_add_u32 s55, s55, s88
    s_add_u32 m0, s51, 98304
    s_add_u32 s53, s55, 0
    buffer_load_dwordx4 v4, s[24:27], s53 offen nt lds
    v_mul_f32 v246, v246, v24
    v_mul_f32 v247, v247, v24
    v_cvt_pk_bf16_f32 v161, v246, v247
    v_mfma_f32_32x32x16_bf16 a[16:31], v[96:99], v[140:143], a[16:31]
    ds_read_b64_tr_b16 v[64:65], v58 offset:0
    ds_read_b64_tr_b16 v[66:67], v58 offset:1024
    v_sub_f32 v248, v248, v28
    v_sub_f32 v249, v249, v28
    v_cvt_pk_bf16_f32 v29, v248, v249
    v_mfma_f32_32x32x16_bf16 a[128:143], v[136:139], v[112:115], a[128:143]
    ds_read_b64_tr_b16 v[80:81], v58 offset:16384
    ds_read_b64_tr_b16 v[82:83], v58 offset:17408
    s_add_u32 m0, s51, 99328
    s_add_u32 s53, s55, 32768
    buffer_load_dwordx4 v4, s[24:27], s53 offen nt lds
    v_lshlrev_b32 v248, 16, v29
    v_and_b32 v249, 0xffff0000, v29
    v_mul_f32 v248, v248, v24
    v_mfma_f32_32x32x16_bf16 a[144:159], v[140:143], v[112:115], a[144:159]
    ds_read_b64_tr_b16 v[68:69], v59 offset:0
    ds_read_b64_tr_b16 v[70:71], v59 offset:1024
    v_mul_f32 v249, v249, v24
    v_cvt_pk_bf16_f32 v162, v248, v249
    v_sub_f32 v250, v250, v28
    v_mfma_f32_32x32x16_bf16 a[32:47], v[100:103], v[136:139], a[32:47]
    ds_read_b64_tr_b16 v[84:85], v59 offset:16384
    ds_read_b64_tr_b16 v[86:87], v59 offset:17408
    s_add_u32 m0, s51, 100352
    s_add_u32 s53, s55, 65536
    buffer_load_dwordx4 v4, s[24:27], s53 offen nt lds
    v_sub_f32 v251, v251, v28
    v_cvt_pk_bf16_f32 v29, v250, v251
    v_lshlrev_b32 v250, 16, v29
    v_mfma_f32_32x32x16_bf16 a[48:63], v[100:103], v[140:143], a[48:63]
    ds_read_b64_tr_b16 v[72:73], v60 offset:0
    ds_read_b64_tr_b16 v[74:75], v60 offset:1024
    v_and_b32 v251, 0xffff0000, v29
    v_mul_f32 v250, v250, v24
    v_mul_f32 v251, v251, v24
    v_mfma_f32_32x32x16_bf16 a[160:175], v[136:139], v[116:119], a[160:175]
    ds_read_b64_tr_b16 v[88:89], v60 offset:16384
    ds_read_b64_tr_b16 v[90:91], v60 offset:17408
    s_add_u32 m0, s51, 101376
    s_add_u32 s53, s55, 98304
    buffer_load_dwordx4 v4, s[24:27], s53 offen nt lds
    v_cvt_pk_bf16_f32 v163, v250, v251
    v_mfma_f32_32x32x16_bf16 a[176:191], v[140:143], v[116:119], a[176:191]
    ds_read_b64_tr_b16 v[76:77], v61 offset:0
    ds_read_b64_tr_b16 v[78:79], v61 offset:1024
    v_mfma_f32_32x32x16_bf16 a[64:79], v[104:107], v[136:139], a[64:79]
    ds_read_b64_tr_b16 v[92:93], v61 offset:16384
    ds_read_b64_tr_b16 v[94:95], v61 offset:17408
    s_add_u32 m0, s51, 114688
    s_add_u32 s53, s55, 0
    buffer_load_dwordx4 v4, s[28:31], s53 offen nt lds
    v_mfma_f32_32x32x16_bf16 a[80:95], v[104:107], v[140:143], a[80:95]
    v_mfma_f32_32x32x16_bf16 a[192:207], v[136:139], v[120:123], a[192:207]
    s_add_u32 m0, s51, 115712
    s_add_u32 s53, s55, 32768
    buffer_load_dwordx4 v4, s[28:31], s53 offen nt lds
    v_mfma_f32_32x32x16_bf16 a[208:223], v[140:143], v[120:123], a[208:223]
    v_mfma_f32_32x32x16_bf16 a[96:111], v[108:111], v[136:139], a[96:111]
    s_add_u32 m0, s51, 116736
    s_add_u32 s53, s55, 65536
    buffer_load_dwordx4 v4, s[28:31], s53 offen nt lds
    v_mfma_f32_32x32x16_bf16 a[112:127], v[108:111], v[140:143], a[112:127]
    v_mfma_f32_32x32x16_bf16 a[224:239], v[136:139], v[124:127], a[224:239]
    s_add_u32 m0, s51, 117760
    s_add_u32 s53, s55, 98304
    buffer_load_dwordx4 v4, s[28:31], s53 offen nt lds
    v_mfma_f32_32x32x16_bf16 a[240:255], v[140:143], v[124:127], a[240:255]
    s_waitcnt lgkmcnt(0)
    v_mfma_f32_32x32x16_bf16 a[0:15], v[64:67], v[128:131], a[0:15]
    ds_read_b128 v[136:139], v49 offset:0
    ds_read_b128 v[140:143], v49 offset:4096
    s_add_u32 s97, s96, 5
    s_and_b32 s97, s97, 7
    s_lshl_b32 s97, s97, 7
    s_add_u32 s97, s97, s48
    s_add_u32 m0, s49, 65536
    s_add_u32 s53, s97, 0
    buffer_load_dwordx4 v36, s[20:23], s53 offen lds
    v_mfma_f32_32x32x16_bf16 a[16:31], v[64:67], v[132:135], a[16:31]
    ds_read_b64_tr_b16 v[96:97], v58 offset:4096
    ds_read_b64_tr_b16 v[98:99], v58 offset:5120
    v_mfma_f32_32x32x16_bf16 a[128:143], v[128:131], v[80:83], a[128:143]
    ds_read_b64_tr_b16 v[112:113], v58 offset:20480
    ds_read_b64_tr_b16 v[114:115], v58 offset:21504
    s_add_u32 m0, s49, 66560
    s_add_u32 s53, s97, 8192
    buffer_load_dwordx4 v37, s[20:23], s53 offen lds
    v_mfma_f32_32x32x16_bf16 a[144:159], v[132:135], v[80:83], a[144:159]
    ds_read_b64_tr_b16 v[100:101], v59 offset:4096
    ds_read_b64_tr_b16 v[102:103], v59 offset:5120
    v_mfma_f32_32x32x16_bf16 a[32:47], v[68:71], v[128:131], a[32:47]
    ds_read_b64_tr_b16 v[116:117], v59 offset:20480
    ds_read_b64_tr_b16 v[118:119], v59 offset:21504
    s_add_u32 m0, s49, 67584
    s_add_u32 s53, s97, 16384
    buffer_load_dwordx4 v36, s[20:23], s53 offen lds
    v_mfma_f32_32x32x16_bf16 a[48:63], v[68:71], v[132:135], a[48:63]
    ds_read_b64_tr_b16 v[104:105], v60 offset:4096
    ds_read_b64_tr_b16 v[106:107], v60 offset:5120
    v_mfma_f32_32x32x16_bf16 a[160:175], v[128:131], v[84:87], a[160:175]
    ds_read_b64_tr_b16 v[120:121], v60 offset:20480
    ds_read_b64_tr_b16 v[122:123], v60 offset:21504
    s_add_u32 m0, s49, 68608
    s_add_u32 s53, s97, 24576
    buffer_load_dwordx4 v37, s[20:23], s53 offen lds
    v_mfma_f32_32x32x16_bf16 a[176:191], v[132:135], v[84:87], a[176:191]
    ds_read_b64_tr_b16 v[108:109], v61 offset:4096
    ds_read_b64_tr_b16 v[110:111], v61 offset:5120
    v_mfma_f32_32x32x16_bf16 a[64:79], v[72:75], v[128:131], a[64:79]
    ds_read_b64_tr_b16 v[124:125], v61 offset:20480
    ds_read_b64_tr_b16 v[126:127], v61 offset:21504
    s_add_u32 m0, s49, 69632
    s_add_u32 s53, s97, 32768
    buffer_load_dwordx4 v36, s[20:23], s53 offen lds
    v_mfma_f32_32x32x16_bf16 a[80:95], v[72:75], v[132:135], a[80:95]
    v_mfma_f32_32x32x16_bf16 a[192:207], v[128:131], v[88:91], a[192:207]
    s_add_u32 m0, s49, 70656
    s_add_u32 s53, s97, 40960
    buffer_load_dwordx4 v37, s[20:23], s53 offen lds
    v_mfma_f32_32x32x16_bf16 a[208:223], v[132:135], v[88:91], a[208:223]
    v_mfma_f32_32x32x16_bf16 a[96:111], v[76:79], v[128:131], a[96:111]
    s_add_u32 m0, s49, 71680
    s_add_u32 s53, s97, 49152
    buffer_load_dwordx4 v36, s[20:23], s53 offen lds
    v_mfma_f32_32x32x16_bf16 a[112:127], v[76:79], v[132:135], a[112:127]
    v_mfma_f32_32x32x16_bf16 a[224:239], v[128:131], v[92:95], a[224:239]
    s_add_u32 m0, s49, 72704
    s_add_u32 s53, s97, 57344
    buffer_load_dwordx4 v37, s[20:23], s53 offen lds
    v_mfma_f32_32x32x16_bf16 a[240:255], v[132:135], v[92:95], a[240:255]
    s_waitcnt lgkmcnt(0)
    v_mfma_f32_32x32x16_bf16 a[0:15], v[96:99], v[136:139], a[0:15]
    ds_read_b128 v[128:131], v50 offset:0
    ds_read_b128 v[132:135], v50 offset:4096
    s_mov_b32 s53, 0
    buffer_store_dwordx4 v[144:147], v46, s[36:39], s53 offen sc1
    s_mov_b32 s53, 8192
    buffer_store_dwordx4 v[148:151], v46, s[36:39], s53 offen sc1
    s_mov_b32 s53, 16384
    buffer_store_dwordx4 v[152:155], v46, s[36:39], s53 offen sc1
    s_mov_b32 s53, 24576
    buffer_store_dwordx4 v[156:159], v46, s[36:39], s53 offen sc1
    s_mov_b32 s53, 32768
    buffer_store_dwordx4 v[160:163], v46, s[36:39], s53 offen sc1
    v_mfma_f32_32x32x16_bf16 a[16:31], v[96:99], v[140:143], a[16:31]
    ds_read_b64_tr_b16 v[64:65], v58 offset:8192
    ds_read_b64_tr_b16 v[66:67], v58 offset:9216
    v_mfma_f32_32x32x16_bf16 a[128:143], v[136:139], v[112:115], a[128:143]
    ds_read_b64_tr_b16 v[80:81], v58 offset:24576
    ds_read_b64_tr_b16 v[82:83], v58 offset:25600
    s_mov_b32 s92, s56
    s_mov_b32 s93, s57
    s_mov_b32 s94, 5242880
    s_mov_b32 s95, 0x20000
    s_mul_i32 s45, s42, 80
    s_mul_i32 s46, s40, 20
    s_add_u32 s45, s45, s46
    s_lshl_b32 s45, s45, 13
    s_lshl_b32 s46, s41, 8
    s_add_u32 s45, s45, s46
    v_lshrrev_b32 v62, 1, v2
    v_lshlrev_b32 v62, 13, v62
    v_and_b32 v63, 1, v2
    v_lshl_add_u32 v62, v63, 7, v62
    v_mov_b32 v63, 0x2000000
    v_cmp_gt_u32 vcc, 40, v2
    s_nop 1
    v_cndmask_b32 v62, v63, v62, vcc
    buffer_load_dword v11, v62, s[92:95], s45 offen
    v_mfma_f32_32x32x16_bf16 a[144:159], v[140:143], v[112:115], a[144:159]
    ds_read_b64_tr_b16 v[68:69], v59 offset:8192
    ds_read_b64_tr_b16 v[70:71], v59 offset:9216
    v_mfma_f32_32x32x16_bf16 a[32:47], v[100:103], v[136:139], a[32:47]
    ds_read_b64_tr_b16 v[84:85], v59 offset:24576
    ds_read_b64_tr_b16 v[86:87], v59 offset:25600
    v_mfma_f32_32x32x16_bf16 a[48:63], v[100:103], v[140:143], a[48:63]
    ds_read_b64_tr_b16 v[72:73], v60 offset:8192
    ds_read_b64_tr_b16 v[74:75], v60 offset:9216
    v_mfma_f32_32x32x16_bf16 a[160:175], v[136:139], v[116:119], a[160:175]
    ds_read_b64_tr_b16 v[88:89], v60 offset:24576
    ds_read_b64_tr_b16 v[90:91], v60 offset:25600
    v_mfma_f32_32x32x16_bf16 a[176:191], v[140:143], v[116:119], a[176:191]
    ds_read_b64_tr_b16 v[76:77], v61 offset:8192
    ds_read_b64_tr_b16 v[78:79], v61 offset:9216
    v_mfma_f32_32x32x16_bf16 a[64:79], v[104:107], v[136:139], a[64:79]
    ds_read_b64_tr_b16 v[92:93], v61 offset:24576
    ds_read_b64_tr_b16 v[94:95], v61 offset:25600
    v_mfma_f32_32x32x16_bf16 a[80:95], v[104:107], v[140:143], a[80:95]
    v_mfma_f32_32x32x16_bf16 a[192:207], v[136:139], v[120:123], a[192:207]
    v_mfma_f32_32x32x16_bf16 a[208:223], v[140:143], v[120:123], a[208:223]
    v_mfma_f32_32x32x16_bf16 a[96:111], v[108:111], v[136:139], a[96:111]
    v_mfma_f32_32x32x16_bf16 a[112:127], v[108:111], v[140:143], a[112:127]
    v_mfma_f32_32x32x16_bf16 a[224:239], v[136:139], v[124:127], a[224:239]
    v_mfma_f32_32x32x16_bf16 a[240:255], v[140:143], v[124:127], a[240:255]
    s_waitcnt lgkmcnt(0)
    v_mfma_f32_32x32x16_bf16 a[0:15], v[64:67], v[128:131], a[0:15]
    ds_read_b128 v[136:139], v51 offset:0
    ds_read_b128 v[140:143], v51 offset:4096
    v_mfma_f32_32x32x16_bf16 a[16:31], v[64:67], v[132:135], a[16:31]
    ds_read_b64_tr_b16 v[96:97], v58 offset:12288
    ds_read_b64_tr_b16 v[98:99], v58 offset:13312
    v_mfma_f32_32x32x16_bf16 a[128:143], v[128:131], v[80:83], a[128:143]
    ds_read_b64_tr_b16 v[112:113], v58 offset:28672
    ds_read_b64_tr_b16 v[114:115], v58 offset:29696
    v_mfma_f32_32x32x16_bf16 a[144:159], v[132:135], v[80:83], a[144:159]
    ds_read_b64_tr_b16 v[100:101], v59 offset:12288
    ds_read_b64_tr_b16 v[102:103], v59 offset:13312
    v_mfma_f32_32x32x16_bf16 a[32:47], v[68:71], v[128:131], a[32:47]
    ds_read_b64_tr_b16 v[116:117], v59 offset:28672
    ds_read_b64_tr_b16 v[118:119], v59 offset:29696
    v_mfma_f32_32x32x16_bf16 a[48:63], v[68:71], v[132:135], a[48:63]
    ds_read_b64_tr_b16 v[104:105], v60 offset:12288
    ds_read_b64_tr_b16 v[106:107], v60 offset:13312
    v_mfma_f32_32x32x16_bf16 a[160:175], v[128:131], v[84:87], a[160:175]
    ds_read_b64_tr_b16 v[120:121], v60 offset:28672
    ds_read_b64_tr_b16 v[122:123], v60 offset:29696
    v_mfma_f32_32x32x16_bf16 a[176:191], v[132:135], v[84:87], a[176:191]
    ds_read_b64_tr_b16 v[108:109], v61 offset:12288
    ds_read_b64_tr_b16 v[110:111], v61 offset:13312
    v_mfma_f32_32x32x16_bf16 a[64:79], v[72:75], v[128:131], a[64:79]
    ds_read_b64_tr_b16 v[124:125], v61 offset:28672
    ds_read_b64_tr_b16 v[126:127], v61 offset:29696
    v_mfma_f32_32x32x16_bf16 a[80:95], v[72:75], v[132:135], a[80:95]
    v_mfma_f32_32x32x16_bf16 a[192:207], v[128:131], v[88:91], a[192:207]
    v_mfma_f32_32x32x16_bf16 a[208:223], v[132:135], v[88:91], a[208:223]
    v_mfma_f32_32x32x16_bf16 a[96:111], v[76:79], v[128:131], a[96:111]
    v_mfma_f32_32x32x16_bf16 a[112:127], v[76:79], v[132:135], a[112:127]
    v_mfma_f32_32x32x16_bf16 a[224:239], v[128:131], v[92:95], a[224:239]
    v_mfma_f32_32x32x16_bf16 a[240:255], v[132:135], v[92:95], a[240:255]
    s_waitcnt lgkmcnt(0)
    s_waitcnt vmcnt(14)
    s_waitcnt vmcnt(1)
    s_barrier
    s_waitcnt vmcnt(63)
    v_readfirstlane_b32 s43, v54
    s_nop 3
    s_cmp_eq_u32 s43, 0
    s_cselect_b32 s47, s47, s43
    v_mov_b32 v57, s47
    s_mov_b32 s100, s47
    s_add_u32 s92, s14, 68288512
    s_addc_u32 s93, s15, 0
    s_mov_b32 s94, 38912
    s_mov_b32 s95, 0x20000
    s_lshr_b32 s43, s2, 2
    s_add_u32 s43, s43, 32
    s_lshl_b32 s43, s43, 7
    s_and_b32 s46, s2, 3
    s_lshl_b32 s46, s46, 2
    s_add_u32 s43, s43, s46
    buffer_store_dword v57, v56, s[92:95], s43 offen sc1
    v_mfma_f32_32x32x16_bf16 a[0:15], v[96:99], v[136:139], a[0:15]
    ds_read_b128 v[128:131], v48 offset:32768
    ds_read_b128 v[132:135], v48 offset:36864
    s_add_u32 s55, s96, 5
    s_and_b32 s55, s55, 7
    s_lshl_b32 s55, s55, 19
    s_add_u32 s55, s55, s88
    s_add_u32 m0, s51, 131072
    s_add_u32 s53, s55, 0
    buffer_load_dwordx4 v4, s[24:27], s53 offen nt lds
    v_mfma_f32_32x32x16_bf16 a[16:31], v[96:99], v[140:143], a[16:31]
    ds_read_b64_tr_b16 v[64:65], v32 offset:32768
    ds_read_b64_tr_b16 v[66:67], v32 offset:33792
    v_mfma_f32_32x32x16_bf16 a[128:143], v[136:139], v[112:115], a[128:143]
    ds_read_b64_tr_b16 v[80:81], v32 offset:49152
    ds_read_b64_tr_b16 v[82:83], v32 offset:50176
    s_add_u32 m0, s51, 132096
    s_add_u32 s53, s55, 32768
    buffer_load_dwordx4 v4, s[24:27], s53 offen nt lds
    v_mfma_f32_32x32x16_bf16 a[144:159], v[140:143], v[112:115], a[144:159]
    ds_read_b64_tr_b16 v[68:69], v33 offset:32768
    ds_read_b64_tr_b16 v[70:71], v33 offset:33792
    v_mfma_f32_32x32x16_bf16 a[32:47], v[100:103], v[136:139], a[32:47]
    ds_read_b64_tr_b16 v[84:85], v33 offset:49152
    ds_read_b64_tr_b16 v[86:87], v33 offset:50176
    s_add_u32 m0, s51, 133120
    s_add_u32 s53, s55, 65536
    buffer_load_dwordx4 v4, s[24:27], s53 offen nt lds
    v_mfma_f32_32x32x16_bf16 a[48:63], v[100:103], v[140:143], a[48:63]
    ds_read_b64_tr_b16 v[72:73], v34 offset:32768
    ds_read_b64_tr_b16 v[74:75], v34 offset:33792
    v_mfma_f32_32x32x16_bf16 a[160:175], v[136:139], v[116:119], a[160:175]
    ds_read_b64_tr_b16 v[88:89], v34 offset:49152
    ds_read_b64_tr_b16 v[90:91], v34 offset:50176
    s_add_u32 m0, s51, 134144
    s_add_u32 s53, s55, 98304
    buffer_load_dwordx4 v4, s[24:27], s53 offen nt lds
    v_mfma_f32_32x32x16_bf16 a[176:191], v[140:143], v[116:119], a[176:191]
    ds_read_b64_tr_b16 v[76:77], v35 offset:32768
    ds_read_b64_tr_b16 v[78:79], v35 offset:33792
    v_mfma_f32_32x32x16_bf16 a[64:79], v[104:107], v[136:139], a[64:79]
    ds_read_b64_tr_b16 v[92:93], v35 offset:49152
    ds_read_b64_tr_b16 v[94:95], v35 offset:50176
    s_add_u32 m0, s51, 147456
    s_add_u32 s53, s55, 0
    buffer_load_dwordx4 v4, s[28:31], s53 offen nt lds
    v_mfma_f32_32x32x16_bf16 a[80:95], v[104:107], v[140:143], a[80:95]
    v_mfma_f32_32x32x16_bf16 a[192:207], v[136:139], v[120:123], a[192:207]
    s_add_u32 m0, s51, 148480
    s_add_u32 s53, s55, 32768
    buffer_load_dwordx4 v4, s[28:31], s53 offen nt lds
    v_mfma_f32_32x32x16_bf16 a[208:223], v[140:143], v[120:123], a[208:223]
    v_mfma_f32_32x32x16_bf16 a[96:111], v[108:111], v[136:139], a[96:111]
    s_add_u32 m0, s51, 149504
    s_add_u32 s53, s55, 65536
    buffer_load_dwordx4 v4, s[28:31], s53 offen nt lds
    v_mfma_f32_32x32x16_bf16 a[112:127], v[108:111], v[140:143], a[112:127]
    v_mfma_f32_32x32x16_bf16 a[224:239], v[136:139], v[124:127], a[224:239]
    s_add_u32 m0, s51, 150528
    s_add_u32 s53, s55, 98304
    buffer_load_dwordx4 v4, s[28:31], s53 offen nt lds
    v_mfma_f32_32x32x16_bf16 a[240:255], v[140:143], v[124:127], a[240:255]
    s_waitcnt lgkmcnt(0)
    v_mfma_f32_32x32x16_bf16 a[0:15], v[64:67], v[128:131], a[0:15]
    ds_read_b128 v[136:139], v49 offset:32768
    ds_read_b128 v[140:143], v49 offset:36864
    s_add_u32 s97, s96, 6
    s_and_b32 s97, s97, 7
    s_lshl_b32 s97, s97, 7
    s_add_u32 s97, s97, s48
    s_add_u32 m0, s49, 0
    s_add_u32 s53, s97, 0
    buffer_load_dwordx4 v36, s[20:23], s53 offen lds
    v_mfma_f32_32x32x16_bf16 a[16:31], v[64:67], v[132:135], a[16:31]
    ds_read_b64_tr_b16 v[96:97], v32 offset:36864
    ds_read_b64_tr_b16 v[98:99], v32 offset:37888
    v_mfma_f32_32x32x16_bf16 a[128:143], v[128:131], v[80:83], a[128:143]
    ds_read_b64_tr_b16 v[112:113], v32 offset:53248
    ds_read_b64_tr_b16 v[114:115], v32 offset:54272
    s_add_u32 m0, s49, 1024
    s_add_u32 s53, s97, 8192
    buffer_load_dwordx4 v37, s[20:23], s53 offen lds
    v_mfma_f32_32x32x16_bf16 a[144:159], v[132:135], v[80:83], a[144:159]
    ds_read_b64_tr_b16 v[100:101], v33 offset:36864
    ds_read_b64_tr_b16 v[102:103], v33 offset:37888
    v_mfma_f32_32x32x16_bf16 a[32:47], v[68:71], v[128:131], a[32:47]
    ds_read_b64_tr_b16 v[116:117], v33 offset:53248
    ds_read_b64_tr_b16 v[118:119], v33 offset:54272
    s_add_u32 m0, s49, 2048
    s_add_u32 s53, s97, 16384
    buffer_load_dwordx4 v36, s[20:23], s53 offen lds
    v_mfma_f32_32x32x16_bf16 a[48:63], v[68:71], v[132:135], a[48:63]
    ds_read_b64_tr_b16 v[104:105], v34 offset:36864
    ds_read_b64_tr_b16 v[106:107], v34 offset:37888
    v_mfma_f32_32x32x16_bf16 a[160:175], v[128:131], v[84:87], a[160:175]
    ds_read_b64_tr_b16 v[120:121], v34 offset:53248
    ds_read_b64_tr_b16 v[122:123], v34 offset:54272
    s_add_u32 m0, s49, 3072
    s_add_u32 s53, s97, 24576
    buffer_load_dwordx4 v37, s[20:23], s53 offen lds
    v_mfma_f32_32x32x16_bf16 a[176:191], v[132:135], v[84:87], a[176:191]
    ds_read_b64_tr_b16 v[108:109], v35 offset:36864
    ds_read_b64_tr_b16 v[110:111], v35 offset:37888
    v_mfma_f32_32x32x16_bf16 a[64:79], v[72:75], v[128:131], a[64:79]
    ds_read_b64_tr_b16 v[124:125], v35 offset:53248
    ds_read_b64_tr_b16 v[126:127], v35 offset:54272
    s_add_u32 m0, s49, 4096
    s_add_u32 s53, s97, 32768
    buffer_load_dwordx4 v36, s[20:23], s53 offen lds
    v_mfma_f32_32x32x16_bf16 a[80:95], v[72:75], v[132:135], a[80:95]
    v_mfma_f32_32x32x16_bf16 a[192:207], v[128:131], v[88:91], a[192:207]
    s_add_u32 m0, s49, 5120
    s_add_u32 s53, s97, 40960
    buffer_load_dwordx4 v37, s[20:23], s53 offen lds
    v_mfma_f32_32x32x16_bf16 a[208:223], v[132:135], v[88:91], a[208:223]
    v_mfma_f32_32x32x16_bf16 a[96:111], v[76:79], v[128:131], a[96:111]
    s_add_u32 m0, s49, 6144
    s_add_u32 s53, s97, 49152
    buffer_load_dwordx4 v36, s[20:23], s53 offen lds
    v_mfma_f32_32x32x16_bf16 a[112:127], v[76:79], v[132:135], a[112:127]
    v_mfma_f32_32x32x16_bf16 a[224:239], v[128:131], v[92:95], a[224:239]
    s_add_u32 m0, s49, 7168
    s_add_u32 s53, s97, 57344
    buffer_load_dwordx4 v37, s[20:23], s53 offen lds
    v_mfma_f32_32x32x16_bf16 a[240:255], v[132:135], v[92:95], a[240:255]
    s_waitcnt lgkmcnt(0)
    v_mfma_f32_32x32x16_bf16 a[0:15], v[96:99], v[136:139], a[0:15]
    ds_read_b128 v[128:131], v50 offset:32768
    ds_read_b128 v[132:135], v50 offset:36864
    v_mfma_f32_32x32x16_bf16 a[16:31], v[96:99], v[140:143], a[16:31]
    ds_read_b64_tr_b16 v[64:65], v32 offset:40960
    ds_read_b64_tr_b16 v[66:67], v32 offset:41984
    v_mfma_f32_32x32x16_bf16 a[128:143], v[136:139], v[112:115], a[128:143]
    ds_read_b64_tr_b16 v[80:81], v32 offset:57344
    ds_read_b64_tr_b16 v[82:83], v32 offset:58368
    v_mfma_f32_32x32x16_bf16 a[144:159], v[140:143], v[112:115], a[144:159]
    ds_read_b64_tr_b16 v[68:69], v33 offset:40960
    ds_read_b64_tr_b16 v[70:71], v33 offset:41984
    v_mfma_f32_32x32x16_bf16 a[32:47], v[100:103], v[136:139], a[32:47]
    ds_read_b64_tr_b16 v[84:85], v33 offset:57344
    ds_read_b64_tr_b16 v[86:87], v33 offset:58368
    v_mfma_f32_32x32x16_bf16 a[48:63], v[100:103], v[140:143], a[48:63]
    ds_read_b64_tr_b16 v[72:73], v34 offset:40960
    ds_read_b64_tr_b16 v[74:75], v34 offset:41984
    v_mfma_f32_32x32x16_bf16 a[160:175], v[136:139], v[116:119], a[160:175]
    ds_read_b64_tr_b16 v[88:89], v34 offset:57344
    ds_read_b64_tr_b16 v[90:91], v34 offset:58368
    v_mfma_f32_32x32x16_bf16 a[176:191], v[140:143], v[116:119], a[176:191]
    ds_read_b64_tr_b16 v[76:77], v35 offset:40960
    ds_read_b64_tr_b16 v[78:79], v35 offset:41984
    v_mfma_f32_32x32x16_bf16 a[64:79], v[104:107], v[136:139], a[64:79]
    ds_read_b64_tr_b16 v[92:93], v35 offset:57344
    ds_read_b64_tr_b16 v[94:95], v35 offset:58368
    v_mfma_f32_32x32x16_bf16 a[80:95], v[104:107], v[140:143], a[80:95]
    v_mfma_f32_32x32x16_bf16 a[192:207], v[136:139], v[120:123], a[192:207]
    v_mfma_f32_32x32x16_bf16 a[208:223], v[140:143], v[120:123], a[208:223]
    v_mfma_f32_32x32x16_bf16 a[96:111], v[108:111], v[136:139], a[96:111]
    v_mfma_f32_32x32x16_bf16 a[112:127], v[108:111], v[140:143], a[112:127]
    v_mfma_f32_32x32x16_bf16 a[224:239], v[136:139], v[124:127], a[224:239]
    v_mfma_f32_32x32x16_bf16 a[240:255], v[140:143], v[124:127], a[240:255]
    s_waitcnt lgkmcnt(0)
    v_mfma_f32_32x32x16_bf16 a[0:15], v[64:67], v[128:131], a[0:15]
    ds_read_b128 v[136:139], v51 offset:32768
    ds_read_b128 v[140:143], v51 offset:36864
    v_mfma_f32_32x32x16_bf16 a[16:31], v[64:67], v[132:135], a[16:31]
    ds_read_b64_tr_b16 v[96:97], v32 offset:45056
    ds_read_b64_tr_b16 v[98:99], v32 offset:46080
    v_mfma_f32_32x32x16_bf16 a[128:143], v[128:131], v[80:83], a[128:143]
    ds_read_b64_tr_b16 v[112:113], v32 offset:61440
    ds_read_b64_tr_b16 v[114:115], v32 offset:62464
    v_mfma_f32_32x32x16_bf16 a[144:159], v[132:135], v[80:83], a[144:159]
    ds_read_b64_tr_b16 v[100:101], v33 offset:45056
    ds_read_b64_tr_b16 v[102:103], v33 offset:46080
    v_mfma_f32_32x32x16_bf16 a[32:47], v[68:71], v[128:131], a[32:47]
    ds_read_b64_tr_b16 v[116:117], v33 offset:61440
    ds_read_b64_tr_b16 v[118:119], v33 offset:62464
    v_mfma_f32_32x32x16_bf16 a[48:63], v[68:71], v[132:135], a[48:63]
    ds_read_b64_tr_b16 v[104:105], v34 offset:45056
    ds_read_b64_tr_b16 v[106:107], v34 offset:46080
    v_mfma_f32_32x32x16_bf16 a[160:175], v[128:131], v[84:87], a[160:175]
    ds_read_b64_tr_b16 v[120:121], v34 offset:61440
    ds_read_b64_tr_b16 v[122:123], v34 offset:62464
    v_mfma_f32_32x32x16_bf16 a[176:191], v[132:135], v[84:87], a[176:191]
    ds_read_b64_tr_b16 v[108:109], v35 offset:45056
    ds_read_b64_tr_b16 v[110:111], v35 offset:46080
    v_mfma_f32_32x32x16_bf16 a[64:79], v[72:75], v[128:131], a[64:79]
    ds_read_b64_tr_b16 v[124:125], v35 offset:61440
    ds_read_b64_tr_b16 v[126:127], v35 offset:62464
    v_mfma_f32_32x32x16_bf16 a[80:95], v[72:75], v[132:135], a[80:95]
    v_mfma_f32_32x32x16_bf16 a[192:207], v[128:131], v[88:91], a[192:207]
    v_mfma_f32_32x32x16_bf16 a[208:223], v[132:135], v[88:91], a[208:223]
    v_mfma_f32_32x32x16_bf16 a[96:111], v[76:79], v[128:131], a[96:111]
    v_mfma_f32_32x32x16_bf16 a[112:127], v[76:79], v[132:135], a[112:127]
    v_mfma_f32_32x32x16_bf16 a[224:239], v[128:131], v[92:95], a[224:239]
    v_mfma_f32_32x32x16_bf16 a[240:255], v[132:135], v[92:95], a[240:255]
    s_waitcnt lgkmcnt(0)
    s_waitcnt vmcnt(8)
    s_barrier
    v_mfma_f32_32x32x16_bf16 a[0:15], v[96:99], v[136:139], a[0:15]
    ds_read_b128 v[128:131], v40 offset:0
    ds_read_b128 v[132:135], v40 offset:4096
    s_add_u32 s55, s96, 6
    s_and_b32 s55, s55, 7
    s_lshl_b32 s55, s55, 19
    s_add_u32 s55, s55, s88
    s_add_u32 m0, s51, 98304
    s_add_u32 s53, s55, 0
    buffer_load_dwordx4 v4, s[24:27], s53 offen nt lds
    v_mfma_f32_32x32x16_bf16 a[16:31], v[96:99], v[140:143], a[16:31]
    ds_read_b64_tr_b16 v[64:65], v58 offset:0
    ds_read_b64_tr_b16 v[66:67], v58 offset:1024
    v_mfma_f32_32x32x16_bf16 a[128:143], v[136:139], v[112:115], a[128:143]
    ds_read_b64_tr_b16 v[80:81], v58 offset:16384
    ds_read_b64_tr_b16 v[82:83], v58 offset:17408
    s_add_u32 m0, s51, 99328
    s_add_u32 s53, s55, 32768
    buffer_load_dwordx4 v4, s[24:27], s53 offen nt lds
    v_mfma_f32_32x32x16_bf16 a[144:159], v[140:143], v[112:115], a[144:159]
    ds_read_b64_tr_b16 v[68:69], v59 offset:0
    ds_read_b64_tr_b16 v[70:71], v59 offset:1024
    v_mfma_f32_32x32x16_bf16 a[32:47], v[100:103], v[136:139], a[32:47]
    ds_read_b64_tr_b16 v[84:85], v59 offset:16384
    ds_read_b64_tr_b16 v[86:87], v59 offset:17408
    s_add_u32 m0, s51, 100352
    s_add_u32 s53, s55, 65536
    buffer_load_dwordx4 v4, s[24:27], s53 offen nt lds
    v_mfma_f32_32x32x16_bf16 a[48:63], v[100:103], v[140:143], a[48:63]
    ds_read_b64_tr_b16 v[72:73], v60 offset:0
    ds_read_b64_tr_b16 v[74:75], v60 offset:1024
    v_mfma_f32_32x32x16_bf16 a[160:175], v[136:139], v[116:119], a[160:175]
    ds_read_b64_tr_b16 v[88:89], v60 offset:16384
    ds_read_b64_tr_b16 v[90:91], v60 offset:17408
    s_add_u32 m0, s51, 101376
    s_add_u32 s53, s55, 98304
    buffer_load_dwordx4 v4, s[24:27], s53 offen nt lds
    v_mfma_f32_32x32x16_bf16 a[176:191], v[140:143], v[116:119], a[176:191]
    ds_read_b64_tr_b16 v[76:77], v61 offset:0
    ds_read_b64_tr_b16 v[78:79], v61 offset:1024
    v_mfma_f32_32x32x16_bf16 a[64:79], v[104:107], v[136:139], a[64:79]
    ds_read_b64_tr_b16 v[92:93], v61 offset:16384
    ds_read_b64_tr_b16 v[94:95], v61 offset:17408
    s_add_u32 m0, s51, 114688
    s_add_u32 s53, s55, 0
    buffer_load_dwordx4 v4, s[28:31], s53 offen nt lds
    v_mfma_f32_32x32x16_bf16 a[80:95], v[104:107], v[140:143], a[80:95]
    v_mfma_f32_32x32x16_bf16 a[192:207], v[136:139], v[120:123], a[192:207]
    s_add_u32 m0, s51, 115712
    s_add_u32 s53, s55, 32768
    buffer_load_dwordx4 v4, s[28:31], s53 offen nt lds
    v_mfma_f32_32x32x16_bf16 a[208:223], v[140:143], v[120:123], a[208:223]
    v_mfma_f32_32x32x16_bf16 a[96:111], v[108:111], v[136:139], a[96:111]
    s_add_u32 m0, s51, 116736
    s_add_u32 s53, s55, 65536
    buffer_load_dwordx4 v4, s[28:31], s53 offen nt lds
    v_mfma_f32_32x32x16_bf16 a[112:127], v[108:111], v[140:143], a[112:127]
    v_mfma_f32_32x32x16_bf16 a[224:239], v[136:139], v[124:127], a[224:239]
    s_add_u32 m0, s51, 117760
    s_add_u32 s53, s55, 98304
    buffer_load_dwordx4 v4, s[28:31], s53 offen nt lds
    v_mfma_f32_32x32x16_bf16 a[240:255], v[140:143], v[124:127], a[240:255]
    s_waitcnt lgkmcnt(0)
    v_mfma_f32_32x32x16_bf16 a[0:15], v[64:67], v[128:131], a[0:15]
    ds_read_b128 v[136:139], v41 offset:0
    ds_read_b128 v[140:143], v41 offset:4096
    s_add_u32 s97, s96, 7
    s_and_b32 s97, s97, 7
    s_lshl_b32 s97, s97, 7
    s_add_u32 s97, s97, s48
    s_add_u32 m0, s49, 32768
    s_add_u32 s53, s97, 0
    buffer_load_dwordx4 v36, s[20:23], s53 offen lds
    v_mfma_f32_32x32x16_bf16 a[16:31], v[64:67], v[132:135], a[16:31]
    ds_read_b64_tr_b16 v[96:97], v58 offset:4096
    ds_read_b64_tr_b16 v[98:99], v58 offset:5120
    v_mfma_f32_32x32x16_bf16 a[128:143], v[128:131], v[80:83], a[128:143]
    ds_read_b64_tr_b16 v[112:113], v58 offset:20480
    ds_read_b64_tr_b16 v[114:115], v58 offset:21504
    s_add_u32 m0, s49, 33792
    s_add_u32 s53, s97, 8192
    buffer_load_dwordx4 v37, s[20:23], s53 offen lds
    v_mfma_f32_32x32x16_bf16 a[144:159], v[132:135], v[80:83], a[144:159]
    ds_read_b64_tr_b16 v[100:101], v59 offset:4096
    ds_read_b64_tr_b16 v[102:103], v59 offset:5120
    v_mfma_f32_32x32x16_bf16 a[32:47], v[68:71], v[128:131], a[32:47]
    ds_read_b64_tr_b16 v[116:117], v59 offset:20480
    ds_read_b64_tr_b16 v[118:119], v59 offset:21504
    s_add_u32 m0, s49, 34816
    s_add_u32 s53, s97, 16384
    buffer_load_dwordx4 v36, s[20:23], s53 offen lds
    v_mfma_f32_32x32x16_bf16 a[48:63], v[68:71], v[132:135], a[48:63]
    ds_read_b64_tr_b16 v[104:105], v60 offset:4096
    ds_read_b64_tr_b16 v[106:107], v60 offset:5120
    v_mfma_f32_32x32x16_bf16 a[160:175], v[128:131], v[84:87], a[160:175]
    ds_read_b64_tr_b16 v[120:121], v60 offset:20480
    ds_read_b64_tr_b16 v[122:123], v60 offset:21504
    s_add_u32 m0, s49, 35840
    s_add_u32 s53, s97, 24576
    buffer_load_dwordx4 v37, s[20:23], s53 offen lds
    v_mfma_f32_32x32x16_bf16 a[176:191], v[132:135], v[84:87], a[176:191]
    ds_read_b64_tr_b16 v[108:109], v61 offset:4096
    ds_read_b64_tr_b16 v[110:111], v61 offset:5120
    v_mfma_f32_32x32x16_bf16 a[64:79], v[72:75], v[128:131], a[64:79]
    ds_read_b64_tr_b16 v[124:125], v61 offset:20480
    ds_read_b64_tr_b16 v[126:127], v61 offset:21504
    s_add_u32 m0, s49, 36864
    s_add_u32 s53, s97, 32768
    buffer_load_dwordx4 v36, s[20:23], s53 offen lds
    v_mfma_f32_32x32x16_bf16 a[80:95], v[72:75], v[132:135], a[80:95]
    v_mfma_f32_32x32x16_bf16 a[192:207], v[128:131], v[88:91], a[192:207]
    s_add_u32 m0, s49, 37888
    s_add_u32 s53, s97, 40960
    buffer_load_dwordx4 v37, s[20:23], s53 offen lds
    v_mfma_f32_32x32x16_bf16 a[208:223], v[132:135], v[88:91], a[208:223]
    v_mfma_f32_32x32x16_bf16 a[96:111], v[76:79], v[128:131], a[96:111]
    s_add_u32 m0, s49, 38912
    s_add_u32 s53, s97, 49152
    buffer_load_dwordx4 v36, s[20:23], s53 offen lds
    v_mfma_f32_32x32x16_bf16 a[112:127], v[76:79], v[132:135], a[112:127]
    v_mfma_f32_32x32x16_bf16 a[224:239], v[128:131], v[92:95], a[224:239]
    s_add_u32 m0, s49, 39936
    s_add_u32 s53, s97, 57344
    buffer_load_dwordx4 v37, s[20:23], s53 offen lds
    v_mfma_f32_32x32x16_bf16 a[240:255], v[132:135], v[92:95], a[240:255]
    s_waitcnt lgkmcnt(0)
    v_mfma_f32_32x32x16_bf16 a[0:15], v[96:99], v[136:139], a[0:15]
    ds_read_b128 v[128:131], v42 offset:0
    ds_read_b128 v[132:135], v42 offset:4096
    v_mfma_f32_32x32x16_bf16 a[16:31], v[96:99], v[140:143], a[16:31]
    ds_read_b64_tr_b16 v[64:65], v58 offset:8192
    ds_read_b64_tr_b16 v[66:67], v58 offset:9216
    v_mfma_f32_32x32x16_bf16 a[128:143], v[136:139], v[112:115], a[128:143]
    ds_read_b64_tr_b16 v[80:81], v58 offset:24576
    ds_read_b64_tr_b16 v[82:83], v58 offset:25600
    v_mfma_f32_32x32x16_bf16 a[144:159], v[140:143], v[112:115], a[144:159]
    ds_read_b64_tr_b16 v[68:69], v59 offset:8192
    ds_read_b64_tr_b16 v[70:71], v59 offset:9216
    v_mfma_f32_32x32x16_bf16 a[32:47], v[100:103], v[136:139], a[32:47]
    ds_read_b64_tr_b16 v[84:85], v59 offset:24576
    ds_read_b64_tr_b16 v[86:87], v59 offset:25600
    v_mfma_f32_32x32x16_bf16 a[48:63], v[100:103], v[140:143], a[48:63]
    ds_read_b64_tr_b16 v[72:73], v60 offset:8192
    ds_read_b64_tr_b16 v[74:75], v60 offset:9216
    v_mfma_f32_32x32x16_bf16 a[160:175], v[136:139], v[116:119], a[160:175]
    ds_read_b64_tr_b16 v[88:89], v60 offset:24576
    ds_read_b64_tr_b16 v[90:91], v60 offset:25600
    v_mfma_f32_32x32x16_bf16 a[176:191], v[140:143], v[116:119], a[176:191]
    ds_read_b64_tr_b16 v[76:77], v61 offset:8192
    ds_read_b64_tr_b16 v[78:79], v61 offset:9216
    v_mfma_f32_32x32x16_bf16 a[64:79], v[104:107], v[136:139], a[64:79]
    ds_read_b64_tr_b16 v[92:93], v61 offset:24576
    ds_read_b64_tr_b16 v[94:95], v61 offset:25600
    v_mfma_f32_32x32x16_bf16 a[80:95], v[104:107], v[140:143], a[80:95]
    v_mfma_f32_32x32x16_bf16 a[192:207], v[136:139], v[120:123], a[192:207]
    v_mfma_f32_32x32x16_bf16 a[208:223], v[140:143], v[120:123], a[208:223]
    v_mfma_f32_32x32x16_bf16 a[96:111], v[108:111], v[136:139], a[96:111]
    v_mfma_f32_32x32x16_bf16 a[112:127], v[108:111], v[140:143], a[112:127]
    v_mfma_f32_32x32x16_bf16 a[224:239], v[136:139], v[124:127], a[224:239]
    v_mfma_f32_32x32x16_bf16 a[240:255], v[140:143], v[124:127], a[240:255]
    s_waitcnt lgkmcnt(0)
    v_mfma_f32_32x32x16_bf16 a[0:15], v[64:67], v[128:131], a[0:15]
    ds_read_b128 v[136:139], v43 offset:0
    ds_read_b128 v[140:143], v43 offset:4096
    v_mfma_f32_32x32x16_bf16 a[16:31], v[64:67], v[132:135], a[16:31]
    ds_read_b64_tr_b16 v[96:97], v58 offset:12288
    ds_read_b64_tr_b16 v[98:99], v58 offset:13312
    v_mfma_f32_32x32x16_bf16 a[128:143], v[128:131], v[80:83], a[128:143]
    ds_read_b64_tr_b16 v[112:113], v58 offset:28672
    ds_read_b64_tr_b16 v[114:115], v58 offset:29696
    v_mfma_f32_32x32x16_bf16 a[144:159], v[132:135], v[80:83], a[144:159]
    ds_read_b64_tr_b16 v[100:101], v59 offset:12288
    ds_read_b64_tr_b16 v[102:103], v59 offset:13312
    v_mfma_f32_32x32x16_bf16 a[32:47], v[68:71], v[128:131], a[32:47]
    ds_read_b64_tr_b16 v[116:117], v59 offset:28672
    ds_read_b64_tr_b16 v[118:119], v59 offset:29696
    v_mfma_f32_32x32x16_bf16 a[48:63], v[68:71], v[132:135], a[48:63]
    ds_read_b64_tr_b16 v[104:105], v60 offset:12288
    ds_read_b64_tr_b16 v[106:107], v60 offset:13312
    v_mfma_f32_32x32x16_bf16 a[160:175], v[128:131], v[84:87], a[160:175]
    ds_read_b64_tr_b16 v[120:121], v60 offset:28672
    ds_read_b64_tr_b16 v[122:123], v60 offset:29696
    v_mfma_f32_32x32x16_bf16 a[176:191], v[132:135], v[84:87], a[176:191]
    ds_read_b64_tr_b16 v[108:109], v61 offset:12288
    ds_read_b64_tr_b16 v[110:111], v61 offset:13312
    v_mfma_f32_32x32x16_bf16 a[64:79], v[72:75], v[128:131], a[64:79]
    ds_read_b64_tr_b16 v[124:125], v61 offset:28672
    ds_read_b64_tr_b16 v[126:127], v61 offset:29696
    v_mfma_f32_32x32x16_bf16 a[80:95], v[72:75], v[132:135], a[80:95]
    v_mfma_f32_32x32x16_bf16 a[192:207], v[128:131], v[88:91], a[192:207]
    v_mfma_f32_32x32x16_bf16 a[208:223], v[132:135], v[88:91], a[208:223]
    v_mfma_f32_32x32x16_bf16 a[96:111], v[76:79], v[128:131], a[96:111]
    v_mfma_f32_32x32x16_bf16 a[112:127], v[76:79], v[132:135], a[112:127]
    v_mfma_f32_32x32x16_bf16 a[224:239], v[128:131], v[92:95], a[224:239]
    v_mfma_f32_32x32x16_bf16 a[240:255], v[132:135], v[92:95], a[240:255]
    s_waitcnt lgkmcnt(0)
    s_waitcnt vmcnt(8)
    s_barrier
    v_mfma_f32_32x32x16_bf16 a[0:15], v[96:99], v[136:139], a[0:15]
    ds_read_b128 v[128:131], v48 offset:0
    ds_read_b128 v[132:135], v48 offset:4096
    s_add_u32 s55, s96, 7
    s_and_b32 s55, s55, 7
    s_lshl_b32 s55, s55, 19
    s_add_u32 s55, s55, s88
    s_add_u32 m0, s51, 131072
    s_add_u32 s53, s55, 0
    buffer_load_dwordx4 v4, s[24:27], s53 offen nt lds
    v_mfma_f32_32x32x16_bf16 a[16:31], v[96:99], v[140:143], a[16:31]
    ds_read_b64_tr_b16 v[64:65], v32 offset:32768
    ds_read_b64_tr_b16 v[66:67], v32 offset:33792
    v_mfma_f32_32x32x16_bf16 a[128:143], v[136:139], v[112:115], a[128:143]
    ds_read_b64_tr_b16 v[80:81], v32 offset:49152
    ds_read_b64_tr_b16 v[82:83], v32 offset:50176
    s_add_u32 m0, s51, 132096
    s_add_u32 s53, s55, 32768
    buffer_load_dwordx4 v4, s[24:27], s53 offen nt lds
    v_mfma_f32_32x32x16_bf16 a[144:159], v[140:143], v[112:115], a[144:159]
    ds_read_b64_tr_b16 v[68:69], v33 offset:32768
    ds_read_b64_tr_b16 v[70:71], v33 offset:33792
    v_mfma_f32_32x32x16_bf16 a[32:47], v[100:103], v[136:139], a[32:47]
    ds_read_b64_tr_b16 v[84:85], v33 offset:49152
    ds_read_b64_tr_b16 v[86:87], v33 offset:50176
    s_add_u32 m0, s51, 133120
    s_add_u32 s53, s55, 65536
    buffer_load_dwordx4 v4, s[24:27], s53 offen nt lds
    v_mfma_f32_32x32x16_bf16 a[48:63], v[100:103], v[140:143], a[48:63]
    ds_read_b64_tr_b16 v[72:73], v34 offset:32768
    ds_read_b64_tr_b16 v[74:75], v34 offset:33792
    v_mfma_f32_32x32x16_bf16 a[160:175], v[136:139], v[116:119], a[160:175]
    ds_read_b64_tr_b16 v[88:89], v34 offset:49152
    ds_read_b64_tr_b16 v[90:91], v34 offset:50176
    s_add_u32 m0, s51, 134144
    s_add_u32 s53, s55, 98304
    buffer_load_dwordx4 v4, s[24:27], s53 offen nt lds
    v_mfma_f32_32x32x16_bf16 a[176:191], v[140:143], v[116:119], a[176:191]
    ds_read_b64_tr_b16 v[76:77], v35 offset:32768
    ds_read_b64_tr_b16 v[78:79], v35 offset:33792
    v_mfma_f32_32x32x16_bf16 a[64:79], v[104:107], v[136:139], a[64:79]
    ds_read_b64_tr_b16 v[92:93], v35 offset:49152
    ds_read_b64_tr_b16 v[94:95], v35 offset:50176
    s_add_u32 m0, s51, 147456
    s_add_u32 s53, s55, 0
    buffer_load_dwordx4 v4, s[28:31], s53 offen nt lds
    v_mfma_f32_32x32x16_bf16 a[80:95], v[104:107], v[140:143], a[80:95]
    v_mfma_f32_32x32x16_bf16 a[192:207], v[136:139], v[120:123], a[192:207]
    s_add_u32 m0, s51, 148480
    s_add_u32 s53, s55, 32768
    buffer_load_dwordx4 v4, s[28:31], s53 offen nt lds
    v_mfma_f32_32x32x16_bf16 a[208:223], v[140:143], v[120:123], a[208:223]
    v_mfma_f32_32x32x16_bf16 a[96:111], v[108:111], v[136:139], a[96:111]
    s_add_u32 m0, s51, 149504
    s_add_u32 s53, s55, 65536
    buffer_load_dwordx4 v4, s[28:31], s53 offen nt lds
    v_mfma_f32_32x32x16_bf16 a[112:127], v[108:111], v[140:143], a[112:127]
    v_mfma_f32_32x32x16_bf16 a[224:239], v[136:139], v[124:127], a[224:239]
    s_add_u32 m0, s51, 150528
    s_add_u32 s53, s55, 98304
    buffer_load_dwordx4 v4, s[28:31], s53 offen nt lds
    v_mfma_f32_32x32x16_bf16 a[240:255], v[140:143], v[124:127], a[240:255]
    s_add_u32 s92, s14, 68288512
    s_addc_u32 s93, s15, 0
    s_mov_b32 s94, 38912
    s_mov_b32 s95, 0x20000
    s_lshl_b32 s43, s42, 2
    v_add_u32 v62, s43, v2
    s_sub_u32 s43, 56, s43
    v_add_u32 v63, s43, v2
    v_cmp_gt_u32 vcc, 4, v2
    s_nop 1
    v_cndmask_b32 v62, v63, v62, vcc
    v_add_u32 v62, 32, v62
    v_lshlrev_b32 v62, 7, v62
    v_mov_b32 v63, 0x100000
    v_cmp_gt_u32 vcc, 8, v0
    s_nop 1
    v_cndmask_b32 v47, v63, v62, vcc
    buffer_load_dwordx4 v[12:15], v47, s[92:95], 0 offen sc1
    s_waitcnt lgkmcnt(0)
    v_mfma_f32_32x32x16_bf16 a[0:15], v[64:67], v[128:131], a[0:15]
    ds_read_b128 v[136:139], v49 offset:0
    ds_read_b128 v[140:143], v49 offset:4096
    s_mov_b32 s20, s56
    s_mov_b32 s21, s57
    s_mov_b32 s22, 5242880
    s_mov_b32 s23, 0x20000
    s_add_u32 s16, s14, 0
    s_addc_u32 s17, s15, 0
    s_mov_b32 s18, 2621440
    s_mov_b32 s19, 0x20000
    s_lshl_b32 s43, s42, 2
    s_add_u32 s56, s43, s40
    s_sub_u32 s57, 60, s43
    s_add_u32 s57, s57, s40
    s_mul_i32 s58, s56, 40960
    s_mul_i32 s59, s57, 40960
    v_mfma_f32_32x32x16_bf16 a[16:31], v[64:67], v[132:135], a[16:31]
    ds_read_b64_tr_b16 v[96:97], v32 offset:36864
    ds_read_b64_tr_b16 v[98:99], v32 offset:37888
    v_mfma_f32_32x32x16_bf16 a[128:143], v[128:131], v[80:83], a[128:143]
    ds_read_b64_tr_b16 v[112:113], v32 offset:53248
    ds_read_b64_tr_b16 v[114:115], v32 offset:54272
    s_add_u32 m0, s51, 65536
    s_add_u32 s43, s88, 0
    buffer_load_dwordx4 v4, s[20:23], s43 offen  lds
    v_mfma_f32_32x32x16_bf16 a[144:159], v[132:135], v[80:83], a[144:159]
    ds_read_b64_tr_b16 v[100:101], v33 offset:36864
    ds_read_b64_tr_b16 v[102:103], v33 offset:37888
    v_mfma_f32_32x32x16_bf16 a[32:47], v[68:71], v[128:131], a[32:47]
    ds_read_b64_tr_b16 v[116:117], v33 offset:53248
    ds_read_b64_tr_b16 v[118:119], v33 offset:54272
    s_add_u32 m0, s51, 66560
    s_add_u32 s43, s88, 32768
    buffer_load_dwordx4 v4, s[20:23], s43 offen  lds
    v_mfma_f32_32x32x16_bf16 a[48:63], v[68:71], v[132:135], a[48:63]
    ds_read_b64_tr_b16 v[104:105], v34 offset:36864
    ds_read_b64_tr_b16 v[106:107], v34 offset:37888
    v_mfma_f32_32x32x16_bf16 a[160:175], v[128:131], v[84:87], a[160:175]
    ds_read_b64_tr_b16 v[120:121], v34 offset:53248
    ds_read_b64_tr_b16 v[122:123], v34 offset:54272
    s_add_u32 m0, s51, 67584
    s_add_u32 s43, s88, 65536
    buffer_load_dwordx4 v4, s[20:23], s43 offen  lds
    v_mfma_f32_32x32x16_bf16 a[176:191], v[132:135], v[84:87], a[176:191]
    ds_read_b64_tr_b16 v[108:109], v35 offset:36864
    ds_read_b64_tr_b16 v[110:111], v35 offset:37888
    v_mfma_f32_32x32x16_bf16 a[64:79], v[72:75], v[128:131], a[64:79]
    ds_read_b64_tr_b16 v[124:125], v35 offset:53248
    ds_read_b64_tr_b16 v[126:127], v35 offset:54272
    s_add_u32 m0, s51, 68608
    s_add_u32 s43, s88, 98304
    buffer_load_dwordx4 v4, s[20:23], s43 offen  lds
    v_mfma_f32_32x32x16_bf16 a[80:95], v[72:75], v[132:135], a[80:95]
    v_mfma_f32_32x32x16_bf16 a[192:207], v[128:131], v[88:91], a[192:207]
    s_add_u32 m0, s51, 81920
    s_add_u32 s43, s88, 524288
    buffer_load_dwordx4 v4, s[20:23], s43 offen  lds
    v_mfma_f32_32x32x16_bf16 a[208:223], v[132:135], v[88:91], a[208:223]
    v_mfma_f32_32x32x16_bf16 a[96:111], v[76:79], v[128:131], a[96:111]
    s_add_u32 m0, s51, 82944
    s_add_u32 s43, s88, 557056
    buffer_load_dwordx4 v4, s[20:23], s43 offen  lds
    v_mfma_f32_32x32x16_bf16 a[112:127], v[76:79], v[132:135], a[112:127]
    v_mfma_f32_32x32x16_bf16 a[224:239], v[128:131], v[92:95], a[224:239]
    s_add_u32 m0, s51, 83968
    s_add_u32 s43, s88, 589824
    buffer_load_dwordx4 v4, s[20:23], s43 offen  lds
    v_mfma_f32_32x32x16_bf16 a[240:255], v[132:135], v[92:95], a[240:255]
    s_waitcnt lgkmcnt(0)
    v_mfma_f32_32x32x16_bf16 a[0:15], v[96:99], v[136:139], a[0:15]
    ds_read_b128 v[128:131], v50 offset:0
    ds_read_b128 v[132:135], v50 offset:4096
    s_add_u32 m0, s51, 84992
    s_add_u32 s43, s88, 622592
    buffer_load_dwordx4 v4, s[20:23], s43 offen  lds
    v_mfma_f32_32x32x16_bf16 a[16:31], v[96:99], v[140:143], a[16:31]
    ds_read_b64_tr_b16 v[64:65], v32 offset:40960
    ds_read_b64_tr_b16 v[66:67], v32 offset:41984
    v_mfma_f32_32x32x16_bf16 a[128:143], v[136:139], v[112:115], a[128:143]
    ds_read_b64_tr_b16 v[80:81], v32 offset:57344
    ds_read_b64_tr_b16 v[82:83], v32 offset:58368
    v_mfma_f32_32x32x16_bf16 a[144:159], v[140:143], v[112:115], a[144:159]
    ds_read_b64_tr_b16 v[68:69], v33 offset:40960
    ds_read_b64_tr_b16 v[70:71], v33 offset:41984
    v_mfma_f32_32x32x16_bf16 a[32:47], v[100:103], v[136:139], a[32:47]
    ds_read_b64_tr_b16 v[84:85], v33 offset:57344
    ds_read_b64_tr_b16 v[86:87], v33 offset:58368
    v_mfma_f32_32x32x16_bf16 a[48:63], v[100:103], v[140:143], a[48:63]
    ds_read_b64_tr_b16 v[72:73], v34 offset:40960
    ds_read_b64_tr_b16 v[74:75], v34 offset:41984
    v_mfma_f32_32x32x16_bf16 a[160:175], v[136:139], v[116:119], a[160:175]
    ds_read_b64_tr_b16 v[88:89], v34 offset:57344
    ds_read_b64_tr_b16 v[90:91], v34 offset:58368
    v_mfma_f32_32x32x16_bf16 a[176:191], v[140:143], v[116:119], a[176:191]
    ds_read_b64_tr_b16 v[76:77], v35 offset:40960
    ds_read_b64_tr_b16 v[78:79], v35 offset:41984
    v_mfma_f32_32x32x16_bf16 a[64:79], v[104:107], v[136:139], a[64:79]
    ds_read_b64_tr_b16 v[92:93], v35 offset:57344
    ds_read_b64_tr_b16 v[94:95], v35 offset:58368
    v_mfma_f32_32x32x16_bf16 a[80:95], v[104:107], v[140:143], a[80:95]
    v_mfma_f32_32x32x16_bf16 a[192:207], v[136:139], v[120:123], a[192:207]
    v_mfma_f32_32x32x16_bf16 a[208:223], v[140:143], v[120:123], a[208:223]
    v_mfma_f32_32x32x16_bf16 a[96:111], v[108:111], v[136:139], a[96:111]
    v_mfma_f32_32x32x16_bf16 a[112:127], v[108:111], v[140:143], a[112:127]
    v_mfma_f32_32x32x16_bf16 a[224:239], v[136:139], v[124:127], a[224:239]
    v_mfma_f32_32x32x16_bf16 a[240:255], v[140:143], v[124:127], a[240:255]
    s_waitcnt lgkmcnt(0)
    v_mfma_f32_32x32x16_bf16 a[0:15], v[64:67], v[128:131], a[0:15]
    ds_read_b128 v[136:139], v51 offset:0
    ds_read_b128 v[140:143], v51 offset:4096
    v_mfma_f32_32x32x16_bf16 a[16:31], v[64:67], v[132:135], a[16:31]
    ds_read_b64_tr_b16 v[96:97], v32 offset:45056
    ds_read_b64_tr_b16 v[98:99], v32 offset:46080
    v_mfma_f32_32x32x16_bf16 a[128:143], v[128:131], v[80:83], a[128:143]
    ds_read_b64_tr_b16 v[112:113], v32 offset:61440
    ds_read_b64_tr_b16 v[114:115], v32 offset:62464
    v_mfma_f32_32x32x16_bf16 a[144:159], v[132:135], v[80:83], a[144:159]
    ds_read_b64_tr_b16 v[100:101], v33 offset:45056
    ds_read_b64_tr_b16 v[102:103], v33 offset:46080
    v_mfma_f32_32x32x16_bf16 a[32:47], v[68:71], v[128:131], a[32:47]
    ds_read_b64_tr_b16 v[116:117], v33 offset:61440
    ds_read_b64_tr_b16 v[118:119], v33 offset:62464
    v_mfma_f32_32x32x16_bf16 a[48:63], v[68:71], v[132:135], a[48:63]
    ds_read_b64_tr_b16 v[104:105], v34 offset:45056
    ds_read_b64_tr_b16 v[106:107], v34 offset:46080
    v_mfma_f32_32x32x16_bf16 a[160:175], v[128:131], v[84:87], a[160:175]
    ds_read_b64_tr_b16 v[120:121], v34 offset:61440
    ds_read_b64_tr_b16 v[122:123], v34 offset:62464
    v_mfma_f32_32x32x16_bf16 a[176:191], v[132:135], v[84:87], a[176:191]
    ds_read_b64_tr_b16 v[108:109], v35 offset:45056
    ds_read_b64_tr_b16 v[110:111], v35 offset:46080
    v_mfma_f32_32x32x16_bf16 a[64:79], v[72:75], v[128:131], a[64:79]
    ds_read_b64_tr_b16 v[124:125], v35 offset:61440
    ds_read_b64_tr_b16 v[126:127], v35 offset:62464
    v_mfma_f32_32x32x16_bf16 a[80:95], v[72:75], v[132:135], a[80:95]
    v_mfma_f32_32x32x16_bf16 a[192:207], v[128:131], v[88:91], a[192:207]
    v_mfma_f32_32x32x16_bf16 a[208:223], v[132:135], v[88:91], a[208:223]
    v_mfma_f32_32x32x16_bf16 a[96:111], v[76:79], v[128:131], a[96:111]
    v_mfma_f32_32x32x16_bf16 a[112:127], v[76:79], v[132:135], a[112:127]
    v_mfma_f32_32x32x16_bf16 a[224:239], v[128:131], v[92:95], a[224:239]
    v_mfma_f32_32x32x16_bf16 a[240:255], v[132:135], v[92:95], a[240:255]
    s_waitcnt lgkmcnt(0)
    s_waitcnt vmcnt(9)
    s_waitcnt vmcnt(8)
    s_cmp_lg_u32 s40, 0
    s_cbranch_scc1 Lk12_ln_ok
    v_cmp_eq_u32 vcc, v57, v12
    v_cmp_eq_u32 s[90:91], v57, v13
    s_nop 3
    s_and_b64 vcc, vcc, s[90:91]
    v_cmp_eq_u32 s[90:91], v57, v14
    s_nop 3
    s_and_b64 vcc, vcc, s[90:91]
    v_cmp_eq_u32 s[90:91], v57, v15
    s_nop 3
    s_and_b64 vcc, vcc, s[90:91]
    s_and_b32 s43, vcc_lo, 0xff
    s_cmp_eq_u32 s43, 0xff
    s_cbranch_scc1 Lk12_ln_ok
    s_mov_b32 s45, 2097152
Lk12_ln_spin:
    s_add_u32 s92, s14, 68288512
    s_addc_u32 s93, s15, 0
    s_mov_b32 s94, 38912
    s_mov_b32 s95, 0x20000
    buffer_load_dwordx4 v[12:15], v47, s[92:95], 0 offen sc1
    s_waitcnt vmcnt(0)
    s_sub_u32 s45, s45, 1
    s_cbranch_scc1 Lk12_ln_ok
    v_cmp_eq_u32 vcc, v57, v12
    v_cmp_eq_u32 s[90:91], v57, v13
    s_nop 3
    s_and_b64 vcc, vcc, s[90:91]
    v_cmp_eq_u32 s[90:91], v57, v14
    s_nop 3
    s_and_b64 vcc, vcc, s[90:91]
    v_cmp_eq_u32 s[90:91], v57, v15
    s_nop 3
    s_and_b64 vcc, vcc, s[90:91]
    s_and_b32 s43, vcc_lo, 0xff
    s_cmp_eq_u32 s43, 0xff
    s_cbranch_scc0 Lk12_ln_spin
Lk12_ln_ok:
    s_barrier
    v_mfma_f32_32x32x16_bf16 a[0:15], v[96:99], v[136:139], a[0:15]
    ds_read_b128 v[128:131], v48 offset:32768
    ds_read_b128 v[132:135], v48 offset:36864
    s_add_u32 s43, s58, 0
    buffer_load_dwordx4 v[12:15], v3, s[16:19], s43 offen
    v_mfma_f32_32x32x16_bf16 a[16:31], v[96:99], v[140:143], a[16:31]
    ds_read_b64_tr_b16 v[64:65], v58 offset:0
    ds_read_b64_tr_b16 v[66:67], v58 offset:1024
    v_mfma_f32_32x32x16_bf16 a[128:143], v[136:139], v[112:115], a[128:143]
    ds_read_b64_tr_b16 v[80:81], v58 offset:16384
    ds_read_b64_tr_b16 v[82:83], v58 offset:17408
    s_add_u32 s43, s59, 0
    buffer_load_dwordx4 v[16:19], v3, s[16:19], s43 offen
    v_mfma_f32_32x32x16_bf16 a[144:159], v[140:143], v[112:115], a[144:159]
    ds_read_b64_tr_b16 v[68:69], v59 offset:0
    ds_read_b64_tr_b16 v[70:71], v59 offset:1024
    v_mfma_f32_32x32x16_bf16 a[32:47], v[100:103], v[136:139], a[32:47]
    ds_read_b64_tr_b16 v[84:85], v59 offset:16384
    ds_read_b64_tr_b16 v[86:87], v59 offset:17408
    s_add_u32 s43, s58, 1024
    buffer_load_dwordx4 v[20:23], v3, s[16:19], s43 offen
    v_mfma_f32_32x32x16_bf16 a[48:63], v[100:103], v[140:143], a[48:63]
    ds_read_b64_tr_b16 v[72:73], v60 offset:0
    ds_read_b64_tr_b16 v[74:75], v60 offset:1024
    v_mfma_f32_32x32x16_bf16 a[160:175], v[136:139], v[116:119], a[160:175]
    ds_read_b64_tr_b16 v[88:89], v60 offset:16384
    ds_read_b64_tr_b16 v[90:91], v60 offset:17408
    s_add_u32 s43, s59, 1024
    buffer_load_dwordx4 v[24:27], v3, s[16:19], s43 offen
    v_mfma_f32_32x32x16_bf16 a[176:191], v[140:143], v[116:119], a[176:191]
    ds_read_b64_tr_b16 v[76:77], v61 offset:0
    ds_read_b64_tr_b16 v[78:79], v61 offset:1024
    v_mfma_f32_32x32x16_bf16 a[64:79], v[104:107], v[136:139], a[64:79]
    ds_read_b64_tr_b16 v[92:93], v61 offset:16384
    ds_read_b64_tr_b16 v[94:95], v61 offset:17408
    s_add_u32 s43, s58, 2048
    buffer_load_dwordx4 v[28:31], v3, s[16:19], s43 offen
    v_mfma_f32_32x32x16_bf16 a[80:95], v[104:107], v[140:143], a[80:95]
    v_mfma_f32_32x32x16_bf16 a[192:207], v[136:139], v[120:123], a[192:207]
    s_add_u32 s43, s59, 2048
    buffer_load_dwordx4 v[36:39], v3, s[16:19], s43 offen
    v_mfma_f32_32x32x16_bf16 a[208:223], v[140:143], v[120:123], a[208:223]
    v_mfma_f32_32x32x16_bf16 a[96:111], v[108:111], v[136:139], a[96:111]
    s_add_u32 m0, s51, 0
    s_add_u32 s43, s88, 1048576
    buffer_load_dwordx4 v4, s[20:23], s43 offen  lds
    v_mfma_f32_32x32x16_bf16 a[112:127], v[108:111], v[140:143], a[112:127]
    v_mfma_f32_32x32x16_bf16 a[224:239], v[136:139], v[124:127], a[224:239]
    s_add_u32 m0, s51, 1024
    s_add_u32 s43, s88, 1081344
    buffer_load_dwordx4 v4, s[20:23], s43 offen  lds
    v_mfma_f32_32x32x16_bf16 a[240:255], v[140:143], v[124:127], a[240:255]
    s_waitcnt lgkmcnt(0)
    v_mfma_f32_32x32x16_bf16 a[0:15], v[64:67], v[128:131], a[0:15]
    ds_read_b128 v[136:139], v49 offset:32768
    ds_read_b128 v[140:143], v49 offset:36864
    s_add_u32 m0, s51, 2048
    s_add_u32 s43, s88, 1114112
    buffer_load_dwordx4 v4, s[20:23], s43 offen  lds
    v_mfma_f32_32x32x16_bf16 a[16:31], v[64:67], v[132:135], a[16:31]
    ds_read_b64_tr_b16 v[96:97], v58 offset:4096
    ds_read_b64_tr_b16 v[98:99], v58 offset:5120
    v_mfma_f32_32x32x16_bf16 a[128:143], v[128:131], v[80:83], a[128:143]
    ds_read_b64_tr_b16 v[112:113], v58 offset:20480
    ds_read_b64_tr_b16 v[114:115], v58 offset:21504
    s_add_u32 m0, s51, 3072
    s_add_u32 s43, s88, 1146880
    buffer_load_dwordx4 v4, s[20:23], s43 offen  lds
    v_mfma_f32_32x32x16_bf16 a[144:159], v[132:135], v[80:83], a[144:159]
    ds_read_b64_tr_b16 v[100:101], v59 offset:4096
    ds_read_b64_tr_b16 v[102:103], v59 offset:5120
    v_mfma_f32_32x32x16_bf16 a[32:47], v[68:71], v[128:131], a[32:47]
    ds_read_b64_tr_b16 v[116:117], v59 offset:20480
    ds_read_b64_tr_b16 v[118:119], v59 offset:21504
    s_add_u32 m0, s51, 16384
    s_add_u32 s43, s88, 1572864
    buffer_load_dwordx4 v4, s[20:23], s43 offen  lds
    v_mfma_f32_32x32x16_bf16 a[48:63], v[68:71], v[132:135], a[48:63]
    ds_read_b64_tr_b16 v[104:105], v60 offset:4096
    ds_read_b64_tr_b16 v[106:107], v60 offset:5120
    v_mfma_f32_32x32x16_bf16 a[160:175], v[128:131], v[84:87], a[160:175]
    ds_read_b64_tr_b16 v[120:121], v60 offset:20480
    ds_read_b64_tr_b16 v[122:123], v60 offset:21504
    s_add_u32 m0, s51, 17408
    s_add_u32 s43, s88, 1605632
    buffer_load_dwordx4 v4, s[20:23], s43 offen  lds
    v_mfma_f32_32x32x16_bf16 a[176:191], v[132:135], v[84:87], a[176:191]
    ds_read_b64_tr_b16 v[108:109], v61 offset:4096
    ds_read_b64_tr_b16 v[110:111], v61 offset:5120
    v_mfma_f32_32x32x16_bf16 a[64:79], v[72:75], v[128:131], a[64:79]
    ds_read_b64_tr_b16 v[124:125], v61 offset:20480
    ds_read_b64_tr_b16 v[126:127], v61 offset:21504
    s_add_u32 m0, s51, 18432
    s_add_u32 s43, s88, 1638400
    buffer_load_dwordx4 v4, s[20:23], s43 offen  lds
    v_mfma_f32_32x32x16_bf16 a[80:95], v[72:75], v[132:135], a[80:95]
    v_mfma_f32_32x32x16_bf16 a[192:207], v[128:131], v[88:91], a[192:207]
    s_add_u32 m0, s51, 19456
    s_add_u32 s43, s88, 1671168
    buffer_load_dwordx4 v4, s[20:23], s43 offen  lds
    v_mfma_f32_32x32x16_bf16 a[208:223], v[132:135], v[88:91], a[208:223]
    v_mfma_f32_32x32x16_bf16 a[96:111], v[76:79], v[128:131], a[96:111]
    s_add_u32 m0, s51, 98304
    s_add_u32 s43, s88, 2097152
    buffer_load_dwordx4 v4, s[20:23], s43 offen  lds
    v_mfma_f32_32x32x16_bf16 a[112:127], v[76:79], v[132:135], a[112:127]
    v_mfma_f32_32x32x16_bf16 a[224:239], v[128:131], v[92:95], a[224:239]
    s_add_u32 m0, s51, 99328
    s_add_u32 s43, s88, 2129920
    buffer_load_dwordx4 v4, s[20:23], s43 offen  lds
    v_mfma_f32_32x32x16_bf16 a[240:255], v[132:135], v[92:95], a[240:255]
    s_waitcnt lgkmcnt(0)
    v_mfma_f32_32x32x16_bf16 a[0:15], v[96:99], v[136:139], a[0:15]
    ds_read_b128 v[128:131], v50 offset:32768
    ds_read_b128 v[132:135], v50 offset:36864
    s_add_u32 m0, s51, 100352
    s_add_u32 s43, s88, 2162688
    buffer_load_dwordx4 v4, s[20:23], s43 offen  lds
    v_mfma_f32_32x32x16_bf16 a[16:31], v[96:99], v[140:143], a[16:31]
    ds_read_b64_tr_b16 v[64:65], v58 offset:8192
    ds_read_b64_tr_b16 v[66:67], v58 offset:9216
    v_mfma_f32_32x32x16_bf16 a[128:143], v[136:139], v[112:115], a[128:143]
    ds_read_b64_tr_b16 v[80:81], v58 offset:24576
    ds_read_b64_tr_b16 v[82:83], v58 offset:25600
    s_add_u32 m0, s51, 101376
    s_add_u32 s43, s88, 2195456
    buffer_load_dwordx4 v4, s[20:23], s43 offen  lds
    v_mfma_f32_32x32x16_bf16 a[144:159], v[140:143], v[112:115], a[144:159]
    ds_read_b64_tr_b16 v[68:69], v59 offset:8192
    ds_read_b64_tr_b16 v[70:71], v59 offset:9216
    v_mfma_f32_32x32x16_bf16 a[32:47], v[100:103], v[136:139], a[32:47]
    ds_read_b64_tr_b16 v[84:85], v59 offset:24576
    ds_read_b64_tr_b16 v[86:87], v59 offset:25600
    s_add_u32 m0, s51, 114688
    s_add_u32 s43, s88, 2621440
    buffer_load_dwordx4 v4, s[20:23], s43 offen  lds
    v_mfma_f32_32x32x16_bf16 a[48:63], v[100:103], v[140:143], a[48:63]
    ds_read_b64_tr_b16 v[72:73], v60 offset:8192
    ds_read_b64_tr_b16 v[74:75], v60 offset:9216
    v_mfma_f32_32x32x16_bf16 a[160:175], v[136:139], v[116:119], a[160:175]
    ds_read_b64_tr_b16 v[88:89], v60 offset:24576
    ds_read_b64_tr_b16 v[90:91], v60 offset:25600
    s_add_u32 m0, s51, 115712
    s_add_u32 s43, s88, 2654208
    buffer_load_dwordx4 v4, s[20:23], s43 offen  lds
    v_mfma_f32_32x32x16_bf16 a[176:191], v[140:143], v[116:119], a[176:191]
    ds_read_b64_tr_b16 v[76:77], v61 offset:8192
    ds_read_b64_tr_b16 v[78:79], v61 offset:9216
    v_mfma_f32_32x32x16_bf16 a[64:79], v[104:107], v[136:139], a[64:79]
    ds_read_b64_tr_b16 v[92:93], v61 offset:24576
    ds_read_b64_tr_b16 v[94:95], v61 offset:25600
    s_add_u32 m0, s51, 116736
    s_add_u32 s43, s88, 2686976
    buffer_load_dwordx4 v4, s[20:23], s43 offen  lds
    v_mfma_f32_32x32x16_bf16 a[80:95], v[104:107], v[140:143], a[80:95]
    v_mfma_f32_32x32x16_bf16 a[192:207], v[136:139], v[120:123], a[192:207]
    s_add_u32 m0, s51, 117760
    s_add_u32 s43, s88, 2719744
    buffer_load_dwordx4 v4, s[20:23], s43 offen  lds
    v_mfma_f32_32x32x16_bf16 a[208:223], v[140:143], v[120:123], a[208:223]
    v_mfma_f32_32x32x16_bf16 a[96:111], v[108:111], v[136:139], a[96:111]
    v_mfma_f32_32x32x16_bf16 a[112:127], v[108:111], v[140:143], a[112:127]
    v_mfma_f32_32x32x16_bf16 a[224:239], v[136:139], v[124:127], a[224:239]
    v_mfma_f32_32x32x16_bf16 a[240:255], v[140:143], v[124:127], a[240:255]
    s_waitcnt lgkmcnt(0)
    v_mfma_f32_32x32x16_bf16 a[0:15], v[64:67], v[128:131], a[0:15]
    ds_read_b128 v[136:139], v51 offset:32768
    ds_read_b128 v[140:143], v51 offset:36864
    v_mfma_f32_32x32x16_bf16 a[16:31], v[64:67], v[132:135], a[16:31]
    ds_read_b64_tr_b16 v[96:97], v58 offset:12288
    ds_read_b64_tr_b16 v[98:99], v58 offset:13312
    v_mfma_f32_32x32x16_bf16 a[128:143], v[128:131], v[80:83], a[128:143]
    ds_read_b64_tr_b16 v[112:113], v58 offset:28672
    ds_read_b64_tr_b16 v[114:115], v58 offset:29696
    v_mfma_f32_32x32x16_bf16 a[144:159], v[132:135], v[80:83], a[144:159]
    ds_read_b64_tr_b16 v[100:101], v59 offset:12288
    ds_read_b64_tr_b16 v[102:103], v59 offset:13312
    v_mfma_f32_32x32x16_bf16 a[32:47], v[68:71], v[128:131], a[32:47]
    ds_read_b64_tr_b16 v[116:117], v59 offset:28672
    ds_read_b64_tr_b16 v[118:119], v59 offset:29696
    v_mfma_f32_32x32x16_bf16 a[48:63], v[68:71], v[132:135], a[48:63]
    ds_read_b64_tr_b16 v[104:105], v60 offset:12288
    ds_read_b64_tr_b16 v[106:107], v60 offset:13312
    v_mfma_f32_32x32x16_bf16 a[160:175], v[128:131], v[84:87], a[160:175]
    ds_read_b64_tr_b16 v[120:121], v60 offset:28672
    ds_read_b64_tr_b16 v[122:123], v60 offset:29696
    v_mfma_f32_32x32x16_bf16 a[176:191], v[132:135], v[84:87], a[176:191]
    ds_read_b64_tr_b16 v[108:109], v61 offset:12288
    ds_read_b64_tr_b16 v[110:111], v61 offset:13312
    v_mfma_f32_32x32x16_bf16 a[64:79], v[72:75], v[128:131], a[64:79]
    ds_read_b64_tr_b16 v[124:125], v61 offset:28672
    ds_read_b64_tr_b16 v[126:127], v61 offset:29696
    v_mfma_f32_32x32x16_bf16 a[80:95], v[72:75], v[132:135], a[80:95]
    v_mfma_f32_32x32x16_bf16 a[192:207], v[128:131], v[88:91], a[192:207]
    v_mfma_f32_32x32x16_bf16 a[208:223], v[132:135], v[88:91], a[208:223]
    v_mfma_f32_32x32x16_bf16 a[96:111], v[76:79], v[128:131], a[96:111]
    v_mfma_f32_32x32x16_bf16 a[112:127], v[76:79], v[132:135], a[112:127]
    v_mfma_f32_32x32x16_bf16 a[224:239], v[128:131], v[92:95], a[224:239]
    v_mfma_f32_32x32x16_bf16 a[240:255], v[132:135], v[92:95], a[240:255]
    s_waitcnt lgkmcnt(0)
    v_mfma_f32_32x32x16_bf16 a[0:15], v[96:99], v[136:139], a[0:15]
    v_mfma_f32_32x32x16_bf16 a[16:31], v[96:99], v[140:143], a[16:31]
    v_mfma_f32_32x32x16_bf16 a[128:143], v[136:139], v[112:115], a[128:143]
    v_mfma_f32_32x32x16_bf16 a[144:159], v[140:143], v[112:115], a[144:159]
    v_mfma_f32_32x32x16_bf16 a[32:47], v[100:103], v[136:139], a[32:47]
    v_mfma_f32_32x32x16_bf16 a[48:63], v[100:103], v[140:143], a[48:63]
    v_mfma_f32_32x32x16_bf16 a[160:175], v[136:139], v[116:119], a[160:175]
    v_mfma_f32_32x32x16_bf16 a[176:191], v[140:143], v[116:119], a[176:191]
    v_mfma_f32_32x32x16_bf16 a[64:79], v[104:107], v[136:139], a[64:79]
    v_mfma_f32_32x32x16_bf16 a[80:95], v[104:107], v[140:143], a[80:95]
    v_mfma_f32_32x32x16_bf16 a[192:207], v[136:139], v[120:123], a[192:207]
    v_mfma_f32_32x32x16_bf16 a[208:223], v[140:143], v[120:123], a[208:223]
    v_mfma_f32_32x32x16_bf16 a[96:111], v[108:111], v[136:139], a[96:111]
    v_mfma_f32_32x32x16_bf16 a[112:127], v[108:111], v[140:143], a[112:127]
    v_mfma_f32_32x32x16_bf16 a[224:239], v[136:139], v[124:127], a[224:239]
    v_mfma_f32_32x32x16_bf16 a[240:255], v[140:143], v[124:127], a[240:255]
    s_barrier
    s_lshl_b32 s43, s41, 20
    s_add_u32 s43, s43, 4194304
    s_add_u32 s24, s14, s43
    s_addc_u32 s25, s15, 0
    s_lshl_b32 s43, s42, 16
    s_sub_u32 s26, 1048576, s43
    s_mov_b32 s27, 0x20000
    s_add_u32 s28, s14, 41943040
    s_addc_u32 s29, s15, 0
    s_mov_b32 s30, 16777216
    s_mov_b32 s31, 0x20000
    s_waitcnt vmcnt(26)
    s_barrier
    ds_read_b64_tr_b16 v[64:65], v32 offset:0
    ds_read_b64_tr_b16 v[66:67], v32 offset:1024
    ds_read_b64_tr_b16 v[68:69], v33 offset:0
    ds_read_b64_tr_b16 v[70:71], v33 offset:1024
    ds_read_b64_tr_b16 v[72:73], v34 offset:0
    ds_read_b64_tr_b16 v[74:75], v34 offset:1024
    ds_read_b64_tr_b16 v[76:77], v35 offset:0
    ds_read_b64_tr_b16 v[78:79], v35 offset:1024
    s_waitcnt vmcnt(20)
    s_waitcnt lgkmcnt(6)
    v_mfma_f32_32x32x16_bf16 v[128:143], v[64:67], v[12:15], 0
    ds_read_b64_tr_b16 v[80:81], v32 offset:4096
    s_add_u32 m0, s51, 32768
    s_add_u32 s43, s88, 3145728
    buffer_load_dwordx4 v4, s[20:23], s43 offen  lds
    v_accvgpr_read_b32 v52, a0
    v_accvgpr_read_b32 v53, a1
    v_cvt_pk_bf16_f32 v96, v52, v53
    v_mfma_f32_32x32x16_bf16 v[192:207], v[64:67], v[16:19], 0
    ds_read_b64_tr_b16 v[82:83], v32 offset:5120
    s_add_u32 m0, s51, 33792
    s_add_u32 s43, s88, 3178496
    buffer_load_dwordx4 v4, s[20:23], s43 offen  lds
    v_accvgpr_read_b32 v62, a2
    v_accvgpr_read_b32 v63, a3
    v_cvt_pk_bf16_f32 v97, v62, v63
    s_waitcnt lgkmcnt(6)
    v_mfma_f32_32x32x16_bf16 v[144:159], v[68:71], v[12:15], 0
    ds_read_b64_tr_b16 v[84:85], v33 offset:4096
    s_add_u32 m0, s51, 34816
    s_add_u32 s43, s88, 3211264
    buffer_load_dwordx4 v4, s[20:23], s43 offen  lds
    v_accvgpr_read_b32 v52, a4
    v_accvgpr_read_b32 v53, a5
    v_cvt_pk_bf16_f32 v98, v52, v53
    v_mfma_f32_32x32x16_bf16 v[208:223], v[68:71], v[16:19], 0
    ds_read_b64_tr_b16 v[86:87], v33 offset:5120
    s_add_u32 m0, s51, 35840
    s_add_u32 s43, s88, 3244032
    buffer_load_dwordx4 v4, s[20:23], s43 offen  lds
    v_accvgpr_read_b32 v62, a6
    v_accvgpr_read_b32 v63, a7
    v_cvt_pk_bf16_f32 v99, v62, v63
    s_waitcnt lgkmcnt(4)
    v_mfma_f32_32x32x16_bf16 v[160:175], v[72:75], v[12:15], 0
    ds_read_b64_tr_b16 v[88:89], v34 offset:4096
    s_add_u32 s43, s58, 3072
    buffer_load_dwordx4 a[0:3], v3, s[16:19], s43 offen
    s_add_u32 s43, s59, 3072
    buffer_load_dwordx4 a[4:7], v3, s[16:19], s43 offen
    v_accvgpr_read_b32 v52, a8
    v_accvgpr_read_b32 v53, a9
    v_cvt_pk_bf16_f32 v100, v52, v53
    v_mfma_f32_32x32x16_bf16 v[224:239], v[72:75], v[16:19], 0
    ds_read_b64_tr_b16 v[90:91], v34 offset:5120
    s_add_u32 s53, s52, 0
    buffer_store_dwordx4 v[96:99], v3, s[32:35], s53 offen sc1
    v_accvgpr_read_b32 v62, a10
    v_accvgpr_read_b32 v63, a11
    v_cvt_pk_bf16_f32 v101, v62, v63
    v_mfma_f32_32x32x16_bf16 v[176:191], v[76:79], v[12:15], 0
    ds_read_b64_tr_b16 v[92:93], v35 offset:4096
    s_add_u32 m0, s51, 49152
    s_add_u32 s43, s88, 3670016
    buffer_load_dwordx4 v4, s[20:23], s43 offen  lds
    v_accvgpr_read_b32 v52, a12
    v_accvgpr_read_b32 v53, a13
    v_cvt_pk_bf16_f32 v102, v52, v53
    v_mfma_f32_32x32x16_bf16 v[240:255], v[76:79], v[16:19], 0
    ds_read_b64_tr_b16 v[94:95], v35 offset:5120
    s_add_u32 m0, s51, 50176
    s_add_u32 s43, s88, 3702784
    buffer_load_dwordx4 v4, s[20:23], s43 offen  lds
    v_accvgpr_read_b32 v62, a14
    v_accvgpr_read_b32 v63, a15
    v_cvt_pk_bf16_f32 v103, v62, v63
    s_waitcnt vmcnt(27)
    s_waitcnt lgkmcnt(4)
    v_mfma_f32_32x32x16_bf16 v[128:143], v[80:83], v[20:23], v[128:143]
    ds_read_b64_tr_b16 v[64:65], v32 offset:8192
    s_add_u32 s43, s58, 4096
    buffer_load_dwordx4 a[8:11], v3, s[16:19], s43 offen
    s_add_u32 s43, s59, 4096
    buffer_load_dwordx4 a[12:15], v3, s[16:19], s43 offen
    v_accvgpr_read_b32 v52, a16
    v_accvgpr_read_b32 v53, a17
    v_cvt_pk_bf16_f32 v104, v52, v53
    v_mfma_f32_32x32x16_bf16 v[192:207], v[80:83], v[24:27], v[192:207]
    ds_read_b64_tr_b16 v[66:67], v32 offset:9216
    s_add_u32 m0, s51, 51200
    s_add_u32 s43, s88, 3735552
    buffer_load_dwordx4 v4, s[20:23], s43 offen  lds
    v_accvgpr_read_b32 v62, a18
    v_accvgpr_read_b32 v63, a19
    v_cvt_pk_bf16_f32 v105, v62, v63
    v_mfma_f32_32x32x16_bf16 v[144:159], v[84:87], v[20:23], v[144:159]
    ds_read_b64_tr_b16 v[68:69], v33 offset:8192
    s_add_u32 m0, s51, 52224
    s_add_u32 s43, s88, 3768320
    buffer_load_dwordx4 v4, s[20:23], s43 offen  lds
    v_accvgpr_read_b32 v52, a20
    v_accvgpr_read_b32 v53, a21
    v_cvt_pk_bf16_f32 v106, v52, v53
    v_mfma_f32_32x32x16_bf16 v[208:223], v[84:87], v[24:27], v[208:223]
    ds_read_b64_tr_b16 v[70:71], v33 offset:9216
    s_add_u32 m0, s51, 131072
    s_add_u32 s43, s88, 4194304
    buffer_load_dwordx4 v4, s[20:23], s43 offen  lds
    v_accvgpr_read_b32 v62, a22
    v_accvgpr_read_b32 v63, a23
    v_cvt_pk_bf16_f32 v107, v62, v63
    s_waitcnt lgkmcnt(4)
    v_mfma_f32_32x32x16_bf16 v[160:175], v[88:91], v[20:23], v[160:175]
    ds_read_b64_tr_b16 v[72:73], v34 offset:8192
    s_add_u32 s43, s58, 5120
    buffer_load_dwordx4 a[16:19], v3, s[16:19], s43 offen
    s_add_u32 s43, s59, 5120
    buffer_load_dwordx4 a[20:23], v3, s[16:19], s43 offen
    v_accvgpr_read_b32 v52, a24
    v_accvgpr_read_b32 v53, a25
    v_cvt_pk_bf16_f32 v108, v52, v53
    v_mfma_f32_32x32x16_bf16 v[224:239], v[88:91], v[24:27], v[224:239]
    ds_read_b64_tr_b16 v[74:75], v34 offset:9216
    s_add_u32 m0, s51, 132096
    s_add_u32 s43, s88, 4227072
    buffer_load_dwordx4 v4, s[20:23], s43 offen  lds
    v_accvgpr_read_b32 v62, a26
    v_accvgpr_read_b32 v63, a27
    v_cvt_pk_bf16_f32 v109, v62, v63
    v_mfma_f32_32x32x16_bf16 v[176:191], v[92:95], v[20:23], v[176:191]
    ds_read_b64_tr_b16 v[76:77], v35 offset:8192
    s_add_u32 m0, s51, 133120
    s_add_u32 s43, s88, 4259840
    buffer_load_dwordx4 v4, s[20:23], s43 offen  lds
    v_accvgpr_read_b32 v52, a28
    v_accvgpr_read_b32 v53, a29
    v_cvt_pk_bf16_f32 v110, v52, v53
    v_mfma_f32_32x32x16_bf16 v[240:255], v[92:95], v[24:27], v[240:255]
    ds_read_b64_tr_b16 v[78:79], v35 offset:9216
    s_add_u32 s53, s52, 1024
    buffer_store_dwordx4 v[100:103], v3, s[32:35], s53 offen sc1
    v_accvgpr_read_b32 v62, a30
    v_accvgpr_read_b32 v63, a31
    v_cvt_pk_bf16_f32 v111, v62, v63
    s_waitcnt vmcnt(41)
    s_barrier
    s_waitcnt vmcnt(35)
    s_waitcnt lgkmcnt(4)
    v_mfma_f32_32x32x16_bf16 v[128:143], v[64:67], v[28:31], v[128:143]
    ds_read_b64_tr_b16 v[80:81], v32 offset:12288
    s_add_u32 s43, s58, 6144
    buffer_load_dwordx4 a[24:27], v3, s[16:19], s43 offen
    s_add_u32 s43, s59, 6144
    buffer_load_dwordx4 a[28:31], v3, s[16:19], s43 offen
    v_accvgpr_read_b32 v52, a32
    v_accvgpr_read_b32 v53, a33
    v_cvt_pk_bf16_f32 v112, v52, v53
    v_mfma_f32_32x32x16_bf16 v[192:207], v[64:67], v[36:39], v[192:207]
    ds_read_b64_tr_b16 v[82:83], v32 offset:13312
    s_add_u32 m0, s51, 134144
    s_add_u32 s43, s88, 4292608
    buffer_load_dwordx4 v4, s[20:23], s43 offen  lds
    v_accvgpr_read_b32 v62, a34
    v_accvgpr_read_b32 v63, a35
    v_cvt_pk_bf16_f32 v113, v62, v63
    v_mfma_f32_32x32x16_bf16 v[144:159], v[68:71], v[28:31], v[144:159]
    ds_read_b64_tr_b16 v[84:85], v33 offset:12288
    s_add_u32 m0, s51, 147456
    s_add_u32 s43, s88, 4718592
    buffer_load_dwordx4 v4, s[20:23], s43 offen  lds
    v_accvgpr_read_b32 v52, a36
    v_accvgpr_read_b32 v53, a37
    v_cvt_pk_bf16_f32 v114, v52, v53
    v_mfma_f32_32x32x16_bf16 v[208:223], v[68:71], v[36:39], v[208:223]
    ds_read_b64_tr_b16 v[86:87], v33 offset:13312
    s_add_u32 m0, s51, 148480
    s_add_u32 s43, s88, 4751360
    buffer_load_dwordx4 v4, s[20:23], s43 offen  lds
    v_accvgpr_read_b32 v62, a38
    v_accvgpr_read_b32 v63, a39
    v_cvt_pk_bf16_f32 v115, v62, v63
    s_waitcnt lgkmcnt(4)
    v_mfma_f32_32x32x16_bf16 v[160:175], v[72:75], v[28:31], v[160:175]
    ds_read_b64_tr_b16 v[88:89], v34 offset:12288
    s_add_u32 s43, s58, 7168
    buffer_load_dwordx4 a[32:35], v3, s[16:19], s43 offen
    s_add_u32 s43, s59, 7168
    buffer_load_dwordx4 a[36:39], v3, s[16:19], s43 offen
    v_accvgpr_read_b32 v52, a40
    v_accvgpr_read_b32 v53, a41
    v_cvt_pk_bf16_f32 v116, v52, v53
    v_mfma_f32_32x32x16_bf16 v[224:239], v[72:75], v[36:39], v[224:239]
    ds_read_b64_tr_b16 v[90:91], v34 offset:13312
    s_add_u32 m0, s51, 149504
    s_add_u32 s43, s88, 4784128
    buffer_load_dwordx4 v4, s[20:23], s43 offen  lds
    v_accvgpr_read_b32 v62, a42
    v_accvgpr_read_b32 v63, a43
    v_cvt_pk_bf16_f32 v117, v62, v63
    v_mfma_f32_32x32x16_bf16 v[176:191], v[76:79], v[28:31], v[176:191]
    ds_read_b64_tr_b16 v[92:93], v35 offset:12288
    s_add_u32 m0, s51, 150528
    s_add_u32 s43, s88, 4816896
    buffer_load_dwordx4 v4, s[20:23], s43 offen  lds
    v_accvgpr_read_b32 v52, a44
    v_accvgpr_read_b32 v53, a45
    v_cvt_pk_bf16_f32 v118, v52, v53
    v_mfma_f32_32x32x16_bf16 v[240:255], v[76:79], v[36:39], v[240:255]
    ds_read_b64_tr_b16 v[94:95], v35 offset:13312
    v_accvgpr_read_b32 v62, a46
    v_accvgpr_read_b32 v63, a47
    v_cvt_pk_bf16_f32 v119, v62, v63
    s_waitcnt vmcnt(22)
    s_waitcnt lgkmcnt(4)
    v_mfma_f32_32x32x16_bf16 v[128:143], v[80:83], a[0:3], v[128:143]
    ds_read_b64_tr_b16 v[64:65], v32 offset:16384
    s_add_u32 s43, s58, 8192
    buffer_load_dwordx4 a[40:43], v3, s[16:19], s43 offen
    s_add_u32 s43, s59, 8192
    buffer_load_dwordx4 a[44:47], v3, s[16:19], s43 offen
    v_accvgpr_read_b32 v52, a48
    v_accvgpr_read_b32 v53, a49
    v_cvt_pk_bf16_f32 v120, v52, v53
    v_mfma_f32_32x32x16_bf16 v[192:207], v[80:83], a[4:7], v[192:207]
    ds_read_b64_tr_b16 v[66:67], v32 offset:17408
    s_add_u32 s53, s52, 16384
    buffer_store_dwordx4 v[104:107], v3, s[32:35], s53 offen sc1
    v_accvgpr_read_b32 v62, a50
    v_accvgpr_read_b32 v63, a51
    v_cvt_pk_bf16_f32 v121, v62, v63
    v_mfma_f32_32x32x16_bf16 v[144:159], v[84:87], a[0:3], v[144:159]
    ds_read_b64_tr_b16 v[68:69], v33 offset:16384
    v_accvgpr_read_b32 v52, a52
    v_accvgpr_read_b32 v53, a53
    v_cvt_pk_bf16_f32 v122, v52, v53
    v_mfma_f32_32x32x16_bf16 v[208:223], v[84:87], a[4:7], v[208:223]
    ds_read_b64_tr_b16 v[70:71], v33 offset:17408
    v_accvgpr_read_b32 v62, a54
    v_accvgpr_read_b32 v63, a55
    v_cvt_pk_bf16_f32 v123, v62, v63
    s_waitcnt lgkmcnt(4)
    v_mfma_f32_32x32x16_bf16 v[160:175], v[88:91], a[0:3], v[160:175]
    ds_read_b64_tr_b16 v[72:73], v34 offset:16384
    s_add_u32 s43, s58, 9216
    buffer_load_dwordx4 a[48:51], v3, s[16:19], s43 offen
    s_add_u32 s43, s59, 9216
    buffer_load_dwordx4 a[52:55], v3, s[16:19], s43 offen
    v_accvgpr_read_b32 v52, a56
    v_accvgpr_read_b32 v53, a57
    v_cvt_pk_bf16_f32 v124, v52, v53
    v_mfma_f32_32x32x16_bf16 v[224:239], v[88:91], a[4:7], v[224:239]
    ds_read_b64_tr_b16 v[74:75], v34 offset:17408
    v_accvgpr_read_b32 v62, a58
    v_accvgpr_read_b32 v63, a59
    v_cvt_pk_bf16_f32 v125, v62, v63
    v_mfma_f32_32x32x16_bf16 v[176:191], v[92:95], a[0:3], v[176:191]
    ds_read_b64_tr_b16 v[76:77], v35 offset:16384
    v_accvgpr_read_b32 v52, a60
    v_accvgpr_read_b32 v53, a61
    v_cvt_pk_bf16_f32 v126, v52, v53
    v_mfma_f32_32x32x16_bf16 v[240:255], v[92:95], a[4:7], v[240:255]
    ds_read_b64_tr_b16 v[78:79], v35 offset:17408
    v_accvgpr_read_b32 v62, a62
    v_accvgpr_read_b32 v63, a63
    v_cvt_pk_bf16_f32 v127, v62, v63
    s_waitcnt vmcnt(22)
    s_waitcnt lgkmcnt(4)
    v_mfma_f32_32x32x16_bf16 v[128:143], v[64:67], a[8:11], v[128:143]
    ds_read_b64_tr_b16 v[80:81], v32 offset:20480
    s_add_u32 s43, s58, 10240
    buffer_load_dwordx4 a[56:59], v3, s[16:19], s43 offen
    s_add_u32 s43, s59, 10240
    buffer_load_dwordx4 a[60:63], v3, s[16:19], s43 offen
    v_accvgpr_read_b32 v52, a64
    v_accvgpr_read_b32 v53, a65
    v_cvt_pk_bf16_f32 v96, v52, v53
    v_mfma_f32_32x32x16_bf16 v[192:207], v[64:67], a[12:15], v[192:207]
    ds_read_b64_tr_b16 v[82:83], v32 offset:21504
    v_accvgpr_read_b32 v62, a66
    v_accvgpr_read_b32 v63, a67
    v_cvt_pk_bf16_f32 v97, v62, v63
    v_mfma_f32_32x32x16_bf16 v[144:159], v[68:71], a[8:11], v[144:159]
    ds_read_b64_tr_b16 v[84:85], v33 offset:20480
    v_accvgpr_read_b32 v52, a68
    v_accvgpr_read_b32 v53, a69
    v_cvt_pk_bf16_f32 v98, v52, v53
    v_mfma_f32_32x32x16_bf16 v[208:223], v[68:71], a[12:15], v[208:223]
    ds_read_b64_tr_b16 v[86:87], v33 offset:21504
    s_add_u32 s53, s52, 17408
    buffer_store_dwordx4 v[108:111], v3, s[32:35], s53 offen sc1
    v_accvgpr_read_b32 v62, a70
    v_accvgpr_read_b32 v63, a71
    v_cvt_pk_bf16_f32 v99, v62, v63
    s_waitcnt lgkmcnt(4)
    v_mfma_f32_32x32x16_bf16 v[160:175], v[72:75], a[8:11], v[160:175]
    ds_read_b64_tr_b16 v[88:89], v34 offset:20480
    s_add_u32 s43, s58, 11264
    buffer_load_dwordx4 a[64:67], v3, s[16:19], s43 offen
    s_add_u32 s43, s59, 11264
    buffer_load_dwordx4 a[68:71], v3, s[16:19], s43 offen
    v_accvgpr_read_b32 v52, a72
    v_accvgpr_read_b32 v53, a73
    v_cvt_pk_bf16_f32 v100, v52, v53
    v_mfma_f32_32x32x16_bf16 v[224:239], v[72:75], a[12:15], v[224:239]
    ds_read_b64_tr_b16 v[90:91], v34 offset:21504
    v_accvgpr_read_b32 v62, a74
    v_accvgpr_read_b32 v63, a75
    v_cvt_pk_bf16_f32 v101, v62, v63
    v_mfma_f32_32x32x16_bf16 v[176:191], v[76:79], a[8:11], v[176:191]
    ds_read_b64_tr_b16 v[92:93], v35 offset:20480
    v_accvgpr_read_b32 v52, a76
    v_accvgpr_read_b32 v53, a77
    v_cvt_pk_bf16_f32 v102, v52, v53
    v_mfma_f32_32x32x16_bf16 v[240:255], v[76:79], a[12:15], v[240:255]
    ds_read_b64_tr_b16 v[94:95], v35 offset:21504
    v_accvgpr_read_b32 v62, a78
    v_accvgpr_read_b32 v63, a79
    v_cvt_pk_bf16_f32 v103, v62, v63
    s_waitcnt vmcnt(22)
    s_waitcnt lgkmcnt(4)
    v_mfma_f32_32x32x16_bf16 v[128:143], v[80:83], a[16:19], v[128:143]
    ds_read_b64_tr_b16 v[64:65], v32 offset:24576
    s_add_u32 s43, s58, 12288
    buffer_load_dwordx4 a[72:75], v3, s[16:19], s43 offen
    s_add_u32 s43, s59, 12288
    buffer_load_dwordx4 a[76:79], v3, s[16:19], s43 offen
    v_accvgpr_read_b32 v52, a80
    v_accvgpr_read_b32 v53, a81
    v_cvt_pk_bf16_f32 v104, v52, v53
    v_mfma_f32_32x32x16_bf16 v[192:207], v[80:83], a[20:23], v[192:207]
    ds_read_b64_tr_b16 v[66:67], v32 offset:25600
    v_accvgpr_read_b32 v62, a82
    v_accvgpr_read_b32 v63, a83
    v_cvt_pk_bf16_f32 v105, v62, v63
    v_mfma_f32_32x32x16_bf16 v[144:159], v[84:87], a[16:19], v[144:159]
    ds_read_b64_tr_b16 v[68:69], v33 offset:24576
    v_accvgpr_read_b32 v52, a84
    v_accvgpr_read_b32 v53, a85
    v_cvt_pk_bf16_f32 v106, v52, v53
    v_mfma_f32_32x32x16_bf16 v[208:223], v[84:87], a[20:23], v[208:223]
    ds_read_b64_tr_b16 v[70:71], v33 offset:25600
    v_accvgpr_read_b32 v62, a86
    v_accvgpr_read_b32 v63, a87
    v_cvt_pk_bf16_f32 v107, v62, v63
    s_waitcnt lgkmcnt(4)
    v_mfma_f32_32x32x16_bf16 v[160:175], v[88:91], a[16:19], v[160:175]
    ds_read_b64_tr_b16 v[72:73], v34 offset:24576
    s_add_u32 s43, s58, 13312
    buffer_load_dwordx4 a[80:83], v3, s[16:19], s43 offen
    s_add_u32 s43, s59, 13312
    buffer_load_dwordx4 a[84:87], v3, s[16:19], s43 offen
    v_accvgpr_read_b32 v52, a88
    v_accvgpr_read_b32 v53, a89
    v_cvt_pk_bf16_f32 v108, v52, v53
    v_mfma_f32_32x32x16_bf16 v[224:239], v[88:91], a[20:23], v[224:239]
    ds_read_b64_tr_b16 v[74:75], v34 offset:25600
    s_add_u32 s53, s52, 2048
    buffer_store_dwordx4 v[112:115], v3, s[32:35], s53 offen sc1
    v_accvgpr_read_b32 v62, a90
    v_accvgpr_read_b32 v63, a91
    v_cvt_pk_bf16_f32 v109, v62, v63
    v_mfma_f32_32x32x16_bf16 v[176:191], v[92:95], a[16:19], v[176:191]
    ds_read_b64_tr_b16 v[76:77], v35 offset:24576
    v_accvgpr_read_b32 v52, a92
    v_accvgpr_read_b32 v53, a93
    v_cvt_pk_bf16_f32 v110, v52, v53
    v_mfma_f32_32x32x16_bf16 v[240:255], v[92:95], a[20:23], v[240:255]
    ds_read_b64_tr_b16 v[78:79], v35 offset:25600
    v_accvgpr_read_b32 v62, a94
    v_accvgpr_read_b32 v63, a95
    v_cvt_pk_bf16_f32 v111, v62, v63
    s_waitcnt vmcnt(55)
    s_barrier
    s_waitcnt vmcnt(22)
    s_waitcnt lgkmcnt(4)
    v_mfma_f32_32x32x16_bf16 v[128:143], v[64:67], a[24:27], v[128:143]
    ds_read_b64_tr_b16 v[80:81], v32 offset:28672
    s_add_u32 s43, s58, 14336
    buffer_load_dwordx4 a[88:91], v3, s[16:19], s43 offen
    s_add_u32 s43, s59, 14336
    buffer_load_dwordx4 a[92:95], v3, s[16:19], s43 offen
    v_accvgpr_read_b32 v52, a96
    v_accvgpr_read_b32 v53, a97
    v_cvt_pk_bf16_f32 v112, v52, v53
    v_mfma_f32_32x32x16_bf16 v[192:207], v[64:67], a[28:31], v[192:207]
    ds_read_b64_tr_b16 v[82:83], v32 offset:29696
    v_accvgpr_read_b32 v62, a98
    v_accvgpr_read_b32 v63, a99
    v_cvt_pk_bf16_f32 v113, v62, v63
    v_mfma_f32_32x32x16_bf16 v[144:159], v[68:71], a[24:27], v[144:159]
    ds_read_b64_tr_b16 v[84:85], v33 offset:28672
    v_accvgpr_read_b32 v52, a100
    v_accvgpr_read_b32 v53, a101
    v_cvt_pk_bf16_f32 v114, v52, v53
    v_mfma_f32_32x32x16_bf16 v[208:223], v[68:71], a[28:31], v[208:223]
    ds_read_b64_tr_b16 v[86:87], v33 offset:29696
    v_accvgpr_read_b32 v62, a102
    v_accvgpr_read_b32 v63, a103
    v_cvt_pk_bf16_f32 v115, v62, v63
    s_waitcnt lgkmcnt(4)
    v_mfma_f32_32x32x16_bf16 v[160:175], v[72:75], a[24:27], v[160:175]
    ds_read_b64_tr_b16 v[88:89], v34 offset:28672
    s_add_u32 s43, s58, 15360
    buffer_load_dwordx4 a[96:99], v3, s[16:19], s43 offen
    s_add_u32 s43, s59, 15360
    buffer_load_dwordx4 a[100:103], v3, s[16:19], s43 offen
    v_mfma_f32_32x32x16_bf16 v[224:239], v[72:75], a[28:31], v[224:239]
    ds_read_b64_tr_b16 v[90:91], v34 offset:29696
    v_mfma_f32_32x32x16_bf16 v[176:191], v[76:79], a[24:27], v[176:191]
    ds_read_b64_tr_b16 v[92:93], v35 offset:28672
    v_mfma_f32_32x32x16_bf16 v[240:255], v[76:79], a[28:31], v[240:255]
    ds_read_b64_tr_b16 v[94:95], v35 offset:29696
    s_add_u32 s53, s52, 3072
    buffer_store_dwordx4 v[116:119], v3, s[32:35], s53 offen sc1
    v_accvgpr_read_b32 v52, a104
    v_accvgpr_read_b32 v53, a105
    v_cvt_pk_bf16_f32 v116, v52, v53
    s_waitcnt vmcnt(22)
    s_waitcnt lgkmcnt(4)
    v_mfma_f32_32x32x16_bf16 v[128:143], v[80:83], a[32:35], v[128:143]
    ds_read_b64_tr_b16 v[64:65], v6 offset:0
    v_accvgpr_read_b32 v62, a106
    v_accvgpr_read_b32 v63, a107
    v_cvt_pk_bf16_f32 v117, v62, v63
    v_mfma_f32_32x32x16_bf16 v[192:207], v[80:83], a[36:39], v[192:207]
    ds_read_b64_tr_b16 v[66:67], v6 offset:1024
    v_accvgpr_read_b32 v52, a108
    v_accvgpr_read_b32 v53, a109
    v_cvt_pk_bf16_f32 v118, v52, v53
    v_mfma_f32_32x32x16_bf16 v[144:159], v[84:87], a[32:35], v[144:159]
    ds_read_b64_tr_b16 v[68:69], v7 offset:0
    v_accvgpr_read_b32 v62, a110
    v_accvgpr_read_b32 v63, a111
    v_cvt_pk_bf16_f32 v119, v62, v63
    v_mfma_f32_32x32x16_bf16 v[208:223], v[84:87], a[36:39], v[208:223]
    ds_read_b64_tr_b16 v[70:71], v7 offset:1024
    s_add_u32 s43, s58, 16384
    buffer_load_dwordx4 a[104:107], v3, s[16:19], s43 offen
    s_add_u32 s43, s59, 16384
    buffer_load_dwordx4 a[108:111], v3, s[16:19], s43 offen
    s_waitcnt lgkmcnt(4)
    v_mfma_f32_32x32x16_bf16 v[160:175], v[88:91], a[32:35], v[160:175]
    ds_read_b64_tr_b16 v[72:73], v8 offset:0
    v_mfma_f32_32x32x16_bf16 v[224:239], v[88:91], a[36:39], v[224:239]
    ds_read_b64_tr_b16 v[74:75], v8 offset:1024
    v_mfma_f32_32x32x16_bf16 v[176:191], v[92:95], a[32:35], v[176:191]
    ds_read_b64_tr_b16 v[76:77], v9 offset:0
    v_mfma_f32_32x32x16_bf16 v[240:255], v[92:95], a[36:39], v[240:255]
    ds_read_b64_tr_b16 v[78:79], v9 offset:1024
    s_waitcnt vmcnt(20)
    s_waitcnt lgkmcnt(4)
    v_mfma_f32_32x32x16_bf16 v[128:143], v[64:67], a[40:43], v[128:143]
    ds_read_b64_tr_b16 v[80:81], v6 offset:4096
    v_mfma_f32_32x32x16_bf16 v[192:207], v[64:67], a[44:47], v[192:207]
    ds_read_b64_tr_b16 v[82:83], v6 offset:5120
    s_add_u32 s53, s52, 18432
    buffer_store_dwordx4 v[120:123], v3, s[32:35], s53 offen sc1
    v_accvgpr_read_b32 v52, a112
    v_accvgpr_read_b32 v53, a113
    v_cvt_pk_bf16_f32 v120, v52, v53
    v_mfma_f32_32x32x16_bf16 v[144:159], v[68:71], a[40:43], v[144:159]
    ds_read_b64_tr_b16 v[84:85], v7 offset:4096
    v_accvgpr_read_b32 v62, a114
    v_accvgpr_read_b32 v63, a115
    v_cvt_pk_bf16_f32 v121, v62, v63
    v_mfma_f32_32x32x16_bf16 v[208:223], v[68:71], a[44:47], v[208:223]
    ds_read_b64_tr_b16 v[86:87], v7 offset:5120
    v_accvgpr_read_b32 v52, a116
    v_accvgpr_read_b32 v53, a117
    v_cvt_pk_bf16_f32 v122, v52, v53
    s_waitcnt lgkmcnt(4)
    v_mfma_f32_32x32x16_bf16 v[160:175], v[72:75], a[40:43], v[160:175]
    ds_read_b64_tr_b16 v[88:89], v8 offset:4096
    v_accvgpr_read_b32 v62, a118
    v_accvgpr_read_b32 v63, a119
    v_cvt_pk_bf16_f32 v123, v62, v63
    v_mfma_f32_32x32x16_bf16 v[224:239], v[72:75], a[44:47], v[224:239]
    ds_read_b64_tr_b16 v[90:91], v8 offset:5120
    s_add_u32 s43, s58, 17408
    buffer_load_dwordx4 a[112:115], v3, s[16:19], s43 offen
    s_add_u32 s43, s59, 17408
    buffer_load_dwordx4 a[116:119], v3, s[16:19], s43 offen
    v_mfma_f32_32x32x16_bf16 v[176:191], v[76:79], a[40:43], v[176:191]
    ds_read_b64_tr_b16 v[92:93], v9 offset:4096
    v_mfma_f32_32x32x16_bf16 v[240:255], v[76:79], a[44:47], v[240:255]
    ds_read_b64_tr_b16 v[94:95], v9 offset:5120
    s_waitcnt vmcnt(20)
    s_waitcnt lgkmcnt(4)
    v_mfma_f32_32x32x16_bf16 v[128:143], v[80:83], a[48:51], v[128:143]
    ds_read_b64_tr_b16 v[64:65], v6 offset:8192
    v_mfma_f32_32x32x16_bf16 v[192:207], v[80:83], a[52:55], v[192:207]
    ds_read_b64_tr_b16 v[66:67], v6 offset:9216
    v_mfma_f32_32x32x16_bf16 v[144:159], v[84:87], a[48:51], v[144:159]
    ds_read_b64_tr_b16 v[68:69], v7 offset:8192
    v_mfma_f32_32x32x16_bf16 v[208:223], v[84:87], a[52:55], v[208:223]
    ds_read_b64_tr_b16 v[70:71], v7 offset:9216
    s_add_u32 s53, s52, 19456
    buffer_store_dwordx4 v[124:127], v3, s[32:35], s53 offen sc1
    v_accvgpr_read_b32 v52, a120
    v_accvgpr_read_b32 v53, a121
    v_cvt_pk_bf16_f32 v124, v52, v53
    s_waitcnt lgkmcnt(4)
    v_mfma_f32_32x32x16_bf16 v[160:175], v[88:91], a[48:51], v[160:175]
    ds_read_b64_tr_b16 v[72:73], v8 offset:8192
    v_accvgpr_read_b32 v62, a122
    v_accvgpr_read_b32 v63, a123
    v_cvt_pk_bf16_f32 v125, v62, v63
    v_mfma_f32_32x32x16_bf16 v[224:239], v[88:91], a[52:55], v[224:239]
    ds_read_b64_tr_b16 v[74:75], v8 offset:9216
    v_accvgpr_read_b32 v52, a124
    v_accvgpr_read_b32 v53, a125
    v_cvt_pk_bf16_f32 v126, v52, v53
    v_mfma_f32_32x32x16_bf16 v[176:191], v[92:95], a[48:51], v[176:191]
    ds_read_b64_tr_b16 v[76:77], v9 offset:8192
    v_accvgpr_read_b32 v62, a126
    v_accvgpr_read_b32 v63, a127
    v_cvt_pk_bf16_f32 v127, v62, v63
    v_mfma_f32_32x32x16_bf16 v[240:255], v[92:95], a[52:55], v[240:255]
    ds_read_b64_tr_b16 v[78:79], v9 offset:9216
    s_add_u32 s43, s58, 18432
    buffer_load_dwordx4 a[120:123], v3, s[16:19], s43 offen
    s_add_u32 s43, s59, 18432
    buffer_load_dwordx4 a[124:127], v3, s[16:19], s43 offen
    s_waitcnt vmcnt(63)
    s_barrier
    s_waitcnt vmcnt(21)
    s_waitcnt lgkmcnt(4)
    v_mfma_f32_32x32x16_bf16 v[128:143], v[64:67], a[56:59], v[128:143]
    ds_read_b64_tr_b16 v[80:81], v6 offset:12288
    v_mfma_f32_32x32x16_bf16 v[192:207], v[64:67], a[60:63], v[192:207]
    ds_read_b64_tr_b16 v[82:83], v6 offset:13312
    v_mfma_f32_32x32x16_bf16 v[144:159], v[68:71], a[56:59], v[144:159]
    ds_read_b64_tr_b16 v[84:85], v7 offset:12288
    v_mfma_f32_32x32x16_bf16 v[208:223], v[68:71], a[60:63], v[208:223]
    ds_read_b64_tr_b16 v[86:87], v7 offset:13312
    s_waitcnt lgkmcnt(4)
    v_mfma_f32_32x32x16_bf16 v[160:175], v[72:75], a[56:59], v[160:175]
    ds_read_b64_tr_b16 v[88:89], v8 offset:12288
    v_mfma_f32_32x32x16_bf16 v[224:239], v[72:75], a[60:63], v[224:239]
    ds_read_b64_tr_b16 v[90:91], v8 offset:13312
    s_add_u32 s53, s52, 4096
    buffer_store_dwordx4 v[96:99], v3, s[32:35], s53 offen sc1
    v_accvgpr_read_b32 v52, a128
    v_accvgpr_read_b32 v53, a129
    v_cvt_pk_bf16_f32 v96, v52, v53
    v_mfma_f32_32x32x16_bf16 v[176:191], v[76:79], a[56:59], v[176:191]
    ds_read_b64_tr_b16 v[92:93], v9 offset:12288
    v_accvgpr_read_b32 v62, a130
    v_accvgpr_read_b32 v63, a131
    v_cvt_pk_bf16_f32 v97, v62, v63
    v_mfma_f32_32x32x16_bf16 v[240:255], v[76:79], a[60:63], v[240:255]
    ds_read_b64_tr_b16 v[94:95], v9 offset:13312
    v_accvgpr_read_b32 v52, a132
    v_accvgpr_read_b32 v53, a133
    v_cvt_pk_bf16_f32 v98, v52, v53
    s_waitcnt vmcnt(19)
    s_waitcnt lgkmcnt(4)
    v_mfma_f32_32x32x16_bf16 v[128:143], v[80:83], a[64:67], v[128:143]
    ds_read_b64_tr_b16 v[64:65], v6 offset:16384
    v_accvgpr_read_b32 v62, a134
    v_accvgpr_read_b32 v63, a135
    v_cvt_pk_bf16_f32 v99, v62, v63
    v_mfma_f32_32x32x16_bf16 v[192:207], v[80:83], a[68:71], v[192:207]
    ds_read_b64_tr_b16 v[66:67], v6 offset:17408
    s_add_u32 s43, s58, 19456
    buffer_load_dwordx4 a[128:131], v3, s[16:19], s43 offen
    s_add_u32 s43, s59, 19456
    buffer_load_dwordx4 a[132:135], v3, s[16:19], s43 offen
    v_mfma_f32_32x32x16_bf16 v[144:159], v[84:87], a[64:67], v[144:159]
    ds_read_b64_tr_b16 v[68:69], v7 offset:16384
    v_mfma_f32_32x32x16_bf16 v[208:223], v[84:87], a[68:71], v[208:223]
    ds_read_b64_tr_b16 v[70:71], v7 offset:17408
    s_waitcnt lgkmcnt(4)
    v_mfma_f32_32x32x16_bf16 v[160:175], v[88:91], a[64:67], v[160:175]
    ds_read_b64_tr_b16 v[72:73], v8 offset:16384
    v_mfma_f32_32x32x16_bf16 v[224:239], v[88:91], a[68:71], v[224:239]
    ds_read_b64_tr_b16 v[74:75], v8 offset:17408
    v_mfma_f32_32x32x16_bf16 v[176:191], v[92:95], a[64:67], v[176:191]
    ds_read_b64_tr_b16 v[76:77], v9 offset:16384
    v_mfma_f32_32x32x16_bf16 v[240:255], v[92:95], a[68:71], v[240:255]
    ds_read_b64_tr_b16 v[78:79], v9 offset:17408
    s_add_u32 s53, s52, 5120
    buffer_store_dwordx4 v[100:103], v3, s[32:35], s53 offen sc1
    v_accvgpr_read_b32 v52, a136
    v_accvgpr_read_b32 v53, a137
    v_cvt_pk_bf16_f32 v100, v52, v53
    s_waitcnt vmcnt(20)
    s_waitcnt lgkmcnt(4)
    v_mfma_f32_32x32x16_bf16 v[128:143], v[64:67], a[72:75], v[128:143]
    ds_read_b64_tr_b16 v[80:81], v6 offset:20480
    v_accvgpr_read_b32 v62, a138
    v_accvgpr_read_b32 v63, a139
    v_cvt_pk_bf16_f32 v101, v62, v63
    v_mfma_f32_32x32x16_bf16 v[192:207], v[64:67], a[76:79], v[192:207]
    ds_read_b64_tr_b16 v[82:83], v6 offset:21504
    v_accvgpr_read_b32 v52, a140
    v_accvgpr_read_b32 v53, a141
    v_cvt_pk_bf16_f32 v102, v52, v53
    v_mfma_f32_32x32x16_bf16 v[144:159], v[68:71], a[72:75], v[144:159]
    ds_read_b64_tr_b16 v[84:85], v7 offset:20480
    v_accvgpr_read_b32 v62, a142
    v_accvgpr_read_b32 v63, a143
    v_cvt_pk_bf16_f32 v103, v62, v63
    v_mfma_f32_32x32x16_bf16 v[208:223], v[68:71], a[76:79], v[208:223]
    ds_read_b64_tr_b16 v[86:87], v7 offset:21504
    s_add_u32 s43, s58, 20480
    buffer_load_dwordx4 a[136:139], v3, s[16:19], s43 offen
    s_add_u32 s43, s59, 20480
    buffer_load_dwordx4 a[140:143], v3, s[16:19], s43 offen
    s_waitcnt lgkmcnt(4)
    v_mfma_f32_32x32x16_bf16 v[160:175], v[72:75], a[72:75], v[160:175]
    ds_read_b64_tr_b16 v[88:89], v8 offset:20480
    v_mfma_f32_32x32x16_bf16 v[224:239], v[72:75], a[76:79], v[224:239]
    ds_read_b64_tr_b16 v[90:91], v8 offset:21504
    v_mfma_f32_32x32x16_bf16 v[176:191], v[76:79], a[72:75], v[176:191]
    ds_read_b64_tr_b16 v[92:93], v9 offset:20480
    v_mfma_f32_32x32x16_bf16 v[240:255], v[76:79], a[76:79], v[240:255]
    ds_read_b64_tr_b16 v[94:95], v9 offset:21504
    s_waitcnt vmcnt(20)
    s_waitcnt lgkmcnt(4)
    v_mfma_f32_32x32x16_bf16 v[128:143], v[80:83], a[80:83], v[128:143]
    ds_read_b64_tr_b16 v[64:65], v6 offset:24576
    v_mfma_f32_32x32x16_bf16 v[192:207], v[80:83], a[84:87], v[192:207]
    ds_read_b64_tr_b16 v[66:67], v6 offset:25600
    s_add_u32 s53, s52, 20480
    buffer_store_dwordx4 v[104:107], v3, s[32:35], s53 offen sc1
    v_accvgpr_read_b32 v52, a144
    v_accvgpr_read_b32 v53, a145
    v_cvt_pk_bf16_f32 v104, v52, v53
    v_mfma_f32_32x32x16_bf16 v[144:159], v[84:87], a[80:83], v[144:159]
    ds_read_b64_tr_b16 v[68:69], v7 offset:24576
    v_accvgpr_read_b32 v62, a146
    v_accvgpr_read_b32 v63, a147
    v_cvt_pk_bf16_f32 v105, v62, v63
    v_mfma_f32_32x32x16_bf16 v[208:223], v[84:87], a[84:87], v[208:223]
    ds_read_b64_tr_b16 v[70:71], v7 offset:25600
    v_accvgpr_read_b32 v52, a148
    v_accvgpr_read_b32 v53, a149
    v_cvt_pk_bf16_f32 v106, v52, v53
    s_waitcnt lgkmcnt(4)
    v_mfma_f32_32x32x16_bf16 v[160:175], v[88:91], a[80:83], v[160:175]
    ds_read_b64_tr_b16 v[72:73], v8 offset:24576
    v_accvgpr_read_b32 v62, a150
    v_accvgpr_read_b32 v63, a151
    v_cvt_pk_bf16_f32 v107, v62, v63
    v_mfma_f32_32x32x16_bf16 v[224:239], v[88:91], a[84:87], v[224:239]
    ds_read_b64_tr_b16 v[74:75], v8 offset:25600
    s_add_u32 s43, s58, 21504
    buffer_load_dwordx4 a[144:147], v3, s[16:19], s43 offen
    s_add_u32 s43, s59, 21504
    buffer_load_dwordx4 a[148:151], v3, s[16:19], s43 offen
    v_mfma_f32_32x32x16_bf16 v[176:191], v[92:95], a[80:83], v[176:191]
    ds_read_b64_tr_b16 v[76:77], v9 offset:24576
    v_mfma_f32_32x32x16_bf16 v[240:255], v[92:95], a[84:87], v[240:255]
    ds_read_b64_tr_b16 v[78:79], v9 offset:25600
    s_waitcnt vmcnt(63)
    s_barrier
    s_waitcnt vmcnt(20)
    s_waitcnt lgkmcnt(4)
    v_mfma_f32_32x32x16_bf16 v[128:143], v[64:67], a[88:91], v[128:143]
    ds_read_b64_tr_b16 v[80:81], v6 offset:28672
    v_mfma_f32_32x32x16_bf16 v[192:207], v[64:67], a[92:95], v[192:207]
    ds_read_b64_tr_b16 v[82:83], v6 offset:29696
    v_mfma_f32_32x32x16_bf16 v[144:159], v[68:71], a[88:91], v[144:159]
    ds_read_b64_tr_b16 v[84:85], v7 offset:28672
    v_mfma_f32_32x32x16_bf16 v[208:223], v[68:71], a[92:95], v[208:223]
    ds_read_b64_tr_b16 v[86:87], v7 offset:29696
    s_add_u32 s53, s52, 21504
    buffer_store_dwordx4 v[108:111], v3, s[32:35], s53 offen sc1
    v_accvgpr_read_b32 v52, a152
    v_accvgpr_read_b32 v53, a153
    v_cvt_pk_bf16_f32 v108, v52, v53
    s_waitcnt lgkmcnt(4)
    v_mfma_f32_32x32x16_bf16 v[160:175], v[72:75], a[88:91], v[160:175]
    ds_read_b64_tr_b16 v[88:89], v8 offset:28672
    v_accvgpr_read_b32 v62, a154
    v_accvgpr_read_b32 v63, a155
    v_cvt_pk_bf16_f32 v109, v62, v63
    v_mfma_f32_32x32x16_bf16 v[224:239], v[72:75], a[92:95], v[224:239]
    ds_read_b64_tr_b16 v[90:91], v8 offset:29696
    v_accvgpr_read_b32 v52, a156
    v_accvgpr_read_b32 v53, a157
    v_cvt_pk_bf16_f32 v110, v52, v53
    v_mfma_f32_32x32x16_bf16 v[176:191], v[76:79], a[88:91], v[176:191]
    ds_read_b64_tr_b16 v[92:93], v9 offset:28672
    v_accvgpr_read_b32 v62, a158
    v_accvgpr_read_b32 v63, a159
    v_cvt_pk_bf16_f32 v111, v62, v63
    v_mfma_f32_32x32x16_bf16 v[240:255], v[76:79], a[92:95], v[240:255]
    ds_read_b64_tr_b16 v[94:95], v9 offset:29696
    s_add_u32 s43, s58, 22528
    buffer_load_dwordx4 a[152:155], v3, s[16:19], s43 offen
    s_add_u32 s43, s59, 22528
    buffer_load_dwordx4 a[156:159], v3, s[16:19], s43 offen
    s_waitcnt vmcnt(21)
    s_waitcnt lgkmcnt(4)
    v_mfma_f32_32x32x16_bf16 v[128:143], v[80:83], a[96:99], v[128:143]
    ds_read_b64_tr_b16 v[64:65], v32 offset:32768
    v_mfma_f32_32x32x16_bf16 v[192:207], v[80:83], a[100:103], v[192:207]
    ds_read_b64_tr_b16 v[66:67], v32 offset:33792
    v_mfma_f32_32x32x16_bf16 v[144:159], v[84:87], a[96:99], v[144:159]
    ds_read_b64_tr_b16 v[68:69], v33 offset:32768
    v_mfma_f32_32x32x16_bf16 v[208:223], v[84:87], a[100:103], v[208:223]
    ds_read_b64_tr_b16 v[70:71], v33 offset:33792
    s_waitcnt lgkmcnt(4)
    v_mfma_f32_32x32x16_bf16 v[160:175], v[88:91], a[96:99], v[160:175]
    ds_read_b64_tr_b16 v[72:73], v34 offset:32768
    v_mfma_f32_32x32x16_bf16 v[224:239], v[88:91], a[100:103], v[224:239]
    ds_read_b64_tr_b16 v[74:75], v34 offset:33792
    s_add_u32 s53, s52, 6144
    buffer_store_dwordx4 v[112:115], v3, s[32:35], s53 offen sc1
    v_accvgpr_read_b32 v52, a160
    v_accvgpr_read_b32 v53, a161
    v_cvt_pk_bf16_f32 v112, v52, v53
    v_mfma_f32_32x32x16_bf16 v[176:191], v[92:95], a[96:99], v[176:191]
    ds_read_b64_tr_b16 v[76:77], v35 offset:32768
    v_accvgpr_read_b32 v62, a162
    v_accvgpr_read_b32 v63, a163
    v_cvt_pk_bf16_f32 v113, v62, v63
    v_mfma_f32_32x32x16_bf16 v[240:255], v[92:95], a[100:103], v[240:255]
    ds_read_b64_tr_b16 v[78:79], v35 offset:33792
    v_accvgpr_read_b32 v52, a164
    v_accvgpr_read_b32 v53, a165
    v_cvt_pk_bf16_f32 v114, v52, v53
    s_waitcnt vmcnt(19)
    s_waitcnt lgkmcnt(4)
    v_mfma_f32_32x32x16_bf16 v[128:143], v[64:67], a[104:107], v[128:143]
    ds_read_b64_tr_b16 v[80:81], v32 offset:36864
    v_accvgpr_read_b32 v62, a166
    v_accvgpr_read_b32 v63, a167
    v_cvt_pk_bf16_f32 v115, v62, v63
    v_mfma_f32_32x32x16_bf16 v[192:207], v[64:67], a[108:111], v[192:207]
    ds_read_b64_tr_b16 v[82:83], v32 offset:37888
    s_add_u32 s43, s58, 23552
    buffer_load_dwordx4 a[160:163], v3, s[16:19], s43 offen
    s_add_u32 s43, s59, 23552
    buffer_load_dwordx4 a[164:167], v3, s[16:19], s43 offen
    v_mfma_f32_32x32x16_bf16 v[144:159], v[68:71], a[104:107], v[144:159]
    ds_read_b64_tr_b16 v[84:85], v33 offset:36864
    v_mfma_f32_32x32x16_bf16 v[208:223], v[68:71], a[108:111], v[208:223]
    ds_read_b64_tr_b16 v[86:87], v33 offset:37888
    s_waitcnt lgkmcnt(4)
    v_mfma_f32_32x32x16_bf16 v[160:175], v[72:75], a[104:107], v[160:175]
    ds_read_b64_tr_b16 v[88:89], v34 offset:36864
    v_mfma_f32_32x32x16_bf16 v[224:239], v[72:75], a[108:111], v[224:239]
    ds_read_b64_tr_b16 v[90:91], v34 offset:37888
    v_mfma_f32_32x32x16_bf16 v[176:191], v[76:79], a[104:107], v[176:191]
    ds_read_b64_tr_b16 v[92:93], v35 offset:36864
    v_mfma_f32_32x32x16_bf16 v[240:255], v[76:79], a[108:111], v[240:255]
    ds_read_b64_tr_b16 v[94:95], v35 offset:37888
    s_add_u32 s53, s52, 7168
    buffer_store_dwordx4 v[116:119], v3, s[32:35], s53 offen sc1
    v_accvgpr_read_b32 v52, a168
    v_accvgpr_read_b32 v53, a169
    v_cvt_pk_bf16_f32 v116, v52, v53
    s_waitcnt vmcnt(19)
    s_waitcnt lgkmcnt(4)
    v_mfma_f32_32x32x16_bf16 v[128:143], v[80:83], a[112:115], v[128:143]
    ds_read_b64_tr_b16 v[64:65], v32 offset:40960
    v_accvgpr_read_b32 v62, a170
    v_accvgpr_read_b32 v63, a171
    v_cvt_pk_bf16_f32 v117, v62, v63
    v_mfma_f32_32x32x16_bf16 v[192:207], v[80:83], a[116:119], v[192:207]
    ds_read_b64_tr_b16 v[66:67], v32 offset:41984
    v_accvgpr_read_b32 v52, a172
    v_accvgpr_read_b32 v53, a173
    v_cvt_pk_bf16_f32 v118, v52, v53
    v_mfma_f32_32x32x16_bf16 v[144:159], v[84:87], a[112:115], v[144:159]
    ds_read_b64_tr_b16 v[68:69], v33 offset:40960
    v_accvgpr_read_b32 v62, a174
    v_accvgpr_read_b32 v63, a175
    v_cvt_pk_bf16_f32 v119, v62, v63
    v_mfma_f32_32x32x16_bf16 v[208:223], v[84:87], a[116:119], v[208:223]
    ds_read_b64_tr_b16 v[70:71], v33 offset:41984
    s_add_u32 s43, s58, 24576
    buffer_load_dwordx4 a[168:171], v3, s[16:19], s43 offen
    s_add_u32 s43, s59, 24576
    buffer_load_dwordx4 a[172:175], v3, s[16:19], s43 offen
    s_waitcnt lgkmcnt(4)
    v_mfma_f32_32x32x16_bf16 v[160:175], v[88:91], a[112:115], v[160:175]
    ds_read_b64_tr_b16 v[72:73], v34 offset:40960
    v_mfma_f32_32x32x16_bf16 v[224:239], v[88:91], a[116:119], v[224:239]
    ds_read_b64_tr_b16 v[74:75], v34 offset:41984
    v_mfma_f32_32x32x16_bf16 v[176:191], v[92:95], a[112:115], v[176:191]
    ds_read_b64_tr_b16 v[76:77], v35 offset:40960
    v_mfma_f32_32x32x16_bf16 v[240:255], v[92:95], a[116:119], v[240:255]
    ds_read_b64_tr_b16 v[78:79], v35 offset:41984
    s_waitcnt vmcnt(63)
    s_barrier
    s_waitcnt vmcnt(18)
    s_waitcnt lgkmcnt(4)
    v_mfma_f32_32x32x16_bf16 v[128:143], v[64:67], a[120:123], v[128:143]
    ds_read_b64_tr_b16 v[80:81], v32 offset:45056
    v_mfma_f32_32x32x16_bf16 v[192:207], v[64:67], a[124:127], v[192:207]
    ds_read_b64_tr_b16 v[82:83], v32 offset:46080
    s_add_u32 s53, s52, 22528
    buffer_store_dwordx4 v[120:123], v3, s[32:35], s53 offen sc1
    v_accvgpr_read_b32 v52, a176
    v_accvgpr_read_b32 v53, a177
    v_cvt_pk_bf16_f32 v120, v52, v53
    v_mfma_f32_32x32x16_bf16 v[144:159], v[68:71], a[120:123], v[144:159]
    ds_read_b64_tr_b16 v[84:85], v33 offset:45056
    v_accvgpr_read_b32 v62, a178
    v_accvgpr_read_b32 v63, a179
    v_cvt_pk_bf16_f32 v121, v62, v63
    v_mfma_f32_32x32x16_bf16 v[208:223], v[68:71], a[124:127], v[208:223]
    ds_read_b64_tr_b16 v[86:87], v33 offset:46080
    v_accvgpr_read_b32 v52, a180
    v_accvgpr_read_b32 v53, a181
    v_cvt_pk_bf16_f32 v122, v52, v53
    s_waitcnt lgkmcnt(4)
    v_mfma_f32_32x32x16_bf16 v[160:175], v[72:75], a[120:123], v[160:175]
    ds_read_b64_tr_b16 v[88:89], v34 offset:45056
    v_accvgpr_read_b32 v62, a182
    v_accvgpr_read_b32 v63, a183
    v_cvt_pk_bf16_f32 v123, v62, v63
    v_mfma_f32_32x32x16_bf16 v[224:239], v[72:75], a[124:127], v[224:239]
    ds_read_b64_tr_b16 v[90:91], v34 offset:46080
    s_add_u32 s43, s58, 25600
    buffer_load_dwordx4 a[176:179], v3, s[16:19], s43 offen
    s_add_u32 s43, s59, 25600
    buffer_load_dwordx4 a[180:183], v3, s[16:19], s43 offen
    v_mfma_f32_32x32x16_bf16 v[176:191], v[76:79], a[120:123], v[176:191]
    ds_read_b64_tr_b16 v[92:93], v35 offset:45056
    v_mfma_f32_32x32x16_bf16 v[240:255], v[76:79], a[124:127], v[240:255]
    ds_read_b64_tr_b16 v[94:95], v35 offset:46080
    s_waitcnt vmcnt(18)
    s_waitcnt lgkmcnt(4)
    v_mfma_f32_32x32x16_bf16 v[128:143], v[80:83], a[128:131], v[128:143]
    ds_read_b64_tr_b16 v[64:65], v32 offset:49152
    v_mfma_f32_32x32x16_bf16 v[192:207], v[80:83], a[132:135], v[192:207]
    ds_read_b64_tr_b16 v[66:67], v32 offset:50176
    v_mfma_f32_32x32x16_bf16 v[144:159], v[84:87], a[128:131], v[144:159]
    ds_read_b64_tr_b16 v[68:69], v33 offset:49152
    v_mfma_f32_32x32x16_bf16 v[208:223], v[84:87], a[132:135], v[208:223]
    ds_read_b64_tr_b16 v[70:71], v33 offset:50176
    s_add_u32 s53, s52, 23552
    buffer_store_dwordx4 v[124:127], v3, s[32:35], s53 offen sc1
    v_accvgpr_read_b32 v52, a184
    v_accvgpr_read_b32 v53, a185
    v_cvt_pk_bf16_f32 v124, v52, v53
    s_waitcnt lgkmcnt(4)
    v_mfma_f32_32x32x16_bf16 v[160:175], v[88:91], a[128:131], v[160:175]
    ds_read_b64_tr_b16 v[72:73], v34 offset:49152
    v_accvgpr_read_b32 v62, a186
    v_accvgpr_read_b32 v63, a187
    v_cvt_pk_bf16_f32 v125, v62, v63
    v_mfma_f32_32x32x16_bf16 v[224:239], v[88:91], a[132:135], v[224:239]
    ds_read_b64_tr_b16 v[74:75], v34 offset:50176
    v_accvgpr_read_b32 v52, a188
    v_accvgpr_read_b32 v53, a189
    v_cvt_pk_bf16_f32 v126, v52, v53
    v_mfma_f32_32x32x16_bf16 v[176:191], v[92:95], a[128:131], v[176:191]
    ds_read_b64_tr_b16 v[76:77], v35 offset:49152
    v_accvgpr_read_b32 v62, a190
    v_accvgpr_read_b32 v63, a191
    v_cvt_pk_bf16_f32 v127, v62, v63
    v_mfma_f32_32x32x16_bf16 v[240:255], v[92:95], a[132:135], v[240:255]
    ds_read_b64_tr_b16 v[78:79], v35 offset:50176
    s_add_u32 s43, s58, 26624
    buffer_load_dwordx4 a[184:187], v3, s[16:19], s43 offen
    s_add_u32 s43, s59, 26624
    buffer_load_dwordx4 a[188:191], v3, s[16:19], s43 offen
    s_waitcnt vmcnt(18)
    s_waitcnt lgkmcnt(4)
    v_mfma_f32_32x32x16_bf16 v[128:143], v[64:67], a[136:139], v[128:143]
    ds_read_b64_tr_b16 v[80:81], v32 offset:53248
    v_mfma_f32_32x32x16_bf16 v[192:207], v[64:67], a[140:143], v[192:207]
    ds_read_b64_tr_b16 v[82:83], v32 offset:54272
    v_mfma_f32_32x32x16_bf16 v[144:159], v[68:71], a[136:139], v[144:159]
    ds_read_b64_tr_b16 v[84:85], v33 offset:53248
    v_mfma_f32_32x32x16_bf16 v[208:223], v[68:71], a[140:143], v[208:223]
    ds_read_b64_tr_b16 v[86:87], v33 offset:54272
    s_waitcnt lgkmcnt(4)
    v_mfma_f32_32x32x16_bf16 v[160:175], v[72:75], a[136:139], v[160:175]
    ds_read_b64_tr_b16 v[88:89], v34 offset:53248
    v_mfma_f32_32x32x16_bf16 v[224:239], v[72:75], a[140:143], v[224:239]
    ds_read_b64_tr_b16 v[90:91], v34 offset:54272
    s_add_u32 s53, s52, 8192
    buffer_store_dwordx4 v[96:99], v3, s[32:35], s53 offen sc1
    v_accvgpr_read_b32 v52, a192
    v_accvgpr_read_b32 v53, a193
    v_cvt_pk_bf16_f32 v96, v52, v53
    v_mfma_f32_32x32x16_bf16 v[176:191], v[76:79], a[136:139], v[176:191]
    ds_read_b64_tr_b16 v[92:93], v35 offset:53248
    v_accvgpr_read_b32 v62, a194
    v_accvgpr_read_b32 v63, a195
    v_cvt_pk_bf16_f32 v97, v62, v63
    v_mfma_f32_32x32x16_bf16 v[240:255], v[76:79], a[140:143], v[240:255]
    ds_read_b64_tr_b16 v[94:95], v35 offset:54272
    v_accvgpr_read_b32 v52, a196
    v_accvgpr_read_b32 v53, a197
    v_cvt_pk_bf16_f32 v98, v52, v53
    s_waitcnt vmcnt(16)
    s_waitcnt lgkmcnt(4)
    v_mfma_f32_32x32x16_bf16 v[128:143], v[80:83], a[144:147], v[128:143]
    ds_read_b64_tr_b16 v[64:65], v32 offset:57344
    v_accvgpr_read_b32 v62, a198
    v_accvgpr_read_b32 v63, a199
    v_cvt_pk_bf16_f32 v99, v62, v63
    v_mfma_f32_32x32x16_bf16 v[192:207], v[80:83], a[148:151], v[192:207]
    ds_read_b64_tr_b16 v[66:67], v32 offset:58368
    s_add_u32 s43, s58, 27648
    buffer_load_dwordx4 a[192:195], v3, s[16:19], s43 offen
    s_add_u32 s43, s59, 27648
    buffer_load_dwordx4 a[196:199], v3, s[16:19], s43 offen
    v_mfma_f32_32x32x16_bf16 v[144:159], v[84:87], a[144:147], v[144:159]
    ds_read_b64_tr_b16 v[68:69], v33 offset:57344
    v_mfma_f32_32x32x16_bf16 v[208:223], v[84:87], a[148:151], v[208:223]
    ds_read_b64_tr_b16 v[70:71], v33 offset:58368
    s_waitcnt lgkmcnt(4)
    v_mfma_f32_32x32x16_bf16 v[160:175], v[88:91], a[144:147], v[160:175]
    ds_read_b64_tr_b16 v[72:73], v34 offset:57344
    v_mfma_f32_32x32x16_bf16 v[224:239], v[88:91], a[148:151], v[224:239]
    ds_read_b64_tr_b16 v[74:75], v34 offset:58368
    v_mfma_f32_32x32x16_bf16 v[176:191], v[92:95], a[144:147], v[176:191]
    ds_read_b64_tr_b16 v[76:77], v35 offset:57344
    v_mfma_f32_32x32x16_bf16 v[240:255], v[92:95], a[148:151], v[240:255]
    ds_read_b64_tr_b16 v[78:79], v35 offset:58368
    s_add_u32 s53, s52, 9216
    buffer_store_dwordx4 v[100:103], v3, s[32:35], s53 offen sc1
    v_accvgpr_read_b32 v52, a200
    v_accvgpr_read_b32 v53, a201
    v_cvt_pk_bf16_f32 v100, v52, v53
    s_waitcnt vmcnt(63)
    s_barrier
    s_waitcnt vmcnt(16)
    s_waitcnt lgkmcnt(4)
    v_mfma_f32_32x32x16_bf16 v[128:143], v[64:67], a[152:155], v[128:143]
    ds_read_b64_tr_b16 v[80:81], v32 offset:61440
    v_accvgpr_read_b32 v62, a202
    v_accvgpr_read_b32 v63, a203
    v_cvt_pk_bf16_f32 v101, v62, v63
    v_mfma_f32_32x32x16_bf16 v[192:207], v[64:67], a[156:159], v[192:207]
    ds_read_b64_tr_b16 v[82:83], v32 offset:62464
    v_accvgpr_read_b32 v52, a204
    v_accvgpr_read_b32 v53, a205
    v_cvt_pk_bf16_f32 v102, v52, v53
    v_mfma_f32_32x32x16_bf16 v[144:159], v[68:71], a[152:155], v[144:159]
    ds_read_b64_tr_b16 v[84:85], v33 offset:61440
    v_accvgpr_read_b32 v62, a206
    v_accvgpr_read_b32 v63, a207
    v_cvt_pk_bf16_f32 v103, v62, v63
    v_mfma_f32_32x32x16_bf16 v[208:223], v[68:71], a[156:159], v[208:223]
    ds_read_b64_tr_b16 v[86:87], v33 offset:62464
    s_add_u32 s43, s58, 28672
    buffer_load_dwordx4 a[200:203], v3, s[16:19], s43 offen
    s_add_u32 s43, s59, 28672
    buffer_load_dwordx4 a[204:207], v3, s[16:19], s43 offen
    s_waitcnt lgkmcnt(4)
    v_mfma_f32_32x32x16_bf16 v[160:175], v[72:75], a[152:155], v[160:175]
    ds_read_b64_tr_b16 v[88:89], v34 offset:61440
    v_mfma_f32_32x32x16_bf16 v[224:239], v[72:75], a[156:159], v[224:239]
    ds_read_b64_tr_b16 v[90:91], v34 offset:62464
    v_mfma_f32_32x32x16_bf16 v[176:191], v[76:79], a[152:155], v[176:191]
    ds_read_b64_tr_b16 v[92:93], v35 offset:61440
    v_mfma_f32_32x32x16_bf16 v[240:255], v[76:79], a[156:159], v[240:255]
    ds_read_b64_tr_b16 v[94:95], v35 offset:62464
    s_waitcnt vmcnt(15)
    s_waitcnt lgkmcnt(4)
    v_mfma_f32_32x32x16_bf16 v[128:143], v[80:83], a[160:163], v[128:143]
    ds_read_b64_tr_b16 v[64:65], v6 offset:32768
    v_mfma_f32_32x32x16_bf16 v[192:207], v[80:83], a[164:167], v[192:207]
    ds_read_b64_tr_b16 v[66:67], v6 offset:33792
    s_add_u32 s53, s52, 24576
    buffer_store_dwordx4 v[104:107], v3, s[32:35], s53 offen sc1
    v_accvgpr_read_b32 v52, a208
    v_accvgpr_read_b32 v53, a209
    v_cvt_pk_bf16_f32 v104, v52, v53
    v_mfma_f32_32x32x16_bf16 v[144:159], v[84:87], a[160:163], v[144:159]
    ds_read_b64_tr_b16 v[68:69], v7 offset:32768
    v_accvgpr_read_b32 v62, a210
    v_accvgpr_read_b32 v63, a211
    v_cvt_pk_bf16_f32 v105, v62, v63
    v_mfma_f32_32x32x16_bf16 v[208:223], v[84:87], a[164:167], v[208:223]
    ds_read_b64_tr_b16 v[70:71], v7 offset:33792
    v_accvgpr_read_b32 v52, a212
    v_accvgpr_read_b32 v53, a213
    v_cvt_pk_bf16_f32 v106, v52, v53
    s_waitcnt lgkmcnt(4)
    v_mfma_f32_32x32x16_bf16 v[160:175], v[88:91], a[160:163], v[160:175]
    ds_read_b64_tr_b16 v[72:73], v8 offset:32768
    v_accvgpr_read_b32 v62, a214
    v_accvgpr_read_b32 v63, a215
    v_cvt_pk_bf16_f32 v107, v62, v63
    v_mfma_f32_32x32x16_bf16 v[224:239], v[88:91], a[164:167], v[224:239]
    ds_read_b64_tr_b16 v[74:75], v8 offset:33792
    s_add_u32 s43, s58, 29696
    buffer_load_dwordx4 a[208:211], v3, s[16:19], s43 offen
    s_add_u32 s43, s59, 29696
    buffer_load_dwordx4 a[212:215], v3, s[16:19], s43 offen
    v_mfma_f32_32x32x16_bf16 v[176:191], v[92:95], a[160:163], v[176:191]
    ds_read_b64_tr_b16 v[76:77], v9 offset:32768
    v_mfma_f32_32x32x16_bf16 v[240:255], v[92:95], a[164:167], v[240:255]
    ds_read_b64_tr_b16 v[78:79], v9 offset:33792
    s_waitcnt vmcnt(15)
    s_waitcnt lgkmcnt(4)
    v_mfma_f32_32x32x16_bf16 v[128:143], v[64:67], a[168:171], v[128:143]
    ds_read_b64_tr_b16 v[80:81], v6 offset:36864
    v_mfma_f32_32x32x16_bf16 v[192:207], v[64:67], a[172:175], v[192:207]
    ds_read_b64_tr_b16 v[82:83], v6 offset:37888
    v_mfma_f32_32x32x16_bf16 v[144:159], v[68:71], a[168:171], v[144:159]
    ds_read_b64_tr_b16 v[84:85], v7 offset:36864
    v_mfma_f32_32x32x16_bf16 v[208:223], v[68:71], a[172:175], v[208:223]
    ds_read_b64_tr_b16 v[86:87], v7 offset:37888
    s_add_u32 s53, s52, 25600
    buffer_store_dwordx4 v[108:111], v3, s[32:35], s53 offen sc1
    v_accvgpr_read_b32 v52, a216
    v_accvgpr_read_b32 v53, a217
    v_cvt_pk_bf16_f32 v108, v52, v53
    s_waitcnt lgkmcnt(4)
    v_mfma_f32_32x32x16_bf16 v[160:175], v[72:75], a[168:171], v[160:175]
    ds_read_b64_tr_b16 v[88:89], v8 offset:36864
    v_accvgpr_read_b32 v62, a218
    v_accvgpr_read_b32 v63, a219
    v_cvt_pk_bf16_f32 v109, v62, v63
    v_mfma_f32_32x32x16_bf16 v[224:239], v[72:75], a[172:175], v[224:239]
    ds_read_b64_tr_b16 v[90:91], v8 offset:37888
    v_accvgpr_read_b32 v52, a220
    v_accvgpr_read_b32 v53, a221
    v_cvt_pk_bf16_f32 v110, v52, v53
    v_mfma_f32_32x32x16_bf16 v[176:191], v[76:79], a[168:171], v[176:191]
    ds_read_b64_tr_b16 v[92:93], v9 offset:36864
    v_accvgpr_read_b32 v62, a222
    v_accvgpr_read_b32 v63, a223
    v_cvt_pk_bf16_f32 v111, v62, v63
    v_mfma_f32_32x32x16_bf16 v[240:255], v[76:79], a[172:175], v[240:255]
    ds_read_b64_tr_b16 v[94:95], v9 offset:37888
    s_add_u32 s43, s58, 30720
    buffer_load_dwordx4 a[216:219], v3, s[16:19], s43 offen
    s_add_u32 s43, s59, 30720
    buffer_load_dwordx4 a[220:223], v3, s[16:19], s43 offen
    s_waitcnt vmcnt(15)
    s_waitcnt lgkmcnt(4)
    v_mfma_f32_32x32x16_bf16 v[128:143], v[80:83], a[176:179], v[128:143]
    ds_read_b64_tr_b16 v[64:65], v6 offset:40960
    v_mfma_f32_32x32x16_bf16 v[192:207], v[80:83], a[180:183], v[192:207]
    ds_read_b64_tr_b16 v[66:67], v6 offset:41984
    v_mfma_f32_32x32x16_bf16 v[144:159], v[84:87], a[176:179], v[144:159]
    ds_read_b64_tr_b16 v[68:69], v7 offset:40960
    v_mfma_f32_32x32x16_bf16 v[208:223], v[84:87], a[180:183], v[208:223]
    ds_read_b64_tr_b16 v[70:71], v7 offset:41984
    s_waitcnt lgkmcnt(4)
    v_mfma_f32_32x32x16_bf16 v[160:175], v[88:91], a[176:179], v[160:175]
    ds_read_b64_tr_b16 v[72:73], v8 offset:40960
    v_mfma_f32_32x32x16_bf16 v[224:239], v[88:91], a[180:183], v[224:239]
    ds_read_b64_tr_b16 v[74:75], v8 offset:41984
    s_add_u32 s53, s52, 10240
    buffer_store_dwordx4 v[112:115], v3, s[32:35], s53 offen sc1
    v_accvgpr_read_b32 v52, a224
    v_accvgpr_read_b32 v53, a225
    v_cvt_pk_bf16_f32 v112, v52, v53
    v_mfma_f32_32x32x16_bf16 v[176:191], v[92:95], a[176:179], v[176:191]
    ds_read_b64_tr_b16 v[76:77], v9 offset:40960
    v_accvgpr_read_b32 v62, a226
    v_accvgpr_read_b32 v63, a227
    v_cvt_pk_bf16_f32 v113, v62, v63
    v_mfma_f32_32x32x16_bf16 v[240:255], v[92:95], a[180:183], v[240:255]
    ds_read_b64_tr_b16 v[78:79], v9 offset:41984
    v_accvgpr_read_b32 v52, a228
    v_accvgpr_read_b32 v53, a229
    v_cvt_pk_bf16_f32 v114, v52, v53
    s_waitcnt vmcnt(63)
    s_barrier
    s_waitcnt vmcnt(13)
    s_waitcnt lgkmcnt(4)
    v_mfma_f32_32x32x16_bf16 v[128:143], v[64:67], a[184:187], v[128:143]
    ds_read_b64_tr_b16 v[80:81], v6 offset:45056
    v_accvgpr_read_b32 v62, a230
    v_accvgpr_read_b32 v63, a231
    v_cvt_pk_bf16_f32 v115, v62, v63
    v_mfma_f32_32x32x16_bf16 v[192:207], v[64:67], a[188:191], v[192:207]
    ds_read_b64_tr_b16 v[82:83], v6 offset:46080
    s_add_u32 s43, s58, 31744
    buffer_load_dwordx4 a[224:227], v3, s[16:19], s43 offen
    s_add_u32 s43, s59, 31744
    buffer_load_dwordx4 a[228:231], v3, s[16:19], s43 offen
    v_mfma_f32_32x32x16_bf16 v[144:159], v[68:71], a[184:187], v[144:159]
    ds_read_b64_tr_b16 v[84:85], v7 offset:45056
    v_mfma_f32_32x32x16_bf16 v[208:223], v[68:71], a[188:191], v[208:223]
    ds_read_b64_tr_b16 v[86:87], v7 offset:46080
    s_waitcnt lgkmcnt(4)
    v_mfma_f32_32x32x16_bf16 v[160:175], v[72:75], a[184:187], v[160:175]
    ds_read_b64_tr_b16 v[88:89], v8 offset:45056
    v_mfma_f32_32x32x16_bf16 v[224:239], v[72:75], a[188:191], v[224:239]
    ds_read_b64_tr_b16 v[90:91], v8 offset:46080
    v_mfma_f32_32x32x16_bf16 v[176:191], v[76:79], a[184:187], v[176:191]
    ds_read_b64_tr_b16 v[92:93], v9 offset:45056
    v_mfma_f32_32x32x16_bf16 v[240:255], v[76:79], a[188:191], v[240:255]
    ds_read_b64_tr_b16 v[94:95], v9 offset:46080
    s_add_u32 s53, s52, 11264
    buffer_store_dwordx4 v[116:119], v3, s[32:35], s53 offen sc1
    v_accvgpr_read_b32 v52, a232
    v_accvgpr_read_b32 v53, a233
    v_cvt_pk_bf16_f32 v116, v52, v53
    s_waitcnt vmcnt(13)
    s_waitcnt lgkmcnt(4)
    v_mfma_f32_32x32x16_bf16 v[128:143], v[80:83], a[192:195], v[128:143]
    ds_read_b64_tr_b16 v[64:65], v6 offset:49152
    v_accvgpr_read_b32 v62, a234
    v_accvgpr_read_b32 v63, a235
    v_cvt_pk_bf16_f32 v117, v62, v63
    v_mfma_f32_32x32x16_bf16 v[192:207], v[80:83], a[196:199], v[192:207]
    ds_read_b64_tr_b16 v[66:67], v6 offset:50176
    v_accvgpr_read_b32 v52, a236
    v_accvgpr_read_b32 v53, a237
    v_cvt_pk_bf16_f32 v118, v52, v53
    v_mfma_f32_32x32x16_bf16 v[144:159], v[84:87], a[192:195], v[144:159]
    ds_read_b64_tr_b16 v[68:69], v7 offset:49152
    v_accvgpr_read_b32 v62, a238
    v_accvgpr_read_b32 v63, a239
    v_cvt_pk_bf16_f32 v119, v62, v63
    v_mfma_f32_32x32x16_bf16 v[208:223], v[84:87], a[196:199], v[208:223]
    ds_read_b64_tr_b16 v[70:71], v7 offset:50176
    s_add_u32 s43, s58, 32768
    buffer_load_dwordx4 a[232:235], v3, s[16:19], s43 offen
    s_add_u32 s43, s59, 32768
    buffer_load_dwordx4 a[236:239], v3, s[16:19], s43 offen
    s_waitcnt lgkmcnt(4)
    v_mfma_f32_32x32x16_bf16 v[160:175], v[88:91], a[192:195], v[160:175]
    ds_read_b64_tr_b16 v[72:73], v8 offset:49152
    v_mfma_f32_32x32x16_bf16 v[224:239], v[88:91], a[196:199], v[224:239]
    ds_read_b64_tr_b16 v[74:75], v8 offset:50176
    v_mfma_f32_32x32x16_bf16 v[176:191], v[92:95], a[192:195], v[176:191]
    ds_read_b64_tr_b16 v[76:77], v9 offset:49152
    v_mfma_f32_32x32x16_bf16 v[240:255], v[92:95], a[196:199], v[240:255]
    ds_read_b64_tr_b16 v[78:79], v9 offset:50176
    s_waitcnt vmcnt(12)
    s_waitcnt lgkmcnt(4)
    v_mfma_f32_32x32x16_bf16 v[128:143], v[64:67], a[200:203], v[128:143]
    ds_read_b64_tr_b16 v[80:81], v6 offset:53248
    v_mfma_f32_32x32x16_bf16 v[192:207], v[64:67], a[204:207], v[192:207]
    ds_read_b64_tr_b16 v[82:83], v6 offset:54272
    s_add_u32 s53, s52, 26624
    buffer_store_dwordx4 v[120:123], v3, s[32:35], s53 offen sc1
    v_accvgpr_read_b32 v52, a240
    v_accvgpr_read_b32 v53, a241
    v_cvt_pk_bf16_f32 v120, v52, v53
    v_mfma_f32_32x32x16_bf16 v[144:159], v[68:71], a[200:203], v[144:159]
    ds_read_b64_tr_b16 v[84:85], v7 offset:53248
    v_accvgpr_read_b32 v62, a242
    v_accvgpr_read_b32 v63, a243
    v_cvt_pk_bf16_f32 v121, v62, v63
    v_mfma_f32_32x32x16_bf16 v[208:223], v[68:71], a[204:207], v[208:223]
    ds_read_b64_tr_b16 v[86:87], v7 offset:54272
    v_accvgpr_read_b32 v52, a244
    v_accvgpr_read_b32 v53, a245
    v_cvt_pk_bf16_f32 v122, v52, v53
    s_waitcnt lgkmcnt(4)
    v_mfma_f32_32x32x16_bf16 v[160:175], v[72:75], a[200:203], v[160:175]
    ds_read_b64_tr_b16 v[88:89], v8 offset:53248
    v_accvgpr_read_b32 v62, a246
    v_accvgpr_read_b32 v63, a247
    v_cvt_pk_bf16_f32 v123, v62, v63
    v_mfma_f32_32x32x16_bf16 v[224:239], v[72:75], a[204:207], v[224:239]
    ds_read_b64_tr_b16 v[90:91], v8 offset:54272
    s_add_u32 s43, s58, 33792
    buffer_load_dwordx4 a[240:243], v3, s[16:19], s43 offen
    s_add_u32 s43, s59, 33792
    buffer_load_dwordx4 a[244:247], v3, s[16:19], s43 offen
    v_mfma_f32_32x32x16_bf16 v[176:191], v[76:79], a[200:203], v[176:191]
    ds_read_b64_tr_b16 v[92:93], v9 offset:53248
    v_mfma_f32_32x32x16_bf16 v[240:255], v[76:79], a[204:207], v[240:255]
    ds_read_b64_tr_b16 v[94:95], v9 offset:54272
    s_waitcnt vmcnt(12)
    s_waitcnt lgkmcnt(4)
    v_mfma_f32_32x32x16_bf16 v[128:143], v[80:83], a[208:211], v[128:143]
    ds_read_b64_tr_b16 v[64:65], v6 offset:57344
    v_mfma_f32_32x32x16_bf16 v[192:207], v[80:83], a[212:215], v[192:207]
    ds_read_b64_tr_b16 v[66:67], v6 offset:58368
    v_mfma_f32_32x32x16_bf16 v[144:159], v[84:87], a[208:211], v[144:159]
    ds_read_b64_tr_b16 v[68:69], v7 offset:57344
    v_mfma_f32_32x32x16_bf16 v[208:223], v[84:87], a[212:215], v[208:223]
    ds_read_b64_tr_b16 v[70:71], v7 offset:58368
    s_add_u32 s53, s52, 27648
    buffer_store_dwordx4 v[124:127], v3, s[32:35], s53 offen sc1
    v_accvgpr_read_b32 v52, a248
    v_accvgpr_read_b32 v53, a249
    v_cvt_pk_bf16_f32 v124, v52, v53
    s_waitcnt lgkmcnt(4)
    v_mfma_f32_32x32x16_bf16 v[160:175], v[88:91], a[208:211], v[160:175]
    ds_read_b64_tr_b16 v[72:73], v8 offset:57344
    v_accvgpr_read_b32 v62, a250
    v_accvgpr_read_b32 v63, a251
    v_cvt_pk_bf16_f32 v125, v62, v63
    v_mfma_f32_32x32x16_bf16 v[224:239], v[88:91], a[212:215], v[224:239]
    ds_read_b64_tr_b16 v[74:75], v8 offset:58368
    v_accvgpr_read_b32 v52, a252
    v_accvgpr_read_b32 v53, a253
    v_cvt_pk_bf16_f32 v126, v52, v53
    v_mfma_f32_32x32x16_bf16 v[176:191], v[92:95], a[208:211], v[176:191]
    ds_read_b64_tr_b16 v[76:77], v9 offset:57344
    v_accvgpr_read_b32 v62, a254
    v_accvgpr_read_b32 v63, a255
    v_cvt_pk_bf16_f32 v127, v62, v63
    v_mfma_f32_32x32x16_bf16 v[240:255], v[92:95], a[212:215], v[240:255]
    ds_read_b64_tr_b16 v[78:79], v9 offset:58368
    s_add_u32 s43, s58, 34816
    buffer_load_dwordx4 a[248:251], v3, s[16:19], s43 offen
    s_add_u32 s43, s59, 34816
    buffer_load_dwordx4 a[252:255], v3, s[16:19], s43 offen
    s_waitcnt vmcnt(63)
    s_barrier
    s_waitcnt vmcnt(12)
    s_waitcnt lgkmcnt(4)
    v_mfma_f32_32x32x16_bf16 v[128:143], v[64:67], a[216:219], v[128:143]
    ds_read_b64_tr_b16 v[80:81], v6 offset:61440
    s_add_u32 s43, s58, 35840
    buffer_load_dwordx4 a[0:3], v3, s[16:19], s43 offen
    s_add_u32 s43, s59, 35840
    buffer_load_dwordx4 a[4:7], v3, s[16:19], s43 offen
    v_mfma_f32_32x32x16_bf16 v[192:207], v[64:67], a[220:223], v[192:207]
    ds_read_b64_tr_b16 v[82:83], v6 offset:62464
    s_add_u32 s43, s58, 36864
    buffer_load_dwordx4 a[8:11], v3, s[16:19], s43 offen
    s_add_u32 s43, s59, 36864
    buffer_load_dwordx4 a[12:15], v3, s[16:19], s43 offen
    v_mfma_f32_32x32x16_bf16 v[144:159], v[68:71], a[216:219], v[144:159]
    ds_read_b64_tr_b16 v[84:85], v7 offset:61440
    s_add_u32 s43, s58, 37888
    buffer_load_dwordx4 a[16:19], v3, s[16:19], s43 offen
    s_add_u32 s43, s59, 37888
    buffer_load_dwordx4 a[20:23], v3, s[16:19], s43 offen
    v_mfma_f32_32x32x16_bf16 v[208:223], v[68:71], a[220:223], v[208:223]
    ds_read_b64_tr_b16 v[86:87], v7 offset:62464
    s_add_u32 s43, s58, 38912
    buffer_load_dwordx4 a[24:27], v3, s[16:19], s43 offen
    s_add_u32 s43, s59, 38912
    buffer_load_dwordx4 a[28:31], v3, s[16:19], s43 offen
    s_waitcnt lgkmcnt(4)
    v_mfma_f32_32x32x16_bf16 v[160:175], v[72:75], a[216:219], v[160:175]
    ds_read_b64_tr_b16 v[88:89], v8 offset:61440
    s_add_u32 s43, s58, 39936
    buffer_load_dwordx4 a[32:35], v3, s[16:19], s43 offen
    s_add_u32 s43, s59, 39936
    buffer_load_dwordx4 a[36:39], v3, s[16:19], s43 offen
    v_mfma_f32_32x32x16_bf16 v[224:239], v[72:75], a[220:223], v[224:239]
    ds_read_b64_tr_b16 v[90:91], v8 offset:62464
    s_add_u32 s53, s52, 12288
    buffer_store_dwordx4 v[96:99], v3, s[32:35], s53 offen sc1
    v_mfma_f32_32x32x16_bf16 v[176:191], v[76:79], a[216:219], v[176:191]
    ds_read_b64_tr_b16 v[92:93], v9 offset:61440
    v_mfma_f32_32x32x16_bf16 v[240:255], v[76:79], a[220:223], v[240:255]
    ds_read_b64_tr_b16 v[94:95], v9 offset:62464
    s_waitcnt vmcnt(20)
    s_waitcnt lgkmcnt(4)
    v_mfma_f32_32x32x16_bf16 v[128:143], v[80:83], a[224:227], v[128:143]
    ds_read_b64_tr_b16 v[64:65], v58 offset:0
    v_mfma_f32_32x32x16_bf16 v[192:207], v[80:83], a[228:231], v[192:207]
    ds_read_b64_tr_b16 v[66:67], v58 offset:1024
    v_mfma_f32_32x32x16_bf16 v[144:159], v[84:87], a[224:227], v[144:159]
    ds_read_b64_tr_b16 v[68:69], v59 offset:0
    v_mfma_f32_32x32x16_bf16 v[208:223], v[84:87], a[228:231], v[208:223]
    ds_read_b64_tr_b16 v[70:71], v59 offset:1024
    s_waitcnt lgkmcnt(4)
    v_mfma_f32_32x32x16_bf16 v[160:175], v[88:91], a[224:227], v[160:175]
    ds_read_b64_tr_b16 v[72:73], v60 offset:0
    v_mfma_f32_32x32x16_bf16 v[224:239], v[88:91], a[228:231], v[224:239]
    ds_read_b64_tr_b16 v[74:75], v60 offset:1024
    v_mfma_f32_32x32x16_bf16 v[176:191], v[92:95], a[224:227], v[176:191]
    ds_read_b64_tr_b16 v[76:77], v61 offset:0
    v_mfma_f32_32x32x16_bf16 v[240:255], v[92:95], a[228:231], v[240:255]
    ds_read_b64_tr_b16 v[78:79], v61 offset:1024
    s_add_u32 s53, s52, 13312
    buffer_store_dwordx4 v[100:103], v3, s[32:35], s53 offen sc1
    s_waitcnt vmcnt(18)
    s_waitcnt lgkmcnt(4)
    v_mfma_f32_32x32x16_bf16 v[128:143], v[64:67], a[232:235], v[128:143]
    ds_read_b64_tr_b16 v[80:81], v58 offset:4096
    v_mfma_f32_32x32x16_bf16 v[192:207], v[64:67], a[236:239], v[192:207]
    ds_read_b64_tr_b16 v[82:83], v58 offset:5120
    v_mfma_f32_32x32x16_bf16 v[144:159], v[68:71], a[232:235], v[144:159]
    ds_read_b64_tr_b16 v[84:85], v59 offset:4096
    v_mfma_f32_32x32x16_bf16 v[208:223], v[68:71], a[236:239], v[208:223]
    ds_read_b64_tr_b16 v[86:87], v59 offset:5120
    s_waitcnt lgkmcnt(4)
    v_mfma_f32_32x32x16_bf16 v[160:175], v[72:75], a[232:235], v[160:175]
    ds_read_b64_tr_b16 v[88:89], v60 offset:4096
    v_mfma_f32_32x32x16_bf16 v[224:239], v[72:75], a[236:239], v[224:239]
    ds_read_b64_tr_b16 v[90:91], v60 offset:5120
    v_mfma_f32_32x32x16_bf16 v[176:191], v[76:79], a[232:235], v[176:191]
    ds_read_b64_tr_b16 v[92:93], v61 offset:4096
    v_mfma_f32_32x32x16_bf16 v[240:255], v[76:79], a[236:239], v[240:255]
    ds_read_b64_tr_b16 v[94:95], v61 offset:5120
    s_waitcnt vmcnt(15)
    s_waitcnt lgkmcnt(4)
    v_mfma_f32_32x32x16_bf16 v[128:143], v[80:83], a[240:243], v[128:143]
    ds_read_b64_tr_b16 v[64:65], v58 offset:8192
    v_mfma_f32_32x32x16_bf16 v[192:207], v[80:83], a[244:247], v[192:207]
    ds_read_b64_tr_b16 v[66:67], v58 offset:9216
    s_add_u32 s53, s52, 28672
    buffer_store_dwordx4 v[104:107], v3, s[32:35], s53 offen sc1
    v_mfma_f32_32x32x16_bf16 v[144:159], v[84:87], a[240:243], v[144:159]
    ds_read_b64_tr_b16 v[68:69], v59 offset:8192
    v_mfma_f32_32x32x16_bf16 v[208:223], v[84:87], a[244:247], v[208:223]
    ds_read_b64_tr_b16 v[70:71], v59 offset:9216
    s_waitcnt lgkmcnt(4)
    v_mfma_f32_32x32x16_bf16 v[160:175], v[88:91], a[240:243], v[160:175]
    ds_read_b64_tr_b16 v[72:73], v60 offset:8192
    v_mfma_f32_32x32x16_bf16 v[224:239], v[88:91], a[244:247], v[224:239]
    ds_read_b64_tr_b16 v[74:75], v60 offset:9216
    v_mfma_f32_32x32x16_bf16 v[176:191], v[92:95], a[240:243], v[176:191]
    ds_read_b64_tr_b16 v[76:77], v61 offset:8192
    v_mfma_f32_32x32x16_bf16 v[240:255], v[92:95], a[244:247], v[240:255]
    ds_read_b64_tr_b16 v[78:79], v61 offset:9216
    s_waitcnt vmcnt(63)
    s_barrier
    s_waitcnt vmcnt(13)
    s_waitcnt lgkmcnt(4)
    v_mfma_f32_32x32x16_bf16 v[128:143], v[64:67], a[248:251], v[128:143]
    ds_read_b64_tr_b16 v[80:81], v58 offset:12288
    v_mfma_f32_32x32x16_bf16 v[192:207], v[64:67], a[252:255], v[192:207]
    ds_read_b64_tr_b16 v[82:83], v58 offset:13312
    v_mfma_f32_32x32x16_bf16 v[144:159], v[68:71], a[248:251], v[144:159]
    ds_read_b64_tr_b16 v[84:85], v59 offset:12288
    v_mfma_f32_32x32x16_bf16 v[208:223], v[68:71], a[252:255], v[208:223]
    ds_read_b64_tr_b16 v[86:87], v59 offset:13312
    s_add_u32 s53, s52, 29696
    buffer_store_dwordx4 v[108:111], v3, s[32:35], s53 offen sc1
    s_waitcnt lgkmcnt(4)
    v_mfma_f32_32x32x16_bf16 v[160:175], v[72:75], a[248:251], v[160:175]
    ds_read_b64_tr_b16 v[88:89], v60 offset:12288
    v_mfma_f32_32x32x16_bf16 v[224:239], v[72:75], a[252:255], v[224:239]
    ds_read_b64_tr_b16 v[90:91], v60 offset:13312
    v_mfma_f32_32x32x16_bf16 v[176:191], v[76:79], a[248:251], v[176:191]
    ds_read_b64_tr_b16 v[92:93], v61 offset:12288
    v_mfma_f32_32x32x16_bf16 v[240:255], v[76:79], a[252:255], v[240:255]
    ds_read_b64_tr_b16 v[94:95], v61 offset:13312
    s_waitcnt vmcnt(12)
    s_waitcnt lgkmcnt(4)
    v_mfma_f32_32x32x16_bf16 v[128:143], v[80:83], a[0:3], v[128:143]
    ds_read_b64_tr_b16 v[64:65], v58 offset:16384
    v_mfma_f32_32x32x16_bf16 v[192:207], v[80:83], a[4:7], v[192:207]
    ds_read_b64_tr_b16 v[66:67], v58 offset:17408
    v_mfma_f32_32x32x16_bf16 v[144:159], v[84:87], a[0:3], v[144:159]
    ds_read_b64_tr_b16 v[68:69], v59 offset:16384
    v_mfma_f32_32x32x16_bf16 v[208:223], v[84:87], a[4:7], v[208:223]
    ds_read_b64_tr_b16 v[70:71], v59 offset:17408
    s_waitcnt lgkmcnt(4)
    v_mfma_f32_32x32x16_bf16 v[160:175], v[88:91], a[0:3], v[160:175]
    ds_read_b64_tr_b16 v[72:73], v60 offset:16384
    v_mfma_f32_32x32x16_bf16 v[224:239], v[88:91], a[4:7], v[224:239]
    ds_read_b64_tr_b16 v[74:75], v60 offset:17408
    s_add_u32 s53, s52, 14336
    buffer_store_dwordx4 v[112:115], v3, s[32:35], s53 offen sc1
    v_mfma_f32_32x32x16_bf16 v[176:191], v[92:95], a[0:3], v[176:191]
    ds_read_b64_tr_b16 v[76:77], v61 offset:16384
    v_mfma_f32_32x32x16_bf16 v[240:255], v[92:95], a[4:7], v[240:255]
    ds_read_b64_tr_b16 v[78:79], v61 offset:17408
    s_waitcnt vmcnt(11)
    s_waitcnt lgkmcnt(4)
    v_mfma_f32_32x32x16_bf16 v[128:143], v[64:67], a[8:11], v[128:143]
    ds_read_b64_tr_b16 v[80:81], v58 offset:20480
    v_mfma_f32_32x32x16_bf16 v[192:207], v[64:67], a[12:15], v[192:207]
    ds_read_b64_tr_b16 v[82:83], v58 offset:21504
    v_mfma_f32_32x32x16_bf16 v[144:159], v[68:71], a[8:11], v[144:159]
    ds_read_b64_tr_b16 v[84:85], v59 offset:20480
    v_mfma_f32_32x32x16_bf16 v[208:223], v[68:71], a[12:15], v[208:223]
    ds_read_b64_tr_b16 v[86:87], v59 offset:21504
    s_waitcnt lgkmcnt(4)
    v_mfma_f32_32x32x16_bf16 v[160:175], v[72:75], a[8:11], v[160:175]
    ds_read_b64_tr_b16 v[88:89], v60 offset:20480
    v_mfma_f32_32x32x16_bf16 v[224:239], v[72:75], a[12:15], v[224:239]
    ds_read_b64_tr_b16 v[90:91], v60 offset:21504
    v_mfma_f32_32x32x16_bf16 v[176:191], v[76:79], a[8:11], v[176:191]
    ds_read_b64_tr_b16 v[92:93], v61 offset:20480
    v_mfma_f32_32x32x16_bf16 v[240:255], v[76:79], a[12:15], v[240:255]
    ds_read_b64_tr_b16 v[94:95], v61 offset:21504
    s_add_u32 s53, s52, 15360
    buffer_store_dwordx4 v[116:119], v3, s[32:35], s53 offen sc1
    s_waitcnt vmcnt(10)
    s_waitcnt lgkmcnt(4)
    v_mfma_f32_32x32x16_bf16 v[128:143], v[80:83], a[16:19], v[128:143]
    ds_read_b64_tr_b16 v[64:65], v58 offset:24576
    v_mfma_f32_32x32x16_bf16 v[192:207], v[80:83], a[20:23], v[192:207]
    ds_read_b64_tr_b16 v[66:67], v58 offset:25600
    v_mfma_f32_32x32x16_bf16 v[144:159], v[84:87], a[16:19], v[144:159]
    ds_read_b64_tr_b16 v[68:69], v59 offset:24576
    v_mfma_f32_32x32x16_bf16 v[208:223], v[84:87], a[20:23], v[208:223]
    ds_read_b64_tr_b16 v[70:71], v59 offset:25600
    s_waitcnt lgkmcnt(4)
    v_mfma_f32_32x32x16_bf16 v[160:175], v[88:91], a[16:19], v[160:175]
    ds_read_b64_tr_b16 v[72:73], v60 offset:24576
    v_mfma_f32_32x32x16_bf16 v[224:239], v[88:91], a[20:23], v[224:239]
    ds_read_b64_tr_b16 v[74:75], v60 offset:25600
    v_mfma_f32_32x32x16_bf16 v[176:191], v[92:95], a[16:19], v[176:191]
    ds_read_b64_tr_b16 v[76:77], v61 offset:24576
    v_mfma_f32_32x32x16_bf16 v[240:255], v[92:95], a[20:23], v[240:255]
    ds_read_b64_tr_b16 v[78:79], v61 offset:25600
    s_barrier
    s_waitcnt vmcnt(8)
    s_waitcnt lgkmcnt(4)
    v_mfma_f32_32x32x16_bf16 v[128:143], v[64:67], a[24:27], v[128:143]
    ds_read_b64_tr_b16 v[80:81], v58 offset:28672
    v_mfma_f32_32x32x16_bf16 v[192:207], v[64:67], a[28:31], v[192:207]
    ds_read_b64_tr_b16 v[82:83], v58 offset:29696
    s_add_u32 s53, s52, 30720
    buffer_store_dwordx4 v[120:123], v3, s[32:35], s53 offen sc1
    v_mfma_f32_32x32x16_bf16 v[144:159], v[68:71], a[24:27], v[144:159]
    ds_read_b64_tr_b16 v[84:85], v59 offset:28672
    v_mfma_f32_32x32x16_bf16 v[208:223], v[68:71], a[28:31], v[208:223]
    ds_read_b64_tr_b16 v[86:87], v59 offset:29696
    s_waitcnt lgkmcnt(4)
    v_mfma_f32_32x32x16_bf16 v[160:175], v[72:75], a[24:27], v[160:175]
    ds_read_b64_tr_b16 v[88:89], v60 offset:28672
    v_mfma_f32_32x32x16_bf16 v[224:239], v[72:75], a[28:31], v[224:239]
    ds_read_b64_tr_b16 v[90:91], v60 offset:29696
    v_mfma_f32_32x32x16_bf16 v[176:191], v[76:79], a[24:27], v[176:191]
    ds_read_b64_tr_b16 v[92:93], v61 offset:28672
    v_mfma_f32_32x32x16_bf16 v[240:255], v[76:79], a[28:31], v[240:255]
    ds_read_b64_tr_b16 v[94:95], v61 offset:29696
    s_waitcnt vmcnt(7)
    s_waitcnt lgkmcnt(4)
    v_mfma_f32_32x32x16_bf16 v[128:143], v[80:83], a[32:35], v[128:143]
    v_mfma_f32_32x32x16_bf16 v[192:207], v[80:83], a[36:39], v[192:207]
    v_mfma_f32_32x32x16_bf16 v[144:159], v[84:87], a[32:35], v[144:159]
    v_mfma_f32_32x32x16_bf16 v[208:223], v[84:87], a[36:39], v[208:223]
    s_add_u32 s53, s52, 31744
    buffer_store_dwordx4 v[124:127], v3, s[32:35], s53 offen sc1
    s_waitcnt lgkmcnt(0)
    v_mfma_f32_32x32x16_bf16 v[160:175], v[88:91], a[32:35], v[160:175]
    v_mfma_f32_32x32x16_bf16 v[224:239], v[88:91], a[36:39], v[224:239]
    v_mfma_f32_32x32x16_bf16 v[176:191], v[92:95], a[32:35], v[176:191]
    v_mfma_f32_32x32x16_bf16 v[240:255], v[92:95], a[36:39], v[240:255]
    s_waitcnt vmcnt(0)
    s_barrier
    s_add_u32 s92, s14, 68288512
    s_addc_u32 s93, s15, 0
    s_mov_b32 s94, 38912
    s_mov_b32 s95, 0x20000
    s_lshl_b32 s43, s41, 7
    s_lshl_b32 s46, s42, 2
    s_add_u32 s43, s43, s46
    buffer_store_dword v57, v56, s[92:95], s43 offen sc1
    s_add_u32 s92, s14, 68288512
    s_addc_u32 s93, s15, 0
    s_mov_b32 s94, 38912
    s_mov_b32 s95, 0x20000
    s_lshl_b32 s43, s41, 7
    v_lshlrev_b32 v62, 2, v2
    v_add_u32 v62, s43, v62
    v_mov_b32 v63, 0x100000
    v_cmp_gt_u32 vcc, 8, v0
    s_nop 1
    v_cndmask_b32 v47, v63, v62, vcc
    buffer_load_dword v12, v47, s[92:95], 0 offen sc1
    s_load_dwordx2 s[6:7], s[0:1], 40
    s_load_dwordx4 s[8:11], s[0:1], 64
    s_load_dwordx2 s[12:13], s[0:1], 80
    s_lshl_b32 s52, s56, 5
    s_add_u32 s52, s52, s41
    s_lshl_b32 s52, s52, 13
    s_lshl_b32 s53, s57, 5
    s_add_u32 s53, s53, s41
    s_lshl_b32 s53, s53, 13
    s_mov_b32 s54, 0
    s_waitcnt lgkmcnt(0)
    s_mov_b32 s43, 0x3e0293ee
    v_mov_b32 v32, s43
    v_mov_b32 v33, s43
    v_pk_mul_f32 v[128:129], v[128:129], v[32:33]
    v_pk_mul_f32 v[130:131], v[130:131], v[32:33]
    v_pk_mul_f32 v[132:133], v[132:133], v[32:33]
    v_pk_mul_f32 v[134:135], v[134:135], v[32:33]
    v_cvt_pk_bf16_f32 v24, v128, v129
    v_cvt_pk_bf16_f32 v25, v130, v131
    v_cvt_pk_bf16_f32 v26, v132, v133
    v_cvt_pk_bf16_f32 v27, v134, v135
    v_accvgpr_write_b32 a128, v24
    v_accvgpr_write_b32 a129, v25
    v_accvgpr_write_b32 a130, v26
    v_accvgpr_write_b32 a131, v27
    v_pk_mul_f32 v[136:137], v[136:137], v[32:33]
    v_pk_mul_f32 v[138:139], v[138:139], v[32:33]
    v_pk_mul_f32 v[140:141], v[140:141], v[32:33]
    v_pk_mul_f32 v[142:143], v[142:143], v[32:33]
    v_cvt_pk_bf16_f32 v24, v136, v137
    v_cvt_pk_bf16_f32 v25, v138, v139
    v_cvt_pk_bf16_f32 v26, v140, v141
    v_cvt_pk_bf16_f32 v27, v142, v143
    v_accvgpr_write_b32 a132, v24
    v_accvgpr_write_b32 a133, v25
    v_accvgpr_write_b32 a134, v26
    v_accvgpr_write_b32 a135, v27
    v_pk_mul_f32 v[144:145], v[144:145], v[32:33]
    v_pk_mul_f32 v[146:147], v[146:147], v[32:33]
    v_pk_mul_f32 v[148:149], v[148:149], v[32:33]
    v_pk_mul_f32 v[150:151], v[150:151], v[32:33]
    v_cvt_pk_bf16_f32 v24, v144, v145
    v_cvt_pk_bf16_f32 v25, v146, v147
    v_cvt_pk_bf16_f32 v26, v148, v149
    v_cvt_pk_bf16_f32 v27, v150, v151
    v_accvgpr_write_b32 a136, v24
    v_accvgpr_write_b32 a137, v25
    v_accvgpr_write_b32 a138, v26
    v_accvgpr_write_b32 a139, v27
    v_pk_mul_f32 v[152:153], v[152:153], v[32:33]
    v_pk_mul_f32 v[154:155], v[154:155], v[32:33]
    v_pk_mul_f32 v[156:157], v[156:157], v[32:33]
    v_pk_mul_f32 v[158:159], v[158:159], v[32:33]
    v_cvt_pk_bf16_f32 v24, v152, v153
    v_cvt_pk_bf16_f32 v25, v154, v155
    v_cvt_pk_bf16_f32 v26, v156, v157
    v_cvt_pk_bf16_f32 v27, v158, v159
    v_accvgpr_write_b32 a140, v24
    v_accvgpr_write_b32 a141, v25
    v_accvgpr_write_b32 a142, v26
    v_accvgpr_write_b32 a143, v27
    v_pk_mul_f32 v[160:161], v[160:161], v[32:33]
    v_pk_mul_f32 v[162:163], v[162:163], v[32:33]
    v_pk_mul_f32 v[164:165], v[164:165], v[32:33]
    v_pk_mul_f32 v[166:167], v[166:167], v[32:33]
    v_cvt_pk_bf16_f32 v24, v160, v161
    v_cvt_pk_bf16_f32 v25, v162, v163
    v_cvt_pk_bf16_f32 v26, v164, v165
    v_cvt_pk_bf16_f32 v27, v166, v167
    v_accvgpr_write_b32 a144, v24
    v_accvgpr_write_b32 a145, v25
    v_accvgpr_write_b32 a146, v26
    v_accvgpr_write_b32 a147, v27
    v_pk_mul_f32 v[168:169], v[168:169], v[32:33]
    v_pk_mul_f32 v[170:171], v[170:171], v[32:33]
    v_pk_mul_f32 v[172:173], v[172:173], v[32:33]
    v_pk_mul_f32 v[174:175], v[174:175], v[32:33]
    v_cvt_pk_bf16_f32 v24, v168, v169
    v_cvt_pk_bf16_f32 v25, v170, v171
    v_cvt_pk_bf16_f32 v26, v172, v173
    v_cvt_pk_bf16_f32 v27, v174, v175
    v_accvgpr_write_b32 a148, v24
    v_accvgpr_write_b32 a149, v25
    v_accvgpr_write_b32 a150, v26
    v_accvgpr_write_b32 a151, v27
    v_pk_mul_f32 v[176:177], v[176:177], v[32:33]
    v_pk_mul_f32 v[178:179], v[178:179], v[32:33]
    v_pk_mul_f32 v[180:181], v[180:181], v[32:33]
    v_pk_mul_f32 v[182:183], v[182:183], v[32:33]
    v_cvt_pk_bf16_f32 v24, v176, v177
    v_cvt_pk_bf16_f32 v25, v178, v179
    v_cvt_pk_bf16_f32 v26, v180, v181
    v_cvt_pk_bf16_f32 v27, v182, v183
    v_accvgpr_write_b32 a152, v24
    v_accvgpr_write_b32 a153, v25
    v_accvgpr_write_b32 a154, v26
    v_accvgpr_write_b32 a155, v27
    v_pk_mul_f32 v[184:185], v[184:185], v[32:33]
    v_pk_mul_f32 v[186:187], v[186:187], v[32:33]
    v_pk_mul_f32 v[188:189], v[188:189], v[32:33]
    v_pk_mul_f32 v[190:191], v[190:191], v[32:33]
    v_cvt_pk_bf16_f32 v24, v184, v185
    v_cvt_pk_bf16_f32 v25, v186, v187
    v_cvt_pk_bf16_f32 v26, v188, v189
    v_cvt_pk_bf16_f32 v27, v190, v191
    v_accvgpr_write_b32 a156, v24
    v_accvgpr_write_b32 a157, v25
    v_accvgpr_write_b32 a158, v26
    v_accvgpr_write_b32 a159, v27
    v_pk_mul_f32 v[192:193], v[192:193], v[32:33]
    v_pk_mul_f32 v[194:195], v[194:195], v[32:33]
    v_pk_mul_f32 v[196:197], v[196:197], v[32:33]
    v_pk_mul_f32 v[198:199], v[198:199], v[32:33]
    v_cvt_pk_bf16_f32 v24, v192, v193
    v_cvt_pk_bf16_f32 v25, v194, v195
    v_cvt_pk_bf16_f32 v26, v196, v197
    v_cvt_pk_bf16_f32 v27, v198, v199
    v_accvgpr_write_b32 a160, v24
    v_accvgpr_write_b32 a161, v25
    v_accvgpr_write_b32 a162, v26
    v_accvgpr_write_b32 a163, v27
    v_pk_mul_f32 v[200:201], v[200:201], v[32:33]
    v_pk_mul_f32 v[202:203], v[202:203], v[32:33]
    v_pk_mul_f32 v[204:205], v[204:205], v[32:33]
    v_pk_mul_f32 v[206:207], v[206:207], v[32:33]
    v_cvt_pk_bf16_f32 v24, v200, v201
    v_cvt_pk_bf16_f32 v25, v202, v203
    v_cvt_pk_bf16_f32 v26, v204, v205
    v_cvt_pk_bf16_f32 v27, v206, v207
    v_accvgpr_write_b32 a164, v24
    v_accvgpr_write_b32 a165, v25
    v_accvgpr_write_b32 a166, v26
    v_accvgpr_write_b32 a167, v27
    v_pk_mul_f32 v[208:209], v[208:209], v[32:33]
    v_pk_mul_f32 v[210:211], v[210:211], v[32:33]
    v_pk_mul_f32 v[212:213], v[212:213], v[32:33]
    v_pk_mul_f32 v[214:215], v[214:215], v[32:33]
    v_cvt_pk_bf16_f32 v24, v208, v209
    v_cvt_pk_bf16_f32 v25, v210, v211
    v_cvt_pk_bf16_f32 v26, v212, v213
    v_cvt_pk_bf16_f32 v27, v214, v215
    v_accvgpr_write_b32 a168, v24
    v_accvgpr_write_b32 a169, v25
    v_accvgpr_write_b32 a170, v26
    v_accvgpr_write_b32 a171, v27
    v_pk_mul_f32 v[216:217], v[216:217], v[32:33]
    v_pk_mul_f32 v[218:219], v[218:219], v[32:33]
    v_pk_mul_f32 v[220:221], v[220:221], v[32:33]
    v_pk_mul_f32 v[222:223], v[222:223], v[32:33]
    v_cvt_pk_bf16_f32 v24, v216, v217
    v_cvt_pk_bf16_f32 v25, v218, v219
    v_cvt_pk_bf16_f32 v26, v220, v221
    v_cvt_pk_bf16_f32 v27, v222, v223
    v_accvgpr_write_b32 a172, v24
    v_accvgpr_write_b32 a173, v25
    v_accvgpr_write_b32 a174, v26
    v_accvgpr_write_b32 a175, v27
    v_pk_mul_f32 v[224:225], v[224:225], v[32:33]
    v_pk_mul_f32 v[226:227], v[226:227], v[32:33]
    v_pk_mul_f32 v[228:229], v[228:229], v[32:33]
    v_pk_mul_f32 v[230:231], v[230:231], v[32:33]
    v_cvt_pk_bf16_f32 v24, v224, v225
    v_cvt_pk_bf16_f32 v25, v226, v227
    v_cvt_pk_bf16_f32 v26, v228, v229
    v_cvt_pk_bf16_f32 v27, v230, v231
    v_accvgpr_write_b32 a176, v24
    v_accvgpr_write_b32 a177, v25
    v_accvgpr_write_b32 a178, v26
    v_accvgpr_write_b32 a179, v27
    v_pk_mul_f32 v[232:233], v[232:233], v[32:33]
    v_pk_mul_f32 v[234:235], v[234:235], v[32:33]
    v_pk_mul_f32 v[236:237], v[236:237], v[32:33]
    v_pk_mul_f32 v[238:239], v[238:239], v[32:33]
    v_cvt_pk_bf16_f32 v24, v232, v233
    v_cvt_pk_bf16_f32 v25, v234, v235
    v_cvt_pk_bf16_f32 v26, v236, v237
    v_cvt_pk_bf16_f32 v27, v238, v239
    v_accvgpr_write_b32 a180, v24
    v_accvgpr_write_b32 a181, v25
    v_accvgpr_write_b32 a182, v26
    v_accvgpr_write_b32 a183, v27
    v_pk_mul_f32 v[240:241], v[240:241], v[32:33]
    v_pk_mul_f32 v[242:243], v[242:243], v[32:33]
    v_pk_mul_f32 v[244:245], v[244:245], v[32:33]
    v_pk_mul_f32 v[246:247], v[246:247], v[32:33]
    v_cvt_pk_bf16_f32 v24, v240, v241
    v_cvt_pk_bf16_f32 v25, v242, v243
    v_cvt_pk_bf16_f32 v26, v244, v245
    v_cvt_pk_bf16_f32 v27, v246, v247
    v_accvgpr_write_b32 a184, v24
    v_accvgpr_write_b32 a185, v25
    v_accvgpr_write_b32 a186, v26
    v_accvgpr_write_b32 a187, v27
    v_pk_mul_f32 v[248:249], v[248:249], v[32:33]
    v_pk_mul_f32 v[250:251], v[250:251], v[32:33]
    v_pk_mul_f32 v[252:253], v[252:253], v[32:33]
    v_pk_mul_f32 v[254:255], v[254:255], v[32:33]
    v_cvt_pk_bf16_f32 v24, v248, v249
    v_cvt_pk_bf16_f32 v25, v250, v251
    v_cvt_pk_bf16_f32 v26, v252, v253
    v_cvt_pk_bf16_f32 v27, v254, v255
    v_accvgpr_write_b32 a188, v24
    v_accvgpr_write_b32 a189, v25
    v_accvgpr_write_b32 a190, v26
    v_accvgpr_write_b32 a191, v27
    v_accvgpr_write_b32 a0, 0
    v_accvgpr_write_b32 a1, 0
    v_accvgpr_write_b32 a2, 0
    v_accvgpr_write_b32 a3, 0
    v_accvgpr_write_b32 a4, 0
    v_accvgpr_write_b32 a5, 0
    v_accvgpr_write_b32 a6, 0
    v_accvgpr_write_b32 a7, 0
    v_accvgpr_write_b32 a8, 0
    v_accvgpr_write_b32 a9, 0
    v_accvgpr_write_b32 a10, 0
    v_accvgpr_write_b32 a11, 0
    v_accvgpr_write_b32 a12, 0
    v_accvgpr_write_b32 a13, 0
    v_accvgpr_write_b32 a14, 0
    v_accvgpr_write_b32 a15, 0
    s_waitcnt vmcnt(0)
    s_cmp_lg_u32 s40, 0
    s_cbranch_scc1 Lk12_kv_ok
    v_cmp_eq_u32 vcc, v57, v12
    s_and_b32 s43, vcc_lo, 0xff
    s_cmp_eq_u32 s43, 0xff
    s_cbranch_scc1 Lk12_kv_ok
    s_mov_b32 s45, 2097152
Lk12_kv_spin:
    s_add_u32 s92, s14, 68288512
    s_addc_u32 s93, s15, 0
    s_mov_b32 s94, 38912
    s_mov_b32 s95, 0x20000
    buffer_load_dword v12, v47, s[92:95], 0 offen sc1
    s_waitcnt vmcnt(0)
    s_sub_u32 s45, s45, 1
    s_cbranch_scc1 Lk12_kv_ok
    v_cmp_eq_u32 vcc, v57, v12
    s_and_b32 s43, vcc_lo, 0xff
    s_cmp_eq_u32 s43, 0xff
    s_cbranch_scc0 Lk12_kv_spin
Lk12_kv_ok:
    s_barrier
    s_add_u32 m0, s51, 65536
    s_add_u32 s43, s51, 0
    buffer_load_dwordx4 v3, s[24:27], s43 offen offset:0 lds
    s_add_u32 m0, s51, 65536
    s_add_u32 s43, s51, 0
    buffer_load_dwordx4 v3, s[24:27], s43 offen offset:1024 lds
    s_add_u32 m0, s51, 65536
    s_add_u32 s43, s51, 0
    buffer_load_dwordx4 v3, s[24:27], s43 offen offset:2048 lds
    s_add_u32 m0, s51, 65536
    s_add_u32 s43, s51, 0
    buffer_load_dwordx4 v3, s[24:27], s43 offen offset:3072 lds
    s_add_u32 m0, s51, 81920
    s_add_u32 s43, s51, 16384
    buffer_load_dwordx4 v3, s[24:27], s43 offen offset:0 lds
    s_add_u32 m0, s51, 81920
    s_add_u32 s43, s51, 16384
    buffer_load_dwordx4 v3, s[24:27], s43 offen offset:1024 lds
    s_add_u32 m0, s51, 81920
    s_add_u32 s43, s51, 16384
    buffer_load_dwordx4 v3, s[24:27], s43 offen offset:2048 lds
    s_add_u32 m0, s51, 81920
    s_add_u32 s43, s51, 16384
    buffer_load_dwordx4 v3, s[24:27], s43 offen offset:3072 lds
    s_add_u32 m0, s51, 98304
    s_add_u32 s43, s51, 32768
    buffer_load_dwordx4 v3, s[24:27], s43 offen offset:0 lds
    s_add_u32 m0, s51, 98304
    s_add_u32 s43, s51, 32768
    buffer_load_dwordx4 v3, s[24:27], s43 offen offset:1024 lds
    s_add_u32 m0, s51, 98304
    s_add_u32 s43, s51, 32768
    buffer_load_dwordx4 v3, s[24:27], s43 offen offset:2048 lds
    s_add_u32 m0, s51, 98304
    s_add_u32 s43, s51, 32768
    buffer_load_dwordx4 v3, s[24:27], s43 offen offset:3072 lds
    v_accvgpr_write_b32 a16, 0
    v_accvgpr_write_b32 a17, 0
    v_accvgpr_write_b32 a18, 0
    v_accvgpr_write_b32 a19, 0
    v_accvgpr_write_b32 a20, 0
    v_accvgpr_write_b32 a21, 0
    v_accvgpr_write_b32 a22, 0
    v_accvgpr_write_b32 a23, 0
    v_accvgpr_write_b32 a24, 0
    v_accvgpr_write_b32 a25, 0
    v_accvgpr_write_b32 a26, 0
    v_accvgpr_write_b32 a27, 0
    v_accvgpr_write_b32 a28, 0
    v_accvgpr_write_b32 a29, 0
    v_accvgpr_write_b32 a30, 0
    v_accvgpr_write_b32 a31, 0
    v_accvgpr_write_b32 a32, 0
    v_accvgpr_write_b32 a33, 0
    v_accvgpr_write_b32 a34, 0
    v_accvgpr_write_b32 a35, 0
    v_accvgpr_write_b32 a36, 0
    v_accvgpr_write_b32 a37, 0
    v_accvgpr_write_b32 a38, 0
    v_accvgpr_write_b32 a39, 0
    v_accvgpr_write_b32 a40, 0
    v_accvgpr_write_b32 a41, 0
    v_accvgpr_write_b32 a42, 0
    v_accvgpr_write_b32 a43, 0
    v_accvgpr_write_b32 a44, 0
    v_accvgpr_write_b32 a45, 0
    v_accvgpr_write_b32 a46, 0
    v_accvgpr_write_b32 a47, 0
    v_accvgpr_write_b32 a48, 0
    v_accvgpr_write_b32 a49, 0
    v_accvgpr_write_b32 a50, 0
    v_accvgpr_write_b32 a51, 0
    v_accvgpr_write_b32 a52, 0
    v_accvgpr_write_b32 a53, 0
    v_accvgpr_write_b32 a54, 0
    v_accvgpr_write_b32 a55, 0
    v_accvgpr_write_b32 a56, 0
    v_accvgpr_write_b32 a57, 0
    v_accvgpr_write_b32 a58, 0
    v_accvgpr_write_b32 a59, 0
    v_accvgpr_write_b32 a60, 0
    v_accvgpr_write_b32 a61, 0
    v_accvgpr_write_b32 a62, 0
    v_accvgpr_write_b32 a63, 0
    v_accvgpr_write_b32 a64, 0
    v_accvgpr_write_b32 a65, 0
    v_accvgpr_write_b32 a66, 0
    v_accvgpr_write_b32 a67, 0
    v_accvgpr_write_b32 a68, 0
    v_accvgpr_write_b32 a69, 0
    v_accvgpr_write_b32 a70, 0
    v_accvgpr_write_b32 a71, 0
    v_accvgpr_write_b32 a72, 0
    v_accvgpr_write_b32 a73, 0
    v_accvgpr_write_b32 a74, 0
    v_accvgpr_write_b32 a75, 0
    v_accvgpr_write_b32 a76, 0
    v_accvgpr_write_b32 a77, 0
    v_accvgpr_write_b32 a78, 0
    v_accvgpr_write_b32 a79, 0
    v_accvgpr_write_b32 a80, 0
    v_accvgpr_write_b32 a81, 0
    v_accvgpr_write_b32 a82, 0
    v_accvgpr_write_b32 a83, 0
    v_accvgpr_write_b32 a84, 0
    v_accvgpr_write_b32 a85, 0
    v_accvgpr_write_b32 a86, 0
    v_accvgpr_write_b32 a87, 0
    v_accvgpr_write_b32 a88, 0
    v_accvgpr_write_b32 a89, 0
    v_accvgpr_write_b32 a90, 0
    v_accvgpr_write_b32 a91, 0
    v_accvgpr_write_b32 a92, 0
    v_accvgpr_write_b32 a93, 0
    v_accvgpr_write_b32 a94, 0
    v_accvgpr_write_b32 a95, 0
    v_accvgpr_write_b32 a96, 0
    v_accvgpr_write_b32 a97, 0
    v_accvgpr_write_b32 a98, 0
    v_accvgpr_write_b32 a99, 0
    v_accvgpr_write_b32 a100, 0
    v_accvgpr_write_b32 a101, 0
    v_accvgpr_write_b32 a102, 0
    v_accvgpr_write_b32 a103, 0
    v_accvgpr_write_b32 a104, 0
    v_accvgpr_write_b32 a105, 0
    v_accvgpr_write_b32 a106, 0
    v_accvgpr_write_b32 a107, 0
    v_accvgpr_write_b32 a108, 0
    v_accvgpr_write_b32 a109, 0
    v_accvgpr_write_b32 a110, 0
    v_accvgpr_write_b32 a111, 0
    v_accvgpr_write_b32 a112, 0
    v_accvgpr_write_b32 a113, 0
    v_accvgpr_write_b32 a114, 0
    v_accvgpr_write_b32 a115, 0
    v_accvgpr_write_b32 a116, 0
    v_accvgpr_write_b32 a117, 0
    v_accvgpr_write_b32 a118, 0
    v_accvgpr_write_b32 a119, 0
    v_accvgpr_write_b32 a120, 0
    v_accvgpr_write_b32 a121, 0
    v_accvgpr_write_b32 a122, 0
    v_accvgpr_write_b32 a123, 0
    v_accvgpr_write_b32 a124, 0
    v_accvgpr_write_b32 a125, 0
    v_accvgpr_write_b32 a126, 0
    v_accvgpr_write_b32 a127, 0
    s_add_u32 m0, s51, 65536
    s_add_u32 s46, s51, 131072
    v_mov_b32 v16, 0
    v_mov_b32 v17, 0
    v_mov_b32 v18, 0
    v_mov_b32 v19, 0
    v_mov_b32 v20, 0
    v_mov_b32 v21, 0
    v_and_b32 v24, 31, v2
    v_lshrrev_b32 v25, 5, v2
    v_lshlrev_b32 v25, 2, v25
    v_sub_u32 v24, v24, v25
    s_lshl_b32 s43, s56, 5
    v_add_u32 v13, s43, v24
    v_mov_b32 v22, v13
    s_lshl_b32 s43, s57, 5
    v_add_u32 v14, s43, v24
    v_mov_b32 v23, v14
    s_waitcnt vmcnt(0)
    s_barrier
    v_add_u32 v10, 65536, v3
    v_add_u32 v12, 81920, v3
    v_add_u32 v11, 98304, v3
    ds_read_b128 a[192:195], v10 offset:0
    ds_read_b128 a[196:199], v10 offset:1024
    ds_read_b128 a[200:203], v10 offset:2048
    ds_read_b128 a[204:207], v10 offset:3072
    ds_read_b128 a[208:211], v10 offset:4096
    ds_read_b128 a[212:215], v10 offset:5120
    ds_read_b128 a[216:219], v10 offset:6144
    ds_read_b128 a[220:223], v10 offset:7168
    s_waitcnt lgkmcnt(0)
    v_mfma_f32_32x32x16_bf16 v[64:79], a[192:195], a[128:131], 0
    v_mfma_f32_32x32x16_bf16 v[64:79], a[196:199], a[132:135], v[64:79]
    v_mfma_f32_32x32x16_bf16 v[64:79], a[200:203], a[136:139], v[64:79]
    v_mfma_f32_32x32x16_bf16 v[64:79], a[204:207], a[140:143], v[64:79]
    v_mfma_f32_32x32x16_bf16 v[64:79], a[208:211], a[144:147], v[64:79]
    v_mfma_f32_32x32x16_bf16 v[64:79], a[212:215], a[148:151], v[64:79]
    v_mfma_f32_32x32x16_bf16 v[64:79], a[216:219], a[152:155], v[64:79]
    v_mfma_f32_32x32x16_bf16 v[64:79], a[220:223], a[156:159], v[64:79]
    v_mfma_f32_32x32x16_bf16 v[80:95], a[192:195], a[160:163], 0
    v_mfma_f32_32x32x16_bf16 v[80:95], a[196:199], a[164:167], v[80:95]
    v_mfma_f32_32x32x16_bf16 v[80:95], a[200:203], a[168:171], v[80:95]
    v_mfma_f32_32x32x16_bf16 v[80:95], a[204:207], a[172:175], v[80:95]
    v_mfma_f32_32x32x16_bf16 v[80:95], a[208:211], a[176:179], v[80:95]
    v_mfma_f32_32x32x16_bf16 v[80:95], a[212:215], a[180:183], v[80:95]
    v_mfma_f32_32x32x16_bf16 v[80:95], a[216:219], a[184:187], v[80:95]
    v_mfma_f32_32x32x16_bf16 v[80:95], a[220:223], a[188:191], v[80:95]
    ds_read_b128 a[192:195], v12 offset:0
    ds_read_b128 a[196:199], v12 offset:1024
    ds_read_b128 a[200:203], v12 offset:2048
    ds_read_b128 a[204:207], v12 offset:3072
    ds_read_b128 a[208:211], v12 offset:4096
    ds_read_b128 a[212:215], v12 offset:5120
    ds_read_b128 a[216:219], v12 offset:6144
    ds_read_b128 a[220:223], v12 offset:7168
    ds_read_b128 a[224:227], v10 offset:8192
    ds_read_b128 a[228:231], v10 offset:10240
    ds_read_b128 a[232:235], v10 offset:12288
    ds_read_b128 a[236:239], v10 offset:14336
    ds_read_b128 a[240:243], v10 offset:9216
    ds_read_b128 a[244:247], v10 offset:11264
    ds_read_b128 a[248:251], v10 offset:13312
    ds_read_b128 a[252:255], v10 offset:15360
    v_cmp_le_i32 s[90:91], 0, v13
    v_cmp_le_i32 s[92:93], 1, v13
    v_cmp_le_i32 s[94:95], 2, v13
    v_cmp_le_i32 s[96:97], 3, v13
    v_cndmask_b32 v64, v5, v64, s[90:91]
    v_cndmask_b32 v65, v5, v65, s[92:93]
    v_cndmask_b32 v66, v5, v66, s[94:95]
    v_cndmask_b32 v67, v5, v67, s[96:97]
    v_cmp_le_i32 s[90:91], 8, v13
    v_cmp_le_i32 s[92:93], 9, v13
    v_cmp_le_i32 s[94:95], 10, v13
    v_cmp_le_i32 s[96:97], 11, v13
    v_cndmask_b32 v68, v5, v68, s[90:91]
    v_cndmask_b32 v69, v5, v69, s[92:93]
    v_cndmask_b32 v70, v5, v70, s[94:95]
    v_cndmask_b32 v71, v5, v71, s[96:97]
    v_cmp_le_i32 s[90:91], 16, v13
    v_cmp_le_i32 s[92:93], 17, v13
    v_cmp_le_i32 s[94:95], 18, v13
    v_cmp_le_i32 s[96:97], 19, v13
    v_cndmask_b32 v72, v5, v72, s[90:91]
    v_cndmask_b32 v73, v5, v73, s[92:93]
    v_cndmask_b32 v74, v5, v74, s[94:95]
    v_cndmask_b32 v75, v5, v75, s[96:97]
    v_cmp_le_i32 s[90:91], 24, v13
    v_cmp_le_i32 s[92:93], 25, v13
    v_cmp_le_i32 s[94:95], 26, v13
    v_cmp_le_i32 s[96:97], 27, v13
    v_cndmask_b32 v76, v5, v76, s[90:91]
    v_cndmask_b32 v77, v5, v77, s[92:93]
    s_add_u32 m0, s51, 114688
    s_add_u32 s43, s51, 49152
    buffer_load_dwordx4 v3, s[24:27], s43 offen offset:0 lds
    v_cndmask_b32 v78, v5, v78, s[94:95]
    v_cndmask_b32 v79, v5, v79, s[96:97]
    v_max3_f32 v24, v64, v65, v66
    v_max3_f32 v24, v67, v68, v24
    v_max3_f32 v24, v69, v70, v24
    v_max3_f32 v24, v71, v72, v24
    v_max3_f32 v24, v73, v74, v24
    v_max3_f32 v24, v75, v76, v24
    v_max3_f32 v24, v77, v78, v24
    v_max_f32 v24, v24, v79
    s_add_u32 m0, s51, 114688
    s_add_u32 s43, s51, 49152
    buffer_load_dwordx4 v3, s[24:27], s43 offen offset:1024 lds
    v_mov_b32 v25, v24
    s_nop 1
    v_permlane32_swap_b32 v24, v25
    v_max_f32 v24, v24, v25
    v_sub_f32 v64, v64, v24
    v_sub_f32 v65, v65, v24
    v_sub_f32 v66, v66, v24
    v_sub_f32 v67, v67, v24
    v_sub_f32 v68, v68, v24
    v_sub_f32 v69, v69, v24
    v_sub_f32 v70, v70, v24
    s_add_u32 m0, s51, 114688
    s_add_u32 s43, s51, 49152
    buffer_load_dwordx4 v3, s[24:27], s43 offen offset:2048 lds
    v_sub_f32 v71, v71, v24
    v_sub_f32 v72, v72, v24
    v_sub_f32 v73, v73, v24
    v_sub_f32 v74, v74, v24
    v_sub_f32 v75, v75, v24
    v_sub_f32 v76, v76, v24
    v_sub_f32 v77, v77, v24
    v_sub_f32 v78, v78, v24
    v_sub_f32 v79, v79, v24
    v_sub_f32 v112, 0, v24
    s_add_u32 m0, s51, 114688
    s_add_u32 s43, s51, 49152
    buffer_load_dwordx4 v3, s[24:27], s43 offen offset:3072 lds
    v_sub_f32 v113, 0, v24
    v_sub_f32 v114, 0, v24
    v_sub_f32 v115, 0, v24
    v_sub_f32 v116, 0, v24
    v_sub_f32 v117, 0, v24
    v_sub_f32 v118, 0, v24
    v_sub_f32 v119, 0, v24
    v_sub_f32 v120, 0, v24
    v_sub_f32 v121, 0, v24
    v_sub_f32 v122, 0, v24
    s_add_u32 m0, s51, 0
    s_add_u32 s43, s51, 65536
    buffer_load_dwordx4 v3, s[24:27], s43 offen offset:0 lds
    v_sub_f32 v123, 0, v24
    v_sub_f32 v124, 0, v24
    v_sub_f32 v125, 0, v24
    v_sub_f32 v126, 0, v24
    v_sub_f32 v127, 0, v24
    v_max3_f32 v24, v80, v81, v82
    v_max3_f32 v24, v83, v84, v24
    v_max3_f32 v24, v85, v86, v24
    v_max3_f32 v24, v87, v88, v24
    v_max3_f32 v24, v89, v90, v24
    s_add_u32 m0, s51, 0
    s_add_u32 s43, s51, 65536
    buffer_load_dwordx4 v3, s[24:27], s43 offen offset:1024 lds
    v_max3_f32 v24, v91, v92, v24
    v_max3_f32 v24, v93, v94, v24
    v_max_f32 v24, v24, v95
    v_mov_b32 v25, v24
    s_nop 1
    v_permlane32_swap_b32 v24, v25
    v_max_f32 v24, v24, v25
    v_sub_f32 v80, v80, v24
    v_sub_f32 v81, v81, v24
    v_sub_f32 v82, v82, v24
    v_sub_f32 v83, v83, v24
    s_add_u32 m0, s51, 0
    s_add_u32 s43, s51, 65536
    buffer_load_dwordx4 v3, s[24:27], s43 offen offset:2048 lds
    v_sub_f32 v84, v84, v24
    v_sub_f32 v85, v85, v24
    v_sub_f32 v86, v86, v24
    v_sub_f32 v87, v87, v24
    v_sub_f32 v88, v88, v24
    v_sub_f32 v89, v89, v24
    v_sub_f32 v90, v90, v24
    v_sub_f32 v91, v91, v24
    v_sub_f32 v92, v92, v24
    v_sub_f32 v93, v93, v24
    s_add_u32 m0, s51, 0
    s_add_u32 s43, s51, 65536
    buffer_load_dwordx4 v3, s[24:27], s43 offen offset:3072 lds
    v_sub_f32 v94, v94, v24
    v_sub_f32 v95, v95, v24
    v_sub_f32 v128, 0, v24
    v_sub_f32 v129, 0, v24
    v_sub_f32 v130, 0, v24
    v_sub_f32 v131, 0, v24
    v_sub_f32 v132, 0, v24
    v_sub_f32 v133, 0, v24
    v_sub_f32 v134, 0, v24
    v_sub_f32 v135, 0, v24
    s_add_u32 m0, s51, 16384
    s_add_u32 s43, s51, 81920
    buffer_load_dwordx4 v3, s[24:27], s43 offen offset:0 lds
    v_sub_f32 v136, 0, v24
    v_sub_f32 v137, 0, v24
    v_sub_f32 v138, 0, v24
    v_sub_f32 v139, 0, v24
    v_sub_f32 v140, 0, v24
    v_sub_f32 v141, 0, v24
    v_sub_f32 v142, 0, v24
    v_sub_f32 v143, 0, v24
    v_and_b32 v24, 31, v2
    v_lshrrev_b32 v25, 5, v2
    s_add_u32 m0, s51, 16384
    s_add_u32 s43, s51, 81920
    buffer_load_dwordx4 v3, s[24:27], s43 offen offset:1024 lds
    v_lshlrev_b32 v25, 2, v25
    v_sub_u32 v24, v24, v25
    v_cmp_le_i32 s[90:91], 0, v24
    v_cmp_le_i32 s[92:93], 1, v24
    v_cmp_le_i32 s[94:95], 2, v24
    v_cmp_le_i32 s[96:97], 3, v24
    v_cndmask_b32 v144, v5, v112, s[90:91]
    v_cndmask_b32 v160, v5, v128, s[90:91]
    v_cndmask_b32 v145, v5, v113, s[92:93]
    v_cndmask_b32 v161, v5, v129, s[92:93]
    s_add_u32 m0, s51, 16384
    s_add_u32 s43, s51, 81920
    buffer_load_dwordx4 v3, s[24:27], s43 offen offset:2048 lds
    v_cndmask_b32 v146, v5, v114, s[94:95]
    v_cndmask_b32 v162, v5, v130, s[94:95]
    v_cndmask_b32 v147, v5, v115, s[96:97]
    v_cndmask_b32 v163, v5, v131, s[96:97]
    v_cmp_le_i32 s[90:91], 8, v24
    v_cmp_le_i32 s[92:93], 9, v24
    v_cmp_le_i32 s[94:95], 10, v24
    v_cmp_le_i32 s[96:97], 11, v24
    v_cndmask_b32 v148, v5, v116, s[90:91]
    v_cndmask_b32 v164, v5, v132, s[90:91]
    s_add_u32 m0, s51, 16384
    s_add_u32 s43, s51, 81920
    buffer_load_dwordx4 v3, s[24:27], s43 offen offset:3072 lds
    v_cndmask_b32 v149, v5, v117, s[92:93]
    v_cndmask_b32 v165, v5, v133, s[92:93]
    v_cndmask_b32 v150, v5, v118, s[94:95]
    v_cndmask_b32 v166, v5, v134, s[94:95]
    v_cndmask_b32 v151, v5, v119, s[96:97]
    v_cndmask_b32 v167, v5, v135, s[96:97]
    v_cmp_le_i32 s[90:91], 16, v24
    v_cmp_le_i32 s[92:93], 17, v24
    v_cmp_le_i32 s[94:95], 18, v24
    v_cmp_le_i32 s[96:97], 19, v24
    v_cndmask_b32 v152, v5, v120, s[90:91]
    v_cndmask_b32 v168, v5, v136, s[90:91]
    v_cndmask_b32 v153, v5, v121, s[92:93]
    v_cndmask_b32 v169, v5, v137, s[92:93]
    v_cndmask_b32 v154, v5, v122, s[94:95]
    v_cndmask_b32 v170, v5, v138, s[94:95]
    v_cndmask_b32 v155, v5, v123, s[96:97]
    v_cndmask_b32 v171, v5, v139, s[96:97]
    v_cmp_le_i32 s[90:91], 24, v24
    v_cmp_le_i32 s[92:93], 25, v24
    v_cmp_le_i32 s[94:95], 26, v24
    v_cmp_le_i32 s[96:97], 27, v24
    v_cndmask_b32 v156, v5, v124, s[90:91]
    v_cndmask_b32 v172, v5, v140, s[90:91]
    v_cndmask_b32 v157, v5, v125, s[92:93]
    v_cndmask_b32 v173, v5, v141, s[92:93]
    v_cndmask_b32 v158, v5, v126, s[94:95]
    v_cndmask_b32 v174, v5, v142, s[94:95]
    v_cndmask_b32 v159, v5, v127, s[96:97]
    v_cndmask_b32 v175, v5, v143, s[96:97]
    s_add_u32 m0, s51, 32768
    s_add_u32 s43, s51, 98304
    buffer_load_dwordx4 v3, s[24:27], s43 offen offset:0 lds
    v_mov_b32 v176, v5
    v_mov_b32 v177, v5
    v_mov_b32 v178, v5
    v_mov_b32 v179, v5
    v_mov_b32 v180, v5
    v_mov_b32 v181, v5
    v_mov_b32 v182, v5
    v_mov_b32 v183, v5
    v_mov_b32 v184, v5
    v_mov_b32 v185, v5
    s_add_u32 m0, s51, 32768
    s_add_u32 s43, s51, 98304
    buffer_load_dwordx4 v3, s[24:27], s43 offen offset:1024 lds
    v_mov_b32 v186, v5
    v_mov_b32 v187, v5
    v_mov_b32 v188, v5
    v_mov_b32 v189, v5
    v_mov_b32 v190, v5
    v_mov_b32 v191, v5
    v_exp_f32 v64, v64
    v_exp_f32 v65, v65
    v_add_f32 v16, v16, v64
    v_add_f32 v17, v17, v65
    s_add_u32 m0, s51, 32768
    s_add_u32 s43, s51, 98304
    buffer_load_dwordx4 v3, s[24:27], s43 offen offset:2048 lds
    v_exp_f32 v66, v66
    v_exp_f32 v67, v67
    v_add_f32 v16, v16, v66
    v_add_f32 v17, v17, v67
    v_exp_f32 v68, v68
    v_exp_f32 v69, v69
    v_add_f32 v16, v16, v68
    v_add_f32 v17, v17, v69
    v_exp_f32 v70, v70
    v_exp_f32 v71, v71
    s_add_u32 m0, s51, 32768
    s_add_u32 s43, s51, 98304
    buffer_load_dwordx4 v3, s[24:27], s43 offen offset:3072 lds
    v_add_f32 v16, v16, v70
    v_add_f32 v17, v17, v71
    v_exp_f32 v72, v72
    v_exp_f32 v73, v73
    v_add_f32 v16, v16, v72
    v_add_f32 v17, v17, v73
    v_exp_f32 v74, v74
    v_exp_f32 v75, v75
    v_add_f32 v16, v16, v74
    v_add_f32 v17, v17, v75
    s_add_u32 m0, s51, 49152
    s_add_u32 s43, s51, 114688
    buffer_load_dwordx4 v3, s[24:27], s43 offen offset:0 lds
    v_exp_f32 v76, v76
    v_exp_f32 v77, v77
    v_add_f32 v16, v16, v76
    v_add_f32 v17, v17, v77
    v_exp_f32 v78, v78
    v_exp_f32 v79, v79
    v_add_f32 v16, v16, v78
    v_add_f32 v17, v17, v79
    v_cvt_pk_bf16_f32 v96, v64, v65
    v_cvt_pk_bf16_f32 v97, v66, v67
    s_add_u32 m0, s51, 49152
    s_add_u32 s43, s51, 114688
    buffer_load_dwordx4 v3, s[24:27], s43 offen offset:1024 lds
    v_cvt_pk_bf16_f32 v98, v68, v69
    v_cvt_pk_bf16_f32 v99, v70, v71
    v_cvt_pk_bf16_f32 v100, v72, v73
    v_cvt_pk_bf16_f32 v101, v74, v75
    v_cvt_pk_bf16_f32 v102, v76, v77
    v_cvt_pk_bf16_f32 v103, v78, v79
    v_exp_f32 v80, v80
    v_exp_f32 v81, v81
    v_add_f32 v18, v18, v80
    v_add_f32 v19, v19, v81
    s_add_u32 m0, s51, 49152
    s_add_u32 s43, s51, 114688
    buffer_load_dwordx4 v3, s[24:27], s43 offen offset:2048 lds
    v_exp_f32 v82, v82
    v_exp_f32 v83, v83
    v_add_f32 v18, v18, v82
    v_add_f32 v19, v19, v83
    s_add_u32 m0, s51, 49152
    s_add_u32 s43, s51, 114688
    buffer_load_dwordx4 v3, s[24:27], s43 offen offset:3072 lds
    s_add_u32 m0, s51, 65536
    s_add_u32 s46, s51, 131072
    s_mov_b32 s16, s6
    s_mov_b32 s17, s7
    s_mov_b32 s18, 0
    s_mov_b32 s19, 0x20000
    s_mov_b32 s89, 0
    s_lshl_b32 s44, s41, 2
    s_add_u32 s44, s44, s40
    s_cmp_eq_u32 s42, 7
    s_cselect_b32 s16, s6, s16
    s_cselect_b32 s17, s7, s17
    s_cselect_b32 s18, 5242880, s18
    s_mul_i32 s43, s44, 27648
    s_add_u32 s43, s43, 0
    s_cmp_eq_u32 s42, 7
    s_cselect_b32 s89, s43, s89
    s_cmp_eq_u32 s42, 4
    s_cselect_b32 s16, s6, s16
    s_cselect_b32 s17, s7, s17
    s_cselect_b32 s18, 5242880, s18
    s_mul_i32 s43, s44, 15360
    s_add_u32 s43, s43, 3538944
    s_cmp_eq_u32 s42, 4
    s_cselect_b32 s89, s43, s89
    s_cmp_eq_u32 s42, 5
    s_cselect_b32 s16, s8, s16
    s_cselect_b32 s17, s9, s17
    s_cselect_b32 s18, 2211840, s18
    s_mul_i32 s43, s44, 19456
    s_add_u32 s43, s43, 0
    s_cmp_eq_u32 s42, 5
    s_cselect_b32 s89, s43, s89
    s_cmp_eq_u32 s42, 6
    s_cselect_b32 s16, s10, s16
    s_cselect_b32 s17, s11, s17
    s_cselect_b32 s18, 2211840, s18
    s_mul_i32 s43, s44, 23552
    s_add_u32 s43, s43, 0
    s_cmp_eq_u32 s42, 6
    s_cselect_b32 s89, s43, s89
    s_cmp_eq_u32 s42, 3
    s_cselect_b32 s16, s12, s16
    s_cselect_b32 s17, s13, s17
    s_cselect_b32 s18, 2211840, s18
    s_mul_i32 s43, s44, 11264
    s_add_u32 s43, s43, 0
    s_cmp_eq_u32 s42, 3
    s_cselect_b32 s89, s43, s89
    s_cmp_eq_u32 s42, 2
    s_cselect_b32 s16, s12, s16
    s_cselect_b32 s17, s13, s17
    s_cselect_b32 s18, 2211840, s18
    s_mul_i32 s43, s44, 7168
    s_add_u32 s43, s43, 1441792
    s_cmp_eq_u32 s42, 2
    s_cselect_b32 s89, s43, s89
    s_lshl_b32 s50, s42, 2
    s_sub_u32 s50, s50, 1
    s_max_i32 s50, s50, 0
    s_sub_u32 s50, s50, 1
    s_cbranch_scc1 Lk2_dd_end
Lk2_dd:
    s_waitcnt lgkmcnt(5)
    v_mfma_f32_32x32x16_bf16 v[64:79], a[192:195], a[128:131], v[112:127]
    v_exp_f32 v84, v84
    v_exp_f32 v85, v85
    v_cvt_pk_bf16_f32 v104, v80, v81
    v_add_f32 v18, v18, v84
    v_mfma_f32_32x32x16_bf16 v[64:79], a[196:199], a[132:135], v[64:79]
    v_exp_f32 v86, v86
    v_add_f32 v19, v19, v85
    v_exp_f32 v87, v87
    v_mfma_f32_32x32x16_bf16 v[64:79], a[200:203], a[136:139], v[64:79]
    v_add_f32 v18, v18, v86
    v_exp_f32 v88, v88
    v_add_f32 v19, v19, v87
    v_mfma_f32_32x32x16_bf16 v[64:79], a[204:207], a[140:143], v[64:79]
    v_exp_f32 v89, v89
    v_add_f32 v18, v18, v88
    v_mfma_f32_32x32x16_bf16 v[64:79], a[208:211], a[144:147], v[64:79]
    v_exp_f32 v90, v90
    v_add_f32 v19, v19, v89
    v_exp_f32 v91, v91
    v_mfma_f32_32x32x16_bf16 v[64:79], a[212:215], a[148:151], v[64:79]
    v_add_f32 v18, v18, v90
    v_exp_f32 v92, v92
    v_add_f32 v19, v19, v91
    v_mfma_f32_32x32x16_bf16 v[64:79], a[216:219], a[152:155], v[64:79]
    v_exp_f32 v93, v93
    v_add_f32 v18, v18, v92
    v_exp_f32 v94, v94
    v_mfma_f32_32x32x16_bf16 v[64:79], a[220:223], a[156:159], v[64:79]
    v_add_f32 v19, v19, v93
    v_exp_f32 v95, v95
    buffer_load_dwordx4 v[60:63], v3, s[16:19], s89 offen
    v_mfma_f32_32x32x16_bf16 a[0:15], a[224:227], v[96:99], a[0:15]
    v_add_f32 v18, v18, v94
    v_add_f32 v19, v19, v95
    v_cvt_pk_bf16_f32 v105, v82, v83
    v_cvt_pk_bf16_f32 v106, v84, v85
    v_cvt_pk_bf16_f32 v107, v86, v87
    v_mfma_f32_32x32x16_bf16 a[16:31], a[228:231], v[96:99], a[16:31]
    v_cvt_pk_bf16_f32 v108, v88, v89
    v_cvt_pk_bf16_f32 v109, v90, v91
    v_cvt_pk_bf16_f32 v110, v92, v93
    v_cvt_pk_bf16_f32 v111, v94, v95
    v_mfma_f32_32x32x16_bf16 a[32:47], a[232:235], v[96:99], a[32:47]
    v_exp_f32 v64, v64
    v_exp_f32 v65, v65
    s_waitcnt lgkmcnt(0)
    v_mfma_f32_32x32x16_bf16 a[48:63], a[236:239], v[96:99], a[48:63]
    v_add_f32 v16, v16, v64
    v_exp_f32 v66, v66
    v_add_f32 v17, v17, v65
    v_exp_f32 v67, v67
    v_mfma_f32_32x32x16_bf16 a[0:15], a[240:243], v[100:103], a[0:15]
    v_add_f32 v16, v16, v66
    v_exp_f32 v68, v68
    s_add_u32 s89, s89, 1024
    v_mfma_f32_32x32x16_bf16 a[16:31], a[244:247], v[100:103], a[16:31]
    v_add_f32 v17, v17, v67
    v_exp_f32 v69, v69
    v_mfma_f32_32x32x16_bf16 a[32:47], a[248:251], v[100:103], a[32:47]
    v_add_f32 v16, v16, v68
    v_exp_f32 v70, v70
    v_add_f32 v17, v17, v69
    v_mfma_f32_32x32x16_bf16 a[48:63], a[252:255], v[100:103], a[48:63]
    v_add_f32 v16, v16, v70
    v_exp_f32 v71, v71
    v_exp_f32 v72, v72
    v_mfma_f32_32x32x16_bf16 v[80:95], a[192:195], a[160:163], v[128:143]
    v_add_f32 v17, v17, v71
    v_exp_f32 v73, v73
    v_add_f32 v16, v16, v72
    v_mfma_f32_32x32x16_bf16 v[80:95], a[196:199], a[164:167], v[80:95]
    v_exp_f32 v74, v74
    v_add_f32 v17, v17, v73
    v_exp_f32 v75, v75
    v_mfma_f32_32x32x16_bf16 v[80:95], a[200:203], a[168:171], v[80:95]
    v_add_f32 v16, v16, v74
    s_waitcnt vmcnt(16) lgkmcnt(0)
    s_barrier
    v_mfma_f32_32x32x16_bf16 v[80:95], a[204:207], a[172:175], v[80:95]
    buffer_load_dwordx4 v3, s[24:27], s46 offen offset:0 lds
    ds_read_b128 a[192:195], v11 offset:0
    ds_read_b128 a[196:199], v11 offset:1024
    v_exp_f32 v76, v76
    v_mfma_f32_32x32x16_bf16 v[80:95], a[208:211], a[176:179], v[80:95]
    ds_read_b128 a[200:203], v11 offset:2048
    ds_read_b128 a[204:207], v11 offset:3072
    buffer_load_dwordx4 v3, s[24:27], s46 offen offset:1024 lds
    v_add_f32 v17, v17, v75
    v_mfma_f32_32x32x16_bf16 v[80:95], a[212:215], a[180:183], v[80:95]
    ds_read_b128 a[208:211], v11 offset:4096
    buffer_load_dwordx4 v3, s[24:27], s46 offen offset:2048 lds
    ds_read_b128 a[212:215], v11 offset:5120
    v_exp_f32 v77, v77
    v_mfma_f32_32x32x16_bf16 v[80:95], a[216:219], a[184:187], v[80:95]
    buffer_load_dwordx4 v3, s[24:27], s46 offen offset:3072 lds
    ds_read_b128 a[216:219], v11 offset:6144
    s_add_u32 m0, m0, 16384
    s_and_b32 m0, m0, 0x1ffff
    s_add_u32 s46, s46, 16384
    v_mfma_f32_32x32x16_bf16 v[80:95], a[220:223], a[188:191], v[80:95]
    ds_read_b128 a[220:223], v11 offset:7168
    v_add_f32 v16, v16, v76
    v_exp_f32 v78, v78
    v_mfma_f32_32x32x16_bf16 a[64:79], a[224:227], v[104:107], a[64:79]
    ds_read_b128 a[224:227], v12 offset:8192
    v_add_f32 v17, v17, v77
    v_add_f32 v16, v16, v78
    v_mfma_f32_32x32x16_bf16 a[80:95], a[228:231], v[104:107], a[80:95]
    ds_read_b128 a[228:231], v12 offset:10240
    v_exp_f32 v79, v79
    v_cvt_pk_bf16_f32 v96, v64, v65
    v_cvt_pk_bf16_f32 v97, v66, v67
    v_mfma_f32_32x32x16_bf16 a[96:111], a[232:235], v[104:107], a[96:111]
    ds_read_b128 a[232:235], v12 offset:12288
    v_exp_f32 v80, v80
    v_exp_f32 v81, v81
    v_mfma_f32_32x32x16_bf16 a[112:127], a[236:239], v[104:107], a[112:127]
    ds_read_b128 a[236:239], v12 offset:14336
    v_add_f32 v18, v18, v80
    v_exp_f32 v82, v82
    v_add_f32 v17, v17, v79
    v_add_f32 v19, v19, v81
    v_mfma_f32_32x32x16_bf16 a[64:79], a[240:243], v[108:111], a[64:79]
    ds_read_b128 a[240:243], v12 offset:9216
    v_exp_f32 v83, v83
    v_cvt_pk_bf16_f32 v98, v68, v69
    v_cvt_pk_bf16_f32 v99, v70, v71
    v_cvt_pk_bf16_f32 v100, v72, v73
    v_mfma_f32_32x32x16_bf16 a[80:95], a[244:247], v[108:111], a[80:95]
    ds_read_b128 a[244:247], v12 offset:11264
    v_cvt_pk_bf16_f32 v101, v74, v75
    v_cvt_pk_bf16_f32 v102, v76, v77
    v_cvt_pk_bf16_f32 v103, v78, v79
    v_add_f32 v18, v18, v82
    v_add_f32 v19, v19, v83
    v_mfma_f32_32x32x16_bf16 a[96:111], a[248:251], v[108:111], a[96:111]
    ds_read_b128 a[248:251], v12 offset:13312
    v_mfma_f32_32x32x16_bf16 a[112:127], a[252:255], v[108:111], a[112:127]
    ds_read_b128 a[252:255], v12 offset:15360
    v_mov_b32 v10, v12
    v_mov_b32 v12, v11
    v_add_u32 v11, 0x4000, v11
    v_and_b32 v11, 0x1ffff, v11
    s_sub_u32 s50, s50, 1
    s_cbranch_scc0 Lk2_dd
Lk2_dd_end:
    s_cmp_eq_u32 s42, 0
    s_cselect_b32 s50, 3, 4
    s_lshl_b32 s43, s42, 2
    s_max_u32 s43, s43, 1
    s_sub_i32 s45, s43, s56
    s_lshl_b32 s43, s43, 5
    v_subrev_u32 v13, s43, v22
    s_sub_u32 s50, s50, 1
    s_cbranch_scc1 Lk2_ddm_end
Lk2_ddm:
    s_waitcnt lgkmcnt(5)
    s_cmp_lt_i32 s45, 0
    s_cbranch_scc1 Lsel_DD_0_vis
    s_cmp_eq_i32 s45, 0
    s_cbranch_scc1 Lsel_DD_0_diag
    v_mfma_f32_32x32x16_bf16 v[64:79], a[192:195], a[128:131], v[176:191]
    s_branch Lsel_DD_0_next
Lsel_DD_0_diag:
    v_mfma_f32_32x32x16_bf16 v[64:79], a[192:195], a[128:131], v[144:159]
    s_branch Lsel_DD_0_next
Lsel_DD_0_vis:
    v_mfma_f32_32x32x16_bf16 v[64:79], a[192:195], a[128:131], v[112:127]
Lsel_DD_0_next:
    v_exp_f32 v84, v84
    v_exp_f32 v85, v85
    v_cvt_pk_bf16_f32 v104, v80, v81
    v_add_f32 v18, v18, v84
    v_mfma_f32_32x32x16_bf16 v[64:79], a[196:199], a[132:135], v[64:79]
    v_exp_f32 v86, v86
    v_add_f32 v19, v19, v85
    v_exp_f32 v87, v87
    v_mfma_f32_32x32x16_bf16 v[64:79], a[200:203], a[136:139], v[64:79]
    v_add_f32 v18, v18, v86
    v_exp_f32 v88, v88
    v_mfma_f32_32x32x16_bf16 v[64:79], a[204:207], a[140:143], v[64:79]
    v_add_f32 v19, v19, v87
    v_exp_f32 v89, v89
    v_add_f32 v18, v18, v88
    v_mfma_f32_32x32x16_bf16 v[64:79], a[208:211], a[144:147], v[64:79]
    v_exp_f32 v90, v90
    v_add_f32 v19, v19, v89
    v_exp_f32 v91, v91
    v_mfma_f32_32x32x16_bf16 v[64:79], a[212:215], a[148:151], v[64:79]
    v_add_f32 v18, v18, v90
    v_exp_f32 v92, v92
    v_add_f32 v19, v19, v91
    v_mfma_f32_32x32x16_bf16 v[64:79], a[216:219], a[152:155], v[64:79]
    v_exp_f32 v93, v93
    v_add_f32 v18, v18, v92
    v_mfma_f32_32x32x16_bf16 v[64:79], a[220:223], a[156:159], v[64:79]
    v_exp_f32 v94, v94
    v_add_f32 v19, v19, v93
    v_exp_f32 v95, v95
    v_add_f32 v18, v18, v94
    v_mfma_f32_32x32x16_bf16 a[0:15], a[224:227], v[96:99], a[0:15]
    v_add_f32 v19, v19, v95
    v_cvt_pk_bf16_f32 v105, v82, v83
    v_cvt_pk_bf16_f32 v106, v84, v85
    v_cvt_pk_bf16_f32 v107, v86, v87
    v_mfma_f32_32x32x16_bf16 a[16:31], a[228:231], v[96:99], a[16:31]
    v_cvt_pk_bf16_f32 v108, v88, v89
    v_cvt_pk_bf16_f32 v109, v90, v91
    v_cvt_pk_bf16_f32 v110, v92, v93
    v_cvt_pk_bf16_f32 v111, v94, v95
    v_mfma_f32_32x32x16_bf16 a[32:47], a[232:235], v[96:99], a[32:47]
    v_exp_f32 v64, v64
    v_exp_f32 v65, v65
    s_waitcnt lgkmcnt(0)
    v_mfma_f32_32x32x16_bf16 a[48:63], a[236:239], v[96:99], a[48:63]
    v_add_f32 v16, v16, v64
    v_exp_f32 v66, v66
    v_add_f32 v17, v17, v65
    v_exp_f32 v67, v67
    v_mfma_f32_32x32x16_bf16 a[0:15], a[240:243], v[100:103], a[0:15]
    v_add_f32 v16, v16, v66
    v_exp_f32 v68, v68
    v_mfma_f32_32x32x16_bf16 a[16:31], a[244:247], v[100:103], a[16:31]
    v_add_f32 v17, v17, v67
    v_exp_f32 v69, v69
    v_add_f32 v16, v16, v68
    v_mfma_f32_32x32x16_bf16 a[32:47], a[248:251], v[100:103], a[32:47]
    v_exp_f32 v70, v70
    v_add_f32 v17, v17, v69
    v_exp_f32 v71, v71
    v_mfma_f32_32x32x16_bf16 a[48:63], a[252:255], v[100:103], a[48:63]
    v_add_f32 v16, v16, v70
    v_exp_f32 v72, v72
    v_add_f32 v17, v17, v71
    v_mfma_f32_32x32x16_bf16 v[80:95], a[192:195], a[160:163], v[128:143]
    v_exp_f32 v73, v73
    v_add_f32 v16, v16, v72
    v_mfma_f32_32x32x16_bf16 v[80:95], a[196:199], a[164:167], v[80:95]
    v_exp_f32 v74, v74
    v_add_f32 v17, v17, v73
    v_exp_f32 v75, v75
    v_add_f32 v16, v16, v74
    v_mfma_f32_32x32x16_bf16 v[80:95], a[200:203], a[168:171], v[80:95]
    v_exp_f32 v76, v76
    s_waitcnt vmcnt(16) lgkmcnt(0)
    s_barrier
    v_mfma_f32_32x32x16_bf16 v[80:95], a[204:207], a[172:175], v[80:95]
    buffer_load_dwordx4 v3, s[24:27], s46 offen offset:0 lds
    ds_read_b128 a[192:195], v11 offset:0
    ds_read_b128 a[196:199], v11 offset:1024
    v_add_f32 v17, v17, v75
    v_mfma_f32_32x32x16_bf16 v[80:95], a[208:211], a[176:179], v[80:95]
    ds_read_b128 a[200:203], v11 offset:2048
    ds_read_b128 a[204:207], v11 offset:3072
    buffer_load_dwordx4 v3, s[24:27], s46 offen offset:1024 lds
    v_mfma_f32_32x32x16_bf16 v[80:95], a[212:215], a[180:183], v[80:95]
    ds_read_b128 a[208:211], v11 offset:4096
    buffer_load_dwordx4 v3, s[24:27], s46 offen offset:2048 lds
    ds_read_b128 a[212:215], v11 offset:5120
    v_exp_f32 v77, v77
    v_add_f32 v16, v16, v76
    v_mfma_f32_32x32x16_bf16 v[80:95], a[216:219], a[184:187], v[80:95]
    buffer_load_dwordx4 v3, s[24:27], s46 offen offset:3072 lds
    ds_read_b128 a[216:219], v11 offset:6144
    s_add_u32 m0, m0, 16384
    s_and_b32 m0, m0, 0x1ffff
    s_add_u32 s46, s46, 16384
    v_mfma_f32_32x32x16_bf16 v[80:95], a[220:223], a[188:191], v[80:95]
    ds_read_b128 a[220:223], v11 offset:7168
    v_exp_f32 v78, v78
    v_mfma_f32_32x32x16_bf16 a[64:79], a[224:227], v[104:107], a[64:79]
    ds_read_b128 a[224:227], v12 offset:8192
    v_add_f32 v17, v17, v77
    v_add_f32 v16, v16, v78
    v_exp_f32 v79, v79
    v_mfma_f32_32x32x16_bf16 a[80:95], a[228:231], v[104:107], a[80:95]
    ds_read_b128 a[228:231], v12 offset:10240
    v_add_f32 v17, v17, v79
    v_cvt_pk_bf16_f32 v96, v64, v65
    v_cvt_pk_bf16_f32 v97, v66, v67
    v_mfma_f32_32x32x16_bf16 a[96:111], a[232:235], v[104:107], a[96:111]
    ds_read_b128 a[232:235], v12 offset:12288
    v_exp_f32 v80, v80
    v_exp_f32 v81, v81
    v_mfma_f32_32x32x16_bf16 a[112:127], a[236:239], v[104:107], a[112:127]
    ds_read_b128 a[236:239], v12 offset:14336
    v_add_f32 v18, v18, v80
    v_exp_f32 v82, v82
    v_add_f32 v19, v19, v81
    v_mfma_f32_32x32x16_bf16 a[64:79], a[240:243], v[108:111], a[64:79]
    ds_read_b128 a[240:243], v12 offset:9216
    v_exp_f32 v83, v83
    v_cvt_pk_bf16_f32 v98, v68, v69
    v_cvt_pk_bf16_f32 v99, v70, v71
    v_cvt_pk_bf16_f32 v100, v72, v73
    v_mfma_f32_32x32x16_bf16 a[80:95], a[244:247], v[108:111], a[80:95]
    ds_read_b128 a[244:247], v12 offset:11264
    v_cvt_pk_bf16_f32 v101, v74, v75
    v_cvt_pk_bf16_f32 v102, v76, v77
    v_cvt_pk_bf16_f32 v103, v78, v79
    v_add_f32 v18, v18, v82
    v_add_f32 v19, v19, v83
    v_mfma_f32_32x32x16_bf16 a[96:111], a[248:251], v[108:111], a[96:111]
    ds_read_b128 a[248:251], v12 offset:13312
    v_mfma_f32_32x32x16_bf16 a[112:127], a[252:255], v[108:111], a[112:127]
    ds_read_b128 a[252:255], v12 offset:15360
    v_mov_b32 v10, v12
    v_mov_b32 v12, v11
    v_add_u32 v11, 0x4000, v11
    v_and_b32 v11, 0x1ffff, v11
    s_add_i32 s45, s45, 1
    s_sub_u32 s50, s50, 1
    s_cbranch_scc0 Lk2_ddm
Lk2_ddm_end:
    s_lshl_b32 s43, s42, 7
    s_add_u32 s43, s43, 128
    s_lshr_b32 s45, s43, 5
    s_sub_i32 s45, s45, s57
    s_add_i32 s48, s45, 1
    v_subrev_u32 v13, s43, v23
    v_subrev_u32 v14, 32, v13
    s_waitcnt lgkmcnt(5)
    s_cmp_lt_i32 s45, 0
    s_cbranch_scc1 Lsel_DS_0_vis
    s_cmp_eq_i32 s45, 0
    s_cbranch_scc1 Lsel_DS_0_diag
    v_mfma_f32_32x32x16_bf16 v[64:79], a[192:195], a[160:163], v[176:191]
    s_branch Lsel_DS_0_next
Lsel_DS_0_diag:
    v_mfma_f32_32x32x16_bf16 v[64:79], a[192:195], a[160:163], v[160:175]
    s_branch Lsel_DS_0_next
Lsel_DS_0_vis:
    v_mfma_f32_32x32x16_bf16 v[64:79], a[192:195], a[160:163], v[128:143]
Lsel_DS_0_next:
    v_exp_f32 v84, v84
    v_exp_f32 v85, v85
    ds_read_b128 a[192:195], v11 offset:0
    v_add_f32 v18, v18, v84
    v_mfma_f32_32x32x16_bf16 v[64:79], a[196:199], a[164:167], v[64:79]
    v_exp_f32 v86, v86
    v_add_f32 v19, v19, v85
    v_exp_f32 v87, v87
    v_mfma_f32_32x32x16_bf16 v[64:79], a[200:203], a[168:171], v[64:79]
    ds_read_b128 a[196:199], v11 offset:1024
    v_add_f32 v18, v18, v86
    v_exp_f32 v88, v88
    v_mfma_f32_32x32x16_bf16 v[64:79], a[204:207], a[172:175], v[64:79]
    ds_read_b128 a[200:203], v11 offset:2048
    v_add_f32 v19, v19, v87
    v_exp_f32 v89, v89
    ds_read_b128 a[204:207], v11 offset:3072
    v_mfma_f32_32x32x16_bf16 v[64:79], a[208:211], a[176:179], v[64:79]
    v_add_f32 v18, v18, v88
    v_exp_f32 v90, v90
    ds_read_b128 a[208:211], v11 offset:4096
    v_add_f32 v19, v19, v89
    v_mfma_f32_32x32x16_bf16 v[64:79], a[212:215], a[180:183], v[64:79]
    v_exp_f32 v91, v91
    ds_read_b128 a[212:215], v11 offset:5120
    v_add_f32 v18, v18, v90
    v_mfma_f32_32x32x16_bf16 v[64:79], a[216:219], a[184:187], v[64:79]
    v_exp_f32 v92, v92
    ds_read_b128 a[216:219], v11 offset:6144
    v_add_f32 v19, v19, v91
    v_mfma_f32_32x32x16_bf16 v[64:79], a[220:223], a[188:191], v[64:79]
    v_exp_f32 v93, v93
    ds_read_b128 a[220:223], v11 offset:7168
    v_add_f32 v18, v18, v92
    v_exp_f32 v94, v94
    v_mfma_f32_32x32x16_bf16 a[0:15], a[224:227], v[96:99], a[0:15]
    v_add_f32 v19, v19, v93
    v_exp_f32 v95, v95
    v_add_f32 v18, v18, v94
    v_mfma_f32_32x32x16_bf16 a[16:31], a[228:231], v[96:99], a[16:31]
    v_add_f32 v19, v19, v95
    v_cvt_pk_bf16_f32 v104, v80, v81
    v_cvt_pk_bf16_f32 v105, v82, v83
    v_cvt_pk_bf16_f32 v106, v84, v85
    v_cvt_pk_bf16_f32 v107, v86, v87
    v_mfma_f32_32x32x16_bf16 a[32:47], a[232:235], v[96:99], a[32:47]
    v_exp_f32 v64, v64
    v_exp_f32 v65, v65
    v_cvt_pk_bf16_f32 v108, v88, v89
    v_add_f32 v20, v20, v64
    s_waitcnt lgkmcnt(2)
    v_mfma_f32_32x32x16_bf16 a[48:63], a[236:239], v[96:99], a[48:63]
    v_exp_f32 v66, v66
    v_add_f32 v21, v21, v65
    v_exp_f32 v67, v67
    v_mfma_f32_32x32x16_bf16 a[0:15], a[240:243], v[100:103], a[0:15]
    v_cvt_pk_bf16_f32 v109, v90, v91
    v_cvt_pk_bf16_f32 v110, v92, v93
    v_cvt_pk_bf16_f32 v111, v94, v95
    v_add_f32 v20, v20, v66
    v_exp_f32 v68, v68
    v_mfma_f32_32x32x16_bf16 a[16:31], a[244:247], v[100:103], a[16:31]
    v_add_u32 v10, 0x4000, v10
    v_add_u32 v12, 0x4000, v11
    v_add_f32 v21, v21, v67
    v_exp_f32 v69, v69
    v_mfma_f32_32x32x16_bf16 a[32:47], a[248:251], v[100:103], a[32:47]
    v_add_f32 v20, v20, v68
    v_exp_f32 v70, v70
    v_and_b32 v10, 0x1ffff, v10
    v_and_b32 v12, 0x1ffff, v12
    v_mfma_f32_32x32x16_bf16 a[48:63], a[252:255], v[100:103], a[48:63]
    v_add_f32 v21, v21, v69
    s_cmp_lt_i32 s48, 0
    s_cbranch_scc1 Lsel_DS_1_vis
    s_cmp_eq_i32 s48, 0
    s_cbranch_scc1 Lsel_DS_1_diag
    v_mfma_f32_32x32x16_bf16 v[80:95], a[192:195], a[160:163], v[176:191]
    s_branch Lsel_DS_1_next
Lsel_DS_1_diag:
    v_mfma_f32_32x32x16_bf16 v[80:95], a[192:195], a[160:163], v[160:175]
    s_branch Lsel_DS_1_next
Lsel_DS_1_vis:
    v_mfma_f32_32x32x16_bf16 v[80:95], a[192:195], a[160:163], v[128:143]
Lsel_DS_1_next:
    v_add_f32 v20, v20, v70
    v_exp_f32 v71, v71
    v_exp_f32 v72, v72
    v_mfma_f32_32x32x16_bf16 v[80:95], a[196:199], a[164:167], v[80:95]
    v_add_f32 v21, v21, v71
    v_exp_f32 v73, v73
    v_add_f32 v20, v20, v72
    v_mfma_f32_32x32x16_bf16 v[80:95], a[200:203], a[168:171], v[80:95]
    v_exp_f32 v74, v74
    v_add_f32 v21, v21, v73
    s_waitcnt vmcnt(12) lgkmcnt(0)
    s_barrier
    v_mfma_f32_32x32x16_bf16 v[80:95], a[204:207], a[172:175], v[80:95]
    buffer_load_dwordx4 v3, s[24:27], s46 offen offset:0 lds
    ds_read_b128 a[192:195], v12 offset:0
    ds_read_b128 a[196:199], v12 offset:1024
    v_exp_f32 v75, v75
    v_mfma_f32_32x32x16_bf16 v[80:95], a[208:211], a[176:179], v[80:95]
    ds_read_b128 a[200:203], v12 offset:2048
    ds_read_b128 a[204:207], v12 offset:3072
    buffer_load_dwordx4 v3, s[24:27], s46 offen offset:1024 lds
    v_add_f32 v20, v20, v74
    v_mfma_f32_32x32x16_bf16 v[80:95], a[212:215], a[180:183], v[80:95]
    ds_read_b128 a[208:211], v12 offset:4096
    buffer_load_dwordx4 v3, s[24:27], s46 offen offset:2048 lds
    ds_read_b128 a[212:215], v12 offset:5120
    v_exp_f32 v76, v76
    v_mfma_f32_32x32x16_bf16 v[80:95], a[216:219], a[184:187], v[80:95]
    buffer_load_dwordx4 v3, s[24:27], s46 offen offset:3072 lds
    ds_read_b128 a[216:219], v12 offset:6144
    s_add_u32 m0, m0, 16384
    s_and_b32 m0, m0, 0x1ffff
    s_add_u32 s46, s46, 16384
    v_add_f32 v21, v21, v75
    v_mfma_f32_32x32x16_bf16 v[80:95], a[220:223], a[188:191], v[80:95]
    ds_read_b128 a[220:223], v12 offset:7168
    v_exp_f32 v77, v77
    v_add_f32 v20, v20, v76
    v_exp_f32 v78, v78
    v_mfma_f32_32x32x16_bf16 a[64:79], a[224:227], v[104:107], a[64:79]
    ds_read_b128 a[224:227], v10 offset:8192
    v_add_f32 v21, v21, v77
    v_mfma_f32_32x32x16_bf16 a[80:95], a[228:231], v[104:107], a[80:95]
    ds_read_b128 a[228:231], v10 offset:10240
    v_add_f32 v20, v20, v78
    v_exp_f32 v79, v79
    v_cvt_pk_bf16_f32 v96, v64, v65
    v_mfma_f32_32x32x16_bf16 a[96:111], a[232:235], v[104:107], a[96:111]
    ds_read_b128 a[232:235], v10 offset:12288
    v_exp_f32 v80, v80
    v_exp_f32 v81, v81
    v_mfma_f32_32x32x16_bf16 a[112:127], a[236:239], v[104:107], a[112:127]
    ds_read_b128 a[236:239], v10 offset:14336
    v_add_f32 v18, v18, v80
    v_exp_f32 v82, v82
    v_add_f32 v21, v21, v79
    v_add_f32 v19, v19, v81
    v_mfma_f32_32x32x16_bf16 a[64:79], a[240:243], v[108:111], a[64:79]
    ds_read_b128 a[240:243], v10 offset:9216
    v_exp_f32 v83, v83
    v_cvt_pk_bf16_f32 v97, v66, v67
    v_cvt_pk_bf16_f32 v98, v68, v69
    v_cvt_pk_bf16_f32 v99, v70, v71
    v_mfma_f32_32x32x16_bf16 a[80:95], a[244:247], v[108:111], a[80:95]
    ds_read_b128 a[244:247], v10 offset:11264
    v_cvt_pk_bf16_f32 v100, v72, v73
    v_cvt_pk_bf16_f32 v101, v74, v75
    v_cvt_pk_bf16_f32 v102, v76, v77
    v_cvt_pk_bf16_f32 v103, v78, v79
    v_add_f32 v18, v18, v82
    v_mfma_f32_32x32x16_bf16 a[96:111], a[248:251], v[108:111], a[96:111]
    ds_read_b128 a[248:251], v10 offset:13312
    v_add_f32 v19, v19, v83
    v_mfma_f32_32x32x16_bf16 a[112:127], a[252:255], v[108:111], a[112:127]
    ds_read_b128 a[252:255], v10 offset:15360
    v_mov_b32 v11, v12
    v_add_u32 v12, 0x8000, v12
    v_and_b32 v12, 0x1ffff, v12
    s_add_i32 s45, s45, 2
    s_add_i32 s48, s48, 2
    s_lshl_b32 s43, s42, 2
    s_sub_u32 s50, 27, s43
    s_max_i32 s50, s50, 0
    s_sub_u32 s50, s50, 1
    s_cbranch_scc1 Lk2_ss_end
Lk2_ss:
    s_waitcnt lgkmcnt(5)
    v_mfma_f32_32x32x16_bf16 v[64:79], a[192:195], a[160:163], v[128:143]
    v_exp_f32 v84, v84
    v_exp_f32 v85, v85
    ds_read_b128 a[192:195], v11 offset:16384
    v_add_f32 v18, v18, v84
    v_mfma_f32_32x32x16_bf16 v[64:79], a[196:199], a[164:167], v[64:79]
    v_exp_f32 v86, v86
    v_add_f32 v19, v19, v85
    v_exp_f32 v87, v87
    ds_read_b128 a[196:199], v11 offset:17408
    v_mfma_f32_32x32x16_bf16 v[64:79], a[200:203], a[168:171], v[64:79]
    v_add_f32 v18, v18, v86
    v_exp_f32 v88, v88
    ds_read_b128 a[200:203], v11 offset:18432
    v_add_f32 v19, v19, v87
    v_mfma_f32_32x32x16_bf16 v[64:79], a[204:207], a[172:175], v[64:79]
    v_exp_f32 v89, v89
    ds_read_b128 a[204:207], v11 offset:19456
    v_add_f32 v18, v18, v88
    v_mfma_f32_32x32x16_bf16 v[64:79], a[208:211], a[176:179], v[64:79]
    v_exp_f32 v90, v90
    ds_read_b128 a[208:211], v11 offset:20480
    v_add_f32 v19, v19, v89
    v_exp_f32 v91, v91
    v_mfma_f32_32x32x16_bf16 v[64:79], a[212:215], a[180:183], v[64:79]
    ds_read_b128 a[212:215], v11 offset:21504
    v_add_f32 v18, v18, v90
    v_exp_f32 v92, v92
    v_add_f32 v19, v19, v91
    v_mfma_f32_32x32x16_bf16 v[64:79], a[216:219], a[184:187], v[64:79]
    ds_read_b128 a[216:219], v11 offset:22528
    v_exp_f32 v93, v93
    v_add_f32 v18, v18, v92
    v_mfma_f32_32x32x16_bf16 v[64:79], a[220:223], a[188:191], v[64:79]
    ds_read_b128 a[220:223], v11 offset:23552
    v_exp_f32 v94, v94
    v_add_f32 v19, v19, v93
    v_exp_f32 v95, v95
    v_mfma_f32_32x32x16_bf16 a[64:79], a[224:227], v[96:99], a[64:79]
    ds_read_b128 a[224:227], v10 offset:24576
    v_add_f32 v18, v18, v94
    v_add_f32 v19, v19, v95
    v_cvt_pk_bf16_f32 v104, v80, v81
    v_cvt_pk_bf16_f32 v105, v82, v83
    v_mfma_f32_32x32x16_bf16 a[80:95], a[228:231], v[96:99], a[80:95]
    ds_read_b128 a[228:231], v10 offset:26624
    v_cvt_pk_bf16_f32 v106, v84, v85
    v_cvt_pk_bf16_f32 v107, v86, v87
    v_cvt_pk_bf16_f32 v108, v88, v89
    v_cvt_pk_bf16_f32 v109, v90, v91
    v_mfma_f32_32x32x16_bf16 a[96:111], a[232:235], v[96:99], a[96:111]
    ds_read_b128 a[232:235], v10 offset:28672
    v_exp_f32 v64, v64
    v_exp_f32 v65, v65
    s_waitcnt lgkmcnt(5)
    v_mfma_f32_32x32x16_bf16 a[112:127], a[236:239], v[96:99], a[112:127]
    ds_read_b128 a[236:239], v10 offset:30720
    v_add_f32 v20, v20, v64
    v_exp_f32 v66, v66
    v_add_f32 v21, v21, v65
    v_mfma_f32_32x32x16_bf16 a[64:79], a[240:243], v[100:103], a[64:79]
    ds_read_b128 a[240:243], v10 offset:25600
    v_exp_f32 v67, v67
    v_cvt_pk_bf16_f32 v110, v92, v93
    v_cvt_pk_bf16_f32 v111, v94, v95
    v_add_f32 v20, v20, v66
    v_mfma_f32_32x32x16_bf16 a[80:95], a[244:247], v[100:103], a[80:95]
    ds_read_b128 a[244:247], v10 offset:27648
    v_exp_f32 v68, v68
    v_add_f32 v21, v21, v67
    v_exp_f32 v69, v69
    v_mfma_f32_32x32x16_bf16 a[96:111], a[248:251], v[100:103], a[96:111]
    ds_read_b128 a[248:251], v10 offset:29696
    v_add_f32 v20, v20, v68
    v_exp_f32 v70, v70
    v_mfma_f32_32x32x16_bf16 a[112:127], a[252:255], v[100:103], a[112:127]
    ds_read_b128 a[252:255], v10 offset:31744
    v_add_f32 v21, v21, v69
    v_add_f32 v20, v20, v70
    v_mfma_f32_32x32x16_bf16 v[80:95], a[192:195], a[160:163], v[128:143]
    v_exp_f32 v71, v71
    v_exp_f32 v72, v72
    v_cvt_pk_bf16_f32 v96, v64, v65
    v_add_f32 v21, v21, v71
    v_mfma_f32_32x32x16_bf16 v[80:95], a[196:199], a[164:167], v[80:95]
    v_exp_f32 v73, v73
    v_add_f32 v20, v20, v72
    v_exp_f32 v74, v74
    v_mfma_f32_32x32x16_bf16 v[80:95], a[200:203], a[168:171], v[80:95]
    v_add_f32 v21, v21, v73
    v_exp_f32 v75, v75
    s_waitcnt vmcnt(8) lgkmcnt(0)
    s_barrier
    v_mfma_f32_32x32x16_bf16 v[80:95], a[204:207], a[172:175], v[80:95]
    buffer_load_dwordx4 v3, s[24:27], s46 offen offset:0 lds
    ds_read_b128 a[192:195], v12 offset:0
    ds_read_b128 a[196:199], v12 offset:1024
    v_add_f32 v20, v20, v74
    v_mfma_f32_32x32x16_bf16 v[80:95], a[208:211], a[176:179], v[80:95]
    ds_read_b128 a[200:203], v12 offset:2048
    ds_read_b128 a[204:207], v12 offset:3072
    buffer_load_dwordx4 v3, s[24:27], s46 offen offset:1024 lds
    v_exp_f32 v76, v76
    v_add_f32 v21, v21, v75
    v_mfma_f32_32x32x16_bf16 v[80:95], a[212:215], a[180:183], v[80:95]
    ds_read_b128 a[208:211], v12 offset:4096
    buffer_load_dwordx4 v3, s[24:27], s46 offen offset:2048 lds
    ds_read_b128 a[212:215], v12 offset:5120
    v_exp_f32 v77, v77
    v_mfma_f32_32x32x16_bf16 v[80:95], a[216:219], a[184:187], v[80:95]
    buffer_load_dwordx4 v3, s[24:27], s46 offen offset:3072 lds
    ds_read_b128 a[216:219], v12 offset:6144
    s_add_u32 m0, m0, 16384
    s_and_b32 m0, m0, 0x1ffff
    s_add_u32 s46, s46, 16384
    v_mfma_f32_32x32x16_bf16 v[80:95], a[220:223], a[188:191], v[80:95]
    ds_read_b128 a[220:223], v12 offset:7168
    v_add_f32 v20, v20, v76
    v_exp_f32 v78, v78
    v_add_f32 v21, v21, v77
    v_mfma_f32_32x32x16_bf16 a[64:79], a[224:227], v[104:107], a[64:79]
    ds_read_b128 a[224:227], v11 offset:8192
    v_add_f32 v20, v20, v78
    v_exp_f32 v79, v79
    v_cvt_pk_bf16_f32 v97, v66, v67
    v_mfma_f32_32x32x16_bf16 a[80:95], a[228:231], v[104:107], a[80:95]
    buffer_load_dwordx4 v3, s[24:27], s46 offen offset:0 lds
    ds_read_b128 a[228:231], v11 offset:10240
    v_add_f32 v21, v21, v79
    v_cvt_pk_bf16_f32 v98, v68, v69
    v_cvt_pk_bf16_f32 v99, v70, v71
    v_mfma_f32_32x32x16_bf16 a[96:111], a[232:235], v[104:107], a[96:111]
    ds_read_b128 a[232:235], v11 offset:12288
    v_exp_f32 v80, v80
    buffer_load_dwordx4 v3, s[24:27], s46 offen offset:1024 lds
    v_exp_f32 v81, v81
    v_mfma_f32_32x32x16_bf16 a[112:127], a[236:239], v[104:107], a[112:127]
    ds_read_b128 a[236:239], v11 offset:14336
    buffer_load_dwordx4 v3, s[24:27], s46 offen offset:2048 lds
    v_add_f32 v18, v18, v80
    v_exp_f32 v82, v82
    v_add_f32 v19, v19, v81
    v_mfma_f32_32x32x16_bf16 a[64:79], a[240:243], v[108:111], a[64:79]
    ds_read_b128 a[240:243], v11 offset:9216
    buffer_load_dwordx4 v3, s[24:27], s46 offen offset:3072 lds
    v_exp_f32 v83, v83
    s_add_u32 m0, m0, 16384
    s_and_b32 m0, m0, 0x1ffff
    v_mfma_f32_32x32x16_bf16 a[80:95], a[244:247], v[108:111], a[80:95]
    ds_read_b128 a[244:247], v11 offset:11264
    s_add_u32 s46, s46, 16384
    v_cvt_pk_bf16_f32 v100, v72, v73
    v_cvt_pk_bf16_f32 v101, v74, v75
    v_cvt_pk_bf16_f32 v102, v76, v77
    v_cvt_pk_bf16_f32 v103, v78, v79
    v_mfma_f32_32x32x16_bf16 a[96:111], a[248:251], v[108:111], a[96:111]
    ds_read_b128 a[248:251], v11 offset:13312
    v_add_f32 v18, v18, v82
    v_add_f32 v19, v19, v83
    v_mfma_f32_32x32x16_bf16 a[112:127], a[252:255], v[108:111], a[112:127]
    ds_read_b128 a[252:255], v11 offset:15360
    v_mov_b32 v10, v11
    v_mov_b32 v11, v12
    v_add_u32 v12, 0x8000, v12
    v_and_b32 v12, 0x1ffff, v12
    s_sub_u32 s50, s50, 1
    s_cbranch_scc0 Lk2_ss
Lk2_ss_end:
    s_cmp_eq_u32 s42, 7
    s_cselect_b32 s50, 1, 2
    s_lshl_b32 s43, s42, 2
    s_sub_u32 s44, 60, s43
    s_add_u32 s43, s43, 6
    s_max_u32 s43, s43, s44
    s_sub_i32 s45, s43, s57
    s_add_i32 s48, s45, 1
    s_lshl_b32 s43, s43, 5
    v_subrev_u32 v13, s43, v23
    v_subrev_u32 v14, 32, v13
    s_sub_u32 s50, s50, 1
    s_cbranch_scc1 Lk2_ssm_end
Lk2_ssm:
    s_waitcnt lgkmcnt(5)
    s_cmp_lt_i32 s45, 0
    s_cbranch_scc1 Lsel_SS_0_vis
    s_cmp_eq_i32 s45, 0
    s_cbranch_scc1 Lsel_SS_0_diag
    v_mfma_f32_32x32x16_bf16 v[64:79], a[192:195], a[160:163], v[176:191]
    s_branch Lsel_SS_0_next
Lsel_SS_0_diag:
    v_mfma_f32_32x32x16_bf16 v[64:79], a[192:195], a[160:163], v[160:175]
    s_branch Lsel_SS_0_next
Lsel_SS_0_vis:
    v_mfma_f32_32x32x16_bf16 v[64:79], a[192:195], a[160:163], v[128:143]
Lsel_SS_0_next:
    v_exp_f32 v84, v84
    v_exp_f32 v85, v85
    ds_read_b128 a[192:195], v11 offset:16384
    v_add_f32 v18, v18, v84
    v_mfma_f32_32x32x16_bf16 v[64:79], a[196:199], a[164:167], v[64:79]
    v_exp_f32 v86, v86
    v_add_f32 v19, v19, v85
    v_exp_f32 v87, v87
    ds_read_b128 a[196:199], v11 offset:17408
    v_mfma_f32_32x32x16_bf16 v[64:79], a[200:203], a[168:171], v[64:79]
    v_add_f32 v18, v18, v86
    v_exp_f32 v88, v88
    ds_read_b128 a[200:203], v11 offset:18432
    v_add_f32 v19, v19, v87
    v_mfma_f32_32x32x16_bf16 v[64:79], a[204:207], a[172:175], v[64:79]
    v_exp_f32 v89, v89
    ds_read_b128 a[204:207], v11 offset:19456
    v_add_f32 v18, v18, v88
    v_mfma_f32_32x32x16_bf16 v[64:79], a[208:211], a[176:179], v[64:79]
    v_exp_f32 v90, v90
    ds_read_b128 a[208:211], v11 offset:20480
    v_add_f32 v19, v19, v89
    v_exp_f32 v91, v91
    v_mfma_f32_32x32x16_bf16 v[64:79], a[212:215], a[180:183], v[64:79]
    ds_read_b128 a[212:215], v11 offset:21504
    v_add_f32 v18, v18, v90
    v_exp_f32 v92, v92
    v_add_f32 v19, v19, v91
    v_mfma_f32_32x32x16_bf16 v[64:79], a[216:219], a[184:187], v[64:79]
    ds_read_b128 a[216:219], v11 offset:22528
    v_exp_f32 v93, v93
    v_add_f32 v18, v18, v92
    v_mfma_f32_32x32x16_bf16 v[64:79], a[220:223], a[188:191], v[64:79]
    ds_read_b128 a[220:223], v11 offset:23552
    v_exp_f32 v94, v94
    v_add_f32 v19, v19, v93
    v_exp_f32 v95, v95
    v_mfma_f32_32x32x16_bf16 a[64:79], a[224:227], v[96:99], a[64:79]
    ds_read_b128 a[224:227], v10 offset:24576
    v_add_f32 v18, v18, v94
    v_add_f32 v19, v19, v95
    v_cvt_pk_bf16_f32 v104, v80, v81
    v_cvt_pk_bf16_f32 v105, v82, v83
    v_mfma_f32_32x32x16_bf16 a[80:95], a[228:231], v[96:99], a[80:95]
    ds_read_b128 a[228:231], v10 offset:26624
    v_cvt_pk_bf16_f32 v106, v84, v85
    v_cvt_pk_bf16_f32 v107, v86, v87
    v_cvt_pk_bf16_f32 v108, v88, v89
    v_cvt_pk_bf16_f32 v109, v90, v91
    v_mfma_f32_32x32x16_bf16 a[96:111], a[232:235], v[96:99], a[96:111]
    ds_read_b128 a[232:235], v10 offset:28672
    v_exp_f32 v64, v64
    v_exp_f32 v65, v65
    s_waitcnt lgkmcnt(5)
    v_mfma_f32_32x32x16_bf16 a[112:127], a[236:239], v[96:99], a[112:127]
    ds_read_b128 a[236:239], v10 offset:30720
    v_add_f32 v20, v20, v64
    v_exp_f32 v66, v66
    v_add_f32 v21, v21, v65
    v_mfma_f32_32x32x16_bf16 a[64:79], a[240:243], v[100:103], a[64:79]
    ds_read_b128 a[240:243], v10 offset:25600
    v_exp_f32 v67, v67
    v_cvt_pk_bf16_f32 v110, v92, v93
    v_cvt_pk_bf16_f32 v111, v94, v95
    v_add_f32 v20, v20, v66
    v_mfma_f32_32x32x16_bf16 a[80:95], a[244:247], v[100:103], a[80:95]
    ds_read_b128 a[244:247], v10 offset:27648
    v_exp_f32 v68, v68
    v_add_f32 v21, v21, v67
    v_exp_f32 v69, v69
    v_mfma_f32_32x32x16_bf16 a[96:111], a[248:251], v[100:103], a[96:111]
    ds_read_b128 a[248:251], v10 offset:29696
    v_add_f32 v20, v20, v68
    v_exp_f32 v70, v70
    v_mfma_f32_32x32x16_bf16 a[112:127], a[252:255], v[100:103], a[112:127]
    ds_read_b128 a[252:255], v10 offset:31744
    v_add_f32 v21, v21, v69
    v_add_f32 v20, v20, v70
    s_cmp_lt_i32 s48, 0
    s_cbranch_scc1 Lsel_SS_1_vis
    s_cmp_eq_i32 s48, 0
    s_cbranch_scc1 Lsel_SS_1_diag
    v_mfma_f32_32x32x16_bf16 v[80:95], a[192:195], a[160:163], v[176:191]
    s_branch Lsel_SS_1_next
Lsel_SS_1_diag:
    v_mfma_f32_32x32x16_bf16 v[80:95], a[192:195], a[160:163], v[160:175]
    s_branch Lsel_SS_1_next
Lsel_SS_1_vis:
    v_mfma_f32_32x32x16_bf16 v[80:95], a[192:195], a[160:163], v[128:143]
Lsel_SS_1_next:
    v_exp_f32 v71, v71
    v_exp_f32 v72, v72
    v_cvt_pk_bf16_f32 v96, v64, v65
    v_add_f32 v21, v21, v71
    v_mfma_f32_32x32x16_bf16 v[80:95], a[196:199], a[164:167], v[80:95]
    v_exp_f32 v73, v73
    v_add_f32 v20, v20, v72
    v_exp_f32 v74, v74
    v_mfma_f32_32x32x16_bf16 v[80:95], a[200:203], a[168:171], v[80:95]
    v_add_f32 v21, v21, v73
    v_exp_f32 v75, v75
    s_waitcnt vmcnt(8) lgkmcnt(0)
    s_barrier
    v_mfma_f32_32x32x16_bf16 v[80:95], a[204:207], a[172:175], v[80:95]
    buffer_load_dwordx4 v3, s[24:27], s46 offen offset:0 lds
    ds_read_b128 a[192:195], v12 offset:0
    ds_read_b128 a[196:199], v12 offset:1024
    v_add_f32 v20, v20, v74
    v_mfma_f32_32x32x16_bf16 v[80:95], a[208:211], a[176:179], v[80:95]
    ds_read_b128 a[200:203], v12 offset:2048
    ds_read_b128 a[204:207], v12 offset:3072
    buffer_load_dwordx4 v3, s[24:27], s46 offen offset:1024 lds
    v_exp_f32 v76, v76
    v_add_f32 v21, v21, v75
    v_mfma_f32_32x32x16_bf16 v[80:95], a[212:215], a[180:183], v[80:95]
    ds_read_b128 a[208:211], v12 offset:4096
    buffer_load_dwordx4 v3, s[24:27], s46 offen offset:2048 lds
    ds_read_b128 a[212:215], v12 offset:5120
    v_exp_f32 v77, v77
    v_mfma_f32_32x32x16_bf16 v[80:95], a[216:219], a[184:187], v[80:95]
    buffer_load_dwordx4 v3, s[24:27], s46 offen offset:3072 lds
    ds_read_b128 a[216:219], v12 offset:6144
    s_add_u32 m0, m0, 16384
    s_and_b32 m0, m0, 0x1ffff
    s_add_u32 s46, s46, 16384
    v_mfma_f32_32x32x16_bf16 v[80:95], a[220:223], a[188:191], v[80:95]
    ds_read_b128 a[220:223], v12 offset:7168
    v_add_f32 v20, v20, v76
    v_exp_f32 v78, v78
    v_add_f32 v21, v21, v77
    v_mfma_f32_32x32x16_bf16 a[64:79], a[224:227], v[104:107], a[64:79]
    ds_read_b128 a[224:227], v11 offset:8192
    v_add_f32 v20, v20, v78
    v_exp_f32 v79, v79
    v_cvt_pk_bf16_f32 v97, v66, v67
    v_mfma_f32_32x32x16_bf16 a[80:95], a[228:231], v[104:107], a[80:95]
    buffer_load_dwordx4 v3, s[24:27], s46 offen offset:0 lds
    ds_read_b128 a[228:231], v11 offset:10240
    v_add_f32 v21, v21, v79
    v_cvt_pk_bf16_f32 v98, v68, v69
    v_cvt_pk_bf16_f32 v99, v70, v71
    v_mfma_f32_32x32x16_bf16 a[96:111], a[232:235], v[104:107], a[96:111]
    ds_read_b128 a[232:235], v11 offset:12288
    v_exp_f32 v80, v80
    buffer_load_dwordx4 v3, s[24:27], s46 offen offset:1024 lds
    v_exp_f32 v81, v81
    v_mfma_f32_32x32x16_bf16 a[112:127], a[236:239], v[104:107], a[112:127]
    ds_read_b128 a[236:239], v11 offset:14336
    buffer_load_dwordx4 v3, s[24:27], s46 offen offset:2048 lds
    v_add_f32 v18, v18, v80
    v_exp_f32 v82, v82
    v_add_f32 v19, v19, v81
    v_mfma_f32_32x32x16_bf16 a[64:79], a[240:243], v[108:111], a[64:79]
    ds_read_b128 a[240:243], v11 offset:9216
    buffer_load_dwordx4 v3, s[24:27], s46 offen offset:3072 lds
    v_exp_f32 v83, v83
    s_add_u32 m0, m0, 16384
    s_and_b32 m0, m0, 0x1ffff
    v_mfma_f32_32x32x16_bf16 a[80:95], a[244:247], v[108:111], a[80:95]
    ds_read_b128 a[244:247], v11 offset:11264
    s_add_u32 s46, s46, 16384
    v_cvt_pk_bf16_f32 v100, v72, v73
    v_cvt_pk_bf16_f32 v101, v74, v75
    v_cvt_pk_bf16_f32 v102, v76, v77
    v_cvt_pk_bf16_f32 v103, v78, v79
    v_mfma_f32_32x32x16_bf16 a[96:111], a[248:251], v[108:111], a[96:111]
    ds_read_b128 a[248:251], v11 offset:13312
    v_add_f32 v18, v18, v82
    v_add_f32 v19, v19, v83
    v_mfma_f32_32x32x16_bf16 a[112:127], a[252:255], v[108:111], a[112:127]
    ds_read_b128 a[252:255], v11 offset:15360
    v_mov_b32 v10, v11
    v_mov_b32 v11, v12
    v_add_u32 v12, 0x8000, v12
    v_and_b32 v12, 0x1ffff, v12
    s_add_i32 s45, s45, 2
    s_add_i32 s48, s48, 2
    s_sub_u32 s50, s50, 1
    s_cbranch_scc0 Lk2_ssm
Lk2_ssm_end:
    ds_read_b128 a[192:195], v10 offset:24576
    ds_read_b128 a[196:199], v10 offset:26624
    ds_read_b128 a[200:203], v10 offset:28672
    ds_read_b128 a[204:207], v10 offset:30720
    ds_read_b128 a[208:211], v10 offset:25600
    ds_read_b128 a[212:215], v10 offset:27648
    ds_read_b128 a[216:219], v10 offset:29696
    ds_read_b128 a[220:223], v10 offset:31744
    v_exp_f32 v84, v84
    v_exp_f32 v85, v85
    v_add_f32 v18, v18, v84
    v_add_f32 v19, v19, v85
    v_exp_f32 v86, v86
    v_exp_f32 v87, v87
    v_add_f32 v18, v18, v86
    v_add_f32 v19, v19, v87
    v_exp_f32 v88, v88
    v_exp_f32 v89, v89
    v_add_f32 v18, v18, v88
    v_add_f32 v19, v19, v89
    v_exp_f32 v90, v90
    v_exp_f32 v91, v91
    v_add_f32 v18, v18, v90
    v_add_f32 v19, v19, v91
    v_exp_f32 v92, v92
    v_exp_f32 v93, v93
    v_add_f32 v18, v18, v92
    v_add_f32 v19, v19, v93
    v_exp_f32 v94, v94
    v_exp_f32 v95, v95
    v_add_f32 v18, v18, v94
    v_add_f32 v19, v19, v95
    v_cvt_pk_bf16_f32 v104, v80, v81
    v_cvt_pk_bf16_f32 v105, v82, v83
    v_cvt_pk_bf16_f32 v106, v84, v85
    v_cvt_pk_bf16_f32 v107, v86, v87
    v_cvt_pk_bf16_f32 v108, v88, v89
    v_cvt_pk_bf16_f32 v109, v90, v91
    v_cvt_pk_bf16_f32 v110, v92, v93
    v_cvt_pk_bf16_f32 v111, v94, v95
    s_waitcnt lgkmcnt(8)
    v_mfma_f32_32x32x16_bf16 a[64:79], a[224:227], v[96:99], a[64:79]
    v_mfma_f32_32x32x16_bf16 a[80:95], a[228:231], v[96:99], a[80:95]
    v_mfma_f32_32x32x16_bf16 a[96:111], a[232:235], v[96:99], a[96:111]
    v_mfma_f32_32x32x16_bf16 a[112:127], a[236:239], v[96:99], a[112:127]
    v_mfma_f32_32x32x16_bf16 a[64:79], a[240:243], v[100:103], a[64:79]
    v_mfma_f32_32x32x16_bf16 a[80:95], a[244:247], v[100:103], a[80:95]
    v_mfma_f32_32x32x16_bf16 a[96:111], a[248:251], v[100:103], a[96:111]
    v_mfma_f32_32x32x16_bf16 a[112:127], a[252:255], v[100:103], a[112:127]
    s_waitcnt lgkmcnt(0)
    v_mfma_f32_32x32x16_bf16 a[64:79], a[192:195], v[104:107], a[64:79]
    v_mfma_f32_32x32x16_bf16 a[80:95], a[196:199], v[104:107], a[80:95]
    v_mfma_f32_32x32x16_bf16 a[96:111], a[200:203], v[104:107], a[96:111]
    v_mfma_f32_32x32x16_bf16 a[112:127], a[204:207], v[104:107], a[112:127]
    v_mfma_f32_32x32x16_bf16 a[64:79], a[208:211], v[108:111], a[64:79]
    v_mfma_f32_32x32x16_bf16 a[80:95], a[212:215], v[108:111], a[80:95]
    v_mfma_f32_32x32x16_bf16 a[96:111], a[216:219], v[108:111], a[96:111]
    v_mfma_f32_32x32x16_bf16 a[112:127], a[220:223], v[108:111], a[112:127]
    v_add_f32 v24, v16, v17
    v_mov_b32 v25, v24
    s_nop 1
    v_permlane32_swap_b32 v24, v25
    v_add_f32 v24, v24, v25
    v_rcp_f32 v26, v24
    v_mov_b32 v28, 0
    v_mov_b32 v27, v26
    v_accvgpr_read_b32 v32, a0
    v_accvgpr_read_b32 v33, a1
    v_accvgpr_read_b32 v34, a2
    v_accvgpr_read_b32 v35, a3
    v_accvgpr_read_b32 v36, a4
    v_accvgpr_read_b32 v37, a5
    v_accvgpr_read_b32 v38, a6
    v_accvgpr_read_b32 v39, a7
    v_pk_mul_f32 v[32:33], v[32:33], v[26:27]
    v_pk_mul_f32 v[34:35], v[34:35], v[26:27]
    v_pk_mul_f32 v[36:37], v[36:37], v[26:27]
    v_pk_mul_f32 v[38:39], v[38:39], v[26:27]
    v_cvt_pk_bf16_f32 v40, v32, v33
    v_cvt_pk_bf16_f32 v41, v34, v35
    v_cvt_pk_bf16_f32 v42, v36, v37
    v_cvt_pk_bf16_f32 v43, v38, v39
    s_add_u32 s43, s52, 0
    buffer_store_dwordx4 v[40:43], v3, s[28:31], s43 offen sc1
    v_maximum3_f32 v28, |v32|, |v33|, v28
    v_maximum3_f32 v28, |v34|, |v35|, v28
    v_maximum3_f32 v28, |v36|, |v37|, v28
    v_maximum3_f32 v28, |v38|, |v39|, v28
    v_accvgpr_read_b32 v44, a8
    v_accvgpr_read_b32 v45, a9
    v_accvgpr_read_b32 v46, a10
    v_accvgpr_read_b32 v47, a11
    v_accvgpr_read_b32 v48, a12
    v_accvgpr_read_b32 v49, a13
    v_accvgpr_read_b32 v50, a14
    v_accvgpr_read_b32 v51, a15
    v_pk_mul_f32 v[44:45], v[44:45], v[26:27]
    v_pk_mul_f32 v[46:47], v[46:47], v[26:27]
    v_pk_mul_f32 v[48:49], v[48:49], v[26:27]
    v_pk_mul_f32 v[50:51], v[50:51], v[26:27]
    v_cvt_pk_bf16_f32 v52, v44, v45
    v_cvt_pk_bf16_f32 v53, v46, v47
    v_cvt_pk_bf16_f32 v54, v48, v49
    v_cvt_pk_bf16_f32 v55, v50, v51
    s_add_u32 s43, s52, 1024
    buffer_store_dwordx4 v[52:55], v3, s[28:31], s43 offen sc1
    v_maximum3_f32 v28, |v44|, |v45|, v28
    v_maximum3_f32 v28, |v46|, |v47|, v28
    v_maximum3_f32 v28, |v48|, |v49|, v28
    v_maximum3_f32 v28, |v50|, |v51|, v28
    v_accvgpr_read_b32 v32, a16
    v_accvgpr_read_b32 v33, a17
    v_accvgpr_read_b32 v34, a18
    v_accvgpr_read_b32 v35, a19
    v_accvgpr_read_b32 v36, a20
    v_accvgpr_read_b32 v37, a21
    v_accvgpr_read_b32 v38, a22
    v_accvgpr_read_b32 v39, a23
    v_pk_mul_f32 v[32:33], v[32:33], v[26:27]
    v_pk_mul_f32 v[34:35], v[34:35], v[26:27]
    v_pk_mul_f32 v[36:37], v[36:37], v[26:27]
    v_pk_mul_f32 v[38:39], v[38:39], v[26:27]
    v_cvt_pk_bf16_f32 v40, v32, v33
    v_cvt_pk_bf16_f32 v41, v34, v35
    v_cvt_pk_bf16_f32 v42, v36, v37
    v_cvt_pk_bf16_f32 v43, v38, v39
    s_add_u32 s43, s52, 2048
    buffer_store_dwordx4 v[40:43], v3, s[28:31], s43 offen sc1
    v_maximum3_f32 v28, |v32|, |v33|, v28
    v_maximum3_f32 v28, |v34|, |v35|, v28
    v_maximum3_f32 v28, |v36|, |v37|, v28
    v_maximum3_f32 v28, |v38|, |v39|, v28
    v_accvgpr_read_b32 v44, a24
    v_accvgpr_read_b32 v45, a25
    v_accvgpr_read_b32 v46, a26
    v_accvgpr_read_b32 v47, a27
    v_accvgpr_read_b32 v48, a28
    v_accvgpr_read_b32 v49, a29
    v_accvgpr_read_b32 v50, a30
    v_accvgpr_read_b32 v51, a31
    v_pk_mul_f32 v[44:45], v[44:45], v[26:27]
    v_pk_mul_f32 v[46:47], v[46:47], v[26:27]
    v_pk_mul_f32 v[48:49], v[48:49], v[26:27]
    v_pk_mul_f32 v[50:51], v[50:51], v[26:27]
    v_cvt_pk_bf16_f32 v52, v44, v45
    v_cvt_pk_bf16_f32 v53, v46, v47
    v_cvt_pk_bf16_f32 v54, v48, v49
    v_cvt_pk_bf16_f32 v55, v50, v51
    s_add_u32 s43, s52, 3072
    buffer_store_dwordx4 v[52:55], v3, s[28:31], s43 offen sc1
    v_maximum3_f32 v28, |v44|, |v45|, v28
    v_maximum3_f32 v28, |v46|, |v47|, v28
    v_maximum3_f32 v28, |v48|, |v49|, v28
    v_maximum3_f32 v28, |v50|, |v51|, v28
    v_accvgpr_read_b32 v32, a32
    v_accvgpr_read_b32 v33, a33
    v_accvgpr_read_b32 v34, a34
    v_accvgpr_read_b32 v35, a35
    v_accvgpr_read_b32 v36, a36
    v_accvgpr_read_b32 v37, a37
    v_accvgpr_read_b32 v38, a38
    v_accvgpr_read_b32 v39, a39
    v_pk_mul_f32 v[32:33], v[32:33], v[26:27]
    v_pk_mul_f32 v[34:35], v[34:35], v[26:27]
    v_pk_mul_f32 v[36:37], v[36:37], v[26:27]
    v_pk_mul_f32 v[38:39], v[38:39], v[26:27]
    v_cvt_pk_bf16_f32 v40, v32, v33
    v_cvt_pk_bf16_f32 v41, v34, v35
    v_cvt_pk_bf16_f32 v42, v36, v37
    v_cvt_pk_bf16_f32 v43, v38, v39
    s_add_u32 s43, s52, 4096
    buffer_store_dwordx4 v[40:43], v3, s[28:31], s43 offen sc1
    v_maximum3_f32 v28, |v32|, |v33|, v28
    v_maximum3_f32 v28, |v34|, |v35|, v28
    v_maximum3_f32 v28, |v36|, |v37|, v28
    v_maximum3_f32 v28, |v38|, |v39|, v28
    v_accvgpr_read_b32 v44, a40
    v_accvgpr_read_b32 v45, a41
    v_accvgpr_read_b32 v46, a42
    v_accvgpr_read_b32 v47, a43
    v_accvgpr_read_b32 v48, a44
    v_accvgpr_read_b32 v49, a45
    v_accvgpr_read_b32 v50, a46
    v_accvgpr_read_b32 v51, a47
    v_pk_mul_f32 v[44:45], v[44:45], v[26:27]
    v_pk_mul_f32 v[46:47], v[46:47], v[26:27]
    v_pk_mul_f32 v[48:49], v[48:49], v[26:27]
    v_pk_mul_f32 v[50:51], v[50:51], v[26:27]
    v_cvt_pk_bf16_f32 v52, v44, v45
    v_cvt_pk_bf16_f32 v53, v46, v47
    v_cvt_pk_bf16_f32 v54, v48, v49
    v_cvt_pk_bf16_f32 v55, v50, v51
    s_add_u32 s43, s52, 5120
    buffer_store_dwordx4 v[52:55], v3, s[28:31], s43 offen sc1
    v_maximum3_f32 v28, |v44|, |v45|, v28
    v_maximum3_f32 v28, |v46|, |v47|, v28
    v_maximum3_f32 v28, |v48|, |v49|, v28
    v_maximum3_f32 v28, |v50|, |v51|, v28
    v_accvgpr_read_b32 v32, a48
    v_accvgpr_read_b32 v33, a49
    v_accvgpr_read_b32 v34, a50
    v_accvgpr_read_b32 v35, a51
    v_accvgpr_read_b32 v36, a52
    v_accvgpr_read_b32 v37, a53
    v_accvgpr_read_b32 v38, a54
    v_accvgpr_read_b32 v39, a55
    v_pk_mul_f32 v[32:33], v[32:33], v[26:27]
    v_pk_mul_f32 v[34:35], v[34:35], v[26:27]
    v_pk_mul_f32 v[36:37], v[36:37], v[26:27]
    v_pk_mul_f32 v[38:39], v[38:39], v[26:27]
    v_cvt_pk_bf16_f32 v40, v32, v33
    v_cvt_pk_bf16_f32 v41, v34, v35
    v_cvt_pk_bf16_f32 v42, v36, v37
    v_cvt_pk_bf16_f32 v43, v38, v39
    s_add_u32 s43, s52, 6144
    buffer_store_dwordx4 v[40:43], v3, s[28:31], s43 offen sc1
    v_maximum3_f32 v28, |v32|, |v33|, v28
    v_maximum3_f32 v28, |v34|, |v35|, v28
    v_maximum3_f32 v28, |v36|, |v37|, v28
    v_maximum3_f32 v28, |v38|, |v39|, v28
    v_accvgpr_read_b32 v44, a56
    v_accvgpr_read_b32 v45, a57
    v_accvgpr_read_b32 v46, a58
    v_accvgpr_read_b32 v47, a59
    v_accvgpr_read_b32 v48, a60
    v_accvgpr_read_b32 v49, a61
    v_accvgpr_read_b32 v50, a62
    v_accvgpr_read_b32 v51, a63
    v_pk_mul_f32 v[44:45], v[44:45], v[26:27]
    v_pk_mul_f32 v[46:47], v[46:47], v[26:27]
    v_pk_mul_f32 v[48:49], v[48:49], v[26:27]
    v_pk_mul_f32 v[50:51], v[50:51], v[26:27]
    v_cvt_pk_bf16_f32 v52, v44, v45
    v_cvt_pk_bf16_f32 v53, v46, v47
    v_cvt_pk_bf16_f32 v54, v48, v49
    v_cvt_pk_bf16_f32 v55, v50, v51
    s_add_u32 s43, s52, 7168
    buffer_store_dwordx4 v[52:55], v3, s[28:31], s43 offen sc1
    v_maximum3_f32 v28, |v44|, |v45|, v28
    v_maximum3_f32 v28, |v46|, |v47|, v28
    v_maximum3_f32 v28, |v48|, |v49|, v28
    v_maximum3_f32 v28, |v50|, |v51|, v28
    v_mov_b32 v29, 0x5d800000
    v_cmp_nle_f32 s[90:91], v24, v29
    v_mov_b32 v29, 0x35800000
    v_cmp_nge_f32 s[92:93], v24, v29
    v_mov_b32 v29, 0x7f7f0000
    v_cmp_nle_f32 s[94:95], v28, v29
    s_nop 1
    s_or_b64 s[90:91], s[90:91], s[92:93]
    s_nop 0
    s_or_b64 s[90:91], s[90:91], s[94:95]
    s_cmp_lg_u64 s[90:91], 0
    s_cselect_b32 s43, 1, 0
    s_or_b32 s54, s54, s43
    v_add_f32 v24, v18, v19
    v_add_f32 v24, v24, v20
    v_add_f32 v24, v24, v21
    v_mov_b32 v25, v24
    s_nop 1
    v_permlane32_swap_b32 v24, v25
    v_add_f32 v24, v24, v25
    v_rcp_f32 v26, v24
    v_mov_b32 v28, 0
    v_mov_b32 v27, v26
    v_accvgpr_read_b32 v32, a64
    v_accvgpr_read_b32 v33, a65
    v_accvgpr_read_b32 v34, a66
    v_accvgpr_read_b32 v35, a67
    v_accvgpr_read_b32 v36, a68
    v_accvgpr_read_b32 v37, a69
    v_accvgpr_read_b32 v38, a70
    v_accvgpr_read_b32 v39, a71
    v_pk_mul_f32 v[32:33], v[32:33], v[26:27]
    v_pk_mul_f32 v[34:35], v[34:35], v[26:27]
    v_pk_mul_f32 v[36:37], v[36:37], v[26:27]
    v_pk_mul_f32 v[38:39], v[38:39], v[26:27]
    v_cvt_pk_bf16_f32 v40, v32, v33
    v_cvt_pk_bf16_f32 v41, v34, v35
    v_cvt_pk_bf16_f32 v42, v36, v37
    v_cvt_pk_bf16_f32 v43, v38, v39
    s_add_u32 s43, s53, 0
    buffer_store_dwordx4 v[40:43], v3, s[28:31], s43 offen sc1
    v_maximum3_f32 v28, |v32|, |v33|, v28
    v_maximum3_f32 v28, |v34|, |v35|, v28
    v_maximum3_f32 v28, |v36|, |v37|, v28
    v_maximum3_f32 v28, |v38|, |v39|, v28
    v_accvgpr_read_b32 v44, a72
    v_accvgpr_read_b32 v45, a73
    v_accvgpr_read_b32 v46, a74
    v_accvgpr_read_b32 v47, a75
    v_accvgpr_read_b32 v48, a76
    v_accvgpr_read_b32 v49, a77
    v_accvgpr_read_b32 v50, a78
    v_accvgpr_read_b32 v51, a79
    v_pk_mul_f32 v[44:45], v[44:45], v[26:27]
    v_pk_mul_f32 v[46:47], v[46:47], v[26:27]
    v_pk_mul_f32 v[48:49], v[48:49], v[26:27]
    v_pk_mul_f32 v[50:51], v[50:51], v[26:27]
    v_cvt_pk_bf16_f32 v52, v44, v45
    v_cvt_pk_bf16_f32 v53, v46, v47
    v_cvt_pk_bf16_f32 v54, v48, v49
    v_cvt_pk_bf16_f32 v55, v50, v51
    s_add_u32 s43, s53, 1024
    buffer_store_dwordx4 v[52:55], v3, s[28:31], s43 offen sc1
    v_maximum3_f32 v28, |v44|, |v45|, v28
    v_maximum3_f32 v28, |v46|, |v47|, v28
    v_maximum3_f32 v28, |v48|, |v49|, v28
    v_maximum3_f32 v28, |v50|, |v51|, v28
    v_accvgpr_read_b32 v32, a80
    v_accvgpr_read_b32 v33, a81
    v_accvgpr_read_b32 v34, a82
    v_accvgpr_read_b32 v35, a83
    v_accvgpr_read_b32 v36, a84
    v_accvgpr_read_b32 v37, a85
    v_accvgpr_read_b32 v38, a86
    v_accvgpr_read_b32 v39, a87
    v_pk_mul_f32 v[32:33], v[32:33], v[26:27]
    v_pk_mul_f32 v[34:35], v[34:35], v[26:27]
    v_pk_mul_f32 v[36:37], v[36:37], v[26:27]
    v_pk_mul_f32 v[38:39], v[38:39], v[26:27]
    v_cvt_pk_bf16_f32 v40, v32, v33
    v_cvt_pk_bf16_f32 v41, v34, v35
    v_cvt_pk_bf16_f32 v42, v36, v37
    v_cvt_pk_bf16_f32 v43, v38, v39
    s_add_u32 s43, s53, 2048
    buffer_store_dwordx4 v[40:43], v3, s[28:31], s43 offen sc1
    v_maximum3_f32 v28, |v32|, |v33|, v28
    v_maximum3_f32 v28, |v34|, |v35|, v28
    v_maximum3_f32 v28, |v36|, |v37|, v28
    v_maximum3_f32 v28, |v38|, |v39|, v28
    v_accvgpr_read_b32 v44, a88
    v_accvgpr_read_b32 v45, a89
    v_accvgpr_read_b32 v46, a90
    v_accvgpr_read_b32 v47, a91
    v_accvgpr_read_b32 v48, a92
    v_accvgpr_read_b32 v49, a93
    v_accvgpr_read_b32 v50, a94
    v_accvgpr_read_b32 v51, a95
    v_pk_mul_f32 v[44:45], v[44:45], v[26:27]
    v_pk_mul_f32 v[46:47], v[46:47], v[26:27]
    v_pk_mul_f32 v[48:49], v[48:49], v[26:27]
    v_pk_mul_f32 v[50:51], v[50:51], v[26:27]
    v_cvt_pk_bf16_f32 v52, v44, v45
    v_cvt_pk_bf16_f32 v53, v46, v47
    v_cvt_pk_bf16_f32 v54, v48, v49
    v_cvt_pk_bf16_f32 v55, v50, v51
    s_add_u32 s43, s53, 3072
    buffer_store_dwordx4 v[52:55], v3, s[28:31], s43 offen sc1
    v_maximum3_f32 v28, |v44|, |v45|, v28
    v_maximum3_f32 v28, |v46|, |v47|, v28
    v_maximum3_f32 v28, |v48|, |v49|, v28
    v_maximum3_f32 v28, |v50|, |v51|, v28
    v_accvgpr_read_b32 v32, a96
    v_accvgpr_read_b32 v33, a97
    v_accvgpr_read_b32 v34, a98
    v_accvgpr_read_b32 v35, a99
    v_accvgpr_read_b32 v36, a100
    v_accvgpr_read_b32 v37, a101
    v_accvgpr_read_b32 v38, a102
    v_accvgpr_read_b32 v39, a103
    v_pk_mul_f32 v[32:33], v[32:33], v[26:27]
    v_pk_mul_f32 v[34:35], v[34:35], v[26:27]
    v_pk_mul_f32 v[36:37], v[36:37], v[26:27]
    v_pk_mul_f32 v[38:39], v[38:39], v[26:27]
    v_cvt_pk_bf16_f32 v40, v32, v33
    v_cvt_pk_bf16_f32 v41, v34, v35
    v_cvt_pk_bf16_f32 v42, v36, v37
    v_cvt_pk_bf16_f32 v43, v38, v39
    s_add_u32 s43, s53, 4096
    buffer_store_dwordx4 v[40:43], v3, s[28:31], s43 offen sc1
    v_maximum3_f32 v28, |v32|, |v33|, v28
    v_maximum3_f32 v28, |v34|, |v35|, v28
    v_maximum3_f32 v28, |v36|, |v37|, v28
    v_maximum3_f32 v28, |v38|, |v39|, v28
    v_accvgpr_read_b32 v44, a104
    v_accvgpr_read_b32 v45, a105
    v_accvgpr_read_b32 v46, a106
    v_accvgpr_read_b32 v47, a107
    v_accvgpr_read_b32 v48, a108
    v_accvgpr_read_b32 v49, a109
    v_accvgpr_read_b32 v50, a110
    v_accvgpr_read_b32 v51, a111
    v_pk_mul_f32 v[44:45], v[44:45], v[26:27]
    v_pk_mul_f32 v[46:47], v[46:47], v[26:27]
    v_pk_mul_f32 v[48:49], v[48:49], v[26:27]
    v_pk_mul_f32 v[50:51], v[50:51], v[26:27]
    v_cvt_pk_bf16_f32 v52, v44, v45
    v_cvt_pk_bf16_f32 v53, v46, v47
    v_cvt_pk_bf16_f32 v54, v48, v49
    v_cvt_pk_bf16_f32 v55, v50, v51
    s_add_u32 s43, s53, 5120
    buffer_store_dwordx4 v[52:55], v3, s[28:31], s43 offen sc1
    v_maximum3_f32 v28, |v44|, |v45|, v28
    v_maximum3_f32 v28, |v46|, |v47|, v28
    v_maximum3_f32 v28, |v48|, |v49|, v28
    v_maximum3_f32 v28, |v50|, |v51|, v28
    v_accvgpr_read_b32 v32, a112
    v_accvgpr_read_b32 v33, a113
    v_accvgpr_read_b32 v34, a114
    v_accvgpr_read_b32 v35, a115
    v_accvgpr_read_b32 v36, a116
    v_accvgpr_read_b32 v37, a117
    v_accvgpr_read_b32 v38, a118
    v_accvgpr_read_b32 v39, a119
    v_pk_mul_f32 v[32:33], v[32:33], v[26:27]
    v_pk_mul_f32 v[34:35], v[34:35], v[26:27]
    v_pk_mul_f32 v[36:37], v[36:37], v[26:27]
    v_pk_mul_f32 v[38:39], v[38:39], v[26:27]
    v_cvt_pk_bf16_f32 v40, v32, v33
    v_cvt_pk_bf16_f32 v41, v34, v35
    v_cvt_pk_bf16_f32 v42, v36, v37
    v_cvt_pk_bf16_f32 v43, v38, v39
    s_add_u32 s43, s53, 6144
    buffer_store_dwordx4 v[40:43], v3, s[28:31], s43 offen sc1
    v_maximum3_f32 v28, |v32|, |v33|, v28
    v_maximum3_f32 v28, |v34|, |v35|, v28
    v_maximum3_f32 v28, |v36|, |v37|, v28
    v_maximum3_f32 v28, |v38|, |v39|, v28
    v_accvgpr_read_b32 v44, a120
    v_accvgpr_read_b32 v45, a121
    v_accvgpr_read_b32 v46, a122
    v_accvgpr_read_b32 v47, a123
    v_accvgpr_read_b32 v48, a124
    v_accvgpr_read_b32 v49, a125
    v_accvgpr_read_b32 v50, a126
    v_accvgpr_read_b32 v51, a127
    v_pk_mul_f32 v[44:45], v[44:45], v[26:27]
    v_pk_mul_f32 v[46:47], v[46:47], v[26:27]
    v_pk_mul_f32 v[48:49], v[48:49], v[26:27]
    v_pk_mul_f32 v[50:51], v[50:51], v[26:27]
    v_cvt_pk_bf16_f32 v52, v44, v45
    v_cvt_pk_bf16_f32 v53, v46, v47
    v_cvt_pk_bf16_f32 v54, v48, v49
    v_cvt_pk_bf16_f32 v55, v50, v51
    s_add_u32 s43, s53, 7168
    buffer_store_dwordx4 v[52:55], v3, s[28:31], s43 offen sc1
    v_maximum3_f32 v28, |v44|, |v45|, v28
    v_maximum3_f32 v28, |v46|, |v47|, v28
    v_maximum3_f32 v28, |v48|, |v49|, v28
    v_maximum3_f32 v28, |v50|, |v51|, v28
    v_mov_b32 v29, 0x5d800000
    v_cmp_nle_f32 s[90:91], v24, v29
    v_mov_b32 v29, 0x35800000
    v_cmp_nge_f32 s[92:93], v24, v29
    v_mov_b32 v29, 0x7f7f0000
    v_cmp_nle_f32 s[94:95], v28, v29
    s_nop 1
    s_or_b64 s[90:91], s[90:91], s[92:93]
    s_nop 0
    s_or_b64 s[90:91], s[90:91], s[94:95]
    s_cmp_lg_u64 s[90:91], 0
    s_cselect_b32 s43, 2, 0
    s_or_b32 s54, s54, s43
    s_bitcmp1_b32 s54, 0
    s_cbranch_scc0 Lk2_noslowA
    s_waitcnt vmcnt(0)
    s_mov_b32 s50, s56
    s_mov_b32 s46, 0
    v_mov_b32 v24, 0xff7fffff
    v_mov_b32 v25, 0
    v_accvgpr_write_b32 a0, 0
    v_accvgpr_write_b32 a1, 0
    v_accvgpr_write_b32 a2, 0
    v_accvgpr_write_b32 a3, 0
    v_accvgpr_write_b32 a4, 0
    v_accvgpr_write_b32 a5, 0
    v_accvgpr_write_b32 a6, 0
    v_accvgpr_write_b32 a7, 0
    v_accvgpr_write_b32 a8, 0
    v_accvgpr_write_b32 a9, 0
    v_accvgpr_write_b32 a10, 0
    v_accvgpr_write_b32 a11, 0
    v_accvgpr_write_b32 a12, 0
    v_accvgpr_write_b32 a13, 0
    v_accvgpr_write_b32 a14, 0
    v_accvgpr_write_b32 a15, 0
    v_accvgpr_write_b32 a16, 0
    v_accvgpr_write_b32 a17, 0
    v_accvgpr_write_b32 a18, 0
    v_accvgpr_write_b32 a19, 0
    v_accvgpr_write_b32 a20, 0
    v_accvgpr_write_b32 a21, 0
    v_accvgpr_write_b32 a22, 0
    v_accvgpr_write_b32 a23, 0
    v_accvgpr_write_b32 a24, 0
    v_accvgpr_write_b32 a25, 0
    v_accvgpr_write_b32 a26, 0
    v_accvgpr_write_b32 a27, 0
    v_accvgpr_write_b32 a28, 0
    v_accvgpr_write_b32 a29, 0
    v_accvgpr_write_b32 a30, 0
    v_accvgpr_write_b32 a31, 0
    v_accvgpr_write_b32 a32, 0
    v_accvgpr_write_b32 a33, 0
    v_accvgpr_write_b32 a34, 0
    v_accvgpr_write_b32 a35, 0
    v_accvgpr_write_b32 a36, 0
    v_accvgpr_write_b32 a37, 0
    v_accvgpr_write_b32 a38, 0
    v_accvgpr_write_b32 a39, 0
    v_accvgpr_write_b32 a40, 0
    v_accvgpr_write_b32 a41, 0
    v_accvgpr_write_b32 a42, 0
    v_accvgpr_write_b32 a43, 0
    v_accvgpr_write_b32 a44, 0
    v_accvgpr_write_b32 a45, 0
    v_accvgpr_write_b32 a46, 0
    v_accvgpr_write_b32 a47, 0
    v_accvgpr_write_b32 a48, 0
    v_accvgpr_write_b32 a49, 0
    v_accvgpr_write_b32 a50, 0
    v_accvgpr_write_b32 a51, 0
    v_accvgpr_write_b32 a52, 0
    v_accvgpr_write_b32 a53, 0
    v_accvgpr_write_b32 a54, 0
    v_accvgpr_write_b32 a55, 0
    v_accvgpr_write_b32 a56, 0
    v_accvgpr_write_b32 a57, 0
    v_accvgpr_write_b32 a58, 0
    v_accvgpr_write_b32 a59, 0
    v_accvgpr_write_b32 a60, 0
    v_accvgpr_write_b32 a61, 0
    v_accvgpr_write_b32 a62, 0
    v_accvgpr_write_b32 a63, 0
    v_and_b32 v13, 31, v2
    v_lshrrev_b32 v28, 5, v2
    v_lshlrev_b32 v28, 2, v28
    v_sub_u32 v13, v13, v28
    s_lshl_b32 s43, s50, 5
    v_add_u32 v13, s43, v13
    s_add_u32 s50, s50, 1
Lk2_slowA:
    s_add_u32 s43, s46, 0
    buffer_load_dwordx4 a[192:195], v3, s[24:27], s43 offen
    s_add_u32 s43, s46, 1024
    buffer_load_dwordx4 a[196:199], v3, s[24:27], s43 offen
    s_add_u32 s43, s46, 2048
    buffer_load_dwordx4 a[200:203], v3, s[24:27], s43 offen
    s_add_u32 s43, s46, 3072
    buffer_load_dwordx4 a[204:207], v3, s[24:27], s43 offen
    s_add_u32 s43, s46, 4096
    buffer_load_dwordx4 a[208:211], v3, s[24:27], s43 offen
    s_add_u32 s43, s46, 5120
    buffer_load_dwordx4 a[212:215], v3, s[24:27], s43 offen
    s_add_u32 s43, s46, 6144
    buffer_load_dwordx4 a[216:219], v3, s[24:27], s43 offen
    s_add_u32 s43, s46, 7168
    buffer_load_dwordx4 a[220:223], v3, s[24:27], s43 offen
    s_add_u32 s43, s46, 8192
    buffer_load_dwordx4 a[224:227], v3, s[24:27], s43 offen
    s_add_u32 s43, s46, 10240
    buffer_load_dwordx4 a[228:231], v3, s[24:27], s43 offen
    s_add_u32 s43, s46, 12288
    buffer_load_dwordx4 a[232:235], v3, s[24:27], s43 offen
    s_add_u32 s43, s46, 14336
    buffer_load_dwordx4 a[236:239], v3, s[24:27], s43 offen
    s_add_u32 s43, s46, 9216
    buffer_load_dwordx4 a[240:243], v3, s[24:27], s43 offen
    s_add_u32 s43, s46, 11264
    buffer_load_dwordx4 a[244:247], v3, s[24:27], s43 offen
    s_add_u32 s43, s46, 13312
    buffer_load_dwordx4 a[248:251], v3, s[24:27], s43 offen
    s_add_u32 s43, s46, 15360
    buffer_load_dwordx4 a[252:255], v3, s[24:27], s43 offen
    s_waitcnt vmcnt(8)
    v_mfma_f32_32x32x16_bf16 v[64:79], a[192:195], a[128:131], 0
    v_mfma_f32_32x32x16_bf16 v[64:79], a[196:199], a[132:135], v[64:79]
    v_mfma_f32_32x32x16_bf16 v[64:79], a[200:203], a[136:139], v[64:79]
    v_mfma_f32_32x32x16_bf16 v[64:79], a[204:207], a[140:143], v[64:79]
    v_mfma_f32_32x32x16_bf16 v[64:79], a[208:211], a[144:147], v[64:79]
    v_mfma_f32_32x32x16_bf16 v[64:79], a[212:215], a[148:151], v[64:79]
    v_mfma_f32_32x32x16_bf16 v[64:79], a[216:219], a[152:155], v[64:79]
    v_mfma_f32_32x32x16_bf16 v[64:79], a[220:223], a[156:159], v[64:79]
    v_cmp_le_i32 s[90:91], 0, v13
    v_cmp_le_i32 s[92:93], 1, v13
    v_cmp_le_i32 s[94:95], 2, v13
    v_cmp_le_i32 s[96:97], 3, v13
    s_nop 7
    v_cndmask_b32 v64, v5, v64, s[90:91]
    v_cndmask_b32 v65, v5, v65, s[92:93]
    v_cndmask_b32 v66, v5, v66, s[94:95]
    v_cndmask_b32 v67, v5, v67, s[96:97]
    v_cmp_le_i32 s[90:91], 8, v13
    v_cmp_le_i32 s[92:93], 9, v13
    v_cmp_le_i32 s[94:95], 10, v13
    v_cmp_le_i32 s[96:97], 11, v13
    v_cndmask_b32 v68, v5, v68, s[90:91]
    v_cndmask_b32 v69, v5, v69, s[92:93]
    v_cndmask_b32 v70, v5, v70, s[94:95]
    v_cndmask_b32 v71, v5, v71, s[96:97]
    v_cmp_le_i32 s[90:91], 16, v13
    v_cmp_le_i32 s[92:93], 17, v13
    v_cmp_le_i32 s[94:95], 18, v13
    v_cmp_le_i32 s[96:97], 19, v13
    v_cndmask_b32 v72, v5, v72, s[90:91]
    v_cndmask_b32 v73, v5, v73, s[92:93]
    v_cndmask_b32 v74, v5, v74, s[94:95]
    v_cndmask_b32 v75, v5, v75, s[96:97]
    v_cmp_le_i32 s[90:91], 24, v13
    v_cmp_le_i32 s[92:93], 25, v13
    v_cmp_le_i32 s[94:95], 26, v13
    v_cmp_le_i32 s[96:97], 27, v13
    v_cndmask_b32 v76, v5, v76, s[90:91]
    v_cndmask_b32 v77, v5, v77, s[92:93]
    v_cndmask_b32 v78, v5, v78, s[94:95]
    v_cndmask_b32 v79, v5, v79, s[96:97]
    v_max3_f32 v26, v64, v65, v24
    v_max3_f32 v26, v66, v67, v26
    v_max3_f32 v26, v68, v69, v26
    v_max3_f32 v26, v70, v71, v26
    v_max3_f32 v26, v72, v73, v26
    v_max3_f32 v26, v74, v75, v26
    v_max3_f32 v26, v76, v77, v26
    v_max3_f32 v26, v78, v79, v26
    v_mov_b32 v28, v26
    s_nop 1
    v_permlane32_swap_b32 v26, v28
    v_max_f32 v26, v26, v28
    v_sub_f32 v27, v24, v26
    v_exp_f32 v27, v27
    v_mov_b32 v24, v26
    v_mul_f32 v25, v25, v27
    v_sub_f32 v64, v64, v26
    v_exp_f32 v64, v64
    v_sub_f32 v65, v65, v26
    v_exp_f32 v65, v65
    v_sub_f32 v66, v66, v26
    v_exp_f32 v66, v66
    v_sub_f32 v67, v67, v26
    v_exp_f32 v67, v67
    v_sub_f32 v68, v68, v26
    v_exp_f32 v68, v68
    v_sub_f32 v69, v69, v26
    v_exp_f32 v69, v69
    v_sub_f32 v70, v70, v26
    v_exp_f32 v70, v70
    v_sub_f32 v71, v71, v26
    v_exp_f32 v71, v71
    v_sub_f32 v72, v72, v26
    v_exp_f32 v72, v72
    v_sub_f32 v73, v73, v26
    v_exp_f32 v73, v73
    v_sub_f32 v74, v74, v26
    v_exp_f32 v74, v74
    v_sub_f32 v75, v75, v26
    v_exp_f32 v75, v75
    v_sub_f32 v76, v76, v26
    v_exp_f32 v76, v76
    v_sub_f32 v77, v77, v26
    v_exp_f32 v77, v77
    v_sub_f32 v78, v78, v26
    v_exp_f32 v78, v78
    v_sub_f32 v79, v79, v26
    v_exp_f32 v79, v79
    v_add_f32 v25, v25, v64
    v_add_f32 v25, v25, v65
    v_add_f32 v25, v25, v66
    v_add_f32 v25, v25, v67
    v_add_f32 v25, v25, v68
    v_add_f32 v25, v25, v69
    v_add_f32 v25, v25, v70
    v_add_f32 v25, v25, v71
    v_add_f32 v25, v25, v72
    v_add_f32 v25, v25, v73
    v_add_f32 v25, v25, v74
    v_add_f32 v25, v25, v75
    v_add_f32 v25, v25, v76
    v_add_f32 v25, v25, v77
    v_add_f32 v25, v25, v78
    v_add_f32 v25, v25, v79
    v_cvt_pk_bf16_f32 v96, v64, v65
    v_cvt_pk_bf16_f32 v97, v66, v67
    v_cvt_pk_bf16_f32 v98, v68, v69
    v_cvt_pk_bf16_f32 v99, v70, v71
    v_cvt_pk_bf16_f32 v100, v72, v73
    v_cvt_pk_bf16_f32 v101, v74, v75
    v_cvt_pk_bf16_f32 v102, v76, v77
    v_cvt_pk_bf16_f32 v103, v78, v79
    v_accvgpr_read_b32 v28, a0
    v_mul_f32 v28, v28, v27
    v_accvgpr_write_b32 a0, v28
    v_accvgpr_read_b32 v28, a1
    v_mul_f32 v28, v28, v27
    v_accvgpr_write_b32 a1, v28
    v_accvgpr_read_b32 v28, a2
    v_mul_f32 v28, v28, v27
    v_accvgpr_write_b32 a2, v28
    v_accvgpr_read_b32 v28, a3
    v_mul_f32 v28, v28, v27
    v_accvgpr_write_b32 a3, v28
    v_accvgpr_read_b32 v28, a4
    v_mul_f32 v28, v28, v27
    v_accvgpr_write_b32 a4, v28
    v_accvgpr_read_b32 v28, a5
    v_mul_f32 v28, v28, v27
    v_accvgpr_write_b32 a5, v28
    v_accvgpr_read_b32 v28, a6
    v_mul_f32 v28, v28, v27
    v_accvgpr_write_b32 a6, v28
    v_accvgpr_read_b32 v28, a7
    v_mul_f32 v28, v28, v27
    v_accvgpr_write_b32 a7, v28
    v_accvgpr_read_b32 v28, a8
    v_mul_f32 v28, v28, v27
    v_accvgpr_write_b32 a8, v28
    v_accvgpr_read_b32 v28, a9
    v_mul_f32 v28, v28, v27
    v_accvgpr_write_b32 a9, v28
    v_accvgpr_read_b32 v28, a10
    v_mul_f32 v28, v28, v27
    v_accvgpr_write_b32 a10, v28
    v_accvgpr_read_b32 v28, a11
    v_mul_f32 v28, v28, v27
    v_accvgpr_write_b32 a11, v28
    v_accvgpr_read_b32 v28, a12
    v_mul_f32 v28, v28, v27
    v_accvgpr_write_b32 a12, v28
    v_accvgpr_read_b32 v28, a13
    v_mul_f32 v28, v28, v27
    v_accvgpr_write_b32 a13, v28
    v_accvgpr_read_b32 v28, a14
    v_mul_f32 v28, v28, v27
    v_accvgpr_write_b32 a14, v28
    v_accvgpr_read_b32 v28, a15
    v_mul_f32 v28, v28, v27
    v_accvgpr_write_b32 a15, v28
    v_accvgpr_read_b32 v28, a16
    v_mul_f32 v28, v28, v27
    v_accvgpr_write_b32 a16, v28
    v_accvgpr_read_b32 v28, a17
    v_mul_f32 v28, v28, v27
    v_accvgpr_write_b32 a17, v28
    v_accvgpr_read_b32 v28, a18
    v_mul_f32 v28, v28, v27
    v_accvgpr_write_b32 a18, v28
    v_accvgpr_read_b32 v28, a19
    v_mul_f32 v28, v28, v27
    v_accvgpr_write_b32 a19, v28
    v_accvgpr_read_b32 v28, a20
    v_mul_f32 v28, v28, v27
    v_accvgpr_write_b32 a20, v28
    v_accvgpr_read_b32 v28, a21
    v_mul_f32 v28, v28, v27
    v_accvgpr_write_b32 a21, v28
    v_accvgpr_read_b32 v28, a22
    v_mul_f32 v28, v28, v27
    v_accvgpr_write_b32 a22, v28
    v_accvgpr_read_b32 v28, a23
    v_mul_f32 v28, v28, v27
    v_accvgpr_write_b32 a23, v28
    v_accvgpr_read_b32 v28, a24
    v_mul_f32 v28, v28, v27
    v_accvgpr_write_b32 a24, v28
    v_accvgpr_read_b32 v28, a25
    v_mul_f32 v28, v28, v27
    v_accvgpr_write_b32 a25, v28
    v_accvgpr_read_b32 v28, a26
    v_mul_f32 v28, v28, v27
    v_accvgpr_write_b32 a26, v28
    v_accvgpr_read_b32 v28, a27
    v_mul_f32 v28, v28, v27
    v_accvgpr_write_b32 a27, v28
    v_accvgpr_read_b32 v28, a28
    v_mul_f32 v28, v28, v27
    v_accvgpr_write_b32 a28, v28
    v_accvgpr_read_b32 v28, a29
    v_mul_f32 v28, v28, v27
    v_accvgpr_write_b32 a29, v28
    v_accvgpr_read_b32 v28, a30
    v_mul_f32 v28, v28, v27
    v_accvgpr_write_b32 a30, v28
    v_accvgpr_read_b32 v28, a31
    v_mul_f32 v28, v28, v27
    v_accvgpr_write_b32 a31, v28
    v_accvgpr_read_b32 v28, a32
    v_mul_f32 v28, v28, v27
    v_accvgpr_write_b32 a32, v28
    v_accvgpr_read_b32 v28, a33
    v_mul_f32 v28, v28, v27
    v_accvgpr_write_b32 a33, v28
    v_accvgpr_read_b32 v28, a34
    v_mul_f32 v28, v28, v27
    v_accvgpr_write_b32 a34, v28
    v_accvgpr_read_b32 v28, a35
    v_mul_f32 v28, v28, v27
    v_accvgpr_write_b32 a35, v28
    v_accvgpr_read_b32 v28, a36
    v_mul_f32 v28, v28, v27
    v_accvgpr_write_b32 a36, v28
    v_accvgpr_read_b32 v28, a37
    v_mul_f32 v28, v28, v27
    v_accvgpr_write_b32 a37, v28
    v_accvgpr_read_b32 v28, a38
    v_mul_f32 v28, v28, v27
    v_accvgpr_write_b32 a38, v28
    v_accvgpr_read_b32 v28, a39
    v_mul_f32 v28, v28, v27
    v_accvgpr_write_b32 a39, v28
    v_accvgpr_read_b32 v28, a40
    v_mul_f32 v28, v28, v27
    v_accvgpr_write_b32 a40, v28
    v_accvgpr_read_b32 v28, a41
    v_mul_f32 v28, v28, v27
    v_accvgpr_write_b32 a41, v28
    v_accvgpr_read_b32 v28, a42
    v_mul_f32 v28, v28, v27
    v_accvgpr_write_b32 a42, v28
    v_accvgpr_read_b32 v28, a43
    v_mul_f32 v28, v28, v27
    v_accvgpr_write_b32 a43, v28
    v_accvgpr_read_b32 v28, a44
    v_mul_f32 v28, v28, v27
    v_accvgpr_write_b32 a44, v28
    v_accvgpr_read_b32 v28, a45
    v_mul_f32 v28, v28, v27
    v_accvgpr_write_b32 a45, v28
    v_accvgpr_read_b32 v28, a46
    v_mul_f32 v28, v28, v27
    v_accvgpr_write_b32 a46, v28
    v_accvgpr_read_b32 v28, a47
    v_mul_f32 v28, v28, v27
    v_accvgpr_write_b32 a47, v28
    v_accvgpr_read_b32 v28, a48
    v_mul_f32 v28, v28, v27
    v_accvgpr_write_b32 a48, v28
    v_accvgpr_read_b32 v28, a49
    v_mul_f32 v28, v28, v27
    v_accvgpr_write_b32 a49, v28
    v_accvgpr_read_b32 v28, a50
    v_mul_f32 v28, v28, v27
    v_accvgpr_write_b32 a50, v28
    v_accvgpr_read_b32 v28, a51
    v_mul_f32 v28, v28, v27
    v_accvgpr_write_b32 a51, v28
    v_accvgpr_read_b32 v28, a52
    v_mul_f32 v28, v28, v27
    v_accvgpr_write_b32 a52, v28
    v_accvgpr_read_b32 v28, a53
    v_mul_f32 v28, v28, v27
    v_accvgpr_write_b32 a53, v28
    v_accvgpr_read_b32 v28, a54
    v_mul_f32 v28, v28, v27
    v_accvgpr_write_b32 a54, v28
    v_accvgpr_read_b32 v28, a55
    v_mul_f32 v28, v28, v27
    v_accvgpr_write_b32 a55, v28
    v_accvgpr_read_b32 v28, a56
    v_mul_f32 v28, v28, v27
    v_accvgpr_write_b32 a56, v28
    v_accvgpr_read_b32 v28, a57
    v_mul_f32 v28, v28, v27
    v_accvgpr_write_b32 a57, v28
    v_accvgpr_read_b32 v28, a58
    v_mul_f32 v28, v28, v27
    v_accvgpr_write_b32 a58, v28
    v_accvgpr_read_b32 v28, a59
    v_mul_f32 v28, v28, v27
    v_accvgpr_write_b32 a59, v28
    v_accvgpr_read_b32 v28, a60
    v_mul_f32 v28, v28, v27
    v_accvgpr_write_b32 a60, v28
    v_accvgpr_read_b32 v28, a61
    v_mul_f32 v28, v28, v27
    v_accvgpr_write_b32 a61, v28
    v_accvgpr_read_b32 v28, a62
    v_mul_f32 v28, v28, v27
    v_accvgpr_write_b32 a62, v28
    v_accvgpr_read_b32 v28, a63
    v_mul_f32 v28, v28, v27
    v_accvgpr_write_b32 a63, v28
    s_waitcnt vmcnt(0)
    v_mfma_f32_32x32x16_bf16 a[0:15], a[224:227], v[96:99], a[0:15]
    v_mfma_f32_32x32x16_bf16 a[16:31], a[228:231], v[96:99], a[16:31]
    v_mfma_f32_32x32x16_bf16 a[32:47], a[232:235], v[96:99], a[32:47]
    v_mfma_f32_32x32x16_bf16 a[48:63], a[236:239], v[96:99], a[48:63]
    v_mfma_f32_32x32x16_bf16 a[0:15], a[240:243], v[100:103], a[0:15]
    v_mfma_f32_32x32x16_bf16 a[16:31], a[244:247], v[100:103], a[16:31]
    v_mfma_f32_32x32x16_bf16 a[32:47], a[248:251], v[100:103], a[32:47]
    v_mfma_f32_32x32x16_bf16 a[48:63], a[252:255], v[100:103], a[48:63]
    s_add_u32 s46, s46, 16384
    v_subrev_u32 v13, 32, v13
    s_sub_u32 s50, s50, 1
    s_cmp_lg_u32 s50, 0
    s_nop 15
    s_cbranch_scc1 Lk2_slowA
    v_mov_b32 v16, v25
    v_mov_b32 v17, 0
    v_add_f32 v24, v16, v17
    v_mov_b32 v25, v24
    s_nop 1
    v_permlane32_swap_b32 v24, v25
    v_add_f32 v24, v24, v25
    v_rcp_f32 v26, v24
    v_mov_b32 v28, 0
    v_mov_b32 v27, v26
    v_accvgpr_read_b32 v32, a0
    v_accvgpr_read_b32 v33, a1
    v_accvgpr_read_b32 v34, a2
    v_accvgpr_read_b32 v35, a3
    v_accvgpr_read_b32 v36, a4
    v_accvgpr_read_b32 v37, a5
    v_accvgpr_read_b32 v38, a6
    v_accvgpr_read_b32 v39, a7
    v_pk_mul_f32 v[32:33], v[32:33], v[26:27]
    v_pk_mul_f32 v[34:35], v[34:35], v[26:27]
    v_pk_mul_f32 v[36:37], v[36:37], v[26:27]
    v_pk_mul_f32 v[38:39], v[38:39], v[26:27]
    v_cvt_pk_bf16_f32 v40, v32, v33
    v_cvt_pk_bf16_f32 v41, v34, v35
    v_cvt_pk_bf16_f32 v42, v36, v37
    v_cvt_pk_bf16_f32 v43, v38, v39
    s_add_u32 s43, s52, 0
    buffer_store_dwordx4 v[40:43], v3, s[28:31], s43 offen sc1
    v_maximum3_f32 v28, |v32|, |v33|, v28
    v_maximum3_f32 v28, |v34|, |v35|, v28
    v_maximum3_f32 v28, |v36|, |v37|, v28
    v_maximum3_f32 v28, |v38|, |v39|, v28
    v_accvgpr_read_b32 v44, a8
    v_accvgpr_read_b32 v45, a9
    v_accvgpr_read_b32 v46, a10
    v_accvgpr_read_b32 v47, a11
    v_accvgpr_read_b32 v48, a12
    v_accvgpr_read_b32 v49, a13
    v_accvgpr_read_b32 v50, a14
    v_accvgpr_read_b32 v51, a15
    v_pk_mul_f32 v[44:45], v[44:45], v[26:27]
    v_pk_mul_f32 v[46:47], v[46:47], v[26:27]
    v_pk_mul_f32 v[48:49], v[48:49], v[26:27]
    v_pk_mul_f32 v[50:51], v[50:51], v[26:27]
    v_cvt_pk_bf16_f32 v52, v44, v45
    v_cvt_pk_bf16_f32 v53, v46, v47
    v_cvt_pk_bf16_f32 v54, v48, v49
    v_cvt_pk_bf16_f32 v55, v50, v51
    s_add_u32 s43, s52, 1024
    buffer_store_dwordx4 v[52:55], v3, s[28:31], s43 offen sc1
    v_maximum3_f32 v28, |v44|, |v45|, v28
    v_maximum3_f32 v28, |v46|, |v47|, v28
    v_maximum3_f32 v28, |v48|, |v49|, v28
    v_maximum3_f32 v28, |v50|, |v51|, v28
    v_accvgpr_read_b32 v32, a16
    v_accvgpr_read_b32 v33, a17
    v_accvgpr_read_b32 v34, a18
    v_accvgpr_read_b32 v35, a19
    v_accvgpr_read_b32 v36, a20
    v_accvgpr_read_b32 v37, a21
    v_accvgpr_read_b32 v38, a22
    v_accvgpr_read_b32 v39, a23
    v_pk_mul_f32 v[32:33], v[32:33], v[26:27]
    v_pk_mul_f32 v[34:35], v[34:35], v[26:27]
    v_pk_mul_f32 v[36:37], v[36:37], v[26:27]
    v_pk_mul_f32 v[38:39], v[38:39], v[26:27]
    v_cvt_pk_bf16_f32 v40, v32, v33
    v_cvt_pk_bf16_f32 v41, v34, v35
    v_cvt_pk_bf16_f32 v42, v36, v37
    v_cvt_pk_bf16_f32 v43, v38, v39
    s_add_u32 s43, s52, 2048
    buffer_store_dwordx4 v[40:43], v3, s[28:31], s43 offen sc1
    v_maximum3_f32 v28, |v32|, |v33|, v28
    v_maximum3_f32 v28, |v34|, |v35|, v28
    v_maximum3_f32 v28, |v36|, |v37|, v28
    v_maximum3_f32 v28, |v38|, |v39|, v28
    v_accvgpr_read_b32 v44, a24
    v_accvgpr_read_b32 v45, a25
    v_accvgpr_read_b32 v46, a26
    v_accvgpr_read_b32 v47, a27
    v_accvgpr_read_b32 v48, a28
    v_accvgpr_read_b32 v49, a29
    v_accvgpr_read_b32 v50, a30
    v_accvgpr_read_b32 v51, a31
    v_pk_mul_f32 v[44:45], v[44:45], v[26:27]
    v_pk_mul_f32 v[46:47], v[46:47], v[26:27]
    v_pk_mul_f32 v[48:49], v[48:49], v[26:27]
    v_pk_mul_f32 v[50:51], v[50:51], v[26:27]
    v_cvt_pk_bf16_f32 v52, v44, v45
    v_cvt_pk_bf16_f32 v53, v46, v47
    v_cvt_pk_bf16_f32 v54, v48, v49
    v_cvt_pk_bf16_f32 v55, v50, v51
    s_add_u32 s43, s52, 3072
    buffer_store_dwordx4 v[52:55], v3, s[28:31], s43 offen sc1
    v_maximum3_f32 v28, |v44|, |v45|, v28
    v_maximum3_f32 v28, |v46|, |v47|, v28
    v_maximum3_f32 v28, |v48|, |v49|, v28
    v_maximum3_f32 v28, |v50|, |v51|, v28
    v_accvgpr_read_b32 v32, a32
    v_accvgpr_read_b32 v33, a33
    v_accvgpr_read_b32 v34, a34
    v_accvgpr_read_b32 v35, a35
    v_accvgpr_read_b32 v36, a36
    v_accvgpr_read_b32 v37, a37
    v_accvgpr_read_b32 v38, a38
    v_accvgpr_read_b32 v39, a39
    v_pk_mul_f32 v[32:33], v[32:33], v[26:27]
    v_pk_mul_f32 v[34:35], v[34:35], v[26:27]
    v_pk_mul_f32 v[36:37], v[36:37], v[26:27]
    v_pk_mul_f32 v[38:39], v[38:39], v[26:27]
    v_cvt_pk_bf16_f32 v40, v32, v33
    v_cvt_pk_bf16_f32 v41, v34, v35
    v_cvt_pk_bf16_f32 v42, v36, v37
    v_cvt_pk_bf16_f32 v43, v38, v39
    s_add_u32 s43, s52, 4096
    buffer_store_dwordx4 v[40:43], v3, s[28:31], s43 offen sc1
    v_maximum3_f32 v28, |v32|, |v33|, v28
    v_maximum3_f32 v28, |v34|, |v35|, v28
    v_maximum3_f32 v28, |v36|, |v37|, v28
    v_maximum3_f32 v28, |v38|, |v39|, v28
    v_accvgpr_read_b32 v44, a40
    v_accvgpr_read_b32 v45, a41
    v_accvgpr_read_b32 v46, a42
    v_accvgpr_read_b32 v47, a43
    v_accvgpr_read_b32 v48, a44
    v_accvgpr_read_b32 v49, a45
    v_accvgpr_read_b32 v50, a46
    v_accvgpr_read_b32 v51, a47
    v_pk_mul_f32 v[44:45], v[44:45], v[26:27]
    v_pk_mul_f32 v[46:47], v[46:47], v[26:27]
    v_pk_mul_f32 v[48:49], v[48:49], v[26:27]
    v_pk_mul_f32 v[50:51], v[50:51], v[26:27]
    v_cvt_pk_bf16_f32 v52, v44, v45
    v_cvt_pk_bf16_f32 v53, v46, v47
    v_cvt_pk_bf16_f32 v54, v48, v49
    v_cvt_pk_bf16_f32 v55, v50, v51
    s_add_u32 s43, s52, 5120
    buffer_store_dwordx4 v[52:55], v3, s[28:31], s43 offen sc1
    v_maximum3_f32 v28, |v44|, |v45|, v28
    v_maximum3_f32 v28, |v46|, |v47|, v28
    v_maximum3_f32 v28, |v48|, |v49|, v28
    v_maximum3_f32 v28, |v50|, |v51|, v28
    v_accvgpr_read_b32 v32, a48
    v_accvgpr_read_b32 v33, a49
    v_accvgpr_read_b32 v34, a50
    v_accvgpr_read_b32 v35, a51
    v_accvgpr_read_b32 v36, a52
    v_accvgpr_read_b32 v37, a53
    v_accvgpr_read_b32 v38, a54
    v_accvgpr_read_b32 v39, a55
    v_pk_mul_f32 v[32:33], v[32:33], v[26:27]
    v_pk_mul_f32 v[34:35], v[34:35], v[26:27]
    v_pk_mul_f32 v[36:37], v[36:37], v[26:27]
    v_pk_mul_f32 v[38:39], v[38:39], v[26:27]
    v_cvt_pk_bf16_f32 v40, v32, v33
    v_cvt_pk_bf16_f32 v41, v34, v35
    v_cvt_pk_bf16_f32 v42, v36, v37
    v_cvt_pk_bf16_f32 v43, v38, v39
    s_add_u32 s43, s52, 6144
    buffer_store_dwordx4 v[40:43], v3, s[28:31], s43 offen sc1
    v_maximum3_f32 v28, |v32|, |v33|, v28
    v_maximum3_f32 v28, |v34|, |v35|, v28
    v_maximum3_f32 v28, |v36|, |v37|, v28
    v_maximum3_f32 v28, |v38|, |v39|, v28
    v_accvgpr_read_b32 v44, a56
    v_accvgpr_read_b32 v45, a57
    v_accvgpr_read_b32 v46, a58
    v_accvgpr_read_b32 v47, a59
    v_accvgpr_read_b32 v48, a60
    v_accvgpr_read_b32 v49, a61
    v_accvgpr_read_b32 v50, a62
    v_accvgpr_read_b32 v51, a63
    v_pk_mul_f32 v[44:45], v[44:45], v[26:27]
    v_pk_mul_f32 v[46:47], v[46:47], v[26:27]
    v_pk_mul_f32 v[48:49], v[48:49], v[26:27]
    v_pk_mul_f32 v[50:51], v[50:51], v[26:27]
    v_cvt_pk_bf16_f32 v52, v44, v45
    v_cvt_pk_bf16_f32 v53, v46, v47
    v_cvt_pk_bf16_f32 v54, v48, v49
    v_cvt_pk_bf16_f32 v55, v50, v51
    s_add_u32 s43, s52, 7168
    buffer_store_dwordx4 v[52:55], v3, s[28:31], s43 offen sc1
    v_maximum3_f32 v28, |v44|, |v45|, v28
    v_maximum3_f32 v28, |v46|, |v47|, v28
    v_maximum3_f32 v28, |v48|, |v49|, v28
    v_maximum3_f32 v28, |v50|, |v51|, v28
    v_mov_b32 v29, 0x5d800000
    v_cmp_nle_f32 s[90:91], v24, v29
    v_mov_b32 v29, 0x35800000
    v_cmp_nge_f32 s[92:93], v24, v29
    v_mov_b32 v29, 0x7f7f0000
    v_cmp_nle_f32 s[94:95], v28, v29
    s_nop 1
    s_or_b64 s[90:91], s[90:91], s[92:93]
    s_nop 0
    s_or_b64 s[90:91], s[90:91], s[94:95]
    s_cmp_lg_u64 s[90:91], 0
    s_cselect_b32 s43, 0, 0
    s_or_b32 s54, s54, s43
Lk2_noslowA:
    s_bitcmp1_b32 s54, 1
    s_cbranch_scc0 Lk2_noslowB
    s_waitcnt vmcnt(0)
    s_mov_b32 s50, s57
    s_mov_b32 s46, 0
    v_mov_b32 v24, 0xff7fffff
    v_mov_b32 v25, 0
    v_accvgpr_write_b32 a64, 0
    v_accvgpr_write_b32 a65, 0
    v_accvgpr_write_b32 a66, 0
    v_accvgpr_write_b32 a67, 0
    v_accvgpr_write_b32 a68, 0
    v_accvgpr_write_b32 a69, 0
    v_accvgpr_write_b32 a70, 0
    v_accvgpr_write_b32 a71, 0
    v_accvgpr_write_b32 a72, 0
    v_accvgpr_write_b32 a73, 0
    v_accvgpr_write_b32 a74, 0
    v_accvgpr_write_b32 a75, 0
    v_accvgpr_write_b32 a76, 0
    v_accvgpr_write_b32 a77, 0
    v_accvgpr_write_b32 a78, 0
    v_accvgpr_write_b32 a79, 0
    v_accvgpr_write_b32 a80, 0
    v_accvgpr_write_b32 a81, 0
    v_accvgpr_write_b32 a82, 0
    v_accvgpr_write_b32 a83, 0
    v_accvgpr_write_b32 a84, 0
    v_accvgpr_write_b32 a85, 0
    v_accvgpr_write_b32 a86, 0
    v_accvgpr_write_b32 a87, 0
    v_accvgpr_write_b32 a88, 0
    v_accvgpr_write_b32 a89, 0
    v_accvgpr_write_b32 a90, 0
    v_accvgpr_write_b32 a91, 0
    v_accvgpr_write_b32 a92, 0
    v_accvgpr_write_b32 a93, 0
    v_accvgpr_write_b32 a94, 0
    v_accvgpr_write_b32 a95, 0
    v_accvgpr_write_b32 a96, 0
    v_accvgpr_write_b32 a97, 0
    v_accvgpr_write_b32 a98, 0
    v_accvgpr_write_b32 a99, 0
    v_accvgpr_write_b32 a100, 0
    v_accvgpr_write_b32 a101, 0
    v_accvgpr_write_b32 a102, 0
    v_accvgpr_write_b32 a103, 0
    v_accvgpr_write_b32 a104, 0
    v_accvgpr_write_b32 a105, 0
    v_accvgpr_write_b32 a106, 0
    v_accvgpr_write_b32 a107, 0
    v_accvgpr_write_b32 a108, 0
    v_accvgpr_write_b32 a109, 0
    v_accvgpr_write_b32 a110, 0
    v_accvgpr_write_b32 a111, 0
    v_accvgpr_write_b32 a112, 0
    v_accvgpr_write_b32 a113, 0
    v_accvgpr_write_b32 a114, 0
    v_accvgpr_write_b32 a115, 0
    v_accvgpr_write_b32 a116, 0
    v_accvgpr_write_b32 a117, 0
    v_accvgpr_write_b32 a118, 0
    v_accvgpr_write_b32 a119, 0
    v_accvgpr_write_b32 a120, 0
    v_accvgpr_write_b32 a121, 0
    v_accvgpr_write_b32 a122, 0
    v_accvgpr_write_b32 a123, 0
    v_accvgpr_write_b32 a124, 0
    v_accvgpr_write_b32 a125, 0
    v_accvgpr_write_b32 a126, 0
    v_accvgpr_write_b32 a127, 0
    v_and_b32 v13, 31, v2
    v_lshrrev_b32 v28, 5, v2
    v_lshlrev_b32 v28, 2, v28
    v_sub_u32 v13, v13, v28
    s_lshl_b32 s43, s50, 5
    v_add_u32 v13, s43, v13
    s_add_u32 s50, s50, 1
Lk2_slowB:
    s_add_u32 s43, s46, 0
    buffer_load_dwordx4 a[192:195], v3, s[24:27], s43 offen
    s_add_u32 s43, s46, 1024
    buffer_load_dwordx4 a[196:199], v3, s[24:27], s43 offen
    s_add_u32 s43, s46, 2048
    buffer_load_dwordx4 a[200:203], v3, s[24:27], s43 offen
    s_add_u32 s43, s46, 3072
    buffer_load_dwordx4 a[204:207], v3, s[24:27], s43 offen
    s_add_u32 s43, s46, 4096
    buffer_load_dwordx4 a[208:211], v3, s[24:27], s43 offen
    s_add_u32 s43, s46, 5120
    buffer_load_dwordx4 a[212:215], v3, s[24:27], s43 offen
    s_add_u32 s43, s46, 6144
    buffer_load_dwordx4 a[216:219], v3, s[24:27], s43 offen
    s_add_u32 s43, s46, 7168
    buffer_load_dwordx4 a[220:223], v3, s[24:27], s43 offen
    s_add_u32 s43, s46, 8192
    buffer_load_dwordx4 a[224:227], v3, s[24:27], s43 offen
    s_add_u32 s43, s46, 10240
    buffer_load_dwordx4 a[228:231], v3, s[24:27], s43 offen
    s_add_u32 s43, s46, 12288
    buffer_load_dwordx4 a[232:235], v3, s[24:27], s43 offen
    s_add_u32 s43, s46, 14336
    buffer_load_dwordx4 a[236:239], v3, s[24:27], s43 offen
    s_add_u32 s43, s46, 9216
    buffer_load_dwordx4 a[240:243], v3, s[24:27], s43 offen
    s_add_u32 s43, s46, 11264
    buffer_load_dwordx4 a[244:247], v3, s[24:27], s43 offen
    s_add_u32 s43, s46, 13312
    buffer_load_dwordx4 a[248:251], v3, s[24:27], s43 offen
    s_add_u32 s43, s46, 15360
    buffer_load_dwordx4 a[252:255], v3, s[24:27], s43 offen
    s_waitcnt vmcnt(8)
    v_mfma_f32_32x32x16_bf16 v[64:79], a[192:195], a[160:163], 0
    v_mfma_f32_32x32x16_bf16 v[64:79], a[196:199], a[164:167], v[64:79]
    v_mfma_f32_32x32x16_bf16 v[64:79], a[200:203], a[168:171], v[64:79]
    v_mfma_f32_32x32x16_bf16 v[64:79], a[204:207], a[172:175], v[64:79]
    v_mfma_f32_32x32x16_bf16 v[64:79], a[208:211], a[176:179], v[64:79]
    v_mfma_f32_32x32x16_bf16 v[64:79], a[212:215], a[180:183], v[64:79]
    v_mfma_f32_32x32x16_bf16 v[64:79], a[216:219], a[184:187], v[64:79]
    v_mfma_f32_32x32x16_bf16 v[64:79], a[220:223], a[188:191], v[64:79]
    v_cmp_le_i32 s[90:91], 0, v13
    v_cmp_le_i32 s[92:93], 1, v13
    v_cmp_le_i32 s[94:95], 2, v13
    v_cmp_le_i32 s[96:97], 3, v13
    s_nop 7
    v_cndmask_b32 v64, v5, v64, s[90:91]
    v_cndmask_b32 v65, v5, v65, s[92:93]
    v_cndmask_b32 v66, v5, v66, s[94:95]
    v_cndmask_b32 v67, v5, v67, s[96:97]
    v_cmp_le_i32 s[90:91], 8, v13
    v_cmp_le_i32 s[92:93], 9, v13
    v_cmp_le_i32 s[94:95], 10, v13
    v_cmp_le_i32 s[96:97], 11, v13
    v_cndmask_b32 v68, v5, v68, s[90:91]
    v_cndmask_b32 v69, v5, v69, s[92:93]
    v_cndmask_b32 v70, v5, v70, s[94:95]
    v_cndmask_b32 v71, v5, v71, s[96:97]
    v_cmp_le_i32 s[90:91], 16, v13
    v_cmp_le_i32 s[92:93], 17, v13
    v_cmp_le_i32 s[94:95], 18, v13
    v_cmp_le_i32 s[96:97], 19, v13
    v_cndmask_b32 v72, v5, v72, s[90:91]
    v_cndmask_b32 v73, v5, v73, s[92:93]
    v_cndmask_b32 v74, v5, v74, s[94:95]
    v_cndmask_b32 v75, v5, v75, s[96:97]
    v_cmp_le_i32 s[90:91], 24, v13
    v_cmp_le_i32 s[92:93], 25, v13
    v_cmp_le_i32 s[94:95], 26, v13
    v_cmp_le_i32 s[96:97], 27, v13
    v_cndmask_b32 v76, v5, v76, s[90:91]
    v_cndmask_b32 v77, v5, v77, s[92:93]
    v_cndmask_b32 v78, v5, v78, s[94:95]
    v_cndmask_b32 v79, v5, v79, s[96:97]
    v_max3_f32 v26, v64, v65, v24
    v_max3_f32 v26, v66, v67, v26
    v_max3_f32 v26, v68, v69, v26
    v_max3_f32 v26, v70, v71, v26
    v_max3_f32 v26, v72, v73, v26
    v_max3_f32 v26, v74, v75, v26
    v_max3_f32 v26, v76, v77, v26
    v_max3_f32 v26, v78, v79, v26
    v_mov_b32 v28, v26
    s_nop 1
    v_permlane32_swap_b32 v26, v28
    v_max_f32 v26, v26, v28
    v_sub_f32 v27, v24, v26
    v_exp_f32 v27, v27
    v_mov_b32 v24, v26
    v_mul_f32 v25, v25, v27
    v_sub_f32 v64, v64, v26
    v_exp_f32 v64, v64
    v_sub_f32 v65, v65, v26
    v_exp_f32 v65, v65
    v_sub_f32 v66, v66, v26
    v_exp_f32 v66, v66
    v_sub_f32 v67, v67, v26
    v_exp_f32 v67, v67
    v_sub_f32 v68, v68, v26
    v_exp_f32 v68, v68
    v_sub_f32 v69, v69, v26
    v_exp_f32 v69, v69
    v_sub_f32 v70, v70, v26
    v_exp_f32 v70, v70
    v_sub_f32 v71, v71, v26
    v_exp_f32 v71, v71
    v_sub_f32 v72, v72, v26
    v_exp_f32 v72, v72
    v_sub_f32 v73, v73, v26
    v_exp_f32 v73, v73
    v_sub_f32 v74, v74, v26
    v_exp_f32 v74, v74
    v_sub_f32 v75, v75, v26
    v_exp_f32 v75, v75
    v_sub_f32 v76, v76, v26
    v_exp_f32 v76, v76
    v_sub_f32 v77, v77, v26
    v_exp_f32 v77, v77
    v_sub_f32 v78, v78, v26
    v_exp_f32 v78, v78
    v_sub_f32 v79, v79, v26
    v_exp_f32 v79, v79
    v_add_f32 v25, v25, v64
    v_add_f32 v25, v25, v65
    v_add_f32 v25, v25, v66
    v_add_f32 v25, v25, v67
    v_add_f32 v25, v25, v68
    v_add_f32 v25, v25, v69
    v_add_f32 v25, v25, v70
    v_add_f32 v25, v25, v71
    v_add_f32 v25, v25, v72
    v_add_f32 v25, v25, v73
    v_add_f32 v25, v25, v74
    v_add_f32 v25, v25, v75
    v_add_f32 v25, v25, v76
    v_add_f32 v25, v25, v77
    v_add_f32 v25, v25, v78
    v_add_f32 v25, v25, v79
    v_cvt_pk_bf16_f32 v96, v64, v65
    v_cvt_pk_bf16_f32 v97, v66, v67
    v_cvt_pk_bf16_f32 v98, v68, v69
    v_cvt_pk_bf16_f32 v99, v70, v71
    v_cvt_pk_bf16_f32 v100, v72, v73
    v_cvt_pk_bf16_f32 v101, v74, v75
    v_cvt_pk_bf16_f32 v102, v76, v77
    v_cvt_pk_bf16_f32 v103, v78, v79
    v_accvgpr_read_b32 v28, a64
    v_mul_f32 v28, v28, v27
    v_accvgpr_write_b32 a64, v28
    v_accvgpr_read_b32 v28, a65
    v_mul_f32 v28, v28, v27
    v_accvgpr_write_b32 a65, v28
    v_accvgpr_read_b32 v28, a66
    v_mul_f32 v28, v28, v27
    v_accvgpr_write_b32 a66, v28
    v_accvgpr_read_b32 v28, a67
    v_mul_f32 v28, v28, v27
    v_accvgpr_write_b32 a67, v28
    v_accvgpr_read_b32 v28, a68
    v_mul_f32 v28, v28, v27
    v_accvgpr_write_b32 a68, v28
    v_accvgpr_read_b32 v28, a69
    v_mul_f32 v28, v28, v27
    v_accvgpr_write_b32 a69, v28
    v_accvgpr_read_b32 v28, a70
    v_mul_f32 v28, v28, v27
    v_accvgpr_write_b32 a70, v28
    v_accvgpr_read_b32 v28, a71
    v_mul_f32 v28, v28, v27
    v_accvgpr_write_b32 a71, v28
    v_accvgpr_read_b32 v28, a72
    v_mul_f32 v28, v28, v27
    v_accvgpr_write_b32 a72, v28
    v_accvgpr_read_b32 v28, a73
    v_mul_f32 v28, v28, v27
    v_accvgpr_write_b32 a73, v28
    v_accvgpr_read_b32 v28, a74
    v_mul_f32 v28, v28, v27
    v_accvgpr_write_b32 a74, v28
    v_accvgpr_read_b32 v28, a75
    v_mul_f32 v28, v28, v27
    v_accvgpr_write_b32 a75, v28
    v_accvgpr_read_b32 v28, a76
    v_mul_f32 v28, v28, v27
    v_accvgpr_write_b32 a76, v28
    v_accvgpr_read_b32 v28, a77
    v_mul_f32 v28, v28, v27
    v_accvgpr_write_b32 a77, v28
    v_accvgpr_read_b32 v28, a78
    v_mul_f32 v28, v28, v27
    v_accvgpr_write_b32 a78, v28
    v_accvgpr_read_b32 v28, a79
    v_mul_f32 v28, v28, v27
    v_accvgpr_write_b32 a79, v28
    v_accvgpr_read_b32 v28, a80
    v_mul_f32 v28, v28, v27
    v_accvgpr_write_b32 a80, v28
    v_accvgpr_read_b32 v28, a81
    v_mul_f32 v28, v28, v27
    v_accvgpr_write_b32 a81, v28
    v_accvgpr_read_b32 v28, a82
    v_mul_f32 v28, v28, v27
    v_accvgpr_write_b32 a82, v28
    v_accvgpr_read_b32 v28, a83
    v_mul_f32 v28, v28, v27
    v_accvgpr_write_b32 a83, v28
    v_accvgpr_read_b32 v28, a84
    v_mul_f32 v28, v28, v27
    v_accvgpr_write_b32 a84, v28
    v_accvgpr_read_b32 v28, a85
    v_mul_f32 v28, v28, v27
    v_accvgpr_write_b32 a85, v28
    v_accvgpr_read_b32 v28, a86
    v_mul_f32 v28, v28, v27
    v_accvgpr_write_b32 a86, v28
    v_accvgpr_read_b32 v28, a87
    v_mul_f32 v28, v28, v27
    v_accvgpr_write_b32 a87, v28
    v_accvgpr_read_b32 v28, a88
    v_mul_f32 v28, v28, v27
    v_accvgpr_write_b32 a88, v28
    v_accvgpr_read_b32 v28, a89
    v_mul_f32 v28, v28, v27
    v_accvgpr_write_b32 a89, v28
    v_accvgpr_read_b32 v28, a90
    v_mul_f32 v28, v28, v27
    v_accvgpr_write_b32 a90, v28
    v_accvgpr_read_b32 v28, a91
    v_mul_f32 v28, v28, v27
    v_accvgpr_write_b32 a91, v28
    v_accvgpr_read_b32 v28, a92
    v_mul_f32 v28, v28, v27
    v_accvgpr_write_b32 a92, v28
    v_accvgpr_read_b32 v28, a93
    v_mul_f32 v28, v28, v27
    v_accvgpr_write_b32 a93, v28
    v_accvgpr_read_b32 v28, a94
    v_mul_f32 v28, v28, v27
    v_accvgpr_write_b32 a94, v28
    v_accvgpr_read_b32 v28, a95
    v_mul_f32 v28, v28, v27
    v_accvgpr_write_b32 a95, v28
    v_accvgpr_read_b32 v28, a96
    v_mul_f32 v28, v28, v27
    v_accvgpr_write_b32 a96, v28
    v_accvgpr_read_b32 v28, a97
    v_mul_f32 v28, v28, v27
    v_accvgpr_write_b32 a97, v28
    v_accvgpr_read_b32 v28, a98
    v_mul_f32 v28, v28, v27
    v_accvgpr_write_b32 a98, v28
    v_accvgpr_read_b32 v28, a99
    v_mul_f32 v28, v28, v27
    v_accvgpr_write_b32 a99, v28
    v_accvgpr_read_b32 v28, a100
    v_mul_f32 v28, v28, v27
    v_accvgpr_write_b32 a100, v28
    v_accvgpr_read_b32 v28, a101
    v_mul_f32 v28, v28, v27
    v_accvgpr_write_b32 a101, v28
    v_accvgpr_read_b32 v28, a102
    v_mul_f32 v28, v28, v27
    v_accvgpr_write_b32 a102, v28
    v_accvgpr_read_b32 v28, a103
    v_mul_f32 v28, v28, v27
    v_accvgpr_write_b32 a103, v28
    v_accvgpr_read_b32 v28, a104
    v_mul_f32 v28, v28, v27
    v_accvgpr_write_b32 a104, v28
    v_accvgpr_read_b32 v28, a105
    v_mul_f32 v28, v28, v27
    v_accvgpr_write_b32 a105, v28
    v_accvgpr_read_b32 v28, a106
    v_mul_f32 v28, v28, v27
    v_accvgpr_write_b32 a106, v28
    v_accvgpr_read_b32 v28, a107
    v_mul_f32 v28, v28, v27
    v_accvgpr_write_b32 a107, v28
    v_accvgpr_read_b32 v28, a108
    v_mul_f32 v28, v28, v27
    v_accvgpr_write_b32 a108, v28
    v_accvgpr_read_b32 v28, a109
    v_mul_f32 v28, v28, v27
    v_accvgpr_write_b32 a109, v28
    v_accvgpr_read_b32 v28, a110
    v_mul_f32 v28, v28, v27
    v_accvgpr_write_b32 a110, v28
    v_accvgpr_read_b32 v28, a111
    v_mul_f32 v28, v28, v27
    v_accvgpr_write_b32 a111, v28
    v_accvgpr_read_b32 v28, a112
    v_mul_f32 v28, v28, v27
    v_accvgpr_write_b32 a112, v28
    v_accvgpr_read_b32 v28, a113
    v_mul_f32 v28, v28, v27
    v_accvgpr_write_b32 a113, v28
    v_accvgpr_read_b32 v28, a114
    v_mul_f32 v28, v28, v27
    v_accvgpr_write_b32 a114, v28
    v_accvgpr_read_b32 v28, a115
    v_mul_f32 v28, v28, v27
    v_accvgpr_write_b32 a115, v28
    v_accvgpr_read_b32 v28, a116
    v_mul_f32 v28, v28, v27
    v_accvgpr_write_b32 a116, v28
    v_accvgpr_read_b32 v28, a117
    v_mul_f32 v28, v28, v27
    v_accvgpr_write_b32 a117, v28
    v_accvgpr_read_b32 v28, a118
    v_mul_f32 v28, v28, v27
    v_accvgpr_write_b32 a118, v28
    v_accvgpr_read_b32 v28, a119
    v_mul_f32 v28, v28, v27
    v_accvgpr_write_b32 a119, v28
    v_accvgpr_read_b32 v28, a120
    v_mul_f32 v28, v28, v27
    v_accvgpr_write_b32 a120, v28
    v_accvgpr_read_b32 v28, a121
    v_mul_f32 v28, v28, v27
    v_accvgpr_write_b32 a121, v28
    v_accvgpr_read_b32 v28, a122
    v_mul_f32 v28, v28, v27
    v_accvgpr_write_b32 a122, v28
    v_accvgpr_read_b32 v28, a123
    v_mul_f32 v28, v28, v27
    v_accvgpr_write_b32 a123, v28
    v_accvgpr_read_b32 v28, a124
    v_mul_f32 v28, v28, v27
    v_accvgpr_write_b32 a124, v28
    v_accvgpr_read_b32 v28, a125
    v_mul_f32 v28, v28, v27
    v_accvgpr_write_b32 a125, v28
    v_accvgpr_read_b32 v28, a126
    v_mul_f32 v28, v28, v27
    v_accvgpr_write_b32 a126, v28
    v_accvgpr_read_b32 v28, a127
    v_mul_f32 v28, v28, v27
    v_accvgpr_write_b32 a127, v28
    s_waitcnt vmcnt(0)
    v_mfma_f32_32x32x16_bf16 a[64:79], a[224:227], v[96:99], a[64:79]
    v_mfma_f32_32x32x16_bf16 a[80:95], a[228:231], v[96:99], a[80:95]
    v_mfma_f32_32x32x16_bf16 a[96:111], a[232:235], v[96:99], a[96:111]
    v_mfma_f32_32x32x16_bf16 a[112:127], a[236:239], v[96:99], a[112:127]
    v_mfma_f32_32x32x16_bf16 a[64:79], a[240:243], v[100:103], a[64:79]
    v_mfma_f32_32x32x16_bf16 a[80:95], a[244:247], v[100:103], a[80:95]
    v_mfma_f32_32x32x16_bf16 a[96:111], a[248:251], v[100:103], a[96:111]
    v_mfma_f32_32x32x16_bf16 a[112:127], a[252:255], v[100:103], a[112:127]
    s_add_u32 s46, s46, 16384
    v_subrev_u32 v13, 32, v13
    s_sub_u32 s50, s50, 1
    s_cmp_lg_u32 s50, 0
    s_nop 15
    s_cbranch_scc1 Lk2_slowB
    v_mov_b32 v16, v25
    v_mov_b32 v17, 0
    v_add_f32 v24, v16, v17
    v_mov_b32 v25, v24
    s_nop 1
    v_permlane32_swap_b32 v24, v25
    v_add_f32 v24, v24, v25
    v_rcp_f32 v26, v24
    v_mov_b32 v28, 0
    v_mov_b32 v27, v26
    v_accvgpr_read_b32 v32, a64
    v_accvgpr_read_b32 v33, a65
    v_accvgpr_read_b32 v34, a66
    v_accvgpr_read_b32 v35, a67
    v_accvgpr_read_b32 v36, a68
    v_accvgpr_read_b32 v37, a69
    v_accvgpr_read_b32 v38, a70
    v_accvgpr_read_b32 v39, a71
    v_pk_mul_f32 v[32:33], v[32:33], v[26:27]
    v_pk_mul_f32 v[34:35], v[34:35], v[26:27]
    v_pk_mul_f32 v[36:37], v[36:37], v[26:27]
    v_pk_mul_f32 v[38:39], v[38:39], v[26:27]
    v_cvt_pk_bf16_f32 v40, v32, v33
    v_cvt_pk_bf16_f32 v41, v34, v35
    v_cvt_pk_bf16_f32 v42, v36, v37
    v_cvt_pk_bf16_f32 v43, v38, v39
    s_add_u32 s43, s53, 0
    buffer_store_dwordx4 v[40:43], v3, s[28:31], s43 offen sc1
    v_maximum3_f32 v28, |v32|, |v33|, v28
    v_maximum3_f32 v28, |v34|, |v35|, v28
    v_maximum3_f32 v28, |v36|, |v37|, v28
    v_maximum3_f32 v28, |v38|, |v39|, v28
    v_accvgpr_read_b32 v44, a72
    v_accvgpr_read_b32 v45, a73
    v_accvgpr_read_b32 v46, a74
    v_accvgpr_read_b32 v47, a75
    v_accvgpr_read_b32 v48, a76
    v_accvgpr_read_b32 v49, a77
    v_accvgpr_read_b32 v50, a78
    v_accvgpr_read_b32 v51, a79
    v_pk_mul_f32 v[44:45], v[44:45], v[26:27]
    v_pk_mul_f32 v[46:47], v[46:47], v[26:27]
    v_pk_mul_f32 v[48:49], v[48:49], v[26:27]
    v_pk_mul_f32 v[50:51], v[50:51], v[26:27]
    v_cvt_pk_bf16_f32 v52, v44, v45
    v_cvt_pk_bf16_f32 v53, v46, v47
    v_cvt_pk_bf16_f32 v54, v48, v49
    v_cvt_pk_bf16_f32 v55, v50, v51
    s_add_u32 s43, s53, 1024
    buffer_store_dwordx4 v[52:55], v3, s[28:31], s43 offen sc1
    v_maximum3_f32 v28, |v44|, |v45|, v28
    v_maximum3_f32 v28, |v46|, |v47|, v28
    v_maximum3_f32 v28, |v48|, |v49|, v28
    v_maximum3_f32 v28, |v50|, |v51|, v28
    v_accvgpr_read_b32 v32, a80
    v_accvgpr_read_b32 v33, a81
    v_accvgpr_read_b32 v34, a82
    v_accvgpr_read_b32 v35, a83
    v_accvgpr_read_b32 v36, a84
    v_accvgpr_read_b32 v37, a85
    v_accvgpr_read_b32 v38, a86
    v_accvgpr_read_b32 v39, a87
    v_pk_mul_f32 v[32:33], v[32:33], v[26:27]
    v_pk_mul_f32 v[34:35], v[34:35], v[26:27]
    v_pk_mul_f32 v[36:37], v[36:37], v[26:27]
    v_pk_mul_f32 v[38:39], v[38:39], v[26:27]
    v_cvt_pk_bf16_f32 v40, v32, v33
    v_cvt_pk_bf16_f32 v41, v34, v35
    v_cvt_pk_bf16_f32 v42, v36, v37
    v_cvt_pk_bf16_f32 v43, v38, v39
    s_add_u32 s43, s53, 2048
    buffer_store_dwordx4 v[40:43], v3, s[28:31], s43 offen sc1
    v_maximum3_f32 v28, |v32|, |v33|, v28
    v_maximum3_f32 v28, |v34|, |v35|, v28
    v_maximum3_f32 v28, |v36|, |v37|, v28
    v_maximum3_f32 v28, |v38|, |v39|, v28
    v_accvgpr_read_b32 v44, a88
    v_accvgpr_read_b32 v45, a89
    v_accvgpr_read_b32 v46, a90
    v_accvgpr_read_b32 v47, a91
    v_accvgpr_read_b32 v48, a92
    v_accvgpr_read_b32 v49, a93
    v_accvgpr_read_b32 v50, a94
    v_accvgpr_read_b32 v51, a95
    v_pk_mul_f32 v[44:45], v[44:45], v[26:27]
    v_pk_mul_f32 v[46:47], v[46:47], v[26:27]
    v_pk_mul_f32 v[48:49], v[48:49], v[26:27]
    v_pk_mul_f32 v[50:51], v[50:51], v[26:27]
    v_cvt_pk_bf16_f32 v52, v44, v45
    v_cvt_pk_bf16_f32 v53, v46, v47
    v_cvt_pk_bf16_f32 v54, v48, v49
    v_cvt_pk_bf16_f32 v55, v50, v51
    s_add_u32 s43, s53, 3072
    buffer_store_dwordx4 v[52:55], v3, s[28:31], s43 offen sc1
    v_maximum3_f32 v28, |v44|, |v45|, v28
    v_maximum3_f32 v28, |v46|, |v47|, v28
    v_maximum3_f32 v28, |v48|, |v49|, v28
    v_maximum3_f32 v28, |v50|, |v51|, v28
    v_accvgpr_read_b32 v32, a96
    v_accvgpr_read_b32 v33, a97
    v_accvgpr_read_b32 v34, a98
    v_accvgpr_read_b32 v35, a99
    v_accvgpr_read_b32 v36, a100
    v_accvgpr_read_b32 v37, a101
    v_accvgpr_read_b32 v38, a102
    v_accvgpr_read_b32 v39, a103
    v_pk_mul_f32 v[32:33], v[32:33], v[26:27]
    v_pk_mul_f32 v[34:35], v[34:35], v[26:27]
    v_pk_mul_f32 v[36:37], v[36:37], v[26:27]
    v_pk_mul_f32 v[38:39], v[38:39], v[26:27]
    v_cvt_pk_bf16_f32 v40, v32, v33
    v_cvt_pk_bf16_f32 v41, v34, v35
    v_cvt_pk_bf16_f32 v42, v36, v37
    v_cvt_pk_bf16_f32 v43, v38, v39
    s_add_u32 s43, s53, 4096
    buffer_store_dwordx4 v[40:43], v3, s[28:31], s43 offen sc1
    v_maximum3_f32 v28, |v32|, |v33|, v28
    v_maximum3_f32 v28, |v34|, |v35|, v28
    v_maximum3_f32 v28, |v36|, |v37|, v28
    v_maximum3_f32 v28, |v38|, |v39|, v28
    v_accvgpr_read_b32 v44, a104
    v_accvgpr_read_b32 v45, a105
    v_accvgpr_read_b32 v46, a106
    v_accvgpr_read_b32 v47, a107
    v_accvgpr_read_b32 v48, a108
    v_accvgpr_read_b32 v49, a109
    v_accvgpr_read_b32 v50, a110
    v_accvgpr_read_b32 v51, a111
    v_pk_mul_f32 v[44:45], v[44:45], v[26:27]
    v_pk_mul_f32 v[46:47], v[46:47], v[26:27]
    v_pk_mul_f32 v[48:49], v[48:49], v[26:27]
    v_pk_mul_f32 v[50:51], v[50:51], v[26:27]
    v_cvt_pk_bf16_f32 v52, v44, v45
    v_cvt_pk_bf16_f32 v53, v46, v47
    v_cvt_pk_bf16_f32 v54, v48, v49
    v_cvt_pk_bf16_f32 v55, v50, v51
    s_add_u32 s43, s53, 5120
    buffer_store_dwordx4 v[52:55], v3, s[28:31], s43 offen sc1
    v_maximum3_f32 v28, |v44|, |v45|, v28
    v_maximum3_f32 v28, |v46|, |v47|, v28
    v_maximum3_f32 v28, |v48|, |v49|, v28
    v_maximum3_f32 v28, |v50|, |v51|, v28
    v_accvgpr_read_b32 v32, a112
    v_accvgpr_read_b32 v33, a113
    v_accvgpr_read_b32 v34, a114
    v_accvgpr_read_b32 v35, a115
    v_accvgpr_read_b32 v36, a116
    v_accvgpr_read_b32 v37, a117
    v_accvgpr_read_b32 v38, a118
    v_accvgpr_read_b32 v39, a119
    v_pk_mul_f32 v[32:33], v[32:33], v[26:27]
    v_pk_mul_f32 v[34:35], v[34:35], v[26:27]
    v_pk_mul_f32 v[36:37], v[36:37], v[26:27]
    v_pk_mul_f32 v[38:39], v[38:39], v[26:27]
    v_cvt_pk_bf16_f32 v40, v32, v33
    v_cvt_pk_bf16_f32 v41, v34, v35
    v_cvt_pk_bf16_f32 v42, v36, v37
    v_cvt_pk_bf16_f32 v43, v38, v39
    s_add_u32 s43, s53, 6144
    buffer_store_dwordx4 v[40:43], v3, s[28:31], s43 offen sc1
    v_maximum3_f32 v28, |v32|, |v33|, v28
    v_maximum3_f32 v28, |v34|, |v35|, v28
    v_maximum3_f32 v28, |v36|, |v37|, v28
    v_maximum3_f32 v28, |v38|, |v39|, v28
    v_accvgpr_read_b32 v44, a120
    v_accvgpr_read_b32 v45, a121
    v_accvgpr_read_b32 v46, a122
    v_accvgpr_read_b32 v47, a123
    v_accvgpr_read_b32 v48, a124
    v_accvgpr_read_b32 v49, a125
    v_accvgpr_read_b32 v50, a126
    v_accvgpr_read_b32 v51, a127
    v_pk_mul_f32 v[44:45], v[44:45], v[26:27]
    v_pk_mul_f32 v[46:47], v[46:47], v[26:27]
    v_pk_mul_f32 v[48:49], v[48:49], v[26:27]
    v_pk_mul_f32 v[50:51], v[50:51], v[26:27]
    v_cvt_pk_bf16_f32 v52, v44, v45
    v_cvt_pk_bf16_f32 v53, v46, v47
    v_cvt_pk_bf16_f32 v54, v48, v49
    v_cvt_pk_bf16_f32 v55, v50, v51
    s_add_u32 s43, s53, 7168
    buffer_store_dwordx4 v[52:55], v3, s[28:31], s43 offen sc1
    v_maximum3_f32 v28, |v44|, |v45|, v28
    v_maximum3_f32 v28, |v46|, |v47|, v28
    v_maximum3_f32 v28, |v48|, |v49|, v28
    v_maximum3_f32 v28, |v50|, |v51|, v28
    v_mov_b32 v29, 0x5d800000
    v_cmp_nle_f32 s[90:91], v24, v29
    v_mov_b32 v29, 0x35800000
    v_cmp_nge_f32 s[92:93], v24, v29
    v_mov_b32 v29, 0x7f7f0000
    v_cmp_nle_f32 s[94:95], v28, v29
    s_nop 1
    s_or_b64 s[90:91], s[90:91], s[92:93]
    s_nop 0
    s_or_b64 s[90:91], s[90:91], s[94:95]
    s_cmp_lg_u64 s[90:91], 0
    s_cselect_b32 s43, 0, 0
    s_or_b32 s54, s54, s43
Lk2_noslowB:
    s_waitcnt vmcnt(0)
    s_barrier
    s_add_u32 s92, s14, 68288512
    s_addc_u32 s93, s15, 0
    s_mov_b32 s94, 38912
    s_mov_b32 s95, 0x20000
    v_mov_b32 v10, s100
    v_mov_b32 v11, 0x100000
    v_mov_b32 v12, 0
    v_cmp_eq_u32 vcc, 0, v0
    s_nop 1
    v_cndmask_b32 v11, v11, v12, vcc
    s_lshr_b32 s45, s41, 3
    s_and_b32 s46, s41, 7
    s_lshl_b32 s46, s46, 2
    s_lshl_b32 s43, s42, 2
    s_add_u32 s43, s43, s45
    s_add_u32 s43, s43, 160
    s_lshl_b32 s43, s43, 7
    s_add_u32 s43, s43, s46
    buffer_store_dword v10, v11, s[92:95], s43 offen sc1
    s_sub_u32 s43, 15, s42
    s_lshl_b32 s43, s43, 2
    s_add_u32 s43, s43, s45
    s_add_u32 s43, s43, 160
    s_lshl_b32 s43, s43, 7
    s_add_u32 s43, s43, s46
    buffer_store_dword v10, v11, s[92:95], s43 offen sc1
    s_load_dwordx2 s[14:15], s[0:1], 104
    s_load_dwordx2 s[6:7], s[0:1], 40
    s_load_dwordx2 s[4:5], s[0:1], 0
    s_load_dwordx2 s[8:9], s[0:1], 56
    s_load_dwordx2 s[12:13], s[0:1], 96
    v_lshrrev_b32 v1, 6, v0
    v_and_b32 v2, 63, v0
    v_readfirstlane_b32 s40, v1
    s_and_b32 s44, s2, 7
    s_lshr_b32 s41, s44, 1
    s_lshr_b32 s45, s2, 3
    s_and_b32 s43, s45, 3
    s_lshr_b32 s45, s45, 2
    s_sub_u32 s42, 15, s45
    s_and_b32 s44, s44, 1
    s_cmp_eq_u32 s44, 0
    s_cselect_b32 s42, s45, s42
    s_waitcnt lgkmcnt(0)
    s_add_u32 s16, s14, 41943040
    s_addc_u32 s17, s15, 0
    s_mov_b32 s18, 16777216
    s_mov_b32 s19, 0x20000
    s_mov_b32 s20, s6
    s_mov_b32 s21, s7
    s_mov_b32 s22, 5242880
    s_mov_b32 s23, 0x20000
    v_lshrrev_b32 v6, 5, v2
    v_lshlrev_b32 v3, 10, v6
    v_bfe_u32 v6, v2, 4, 1
    v_lshl_add_u32 v3, v6, 9, v3
    v_and_b32 v6, 15, v2
    v_lshl_add_u32 v3, v6, 4, v3
    v_lshlrev_b32 v4, 4, v2
    s_mov_b32 s44, 3277
    v_add_u32 v6, 0, v2
    v_mul_lo_u32 v7, v6, s44
    v_lshrrev_b32 v7, 16, v7
    v_mul_u32_u24 v8, 20, v7
    v_sub_u32 v8, v6, v8
    v_mul_u32_u24 v7, 1280, v7
    v_lshl_add_u32 v10, v8, 4, v7
    v_add_u32 v6, 64, v2
    v_mul_lo_u32 v7, v6, s44
    v_lshrrev_b32 v7, 16, v7
    v_mul_u32_u24 v8, 20, v7
    v_sub_u32 v8, v6, v8
    v_mul_u32_u24 v7, 1280, v7
    v_lshl_add_u32 v11, v8, 4, v7
    v_add_u32 v6, 128, v2
    v_mul_lo_u32 v7, v6, s44
    v_lshrrev_b32 v7, 16, v7
    v_mul_u32_u24 v8, 20, v7
    v_sub_u32 v8, v6, v8
    v_mul_u32_u24 v7, 1280, v7
    v_lshl_add_u32 v12, v8, 4, v7
    v_add_u32 v6, 192, v2
    v_mul_lo_u32 v7, v6, s44
    v_lshrrev_b32 v7, 16, v7
    v_mul_u32_u24 v8, 20, v7
    v_sub_u32 v8, v6, v8
    v_mul_u32_u24 v7, 1280, v7
    v_lshl_add_u32 v13, v8, 4, v7
    v_add_u32 v6, 256, v2
    v_mul_lo_u32 v7, v6, s44
    v_lshrrev_b32 v7, 16, v7
    v_mul_u32_u24 v8, 20, v7
    v_sub_u32 v8, v6, v8
    v_mul_u32_u24 v7, 1280, v7
    v_lshl_add_u32 v14, v8, 4, v7
    s_lshl_b32 s46, s42, 2
    s_add_u32 s46, s46, s40
    s_lshl_b32 s46, s46, 5
    s_lshl_b32 s44, s41, 3
    s_add_u32 s46, s46, s44
    s_lshl_b32 s46, s46, 13
    s_lshl_b32 s47, s41, 10
    s_lshl_b32 s44, s40, 5
    s_add_u32 s47, s47, s44
    s_mul_i32 s47, s47, 1280
    s_mul_i32 s44, s43, 320
    s_add_u32 s47, s47, s44
    s_mul_i32 s48, s40, 10240
    s_add_u32 m0, s48, 0
    s_add_u32 s44, s47, 0
    buffer_load_dwordx4 v10, s[20:23], s44 offen lds
    s_add_u32 m0, s48, 1024
    s_add_u32 s44, s47, 0
    buffer_load_dwordx4 v11, s[20:23], s44 offen lds
    s_add_u32 m0, s48, 2048
    s_add_u32 s44, s47, 0
    buffer_load_dwordx4 v12, s[20:23], s44 offen lds
    s_add_u32 m0, s48, 3072
    s_add_u32 s44, s47, 0
    buffer_load_dwordx4 v13, s[20:23], s44 offen lds
    s_add_u32 m0, s48, 4096
    s_add_u32 s44, s47, 0
    buffer_load_dwordx4 v14, s[20:23], s44 offen lds
    s_add_u32 m0, s48, 5120
    s_add_u32 s44, s47, 20480
    buffer_load_dwordx4 v10, s[20:23], s44 offen lds
    s_add_u32 m0, s48, 6144
    s_add_u32 s44, s47, 20480
    buffer_load_dwordx4 v11, s[20:23], s44 offen lds
    s_add_u32 m0, s48, 7168
    s_add_u32 s44, s47, 20480
    buffer_load_dwordx4 v12, s[20:23], s44 offen lds
    s_add_u32 m0, s48, 8192
    s_add_u32 s44, s47, 20480
    buffer_load_dwordx4 v13, s[20:23], s44 offen lds
    s_add_u32 m0, s48, 9216
    s_add_u32 s44, s47, 20480
    buffer_load_dwordx4 v14, s[20:23], s44 offen lds
    s_add_u32 m0, s48, 40960
    s_add_u32 s44, s47, 163840
    buffer_load_dwordx4 v10, s[20:23], s44 offen lds
    s_add_u32 m0, s48, 41984
    s_add_u32 s44, s47, 163840
    buffer_load_dwordx4 v11, s[20:23], s44 offen lds
    s_add_u32 m0, s48, 43008
    s_add_u32 s44, s47, 163840
    buffer_load_dwordx4 v12, s[20:23], s44 offen lds
    s_add_u32 m0, s48, 44032
    s_add_u32 s44, s47, 163840
    buffer_load_dwordx4 v13, s[20:23], s44 offen lds
    s_add_u32 m0, s48, 45056
    s_add_u32 s44, s47, 163840
    buffer_load_dwordx4 v14, s[20:23], s44 offen lds
    s_add_u32 m0, s48, 46080
    s_add_u32 s44, s47, 184320
    buffer_load_dwordx4 v10, s[20:23], s44 offen lds
    s_add_u32 m0, s48, 47104
    s_add_u32 s44, s47, 184320
    buffer_load_dwordx4 v11, s[20:23], s44 offen lds
    s_add_u32 m0, s48, 48128
    s_add_u32 s44, s47, 184320
    buffer_load_dwordx4 v12, s[20:23], s44 offen lds
    s_add_u32 m0, s48, 49152
    s_add_u32 s44, s47, 184320
    buffer_load_dwordx4 v13, s[20:23], s44 offen lds
    s_add_u32 m0, s48, 50176
    s_add_u32 s44, s47, 184320
    buffer_load_dwordx4 v14, s[20:23], s44 offen lds
    v_lshrrev_b32 v6, 5, v2
    v_lshlrev_b32 v6, 4, v6
    v_bfe_u32 v7, v2, 4, 1
    v_lshl_add_u32 v6, v7, 2, v6
    v_bfe_u32 v7, v2, 2, 2
    v_add_u32 v6, v6, v7
    v_mul_u32_u24 v16, 320, v6
    v_and_b32 v7, 3, v2
    v_lshl_add_u32 v16, v7, 4, v16
    v_add_u32 v17, 0x10000, v16
    s_add_u32 s24, s14, 79691776
    s_addc_u32 s25, s15, 0
    s_mov_b32 s26, 10485760
    s_mov_b32 s27, 0x20000
    s_mov_b32 s84, s12
    s_mov_b32 s85, s13
    s_mov_b32 s86, 256
    s_mov_b32 s87, 0x20000
    v_mov_b32 v18, 0
    v_mov_b32 v7, 0x100000
    v_cmp_eq_u32 vcc, 0, v0
    s_nop 1
    v_cndmask_b32 v19, v7, v18, vcc
    s_mov_b32 s50, s100
    v_mov_b32 v20, s50
    s_add_u32 s56, s14, 68288512
    s_addc_u32 s57, s15, 0
    s_mov_b32 s58, 38912
    s_mov_b32 s59, 0x20000
    s_lshl_b32 s44, s42, 2
    s_add_u32 s44, s44, s41
    s_add_u32 s44, s44, 160
    s_lshl_b32 s44, s44, 7
    v_lshlrev_b32 v6, 2, v2
    v_mov_b32 v7, 0x100000
    v_cmp_gt_u32 vcc, 8, v0
    s_nop 1
    v_cndmask_b32 v6, v7, v6, vcc
    s_cmp_lg_u32 s40, 0
    s_cbranch_scc1 Lk3_cok
    s_mov_b32 s45, 2097152
Lk3_cspin:
    buffer_load_dword v8, v6, s[56:59], s44 offen sc1
    s_waitcnt vmcnt(0)
    v_cmp_eq_u32 vcc, v20, v8
    s_and_b32 s51, vcc_lo, 0xff
    s_sub_u32 s45, s45, 1
    s_cbranch_scc1 Lk3_cok
    s_cmp_eq_u32 s51, 0xff
    s_cbranch_scc0 Lk3_cspin
Lk3_cok:
    s_waitcnt vmcnt(10)
    s_barrier
    s_add_u32 s45, s46, 0
    buffer_load_dwordx4 a[0:3], v3, s[16:19], s45 offen
    buffer_load_dwordx4 a[4:7], v3, s[16:19], s45 offen offset:256
    s_add_u32 s45, s46, 2048
    buffer_load_dwordx4 a[8:11], v3, s[16:19], s45 offen
    buffer_load_dwordx4 a[12:15], v3, s[16:19], s45 offen offset:256
    s_add_u32 s45, s46, 4096
    buffer_load_dwordx4 a[16:19], v3, s[16:19], s45 offen
    buffer_load_dwordx4 a[20:23], v3, s[16:19], s45 offen offset:256
    s_add_u32 s45, s46, 6144
    buffer_load_dwordx4 a[24:27], v3, s[16:19], s45 offen
    buffer_load_dwordx4 a[28:31], v3, s[16:19], s45 offen offset:256
    s_add_u32 s45, s46, 8192
    buffer_load_dwordx4 a[32:35], v3, s[16:19], s45 offen
    buffer_load_dwordx4 a[36:39], v3, s[16:19], s45 offen offset:256
    s_add_u32 s45, s46, 10240
    buffer_load_dwordx4 a[40:43], v3, s[16:19], s45 offen
    buffer_load_dwordx4 a[44:47], v3, s[16:19], s45 offen offset:256
    ds_read_b64_tr_b16 v[104:105], v16 offset:0
    ds_read_b64_tr_b16 v[106:107], v16 offset:2560
    ds_read_b64_tr_b16 v[108:109], v16 offset:8
    ds_read_b64_tr_b16 v[110:111], v16 offset:2568
    ds_read_b64_tr_b16 v[112:113], v16 offset:64
    ds_read_b64_tr_b16 v[114:115], v16 offset:2624
    ds_read_b64_tr_b16 v[116:117], v16 offset:72
    ds_read_b64_tr_b16 v[118:119], v16 offset:2632
    ds_read_b64_tr_b16 v[120:121], v16 offset:128
    ds_read_b64_tr_b16 v[122:123], v16 offset:2688
    ds_read_b64_tr_b16 v[124:125], v16 offset:136
    ds_read_b64_tr_b16 v[126:127], v16 offset:2696
    ds_read_b64_tr_b16 v[128:129], v16 offset:192
    ds_read_b64_tr_b16 v[130:131], v16 offset:2752
    ds_read_b64_tr_b16 v[132:133], v16 offset:200
    ds_read_b64_tr_b16 v[134:135], v16 offset:2760
    ds_read_b64_tr_b16 v[136:137], v16 offset:256
    ds_read_b64_tr_b16 v[138:139], v16 offset:2816
    ds_read_b64_tr_b16 v[140:141], v16 offset:264
    ds_read_b64_tr_b16 v[142:143], v16 offset:2824
    s_waitcnt vmcnt(10)
    s_waitcnt lgkmcnt(15)
    v_mfma_f32_16x16x32_bf16 v[24:27], v[104:107], a[0:3], 0
    ds_read_b64_tr_b16 v[144:145], v16 offset:10240
    v_mfma_f32_16x16x32_bf16 v[28:31], v[108:111], a[0:3], 0
    ds_read_b64_tr_b16 v[146:147], v16 offset:12800
    s_add_u32 s45, s46, 12288
    buffer_load_dwordx4 a[48:51], v3, s[16:19], s45 offen
    buffer_load_dwordx4 a[52:55], v3, s[16:19], s45 offen offset:256
    s_waitcnt lgkmcnt(15)
    v_mfma_f32_16x16x32_bf16 v[32:35], v[112:115], a[0:3], 0
    ds_read_b64_tr_b16 v[148:149], v16 offset:10248
    s_waitcnt lgkmcnt(15)
    v_mfma_f32_16x16x32_bf16 v[36:39], v[116:119], a[0:3], 0
    ds_read_b64_tr_b16 v[150:151], v16 offset:12808
    s_waitcnt lgkmcnt(4)
    v_mfma_f32_16x16x32_bf16 v[40:43], v[120:123], a[0:3], 0
    ds_read_b64_tr_b16 v[152:153], v16 offset:10304
    v_mfma_f32_16x16x32_bf16 v[44:47], v[124:127], a[0:3], 0
    ds_read_b64_tr_b16 v[154:155], v16 offset:12864
    s_add_u32 m0, s48, 81920
    s_add_u32 s44, s47, 327680
    buffer_load_dwordx4 v10, s[20:23], s44 offen lds
    v_mfma_f32_16x16x32_bf16 v[48:51], v[128:131], a[0:3], 0
    ds_read_b64_tr_b16 v[156:157], v16 offset:10312
    v_mfma_f32_16x16x32_bf16 v[52:55], v[132:135], a[0:3], 0
    ds_read_b64_tr_b16 v[158:159], v16 offset:12872
    v_mfma_f32_16x16x32_bf16 v[56:59], v[136:139], a[0:3], 0
    ds_read_b64_tr_b16 v[160:161], v16 offset:10368
    v_mfma_f32_16x16x32_bf16 v[60:63], v[140:143], a[0:3], 0
    ds_read_b64_tr_b16 v[162:163], v16 offset:12928
    s_add_u32 m0, s48, 82944
    s_add_u32 s44, s47, 327680
    buffer_load_dwordx4 v11, s[20:23], s44 offen lds
    v_mfma_f32_16x16x32_bf16 v[64:67], v[104:107], a[4:7], 0
    ds_read_b64_tr_b16 v[164:165], v16 offset:10376
    v_mfma_f32_16x16x32_bf16 v[68:71], v[108:111], a[4:7], 0
    ds_read_b64_tr_b16 v[166:167], v16 offset:12936
    v_mfma_f32_16x16x32_bf16 v[72:75], v[112:115], a[4:7], 0
    ds_read_b64_tr_b16 v[168:169], v16 offset:10432
    v_mfma_f32_16x16x32_bf16 v[76:79], v[116:119], a[4:7], 0
    ds_read_b64_tr_b16 v[170:171], v16 offset:12992
    s_add_u32 m0, s48, 83968
    s_add_u32 s44, s47, 327680
    buffer_load_dwordx4 v12, s[20:23], s44 offen lds
    v_mfma_f32_16x16x32_bf16 v[80:83], v[120:123], a[4:7], 0
    ds_read_b64_tr_b16 v[172:173], v16 offset:10440
    v_mfma_f32_16x16x32_bf16 v[84:87], v[124:127], a[4:7], 0
    ds_read_b64_tr_b16 v[174:175], v16 offset:13000
    v_mfma_f32_16x16x32_bf16 v[88:91], v[128:131], a[4:7], 0
    ds_read_b64_tr_b16 v[176:177], v16 offset:10496
    v_mfma_f32_16x16x32_bf16 v[92:95], v[132:135], a[4:7], 0
    ds_read_b64_tr_b16 v[178:179], v16 offset:13056
    s_add_u32 m0, s48, 84992
    s_add_u32 s44, s47, 327680
    buffer_load_dwordx4 v13, s[20:23], s44 offen lds
    v_mfma_f32_16x16x32_bf16 v[96:99], v[136:139], a[4:7], 0
    ds_read_b64_tr_b16 v[180:181], v16 offset:10504
    v_mfma_f32_16x16x32_bf16 v[100:103], v[140:143], a[4:7], 0
    ds_read_b64_tr_b16 v[182:183], v16 offset:13064
    s_waitcnt vmcnt(14)
    s_waitcnt lgkmcnt(4)
    v_mfma_f32_16x16x32_bf16 v[24:27], v[144:147], a[8:11], v[24:27]
    ds_read_b64_tr_b16 v[104:105], v16 offset:20480
    v_mfma_f32_16x16x32_bf16 v[28:31], v[148:151], a[8:11], v[28:31]
    ds_read_b64_tr_b16 v[106:107], v16 offset:23040
    s_add_u32 s45, s46, 14336
    buffer_load_dwordx4 a[0:3], v3, s[16:19], s45 offen
    buffer_load_dwordx4 a[4:7], v3, s[16:19], s45 offen offset:256
    v_mfma_f32_16x16x32_bf16 v[32:35], v[152:155], a[8:11], v[32:35]
    ds_read_b64_tr_b16 v[108:109], v16 offset:20488
    v_mfma_f32_16x16x32_bf16 v[36:39], v[156:159], a[8:11], v[36:39]
    ds_read_b64_tr_b16 v[110:111], v16 offset:23048
    v_mfma_f32_16x16x32_bf16 v[40:43], v[160:163], a[8:11], v[40:43]
    ds_read_b64_tr_b16 v[112:113], v16 offset:20544
    v_mfma_f32_16x16x32_bf16 v[44:47], v[164:167], a[8:11], v[44:47]
    ds_read_b64_tr_b16 v[114:115], v16 offset:23104
    s_add_u32 m0, s48, 86016
    s_add_u32 s44, s47, 327680
    buffer_load_dwordx4 v14, s[20:23], s44 offen lds
    v_mfma_f32_16x16x32_bf16 v[48:51], v[168:171], a[8:11], v[48:51]
    ds_read_b64_tr_b16 v[116:117], v16 offset:20552
    v_mfma_f32_16x16x32_bf16 v[52:55], v[172:175], a[8:11], v[52:55]
    ds_read_b64_tr_b16 v[118:119], v16 offset:23112
    s_waitcnt lgkmcnt(4)
    v_mfma_f32_16x16x32_bf16 v[56:59], v[176:179], a[8:11], v[56:59]
    ds_read_b64_tr_b16 v[120:121], v16 offset:20608
    v_mfma_f32_16x16x32_bf16 v[60:63], v[180:183], a[8:11], v[60:63]
    ds_read_b64_tr_b16 v[122:123], v16 offset:23168
    s_add_u32 m0, s48, 87040
    s_add_u32 s44, s47, 348160
    buffer_load_dwordx4 v10, s[20:23], s44 offen lds
    v_mfma_f32_16x16x32_bf16 v[64:67], v[144:147], a[12:15], v[64:67]
    ds_read_b64_tr_b16 v[124:125], v16 offset:20616
    v_mfma_f32_16x16x32_bf16 v[68:71], v[148:151], a[12:15], v[68:71]
    ds_read_b64_tr_b16 v[126:127], v16 offset:23176
    v_mfma_f32_16x16x32_bf16 v[72:75], v[152:155], a[12:15], v[72:75]
    ds_read_b64_tr_b16 v[128:129], v16 offset:20672
    v_mfma_f32_16x16x32_bf16 v[76:79], v[156:159], a[12:15], v[76:79]
    ds_read_b64_tr_b16 v[130:131], v16 offset:23232
    s_add_u32 m0, s48, 88064
    s_add_u32 s44, s47, 348160
    buffer_load_dwordx4 v11, s[20:23], s44 offen lds
    v_mfma_f32_16x16x32_bf16 v[80:83], v[160:163], a[12:15], v[80:83]
    ds_read_b64_tr_b16 v[132:133], v16 offset:20680
    v_mfma_f32_16x16x32_bf16 v[84:87], v[164:167], a[12:15], v[84:87]
    ds_read_b64_tr_b16 v[134:135], v16 offset:23240
    v_mfma_f32_16x16x32_bf16 v[88:91], v[168:171], a[12:15], v[88:91]
    ds_read_b64_tr_b16 v[136:137], v16 offset:20736
    v_mfma_f32_16x16x32_bf16 v[92:95], v[172:175], a[12:15], v[92:95]
    ds_read_b64_tr_b16 v[138:139], v16 offset:23296
    s_add_u32 m0, s48, 89088
    s_add_u32 s44, s47, 348160
    buffer_load_dwordx4 v12, s[20:23], s44 offen lds
    v_mfma_f32_16x16x32_bf16 v[96:99], v[176:179], a[12:15], v[96:99]
    ds_read_b64_tr_b16 v[140:141], v16 offset:20744
    v_mfma_f32_16x16x32_bf16 v[100:103], v[180:183], a[12:15], v[100:103]
    ds_read_b64_tr_b16 v[142:143], v16 offset:23304
    s_waitcnt vmcnt(18)
    v_mfma_f32_16x16x32_bf16 v[24:27], v[104:107], a[16:19], v[24:27]
    ds_read_b64_tr_b16 v[144:145], v16 offset:30720
    v_mfma_f32_16x16x32_bf16 v[28:31], v[108:111], a[16:19], v[28:31]
    ds_read_b64_tr_b16 v[146:147], v16 offset:33280
    s_add_u32 s45, s46, 16384
    buffer_load_dwordx4 a[8:11], v3, s[16:19], s45 offen
    buffer_load_dwordx4 a[12:15], v3, s[16:19], s45 offen offset:256
    s_waitcnt lgkmcnt(4)
    v_mfma_f32_16x16x32_bf16 v[32:35], v[112:115], a[16:19], v[32:35]
    ds_read_b64_tr_b16 v[148:149], v16 offset:30728
    v_mfma_f32_16x16x32_bf16 v[36:39], v[116:119], a[16:19], v[36:39]
    ds_read_b64_tr_b16 v[150:151], v16 offset:33288
    v_mfma_f32_16x16x32_bf16 v[40:43], v[120:123], a[16:19], v[40:43]
    ds_read_b64_tr_b16 v[152:153], v16 offset:30784
    v_mfma_f32_16x16x32_bf16 v[44:47], v[124:127], a[16:19], v[44:47]
    ds_read_b64_tr_b16 v[154:155], v16 offset:33344
    s_add_u32 m0, s48, 90112
    s_add_u32 s44, s47, 348160
    buffer_load_dwordx4 v13, s[20:23], s44 offen lds
    v_mfma_f32_16x16x32_bf16 v[48:51], v[128:131], a[16:19], v[48:51]
    ds_read_b64_tr_b16 v[156:157], v16 offset:30792
    v_mfma_f32_16x16x32_bf16 v[52:55], v[132:135], a[16:19], v[52:55]
    ds_read_b64_tr_b16 v[158:159], v16 offset:33352
    v_mfma_f32_16x16x32_bf16 v[56:59], v[136:139], a[16:19], v[56:59]
    ds_read_b64_tr_b16 v[160:161], v16 offset:30848
    s_waitcnt lgkmcnt(4)
    v_mfma_f32_16x16x32_bf16 v[60:63], v[140:143], a[16:19], v[60:63]
    ds_read_b64_tr_b16 v[162:163], v16 offset:33408
    s_add_u32 m0, s48, 91136
    s_add_u32 s44, s47, 348160
    buffer_load_dwordx4 v14, s[20:23], s44 offen lds
    v_mfma_f32_16x16x32_bf16 v[64:67], v[104:107], a[20:23], v[64:67]
    ds_read_b64_tr_b16 v[164:165], v16 offset:30856
    v_mfma_f32_16x16x32_bf16 v[68:71], v[108:111], a[20:23], v[68:71]
    ds_read_b64_tr_b16 v[166:167], v16 offset:33416
    v_mfma_f32_16x16x32_bf16 v[72:75], v[112:115], a[20:23], v[72:75]
    ds_read_b64_tr_b16 v[168:169], v16 offset:30912
    v_mfma_f32_16x16x32_bf16 v[76:79], v[116:119], a[20:23], v[76:79]
    ds_read_b64_tr_b16 v[170:171], v16 offset:33472
    v_mfma_f32_16x16x32_bf16 v[80:83], v[120:123], a[20:23], v[80:83]
    ds_read_b64_tr_b16 v[172:173], v16 offset:30920
    v_mfma_f32_16x16x32_bf16 v[84:87], v[124:127], a[20:23], v[84:87]
    ds_read_b64_tr_b16 v[174:175], v16 offset:33480
    v_mfma_f32_16x16x32_bf16 v[88:91], v[128:131], a[20:23], v[88:91]
    ds_read_b64_tr_b16 v[176:177], v16 offset:30976
    v_mfma_f32_16x16x32_bf16 v[92:95], v[132:135], a[20:23], v[92:95]
    ds_read_b64_tr_b16 v[178:179], v16 offset:33536
    v_mfma_f32_16x16x32_bf16 v[96:99], v[136:139], a[20:23], v[96:99]
    ds_read_b64_tr_b16 v[180:181], v16 offset:30984
    v_mfma_f32_16x16x32_bf16 v[100:103], v[140:143], a[20:23], v[100:103]
    ds_read_b64_tr_b16 v[182:183], v16 offset:33544
    s_waitcnt lgkmcnt(0)
    s_waitcnt vmcnt(28)
    s_barrier
    s_waitcnt vmcnt(20)
    v_mfma_f32_16x16x32_bf16 v[24:27], v[144:147], a[24:27], v[24:27]
    ds_read_b64_tr_b16 v[104:105], v16 offset:40960
    v_mfma_f32_16x16x32_bf16 v[28:31], v[148:151], a[24:27], v[28:31]
    ds_read_b64_tr_b16 v[106:107], v16 offset:43520
    s_add_u32 s45, s46, 18432
    buffer_load_dwordx4 a[16:19], v3, s[16:19], s45 offen
    buffer_load_dwordx4 a[20:23], v3, s[16:19], s45 offen offset:256
    v_mfma_f32_16x16x32_bf16 v[32:35], v[152:155], a[24:27], v[32:35]
    ds_read_b64_tr_b16 v[108:109], v16 offset:40968
    v_mfma_f32_16x16x32_bf16 v[36:39], v[156:159], a[24:27], v[36:39]
    ds_read_b64_tr_b16 v[110:111], v16 offset:43528
    v_mfma_f32_16x16x32_bf16 v[40:43], v[160:163], a[24:27], v[40:43]
    ds_read_b64_tr_b16 v[112:113], v16 offset:41024
    v_mfma_f32_16x16x32_bf16 v[44:47], v[164:167], a[24:27], v[44:47]
    ds_read_b64_tr_b16 v[114:115], v16 offset:43584
    s_add_u32 m0, s48, 0
    s_add_u32 s44, s47, 491520
    buffer_load_dwordx4 v10, s[20:23], s44 offen lds
    v_mfma_f32_16x16x32_bf16 v[48:51], v[168:171], a[24:27], v[48:51]
    ds_read_b64_tr_b16 v[116:117], v16 offset:41032
    v_mfma_f32_16x16x32_bf16 v[52:55], v[172:175], a[24:27], v[52:55]
    ds_read_b64_tr_b16 v[118:119], v16 offset:43592
    v_mfma_f32_16x16x32_bf16 v[56:59], v[176:179], a[24:27], v[56:59]
    ds_read_b64_tr_b16 v[120:121], v16 offset:41088
    v_mfma_f32_16x16x32_bf16 v[60:63], v[180:183], a[24:27], v[60:63]
    ds_read_b64_tr_b16 v[122:123], v16 offset:43648
    s_add_u32 m0, s48, 1024
    s_add_u32 s44, s47, 491520
    buffer_load_dwordx4 v11, s[20:23], s44 offen lds
    v_mfma_f32_16x16x32_bf16 v[64:67], v[144:147], a[28:31], v[64:67]
    ds_read_b64_tr_b16 v[124:125], v16 offset:41096
    v_mfma_f32_16x16x32_bf16 v[68:71], v[148:151], a[28:31], v[68:71]
    ds_read_b64_tr_b16 v[126:127], v16 offset:43656
    v_mfma_f32_16x16x32_bf16 v[72:75], v[152:155], a[28:31], v[72:75]
    ds_read_b64_tr_b16 v[128:129], v16 offset:41152
    v_mfma_f32_16x16x32_bf16 v[76:79], v[156:159], a[28:31], v[76:79]
    ds_read_b64_tr_b16 v[130:131], v16 offset:43712
    s_add_u32 m0, s48, 2048
    s_add_u32 s44, s47, 491520
    buffer_load_dwordx4 v12, s[20:23], s44 offen lds
    v_mfma_f32_16x16x32_bf16 v[80:83], v[160:163], a[28:31], v[80:83]
    ds_read_b64_tr_b16 v[132:133], v16 offset:41160
    v_mfma_f32_16x16x32_bf16 v[84:87], v[164:167], a[28:31], v[84:87]
    ds_read_b64_tr_b16 v[134:135], v16 offset:43720
    v_mfma_f32_16x16x32_bf16 v[88:91], v[168:171], a[28:31], v[88:91]
    ds_read_b64_tr_b16 v[136:137], v16 offset:41216
    v_mfma_f32_16x16x32_bf16 v[92:95], v[172:175], a[28:31], v[92:95]
    ds_read_b64_tr_b16 v[138:139], v16 offset:43776
    s_add_u32 m0, s48, 3072
    s_add_u32 s44, s47, 491520
    buffer_load_dwordx4 v13, s[20:23], s44 offen lds
    v_mfma_f32_16x16x32_bf16 v[96:99], v[176:179], a[28:31], v[96:99]
    ds_read_b64_tr_b16 v[140:141], v16 offset:41224
    v_mfma_f32_16x16x32_bf16 v[100:103], v[180:183], a[28:31], v[100:103]
    ds_read_b64_tr_b16 v[142:143], v16 offset:43784
    s_waitcnt vmcnt(24)
    s_waitcnt lgkmcnt(4)
    v_mfma_f32_16x16x32_bf16 v[24:27], v[104:107], a[32:35], v[24:27]
    ds_read_b64_tr_b16 v[144:145], v16 offset:51200
    v_mfma_f32_16x16x32_bf16 v[28:31], v[108:111], a[32:35], v[28:31]
    ds_read_b64_tr_b16 v[146:147], v16 offset:53760
    s_add_u32 s45, s46, 20480
    buffer_load_dwordx4 a[24:27], v3, s[16:19], s45 offen
    buffer_load_dwordx4 a[28:31], v3, s[16:19], s45 offen offset:256
    v_mfma_f32_16x16x32_bf16 v[32:35], v[112:115], a[32:35], v[32:35]
    ds_read_b64_tr_b16 v[148:149], v16 offset:51208
    v_mfma_f32_16x16x32_bf16 v[36:39], v[116:119], a[32:35], v[36:39]
    ds_read_b64_tr_b16 v[150:151], v16 offset:53768
    v_mfma_f32_16x16x32_bf16 v[40:43], v[120:123], a[32:35], v[40:43]
    ds_read_b64_tr_b16 v[152:153], v16 offset:51264
    v_mfma_f32_16x16x32_bf16 v[44:47], v[124:127], a[32:35], v[44:47]
    ds_read_b64_tr_b16 v[154:155], v16 offset:53824
    s_add_u32 m0, s48, 4096
    s_add_u32 s44, s47, 491520
    buffer_load_dwordx4 v14, s[20:23], s44 offen lds
    v_mfma_f32_16x16x32_bf16 v[48:51], v[128:131], a[32:35], v[48:51]
    ds_read_b64_tr_b16 v[156:157], v16 offset:51272
    v_mfma_f32_16x16x32_bf16 v[52:55], v[132:135], a[32:35], v[52:55]
    ds_read_b64_tr_b16 v[158:159], v16 offset:53832
    s_waitcnt lgkmcnt(4)
    v_mfma_f32_16x16x32_bf16 v[56:59], v[136:139], a[32:35], v[56:59]
    ds_read_b64_tr_b16 v[160:161], v16 offset:51328
    v_mfma_f32_16x16x32_bf16 v[60:63], v[140:143], a[32:35], v[60:63]
    ds_read_b64_tr_b16 v[162:163], v16 offset:53888
    s_add_u32 m0, s48, 5120
    s_add_u32 s44, s47, 512000
    buffer_load_dwordx4 v10, s[20:23], s44 offen lds
    v_mfma_f32_16x16x32_bf16 v[64:67], v[104:107], a[36:39], v[64:67]
    ds_read_b64_tr_b16 v[164:165], v16 offset:51336
    v_mfma_f32_16x16x32_bf16 v[68:71], v[108:111], a[36:39], v[68:71]
    ds_read_b64_tr_b16 v[166:167], v16 offset:53896
    v_mfma_f32_16x16x32_bf16 v[72:75], v[112:115], a[36:39], v[72:75]
    ds_read_b64_tr_b16 v[168:169], v16 offset:51392
    v_mfma_f32_16x16x32_bf16 v[76:79], v[116:119], a[36:39], v[76:79]
    ds_read_b64_tr_b16 v[170:171], v16 offset:53952
    s_add_u32 m0, s48, 6144
    s_add_u32 s44, s47, 512000
    buffer_load_dwordx4 v11, s[20:23], s44 offen lds
    v_mfma_f32_16x16x32_bf16 v[80:83], v[120:123], a[36:39], v[80:83]
    ds_read_b64_tr_b16 v[172:173], v16 offset:51400
    v_mfma_f32_16x16x32_bf16 v[84:87], v[124:127], a[36:39], v[84:87]
    ds_read_b64_tr_b16 v[174:175], v16 offset:53960
    v_mfma_f32_16x16x32_bf16 v[88:91], v[128:131], a[36:39], v[88:91]
    ds_read_b64_tr_b16 v[176:177], v16 offset:51456
    v_mfma_f32_16x16x32_bf16 v[92:95], v[132:135], a[36:39], v[92:95]
    ds_read_b64_tr_b16 v[178:179], v16 offset:54016
    s_add_u32 m0, s48, 7168
    s_add_u32 s44, s47, 512000
    buffer_load_dwordx4 v12, s[20:23], s44 offen lds
    v_mfma_f32_16x16x32_bf16 v[96:99], v[136:139], a[36:39], v[96:99]
    ds_read_b64_tr_b16 v[180:181], v16 offset:51464
    v_mfma_f32_16x16x32_bf16 v[100:103], v[140:143], a[36:39], v[100:103]
    ds_read_b64_tr_b16 v[182:183], v16 offset:54024
    s_waitcnt vmcnt(28)
    v_mfma_f32_16x16x32_bf16 v[24:27], v[144:147], a[40:43], v[24:27]
    ds_read_b64_tr_b16 v[104:105], v16 offset:61440
    v_mfma_f32_16x16x32_bf16 v[28:31], v[148:151], a[40:43], v[28:31]
    ds_read_b64_tr_b16 v[106:107], v16 offset:64000
    s_add_u32 s45, s46, 22528
    buffer_load_dwordx4 a[32:35], v3, s[16:19], s45 offen
    buffer_load_dwordx4 a[36:39], v3, s[16:19], s45 offen offset:256
    s_waitcnt lgkmcnt(4)
    v_mfma_f32_16x16x32_bf16 v[32:35], v[152:155], a[40:43], v[32:35]
    ds_read_b64_tr_b16 v[108:109], v16 offset:61448
    v_mfma_f32_16x16x32_bf16 v[36:39], v[156:159], a[40:43], v[36:39]
    ds_read_b64_tr_b16 v[110:111], v16 offset:64008
    v_mfma_f32_16x16x32_bf16 v[40:43], v[160:163], a[40:43], v[40:43]
    ds_read_b64_tr_b16 v[112:113], v16 offset:61504
    v_mfma_f32_16x16x32_bf16 v[44:47], v[164:167], a[40:43], v[44:47]
    ds_read_b64_tr_b16 v[114:115], v16 offset:64064
    s_add_u32 m0, s48, 8192
    s_add_u32 s44, s47, 512000
    buffer_load_dwordx4 v13, s[20:23], s44 offen lds
    v_mfma_f32_16x16x32_bf16 v[48:51], v[168:171], a[40:43], v[48:51]
    ds_read_b64_tr_b16 v[116:117], v16 offset:61512
    v_mfma_f32_16x16x32_bf16 v[52:55], v[172:175], a[40:43], v[52:55]
    ds_read_b64_tr_b16 v[118:119], v16 offset:64072
    v_mfma_f32_16x16x32_bf16 v[56:59], v[176:179], a[40:43], v[56:59]
    ds_read_b64_tr_b16 v[120:121], v16 offset:61568
    s_waitcnt lgkmcnt(4)
    v_mfma_f32_16x16x32_bf16 v[60:63], v[180:183], a[40:43], v[60:63]
    ds_read_b64_tr_b16 v[122:123], v16 offset:64128
    s_add_u32 m0, s48, 9216
    s_add_u32 s44, s47, 512000
    buffer_load_dwordx4 v14, s[20:23], s44 offen lds
    v_mfma_f32_16x16x32_bf16 v[64:67], v[144:147], a[44:47], v[64:67]
    ds_read_b64_tr_b16 v[124:125], v16 offset:61576
    v_mfma_f32_16x16x32_bf16 v[68:71], v[148:151], a[44:47], v[68:71]
    ds_read_b64_tr_b16 v[126:127], v16 offset:64136
    v_mfma_f32_16x16x32_bf16 v[72:75], v[152:155], a[44:47], v[72:75]
    ds_read_b64_tr_b16 v[128:129], v16 offset:61632
    v_mfma_f32_16x16x32_bf16 v[76:79], v[156:159], a[44:47], v[76:79]
    ds_read_b64_tr_b16 v[130:131], v16 offset:64192
    v_mfma_f32_16x16x32_bf16 v[80:83], v[160:163], a[44:47], v[80:83]
    ds_read_b64_tr_b16 v[132:133], v16 offset:61640
    v_mfma_f32_16x16x32_bf16 v[84:87], v[164:167], a[44:47], v[84:87]
    ds_read_b64_tr_b16 v[134:135], v16 offset:64200
    v_mfma_f32_16x16x32_bf16 v[88:91], v[168:171], a[44:47], v[88:91]
    ds_read_b64_tr_b16 v[136:137], v16 offset:61696
    v_mfma_f32_16x16x32_bf16 v[92:95], v[172:175], a[44:47], v[92:95]
    ds_read_b64_tr_b16 v[138:139], v16 offset:64256
    v_mfma_f32_16x16x32_bf16 v[96:99], v[176:179], a[44:47], v[96:99]
    ds_read_b64_tr_b16 v[140:141], v16 offset:61704
    v_mfma_f32_16x16x32_bf16 v[100:103], v[180:183], a[44:47], v[100:103]
    ds_read_b64_tr_b16 v[142:143], v16 offset:64264
    s_waitcnt vmcnt(30)
    v_mfma_f32_16x16x32_bf16 v[24:27], v[104:107], a[48:51], v[24:27]
    ds_read_b64_tr_b16 v[144:145], v17 offset:6144
    v_mfma_f32_16x16x32_bf16 v[28:31], v[108:111], a[48:51], v[28:31]
    ds_read_b64_tr_b16 v[146:147], v17 offset:8704
    s_add_u32 s45, s46, 24576
    buffer_load_dwordx4 a[40:43], v3, s[16:19], s45 offen
    buffer_load_dwordx4 a[44:47], v3, s[16:19], s45 offen offset:256
    s_waitcnt lgkmcnt(4)
    v_mfma_f32_16x16x32_bf16 v[32:35], v[112:115], a[48:51], v[32:35]
    ds_read_b64_tr_b16 v[148:149], v17 offset:6152
    v_mfma_f32_16x16x32_bf16 v[36:39], v[116:119], a[48:51], v[36:39]
    ds_read_b64_tr_b16 v[150:151], v17 offset:8712
    v_mfma_f32_16x16x32_bf16 v[40:43], v[120:123], a[48:51], v[40:43]
    ds_read_b64_tr_b16 v[152:153], v17 offset:6208
    v_mfma_f32_16x16x32_bf16 v[44:47], v[124:127], a[48:51], v[44:47]
    ds_read_b64_tr_b16 v[154:155], v17 offset:8768
    v_mfma_f32_16x16x32_bf16 v[48:51], v[128:131], a[48:51], v[48:51]
    ds_read_b64_tr_b16 v[156:157], v17 offset:6216
    v_mfma_f32_16x16x32_bf16 v[52:55], v[132:135], a[48:51], v[52:55]
    ds_read_b64_tr_b16 v[158:159], v17 offset:8776
    v_mfma_f32_16x16x32_bf16 v[56:59], v[136:139], a[48:51], v[56:59]
    ds_read_b64_tr_b16 v[160:161], v17 offset:6272
    s_waitcnt lgkmcnt(4)
    v_mfma_f32_16x16x32_bf16 v[60:63], v[140:143], a[48:51], v[60:63]
    ds_read_b64_tr_b16 v[162:163], v17 offset:8832
    v_mfma_f32_16x16x32_bf16 v[64:67], v[104:107], a[52:55], v[64:67]
    ds_read_b64_tr_b16 v[164:165], v17 offset:6280
    v_mfma_f32_16x16x32_bf16 v[68:71], v[108:111], a[52:55], v[68:71]
    ds_read_b64_tr_b16 v[166:167], v17 offset:8840
    v_mfma_f32_16x16x32_bf16 v[72:75], v[112:115], a[52:55], v[72:75]
    ds_read_b64_tr_b16 v[168:169], v17 offset:6336
    v_mfma_f32_16x16x32_bf16 v[76:79], v[116:119], a[52:55], v[76:79]
    ds_read_b64_tr_b16 v[170:171], v17 offset:8896
    v_mfma_f32_16x16x32_bf16 v[80:83], v[120:123], a[52:55], v[80:83]
    ds_read_b64_tr_b16 v[172:173], v17 offset:6344
    v_mfma_f32_16x16x32_bf16 v[84:87], v[124:127], a[52:55], v[84:87]
    ds_read_b64_tr_b16 v[174:175], v17 offset:8904
    v_mfma_f32_16x16x32_bf16 v[88:91], v[128:131], a[52:55], v[88:91]
    ds_read_b64_tr_b16 v[176:177], v17 offset:6400
    v_mfma_f32_16x16x32_bf16 v[92:95], v[132:135], a[52:55], v[92:95]
    ds_read_b64_tr_b16 v[178:179], v17 offset:8960
    v_mfma_f32_16x16x32_bf16 v[96:99], v[136:139], a[52:55], v[96:99]
    ds_read_b64_tr_b16 v[180:181], v17 offset:6408
    v_mfma_f32_16x16x32_bf16 v[100:103], v[140:143], a[52:55], v[100:103]
    ds_read_b64_tr_b16 v[182:183], v17 offset:8968
    s_waitcnt lgkmcnt(0)
    s_waitcnt vmcnt(18)
    s_barrier
    s_waitcnt vmcnt(26)
    v_mfma_f32_16x16x32_bf16 v[24:27], v[144:147], a[0:3], v[24:27]
    ds_read_b64_tr_b16 v[104:105], v17 offset:16384
    v_mfma_f32_16x16x32_bf16 v[28:31], v[148:151], a[0:3], v[28:31]
    ds_read_b64_tr_b16 v[106:107], v17 offset:18944
    s_add_u32 s45, s46, 26624
    buffer_load_dwordx4 a[48:51], v3, s[16:19], s45 offen
    buffer_load_dwordx4 a[52:55], v3, s[16:19], s45 offen offset:256
    v_mfma_f32_16x16x32_bf16 v[32:35], v[152:155], a[0:3], v[32:35]
    ds_read_b64_tr_b16 v[108:109], v17 offset:16392
    v_mfma_f32_16x16x32_bf16 v[36:39], v[156:159], a[0:3], v[36:39]
    ds_read_b64_tr_b16 v[110:111], v17 offset:18952
    v_mfma_f32_16x16x32_bf16 v[40:43], v[160:163], a[0:3], v[40:43]
    ds_read_b64_tr_b16 v[112:113], v17 offset:16448
    v_mfma_f32_16x16x32_bf16 v[44:47], v[164:167], a[0:3], v[44:47]
    ds_read_b64_tr_b16 v[114:115], v17 offset:19008
    s_add_u32 m0, s48, 40960
    s_add_u32 s44, s47, 655360
    buffer_load_dwordx4 v10, s[20:23], s44 offen lds
    v_mfma_f32_16x16x32_bf16 v[48:51], v[168:171], a[0:3], v[48:51]
    ds_read_b64_tr_b16 v[116:117], v17 offset:16456
    v_mfma_f32_16x16x32_bf16 v[52:55], v[172:175], a[0:3], v[52:55]
    ds_read_b64_tr_b16 v[118:119], v17 offset:19016
    v_mfma_f32_16x16x32_bf16 v[56:59], v[176:179], a[0:3], v[56:59]
    ds_read_b64_tr_b16 v[120:121], v17 offset:16512
    v_mfma_f32_16x16x32_bf16 v[60:63], v[180:183], a[0:3], v[60:63]
    ds_read_b64_tr_b16 v[122:123], v17 offset:19072
    s_add_u32 m0, s48, 41984
    s_add_u32 s44, s47, 655360
    buffer_load_dwordx4 v11, s[20:23], s44 offen lds
    v_mfma_f32_16x16x32_bf16 v[64:67], v[144:147], a[4:7], v[64:67]
    ds_read_b64_tr_b16 v[124:125], v17 offset:16520
    v_mfma_f32_16x16x32_bf16 v[68:71], v[148:151], a[4:7], v[68:71]
    ds_read_b64_tr_b16 v[126:127], v17 offset:19080
    v_mfma_f32_16x16x32_bf16 v[72:75], v[152:155], a[4:7], v[72:75]
    ds_read_b64_tr_b16 v[128:129], v17 offset:16576
    v_mfma_f32_16x16x32_bf16 v[76:79], v[156:159], a[4:7], v[76:79]
    ds_read_b64_tr_b16 v[130:131], v17 offset:19136
    s_add_u32 m0, s48, 43008
    s_add_u32 s44, s47, 655360
    buffer_load_dwordx4 v12, s[20:23], s44 offen lds
    v_mfma_f32_16x16x32_bf16 v[80:83], v[160:163], a[4:7], v[80:83]
    ds_read_b64_tr_b16 v[132:133], v17 offset:16584
    v_mfma_f32_16x16x32_bf16 v[84:87], v[164:167], a[4:7], v[84:87]
    ds_read_b64_tr_b16 v[134:135], v17 offset:19144
    v_mfma_f32_16x16x32_bf16 v[88:91], v[168:171], a[4:7], v[88:91]
    ds_read_b64_tr_b16 v[136:137], v17 offset:16640
    v_mfma_f32_16x16x32_bf16 v[92:95], v[172:175], a[4:7], v[92:95]
    ds_read_b64_tr_b16 v[138:139], v17 offset:19200
    s_add_u32 m0, s48, 44032
    s_add_u32 s44, s47, 655360
    buffer_load_dwordx4 v13, s[20:23], s44 offen lds
    v_mfma_f32_16x16x32_bf16 v[96:99], v[176:179], a[4:7], v[96:99]
    ds_read_b64_tr_b16 v[140:141], v17 offset:16648
    v_mfma_f32_16x16x32_bf16 v[100:103], v[180:183], a[4:7], v[100:103]
    ds_read_b64_tr_b16 v[142:143], v17 offset:19208
    s_waitcnt vmcnt(26)
    s_waitcnt lgkmcnt(4)
    v_mfma_f32_16x16x32_bf16 v[24:27], v[104:107], a[8:11], v[24:27]
    ds_read_b64_tr_b16 v[144:145], v17 offset:26624
    v_mfma_f32_16x16x32_bf16 v[28:31], v[108:111], a[8:11], v[28:31]
    ds_read_b64_tr_b16 v[146:147], v17 offset:29184
    s_add_u32 s45, s46, 28672
    buffer_load_dwordx4 a[0:3], v3, s[16:19], s45 offen
    buffer_load_dwordx4 a[4:7], v3, s[16:19], s45 offen offset:256
    v_mfma_f32_16x16x32_bf16 v[32:35], v[112:115], a[8:11], v[32:35]
    ds_read_b64_tr_b16 v[148:149], v17 offset:26632
    v_mfma_f32_16x16x32_bf16 v[36:39], v[116:119], a[8:11], v[36:39]
    ds_read_b64_tr_b16 v[150:151], v17 offset:29192
    v_mfma_f32_16x16x32_bf16 v[40:43], v[120:123], a[8:11], v[40:43]
    ds_read_b64_tr_b16 v[152:153], v17 offset:26688
    v_mfma_f32_16x16x32_bf16 v[44:47], v[124:127], a[8:11], v[44:47]
    ds_read_b64_tr_b16 v[154:155], v17 offset:29248
    s_add_u32 m0, s48, 45056
    s_add_u32 s44, s47, 655360
    buffer_load_dwordx4 v14, s[20:23], s44 offen lds
    v_mfma_f32_16x16x32_bf16 v[48:51], v[128:131], a[8:11], v[48:51]
    ds_read_b64_tr_b16 v[156:157], v17 offset:26696
    v_mfma_f32_16x16x32_bf16 v[52:55], v[132:135], a[8:11], v[52:55]
    ds_read_b64_tr_b16 v[158:159], v17 offset:29256
    s_waitcnt lgkmcnt(4)
    v_mfma_f32_16x16x32_bf16 v[56:59], v[136:139], a[8:11], v[56:59]
    ds_read_b64_tr_b16 v[160:161], v17 offset:26752
    v_mfma_f32_16x16x32_bf16 v[60:63], v[140:143], a[8:11], v[60:63]
    ds_read_b64_tr_b16 v[162:163], v17 offset:29312
    s_add_u32 m0, s48, 46080
    s_add_u32 s44, s47, 675840
    buffer_load_dwordx4 v10, s[20:23], s44 offen lds
    v_mfma_f32_16x16x32_bf16 v[64:67], v[104:107], a[12:15], v[64:67]
    ds_read_b64_tr_b16 v[164:165], v17 offset:26760
    v_mfma_f32_16x16x32_bf16 v[68:71], v[108:111], a[12:15], v[68:71]
    ds_read_b64_tr_b16 v[166:167], v17 offset:29320
    v_mfma_f32_16x16x32_bf16 v[72:75], v[112:115], a[12:15], v[72:75]
    ds_read_b64_tr_b16 v[168:169], v17 offset:26816
    v_mfma_f32_16x16x32_bf16 v[76:79], v[116:119], a[12:15], v[76:79]
    ds_read_b64_tr_b16 v[170:171], v17 offset:29376
    s_add_u32 m0, s48, 47104
    s_add_u32 s44, s47, 675840
    buffer_load_dwordx4 v11, s[20:23], s44 offen lds
    v_mfma_f32_16x16x32_bf16 v[80:83], v[120:123], a[12:15], v[80:83]
    ds_read_b64_tr_b16 v[172:173], v17 offset:26824
    v_mfma_f32_16x16x32_bf16 v[84:87], v[124:127], a[12:15], v[84:87]
    ds_read_b64_tr_b16 v[174:175], v17 offset:29384
    v_mfma_f32_16x16x32_bf16 v[88:91], v[128:131], a[12:15], v[88:91]
    ds_read_b64_tr_b16 v[176:177], v17 offset:26880
    v_mfma_f32_16x16x32_bf16 v[92:95], v[132:135], a[12:15], v[92:95]
    ds_read_b64_tr_b16 v[178:179], v17 offset:29440
    s_add_u32 m0, s48, 48128
    s_add_u32 s44, s47, 675840
    buffer_load_dwordx4 v12, s[20:23], s44 offen lds
    v_mfma_f32_16x16x32_bf16 v[96:99], v[136:139], a[12:15], v[96:99]
    ds_read_b64_tr_b16 v[180:181], v17 offset:26888
    v_mfma_f32_16x16x32_bf16 v[100:103], v[140:143], a[12:15], v[100:103]
    ds_read_b64_tr_b16 v[182:183], v17 offset:29448
    s_waitcnt vmcnt(28)
    v_mfma_f32_16x16x32_bf16 v[24:27], v[144:147], a[16:19], v[24:27]
    ds_read_b64_tr_b16 v[104:105], v17 offset:36864
    v_mfma_f32_16x16x32_bf16 v[28:31], v[148:151], a[16:19], v[28:31]
    ds_read_b64_tr_b16 v[106:107], v17 offset:39424
    s_add_u32 s45, s46, 30720
    buffer_load_dwordx4 a[8:11], v3, s[16:19], s45 offen
    buffer_load_dwordx4 a[12:15], v3, s[16:19], s45 offen offset:256
    s_waitcnt lgkmcnt(4)
    v_mfma_f32_16x16x32_bf16 v[32:35], v[152:155], a[16:19], v[32:35]
    ds_read_b64_tr_b16 v[108:109], v17 offset:36872
    v_mfma_f32_16x16x32_bf16 v[36:39], v[156:159], a[16:19], v[36:39]
    ds_read_b64_tr_b16 v[110:111], v17 offset:39432
    v_mfma_f32_16x16x32_bf16 v[40:43], v[160:163], a[16:19], v[40:43]
    ds_read_b64_tr_b16 v[112:113], v17 offset:36928
    v_mfma_f32_16x16x32_bf16 v[44:47], v[164:167], a[16:19], v[44:47]
    ds_read_b64_tr_b16 v[114:115], v17 offset:39488
    s_add_u32 m0, s48, 49152
    s_add_u32 s44, s47, 675840
    buffer_load_dwordx4 v13, s[20:23], s44 offen lds
    v_mfma_f32_16x16x32_bf16 v[48:51], v[168:171], a[16:19], v[48:51]
    ds_read_b64_tr_b16 v[116:117], v17 offset:36936
    v_mfma_f32_16x16x32_bf16 v[52:55], v[172:175], a[16:19], v[52:55]
    ds_read_b64_tr_b16 v[118:119], v17 offset:39496
    v_mfma_f32_16x16x32_bf16 v[56:59], v[176:179], a[16:19], v[56:59]
    ds_read_b64_tr_b16 v[120:121], v17 offset:36992
    s_waitcnt lgkmcnt(4)
    v_mfma_f32_16x16x32_bf16 v[60:63], v[180:183], a[16:19], v[60:63]
    ds_read_b64_tr_b16 v[122:123], v17 offset:39552
    s_add_u32 m0, s48, 50176
    s_add_u32 s44, s47, 675840
    buffer_load_dwordx4 v14, s[20:23], s44 offen lds
    v_mfma_f32_16x16x32_bf16 v[64:67], v[144:147], a[20:23], v[64:67]
    ds_read_b64_tr_b16 v[124:125], v17 offset:37000
    v_mfma_f32_16x16x32_bf16 v[68:71], v[148:151], a[20:23], v[68:71]
    ds_read_b64_tr_b16 v[126:127], v17 offset:39560
    v_mfma_f32_16x16x32_bf16 v[72:75], v[152:155], a[20:23], v[72:75]
    ds_read_b64_tr_b16 v[128:129], v17 offset:37056
    v_mfma_f32_16x16x32_bf16 v[76:79], v[156:159], a[20:23], v[76:79]
    ds_read_b64_tr_b16 v[130:131], v17 offset:39616
    v_mfma_f32_16x16x32_bf16 v[80:83], v[160:163], a[20:23], v[80:83]
    ds_read_b64_tr_b16 v[132:133], v17 offset:37064
    v_mfma_f32_16x16x32_bf16 v[84:87], v[164:167], a[20:23], v[84:87]
    ds_read_b64_tr_b16 v[134:135], v17 offset:39624
    v_mfma_f32_16x16x32_bf16 v[88:91], v[168:171], a[20:23], v[88:91]
    ds_read_b64_tr_b16 v[136:137], v17 offset:37120
    v_mfma_f32_16x16x32_bf16 v[92:95], v[172:175], a[20:23], v[92:95]
    ds_read_b64_tr_b16 v[138:139], v17 offset:39680
    v_mfma_f32_16x16x32_bf16 v[96:99], v[176:179], a[20:23], v[96:99]
    ds_read_b64_tr_b16 v[140:141], v17 offset:37128
    v_mfma_f32_16x16x32_bf16 v[100:103], v[180:183], a[20:23], v[100:103]
    ds_read_b64_tr_b16 v[142:143], v17 offset:39688
    s_waitcnt vmcnt(26)
    v_mfma_f32_16x16x32_bf16 v[24:27], v[104:107], a[24:27], v[24:27]
    ds_read_b64_tr_b16 v[144:145], v17 offset:47104
    v_mfma_f32_16x16x32_bf16 v[28:31], v[108:111], a[24:27], v[28:31]
    ds_read_b64_tr_b16 v[146:147], v17 offset:49664
    s_add_u32 s45, s46, 32768
    buffer_load_dwordx4 a[16:19], v3, s[16:19], s45 offen
    buffer_load_dwordx4 a[20:23], v3, s[16:19], s45 offen offset:256
    s_waitcnt lgkmcnt(4)
    v_mfma_f32_16x16x32_bf16 v[32:35], v[112:115], a[24:27], v[32:35]
    ds_read_b64_tr_b16 v[148:149], v17 offset:47112
    v_mfma_f32_16x16x32_bf16 v[36:39], v[116:119], a[24:27], v[36:39]
    ds_read_b64_tr_b16 v[150:151], v17 offset:49672
    v_mfma_f32_16x16x32_bf16 v[40:43], v[120:123], a[24:27], v[40:43]
    ds_read_b64_tr_b16 v[152:153], v17 offset:47168
    v_mfma_f32_16x16x32_bf16 v[44:47], v[124:127], a[24:27], v[44:47]
    ds_read_b64_tr_b16 v[154:155], v17 offset:49728
    v_mfma_f32_16x16x32_bf16 v[48:51], v[128:131], a[24:27], v[48:51]
    ds_read_b64_tr_b16 v[156:157], v17 offset:47176
    v_mfma_f32_16x16x32_bf16 v[52:55], v[132:135], a[24:27], v[52:55]
    ds_read_b64_tr_b16 v[158:159], v17 offset:49736
    v_mfma_f32_16x16x32_bf16 v[56:59], v[136:139], a[24:27], v[56:59]
    ds_read_b64_tr_b16 v[160:161], v17 offset:47232
    s_waitcnt lgkmcnt(4)
    v_mfma_f32_16x16x32_bf16 v[60:63], v[140:143], a[24:27], v[60:63]
    ds_read_b64_tr_b16 v[162:163], v17 offset:49792
    v_mfma_f32_16x16x32_bf16 v[64:67], v[104:107], a[28:31], v[64:67]
    ds_read_b64_tr_b16 v[164:165], v17 offset:47240
    v_mfma_f32_16x16x32_bf16 v[68:71], v[108:111], a[28:31], v[68:71]
    ds_read_b64_tr_b16 v[166:167], v17 offset:49800
    v_mfma_f32_16x16x32_bf16 v[72:75], v[112:115], a[28:31], v[72:75]
    ds_read_b64_tr_b16 v[168:169], v17 offset:47296
    v_mfma_f32_16x16x32_bf16 v[76:79], v[116:119], a[28:31], v[76:79]
    ds_read_b64_tr_b16 v[170:171], v17 offset:49856
    v_mfma_f32_16x16x32_bf16 v[80:83], v[120:123], a[28:31], v[80:83]
    ds_read_b64_tr_b16 v[172:173], v17 offset:47304
    v_mfma_f32_16x16x32_bf16 v[84:87], v[124:127], a[28:31], v[84:87]
    ds_read_b64_tr_b16 v[174:175], v17 offset:49864
    v_mfma_f32_16x16x32_bf16 v[88:91], v[128:131], a[28:31], v[88:91]
    ds_read_b64_tr_b16 v[176:177], v17 offset:47360
    v_mfma_f32_16x16x32_bf16 v[92:95], v[132:135], a[28:31], v[92:95]
    ds_read_b64_tr_b16 v[178:179], v17 offset:49920
    v_mfma_f32_16x16x32_bf16 v[96:99], v[136:139], a[28:31], v[96:99]
    ds_read_b64_tr_b16 v[180:181], v17 offset:47368
    v_mfma_f32_16x16x32_bf16 v[100:103], v[140:143], a[28:31], v[100:103]
    ds_read_b64_tr_b16 v[182:183], v17 offset:49928
    s_waitcnt lgkmcnt(0)
    s_waitcnt vmcnt(20)
    s_barrier
    s_waitcnt vmcnt(22)
    v_mfma_f32_16x16x32_bf16 v[24:27], v[144:147], a[32:35], v[24:27]
    ds_read_b64_tr_b16 v[104:105], v16 offset:0
    v_mfma_f32_16x16x32_bf16 v[28:31], v[148:151], a[32:35], v[28:31]
    ds_read_b64_tr_b16 v[106:107], v16 offset:2560
    s_add_u32 s45, s46, 34816
    buffer_load_dwordx4 a[24:27], v3, s[16:19], s45 offen
    buffer_load_dwordx4 a[28:31], v3, s[16:19], s45 offen offset:256
    v_mfma_f32_16x16x32_bf16 v[32:35], v[152:155], a[32:35], v[32:35]
    ds_read_b64_tr_b16 v[108:109], v16 offset:8
    v_mfma_f32_16x16x32_bf16 v[36:39], v[156:159], a[32:35], v[36:39]
    ds_read_b64_tr_b16 v[110:111], v16 offset:2568
    v_mfma_f32_16x16x32_bf16 v[40:43], v[160:163], a[32:35], v[40:43]
    ds_read_b64_tr_b16 v[112:113], v16 offset:64
    v_mfma_f32_16x16x32_bf16 v[44:47], v[164:167], a[32:35], v[44:47]
    ds_read_b64_tr_b16 v[114:115], v16 offset:2624
    s_add_u32 m0, s48, 81920
    s_add_u32 s44, s47, 819200
    buffer_load_dwordx4 v10, s[20:23], s44 offen lds
    v_mfma_f32_16x16x32_bf16 v[48:51], v[168:171], a[32:35], v[48:51]
    ds_read_b64_tr_b16 v[116:117], v16 offset:72
    v_mfma_f32_16x16x32_bf16 v[52:55], v[172:175], a[32:35], v[52:55]
    ds_read_b64_tr_b16 v[118:119], v16 offset:2632
    v_mfma_f32_16x16x32_bf16 v[56:59], v[176:179], a[32:35], v[56:59]
    ds_read_b64_tr_b16 v[120:121], v16 offset:128
    v_mfma_f32_16x16x32_bf16 v[60:63], v[180:183], a[32:35], v[60:63]
    ds_read_b64_tr_b16 v[122:123], v16 offset:2688
    s_add_u32 m0, s48, 82944
    s_add_u32 s44, s47, 819200
    buffer_load_dwordx4 v11, s[20:23], s44 offen lds
    v_mfma_f32_16x16x32_bf16 v[64:67], v[144:147], a[36:39], v[64:67]
    ds_read_b64_tr_b16 v[124:125], v16 offset:136
    v_mfma_f32_16x16x32_bf16 v[68:71], v[148:151], a[36:39], v[68:71]
    ds_read_b64_tr_b16 v[126:127], v16 offset:2696
    v_mfma_f32_16x16x32_bf16 v[72:75], v[152:155], a[36:39], v[72:75]
    ds_read_b64_tr_b16 v[128:129], v16 offset:192
    v_mfma_f32_16x16x32_bf16 v[76:79], v[156:159], a[36:39], v[76:79]
    ds_read_b64_tr_b16 v[130:131], v16 offset:2752
    s_add_u32 m0, s48, 83968
    s_add_u32 s44, s47, 819200
    buffer_load_dwordx4 v12, s[20:23], s44 offen lds
    v_mfma_f32_16x16x32_bf16 v[80:83], v[160:163], a[36:39], v[80:83]
    ds_read_b64_tr_b16 v[132:133], v16 offset:200
    v_mfma_f32_16x16x32_bf16 v[84:87], v[164:167], a[36:39], v[84:87]
    ds_read_b64_tr_b16 v[134:135], v16 offset:2760
    v_mfma_f32_16x16x32_bf16 v[88:91], v[168:171], a[36:39], v[88:91]
    ds_read_b64_tr_b16 v[136:137], v16 offset:256
    v_mfma_f32_16x16x32_bf16 v[92:95], v[172:175], a[36:39], v[92:95]
    ds_read_b64_tr_b16 v[138:139], v16 offset:2816
    s_add_u32 m0, s48, 84992
    s_add_u32 s44, s47, 819200
    buffer_load_dwordx4 v13, s[20:23], s44 offen lds
    v_mfma_f32_16x16x32_bf16 v[96:99], v[176:179], a[36:39], v[96:99]
    ds_read_b64_tr_b16 v[140:141], v16 offset:264
    v_mfma_f32_16x16x32_bf16 v[100:103], v[180:183], a[36:39], v[100:103]
    ds_read_b64_tr_b16 v[142:143], v16 offset:2824
    s_waitcnt vmcnt(24)
    s_waitcnt lgkmcnt(4)
    v_mfma_f32_16x16x32_bf16 v[24:27], v[104:107], a[40:43], v[24:27]
    ds_read_b64_tr_b16 v[144:145], v16 offset:10240
    v_mfma_f32_16x16x32_bf16 v[28:31], v[108:111], a[40:43], v[28:31]
    ds_read_b64_tr_b16 v[146:147], v16 offset:12800
    s_add_u32 s45, s46, 36864
    buffer_load_dwordx4 a[32:35], v3, s[16:19], s45 offen
    buffer_load_dwordx4 a[36:39], v3, s[16:19], s45 offen offset:256
    v_mfma_f32_16x16x32_bf16 v[32:35], v[112:115], a[40:43], v[32:35]
    ds_read_b64_tr_b16 v[148:149], v16 offset:10248
    v_mfma_f32_16x16x32_bf16 v[36:39], v[116:119], a[40:43], v[36:39]
    ds_read_b64_tr_b16 v[150:151], v16 offset:12808
    v_mfma_f32_16x16x32_bf16 v[40:43], v[120:123], a[40:43], v[40:43]
    ds_read_b64_tr_b16 v[152:153], v16 offset:10304
    v_mfma_f32_16x16x32_bf16 v[44:47], v[124:127], a[40:43], v[44:47]
    ds_read_b64_tr_b16 v[154:155], v16 offset:12864
    s_add_u32 m0, s48, 86016
    s_add_u32 s44, s47, 819200
    buffer_load_dwordx4 v14, s[20:23], s44 offen lds
    v_mfma_f32_16x16x32_bf16 v[48:51], v[128:131], a[40:43], v[48:51]
    ds_read_b64_tr_b16 v[156:157], v16 offset:10312
    v_mfma_f32_16x16x32_bf16 v[52:55], v[132:135], a[40:43], v[52:55]
    ds_read_b64_tr_b16 v[158:159], v16 offset:12872
    s_waitcnt lgkmcnt(4)
    v_mfma_f32_16x16x32_bf16 v[56:59], v[136:139], a[40:43], v[56:59]
    ds_read_b64_tr_b16 v[160:161], v16 offset:10368
    v_mfma_f32_16x16x32_bf16 v[60:63], v[140:143], a[40:43], v[60:63]
    ds_read_b64_tr_b16 v[162:163], v16 offset:12928
    s_add_u32 m0, s48, 87040
    s_add_u32 s44, s47, 839680
    buffer_load_dwordx4 v10, s[20:23], s44 offen lds
    v_mfma_f32_16x16x32_bf16 v[64:67], v[104:107], a[44:47], v[64:67]
    ds_read_b64_tr_b16 v[164:165], v16 offset:10376
    v_mfma_f32_16x16x32_bf16 v[68:71], v[108:111], a[44:47], v[68:71]
    ds_read_b64_tr_b16 v[166:167], v16 offset:12936
    v_mfma_f32_16x16x32_bf16 v[72:75], v[112:115], a[44:47], v[72:75]
    ds_read_b64_tr_b16 v[168:169], v16 offset:10432
    v_mfma_f32_16x16x32_bf16 v[76:79], v[116:119], a[44:47], v[76:79]
    ds_read_b64_tr_b16 v[170:171], v16 offset:12992
    s_add_u32 m0, s48, 88064
    s_add_u32 s44, s47, 839680
    buffer_load_dwordx4 v11, s[20:23], s44 offen lds
    v_mfma_f32_16x16x32_bf16 v[80:83], v[120:123], a[44:47], v[80:83]
    ds_read_b64_tr_b16 v[172:173], v16 offset:10440
    v_mfma_f32_16x16x32_bf16 v[84:87], v[124:127], a[44:47], v[84:87]
    ds_read_b64_tr_b16 v[174:175], v16 offset:13000
    v_mfma_f32_16x16x32_bf16 v[88:91], v[128:131], a[44:47], v[88:91]
    ds_read_b64_tr_b16 v[176:177], v16 offset:10496
    v_mfma_f32_16x16x32_bf16 v[92:95], v[132:135], a[44:47], v[92:95]
    ds_read_b64_tr_b16 v[178:179], v16 offset:13056
    s_add_u32 m0, s48, 89088
    s_add_u32 s44, s47, 839680
    buffer_load_dwordx4 v12, s[20:23], s44 offen lds
    v_mfma_f32_16x16x32_bf16 v[96:99], v[136:139], a[44:47], v[96:99]
    ds_read_b64_tr_b16 v[180:181], v16 offset:10504
    v_mfma_f32_16x16x32_bf16 v[100:103], v[140:143], a[44:47], v[100:103]
    ds_read_b64_tr_b16 v[182:183], v16 offset:13064
    s_waitcnt vmcnt(28)
    v_mfma_f32_16x16x32_bf16 v[24:27], v[144:147], a[48:51], v[24:27]
    ds_read_b64_tr_b16 v[104:105], v16 offset:20480
    v_mfma_f32_16x16x32_bf16 v[28:31], v[148:151], a[48:51], v[28:31]
    ds_read_b64_tr_b16 v[106:107], v16 offset:23040
    s_add_u32 s45, s46, 38912
    buffer_load_dwordx4 a[40:43], v3, s[16:19], s45 offen
    buffer_load_dwordx4 a[44:47], v3, s[16:19], s45 offen offset:256
    s_waitcnt lgkmcnt(4)
    v_mfma_f32_16x16x32_bf16 v[32:35], v[152:155], a[48:51], v[32:35]
    ds_read_b64_tr_b16 v[108:109], v16 offset:20488
    v_mfma_f32_16x16x32_bf16 v[36:39], v[156:159], a[48:51], v[36:39]
    ds_read_b64_tr_b16 v[110:111], v16 offset:23048
    v_mfma_f32_16x16x32_bf16 v[40:43], v[160:163], a[48:51], v[40:43]
    ds_read_b64_tr_b16 v[112:113], v16 offset:20544
    v_mfma_f32_16x16x32_bf16 v[44:47], v[164:167], a[48:51], v[44:47]
    ds_read_b64_tr_b16 v[114:115], v16 offset:23104
    s_add_u32 m0, s48, 90112
    s_add_u32 s44, s47, 839680
    buffer_load_dwordx4 v13, s[20:23], s44 offen lds
    v_mfma_f32_16x16x32_bf16 v[48:51], v[168:171], a[48:51], v[48:51]
    ds_read_b64_tr_b16 v[116:117], v16 offset:20552
    v_mfma_f32_16x16x32_bf16 v[52:55], v[172:175], a[48:51], v[52:55]
    ds_read_b64_tr_b16 v[118:119], v16 offset:23112
    v_mfma_f32_16x16x32_bf16 v[56:59], v[176:179], a[48:51], v[56:59]
    ds_read_b64_tr_b16 v[120:121], v16 offset:20608
    s_waitcnt lgkmcnt(4)
    v_mfma_f32_16x16x32_bf16 v[60:63], v[180:183], a[48:51], v[60:63]
    ds_read_b64_tr_b16 v[122:123], v16 offset:23168
    s_add_u32 m0, s48, 91136
    s_add_u32 s44, s47, 839680
    buffer_load_dwordx4 v14, s[20:23], s44 offen lds
    v_mfma_f32_16x16x32_bf16 v[64:67], v[144:147], a[52:55], v[64:67]
    ds_read_b64_tr_b16 v[124:125], v16 offset:20616
    v_mfma_f32_16x16x32_bf16 v[68:71], v[148:151], a[52:55], v[68:71]
    ds_read_b64_tr_b16 v[126:127], v16 offset:23176
    v_mfma_f32_16x16x32_bf16 v[72:75], v[152:155], a[52:55], v[72:75]
    ds_read_b64_tr_b16 v[128:129], v16 offset:20672
    v_mfma_f32_16x16x32_bf16 v[76:79], v[156:159], a[52:55], v[76:79]
    ds_read_b64_tr_b16 v[130:131], v16 offset:23232
    v_mfma_f32_16x16x32_bf16 v[80:83], v[160:163], a[52:55], v[80:83]
    ds_read_b64_tr_b16 v[132:133], v16 offset:20680
    v_mfma_f32_16x16x32_bf16 v[84:87], v[164:167], a[52:55], v[84:87]
    ds_read_b64_tr_b16 v[134:135], v16 offset:23240
    v_mfma_f32_16x16x32_bf16 v[88:91], v[168:171], a[52:55], v[88:91]
    ds_read_b64_tr_b16 v[136:137], v16 offset:20736
    v_mfma_f32_16x16x32_bf16 v[92:95], v[172:175], a[52:55], v[92:95]
    ds_read_b64_tr_b16 v[138:139], v16 offset:23296
    v_mfma_f32_16x16x32_bf16 v[96:99], v[176:179], a[52:55], v[96:99]
    ds_read_b64_tr_b16 v[140:141], v16 offset:20744
    v_mfma_f32_16x16x32_bf16 v[100:103], v[180:183], a[52:55], v[100:103]
    ds_read_b64_tr_b16 v[142:143], v16 offset:23304
    s_waitcnt vmcnt(26)
    v_mfma_f32_16x16x32_bf16 v[24:27], v[104:107], a[0:3], v[24:27]
    ds_read_b64_tr_b16 v[144:145], v16 offset:30720
    v_mfma_f32_16x16x32_bf16 v[28:31], v[108:111], a[0:3], v[28:31]
    ds_read_b64_tr_b16 v[146:147], v16 offset:33280
    s_add_u32 s45, s46, 40960
    buffer_load_dwordx4 a[48:51], v3, s[16:19], s45 offen
    buffer_load_dwordx4 a[52:55], v3, s[16:19], s45 offen offset:256
    s_waitcnt lgkmcnt(4)
    v_mfma_f32_16x16x32_bf16 v[32:35], v[112:115], a[0:3], v[32:35]
    ds_read_b64_tr_b16 v[148:149], v16 offset:30728
    v_mfma_f32_16x16x32_bf16 v[36:39], v[116:119], a[0:3], v[36:39]
    ds_read_b64_tr_b16 v[150:151], v16 offset:33288
    v_mfma_f32_16x16x32_bf16 v[40:43], v[120:123], a[0:3], v[40:43]
    ds_read_b64_tr_b16 v[152:153], v16 offset:30784
    v_mfma_f32_16x16x32_bf16 v[44:47], v[124:127], a[0:3], v[44:47]
    ds_read_b64_tr_b16 v[154:155], v16 offset:33344
    v_mfma_f32_16x16x32_bf16 v[48:51], v[128:131], a[0:3], v[48:51]
    ds_read_b64_tr_b16 v[156:157], v16 offset:30792
    v_mfma_f32_16x16x32_bf16 v[52:55], v[132:135], a[0:3], v[52:55]
    ds_read_b64_tr_b16 v[158:159], v16 offset:33352
    v_mfma_f32_16x16x32_bf16 v[56:59], v[136:139], a[0:3], v[56:59]
    ds_read_b64_tr_b16 v[160:161], v16 offset:30848
    s_waitcnt lgkmcnt(4)
    v_mfma_f32_16x16x32_bf16 v[60:63], v[140:143], a[0:3], v[60:63]
    ds_read_b64_tr_b16 v[162:163], v16 offset:33408
    v_mfma_f32_16x16x32_bf16 v[64:67], v[104:107], a[4:7], v[64:67]
    ds_read_b64_tr_b16 v[164:165], v16 offset:30856
    v_mfma_f32_16x16x32_bf16 v[68:71], v[108:111], a[4:7], v[68:71]
    ds_read_b64_tr_b16 v[166:167], v16 offset:33416
    v_mfma_f32_16x16x32_bf16 v[72:75], v[112:115], a[4:7], v[72:75]
    ds_read_b64_tr_b16 v[168:169], v16 offset:30912
    v_mfma_f32_16x16x32_bf16 v[76:79], v[116:119], a[4:7], v[76:79]
    ds_read_b64_tr_b16 v[170:171], v16 offset:33472
    v_mfma_f32_16x16x32_bf16 v[80:83], v[120:123], a[4:7], v[80:83]
    ds_read_b64_tr_b16 v[172:173], v16 offset:30920
    v_mfma_f32_16x16x32_bf16 v[84:87], v[124:127], a[4:7], v[84:87]
    ds_read_b64_tr_b16 v[174:175], v16 offset:33480
    v_mfma_f32_16x16x32_bf16 v[88:91], v[128:131], a[4:7], v[88:91]
    ds_read_b64_tr_b16 v[176:177], v16 offset:30976
    v_mfma_f32_16x16x32_bf16 v[92:95], v[132:135], a[4:7], v[92:95]
    ds_read_b64_tr_b16 v[178:179], v16 offset:33536
    v_mfma_f32_16x16x32_bf16 v[96:99], v[136:139], a[4:7], v[96:99]
    ds_read_b64_tr_b16 v[180:181], v16 offset:30984
    v_mfma_f32_16x16x32_bf16 v[100:103], v[140:143], a[4:7], v[100:103]
    ds_read_b64_tr_b16 v[182:183], v16 offset:33544
    s_waitcnt lgkmcnt(0)
    s_waitcnt vmcnt(20)
    s_barrier
    s_waitcnt vmcnt(22)
    v_mfma_f32_16x16x32_bf16 v[24:27], v[144:147], a[8:11], v[24:27]
    ds_read_b64_tr_b16 v[104:105], v16 offset:40960
    v_mfma_f32_16x16x32_bf16 v[28:31], v[148:151], a[8:11], v[28:31]
    ds_read_b64_tr_b16 v[106:107], v16 offset:43520
    s_add_u32 s45, s46, 43008
    buffer_load_dwordx4 a[0:3], v3, s[16:19], s45 offen
    buffer_load_dwordx4 a[4:7], v3, s[16:19], s45 offen offset:256
    v_mfma_f32_16x16x32_bf16 v[32:35], v[152:155], a[8:11], v[32:35]
    ds_read_b64_tr_b16 v[108:109], v16 offset:40968
    v_mfma_f32_16x16x32_bf16 v[36:39], v[156:159], a[8:11], v[36:39]
    ds_read_b64_tr_b16 v[110:111], v16 offset:43528
    v_mfma_f32_16x16x32_bf16 v[40:43], v[160:163], a[8:11], v[40:43]
    ds_read_b64_tr_b16 v[112:113], v16 offset:41024
    v_mfma_f32_16x16x32_bf16 v[44:47], v[164:167], a[8:11], v[44:47]
    ds_read_b64_tr_b16 v[114:115], v16 offset:43584
    s_add_u32 m0, s48, 0
    s_add_u32 s44, s47, 983040
    buffer_load_dwordx4 v10, s[20:23], s44 offen lds
    v_mfma_f32_16x16x32_bf16 v[48:51], v[168:171], a[8:11], v[48:51]
    ds_read_b64_tr_b16 v[116:117], v16 offset:41032
    v_mfma_f32_16x16x32_bf16 v[52:55], v[172:175], a[8:11], v[52:55]
    ds_read_b64_tr_b16 v[118:119], v16 offset:43592
    v_mfma_f32_16x16x32_bf16 v[56:59], v[176:179], a[8:11], v[56:59]
    ds_read_b64_tr_b16 v[120:121], v16 offset:41088
    v_mfma_f32_16x16x32_bf16 v[60:63], v[180:183], a[8:11], v[60:63]
    ds_read_b64_tr_b16 v[122:123], v16 offset:43648
    s_add_u32 m0, s48, 1024
    s_add_u32 s44, s47, 983040
    buffer_load_dwordx4 v11, s[20:23], s44 offen lds
    v_mfma_f32_16x16x32_bf16 v[64:67], v[144:147], a[12:15], v[64:67]
    ds_read_b64_tr_b16 v[124:125], v16 offset:41096
    v_mfma_f32_16x16x32_bf16 v[68:71], v[148:151], a[12:15], v[68:71]
    ds_read_b64_tr_b16 v[126:127], v16 offset:43656
    v_mfma_f32_16x16x32_bf16 v[72:75], v[152:155], a[12:15], v[72:75]
    ds_read_b64_tr_b16 v[128:129], v16 offset:41152
    v_mfma_f32_16x16x32_bf16 v[76:79], v[156:159], a[12:15], v[76:79]
    ds_read_b64_tr_b16 v[130:131], v16 offset:43712
    s_add_u32 m0, s48, 2048
    s_add_u32 s44, s47, 983040
    buffer_load_dwordx4 v12, s[20:23], s44 offen lds
    v_mfma_f32_16x16x32_bf16 v[80:83], v[160:163], a[12:15], v[80:83]
    ds_read_b64_tr_b16 v[132:133], v16 offset:41160
    v_mfma_f32_16x16x32_bf16 v[84:87], v[164:167], a[12:15], v[84:87]
    ds_read_b64_tr_b16 v[134:135], v16 offset:43720
    v_mfma_f32_16x16x32_bf16 v[88:91], v[168:171], a[12:15], v[88:91]
    ds_read_b64_tr_b16 v[136:137], v16 offset:41216
    v_mfma_f32_16x16x32_bf16 v[92:95], v[172:175], a[12:15], v[92:95]
    ds_read_b64_tr_b16 v[138:139], v16 offset:43776
    s_add_u32 m0, s48, 3072
    s_add_u32 s44, s47, 983040
    buffer_load_dwordx4 v13, s[20:23], s44 offen lds
    v_mfma_f32_16x16x32_bf16 v[96:99], v[176:179], a[12:15], v[96:99]
    ds_read_b64_tr_b16 v[140:141], v16 offset:41224
    v_mfma_f32_16x16x32_bf16 v[100:103], v[180:183], a[12:15], v[100:103]
    ds_read_b64_tr_b16 v[142:143], v16 offset:43784
    s_waitcnt vmcnt(24)
    s_waitcnt lgkmcnt(4)
    v_mfma_f32_16x16x32_bf16 v[24:27], v[104:107], a[16:19], v[24:27]
    ds_read_b64_tr_b16 v[144:145], v16 offset:51200
    v_mfma_f32_16x16x32_bf16 v[28:31], v[108:111], a[16:19], v[28:31]
    ds_read_b64_tr_b16 v[146:147], v16 offset:53760
    s_add_u32 s45, s46, 45056
    buffer_load_dwordx4 a[8:11], v3, s[16:19], s45 offen
    buffer_load_dwordx4 a[12:15], v3, s[16:19], s45 offen offset:256
    v_mfma_f32_16x16x32_bf16 v[32:35], v[112:115], a[16:19], v[32:35]
    ds_read_b64_tr_b16 v[148:149], v16 offset:51208
    v_mfma_f32_16x16x32_bf16 v[36:39], v[116:119], a[16:19], v[36:39]
    ds_read_b64_tr_b16 v[150:151], v16 offset:53768
    v_mfma_f32_16x16x32_bf16 v[40:43], v[120:123], a[16:19], v[40:43]
    ds_read_b64_tr_b16 v[152:153], v16 offset:51264
    v_mfma_f32_16x16x32_bf16 v[44:47], v[124:127], a[16:19], v[44:47]
    ds_read_b64_tr_b16 v[154:155], v16 offset:53824
    s_add_u32 m0, s48, 4096
    s_add_u32 s44, s47, 983040
    buffer_load_dwordx4 v14, s[20:23], s44 offen lds
    v_mfma_f32_16x16x32_bf16 v[48:51], v[128:131], a[16:19], v[48:51]
    ds_read_b64_tr_b16 v[156:157], v16 offset:51272
    v_mfma_f32_16x16x32_bf16 v[52:55], v[132:135], a[16:19], v[52:55]
    ds_read_b64_tr_b16 v[158:159], v16 offset:53832
    s_waitcnt lgkmcnt(4)
    v_mfma_f32_16x16x32_bf16 v[56:59], v[136:139], a[16:19], v[56:59]
    ds_read_b64_tr_b16 v[160:161], v16 offset:51328
    v_mfma_f32_16x16x32_bf16 v[60:63], v[140:143], a[16:19], v[60:63]
    ds_read_b64_tr_b16 v[162:163], v16 offset:53888
    s_add_u32 m0, s48, 5120
    s_add_u32 s44, s47, 1003520
    buffer_load_dwordx4 v10, s[20:23], s44 offen lds
    v_mfma_f32_16x16x32_bf16 v[64:67], v[104:107], a[20:23], v[64:67]
    ds_read_b64_tr_b16 v[164:165], v16 offset:51336
    v_mfma_f32_16x16x32_bf16 v[68:71], v[108:111], a[20:23], v[68:71]
    ds_read_b64_tr_b16 v[166:167], v16 offset:53896
    v_mfma_f32_16x16x32_bf16 v[72:75], v[112:115], a[20:23], v[72:75]
    ds_read_b64_tr_b16 v[168:169], v16 offset:51392
    v_mfma_f32_16x16x32_bf16 v[76:79], v[116:119], a[20:23], v[76:79]
    ds_read_b64_tr_b16 v[170:171], v16 offset:53952
    s_add_u32 m0, s48, 6144
    s_add_u32 s44, s47, 1003520
    buffer_load_dwordx4 v11, s[20:23], s44 offen lds
    v_mfma_f32_16x16x32_bf16 v[80:83], v[120:123], a[20:23], v[80:83]
    ds_read_b64_tr_b16 v[172:173], v16 offset:51400
    v_mfma_f32_16x16x32_bf16 v[84:87], v[124:127], a[20:23], v[84:87]
    ds_read_b64_tr_b16 v[174:175], v16 offset:53960
    v_mfma_f32_16x16x32_bf16 v[88:91], v[128:131], a[20:23], v[88:91]
    ds_read_b64_tr_b16 v[176:177], v16 offset:51456
    v_mfma_f32_16x16x32_bf16 v[92:95], v[132:135], a[20:23], v[92:95]
    ds_read_b64_tr_b16 v[178:179], v16 offset:54016
    s_add_u32 m0, s48, 7168
    s_add_u32 s44, s47, 1003520
    buffer_load_dwordx4 v12, s[20:23], s44 offen lds
    v_mfma_f32_16x16x32_bf16 v[96:99], v[136:139], a[20:23], v[96:99]
    ds_read_b64_tr_b16 v[180:181], v16 offset:51464
    v_mfma_f32_16x16x32_bf16 v[100:103], v[140:143], a[20:23], v[100:103]
    ds_read_b64_tr_b16 v[182:183], v16 offset:54024
    s_waitcnt vmcnt(28)
    v_mfma_f32_16x16x32_bf16 v[24:27], v[144:147], a[24:27], v[24:27]
    ds_read_b64_tr_b16 v[104:105], v16 offset:61440
    v_mfma_f32_16x16x32_bf16 v[28:31], v[148:151], a[24:27], v[28:31]
    ds_read_b64_tr_b16 v[106:107], v16 offset:64000
    s_add_u32 s45, s46, 47104
    buffer_load_dwordx4 a[16:19], v3, s[16:19], s45 offen
    buffer_load_dwordx4 a[20:23], v3, s[16:19], s45 offen offset:256
    s_waitcnt lgkmcnt(4)
    v_mfma_f32_16x16x32_bf16 v[32:35], v[152:155], a[24:27], v[32:35]
    ds_read_b64_tr_b16 v[108:109], v16 offset:61448
    v_mfma_f32_16x16x32_bf16 v[36:39], v[156:159], a[24:27], v[36:39]
    ds_read_b64_tr_b16 v[110:111], v16 offset:64008
    v_mfma_f32_16x16x32_bf16 v[40:43], v[160:163], a[24:27], v[40:43]
    ds_read_b64_tr_b16 v[112:113], v16 offset:61504
    v_mfma_f32_16x16x32_bf16 v[44:47], v[164:167], a[24:27], v[44:47]
    ds_read_b64_tr_b16 v[114:115], v16 offset:64064
    s_add_u32 m0, s48, 8192
    s_add_u32 s44, s47, 1003520
    buffer_load_dwordx4 v13, s[20:23], s44 offen lds
    v_mfma_f32_16x16x32_bf16 v[48:51], v[168:171], a[24:27], v[48:51]
    ds_read_b64_tr_b16 v[116:117], v16 offset:61512
    v_mfma_f32_16x16x32_bf16 v[52:55], v[172:175], a[24:27], v[52:55]
    ds_read_b64_tr_b16 v[118:119], v16 offset:64072
    v_mfma_f32_16x16x32_bf16 v[56:59], v[176:179], a[24:27], v[56:59]
    ds_read_b64_tr_b16 v[120:121], v16 offset:61568
    s_waitcnt lgkmcnt(4)
    v_mfma_f32_16x16x32_bf16 v[60:63], v[180:183], a[24:27], v[60:63]
    ds_read_b64_tr_b16 v[122:123], v16 offset:64128
    s_add_u32 m0, s48, 9216
    s_add_u32 s44, s47, 1003520
    buffer_load_dwordx4 v14, s[20:23], s44 offen lds
    v_mfma_f32_16x16x32_bf16 v[64:67], v[144:147], a[28:31], v[64:67]
    ds_read_b64_tr_b16 v[124:125], v16 offset:61576
    v_mfma_f32_16x16x32_bf16 v[68:71], v[148:151], a[28:31], v[68:71]
    ds_read_b64_tr_b16 v[126:127], v16 offset:64136
    v_mfma_f32_16x16x32_bf16 v[72:75], v[152:155], a[28:31], v[72:75]
    ds_read_b64_tr_b16 v[128:129], v16 offset:61632
    v_mfma_f32_16x16x32_bf16 v[76:79], v[156:159], a[28:31], v[76:79]
    ds_read_b64_tr_b16 v[130:131], v16 offset:64192
    v_mfma_f32_16x16x32_bf16 v[80:83], v[160:163], a[28:31], v[80:83]
    ds_read_b64_tr_b16 v[132:133], v16 offset:61640
    v_mfma_f32_16x16x32_bf16 v[84:87], v[164:167], a[28:31], v[84:87]
    ds_read_b64_tr_b16 v[134:135], v16 offset:64200
    v_mfma_f32_16x16x32_bf16 v[88:91], v[168:171], a[28:31], v[88:91]
    ds_read_b64_tr_b16 v[136:137], v16 offset:61696
    v_mfma_f32_16x16x32_bf16 v[92:95], v[172:175], a[28:31], v[92:95]
    ds_read_b64_tr_b16 v[138:139], v16 offset:64256
    v_mfma_f32_16x16x32_bf16 v[96:99], v[176:179], a[28:31], v[96:99]
    ds_read_b64_tr_b16 v[140:141], v16 offset:61704
    v_mfma_f32_16x16x32_bf16 v[100:103], v[180:183], a[28:31], v[100:103]
    ds_read_b64_tr_b16 v[142:143], v16 offset:64264
    s_waitcnt vmcnt(26)
    v_mfma_f32_16x16x32_bf16 v[24:27], v[104:107], a[32:35], v[24:27]
    ds_read_b64_tr_b16 v[144:145], v17 offset:6144
    v_mfma_f32_16x16x32_bf16 v[28:31], v[108:111], a[32:35], v[28:31]
    ds_read_b64_tr_b16 v[146:147], v17 offset:8704
    s_add_u32 s45, s46, 49152
    buffer_load_dwordx4 a[24:27], v3, s[16:19], s45 offen
    buffer_load_dwordx4 a[28:31], v3, s[16:19], s45 offen offset:256
    s_waitcnt lgkmcnt(4)
    v_mfma_f32_16x16x32_bf16 v[32:35], v[112:115], a[32:35], v[32:35]
    ds_read_b64_tr_b16 v[148:149], v17 offset:6152
    v_mfma_f32_16x16x32_bf16 v[36:39], v[116:119], a[32:35], v[36:39]
    ds_read_b64_tr_b16 v[150:151], v17 offset:8712
    v_mfma_f32_16x16x32_bf16 v[40:43], v[120:123], a[32:35], v[40:43]
    ds_read_b64_tr_b16 v[152:153], v17 offset:6208
    v_mfma_f32_16x16x32_bf16 v[44:47], v[124:127], a[32:35], v[44:47]
    ds_read_b64_tr_b16 v[154:155], v17 offset:8768
    v_mfma_f32_16x16x32_bf16 v[48:51], v[128:131], a[32:35], v[48:51]
    ds_read_b64_tr_b16 v[156:157], v17 offset:6216
    v_mfma_f32_16x16x32_bf16 v[52:55], v[132:135], a[32:35], v[52:55]
    ds_read_b64_tr_b16 v[158:159], v17 offset:8776
    v_mfma_f32_16x16x32_bf16 v[56:59], v[136:139], a[32:35], v[56:59]
    ds_read_b64_tr_b16 v[160:161], v17 offset:6272
    s_waitcnt lgkmcnt(4)
    v_mfma_f32_16x16x32_bf16 v[60:63], v[140:143], a[32:35], v[60:63]
    ds_read_b64_tr_b16 v[162:163], v17 offset:8832
    v_mfma_f32_16x16x32_bf16 v[64:67], v[104:107], a[36:39], v[64:67]
    ds_read_b64_tr_b16 v[164:165], v17 offset:6280
    v_mfma_f32_16x16x32_bf16 v[68:71], v[108:111], a[36:39], v[68:71]
    ds_read_b64_tr_b16 v[166:167], v17 offset:8840
    v_mfma_f32_16x16x32_bf16 v[72:75], v[112:115], a[36:39], v[72:75]
    ds_read_b64_tr_b16 v[168:169], v17 offset:6336
    v_mfma_f32_16x16x32_bf16 v[76:79], v[116:119], a[36:39], v[76:79]
    ds_read_b64_tr_b16 v[170:171], v17 offset:8896
    v_mfma_f32_16x16x32_bf16 v[80:83], v[120:123], a[36:39], v[80:83]
    ds_read_b64_tr_b16 v[172:173], v17 offset:6344
    v_mfma_f32_16x16x32_bf16 v[84:87], v[124:127], a[36:39], v[84:87]
    ds_read_b64_tr_b16 v[174:175], v17 offset:8904
    v_mfma_f32_16x16x32_bf16 v[88:91], v[128:131], a[36:39], v[88:91]
    ds_read_b64_tr_b16 v[176:177], v17 offset:6400
    v_mfma_f32_16x16x32_bf16 v[92:95], v[132:135], a[36:39], v[92:95]
    ds_read_b64_tr_b16 v[178:179], v17 offset:8960
    v_mfma_f32_16x16x32_bf16 v[96:99], v[136:139], a[36:39], v[96:99]
    ds_read_b64_tr_b16 v[180:181], v17 offset:6408
    v_mfma_f32_16x16x32_bf16 v[100:103], v[140:143], a[36:39], v[100:103]
    ds_read_b64_tr_b16 v[182:183], v17 offset:8968
    s_waitcnt lgkmcnt(0)
    s_waitcnt vmcnt(20)
    s_barrier
    s_waitcnt vmcnt(22)
    v_mfma_f32_16x16x32_bf16 v[24:27], v[144:147], a[40:43], v[24:27]
    ds_read_b64_tr_b16 v[104:105], v17 offset:16384
    v_mfma_f32_16x16x32_bf16 v[28:31], v[148:151], a[40:43], v[28:31]
    ds_read_b64_tr_b16 v[106:107], v17 offset:18944
    s_add_u32 s45, s46, 51200
    buffer_load_dwordx4 a[32:35], v3, s[16:19], s45 offen
    buffer_load_dwordx4 a[36:39], v3, s[16:19], s45 offen offset:256
    v_mfma_f32_16x16x32_bf16 v[32:35], v[152:155], a[40:43], v[32:35]
    ds_read_b64_tr_b16 v[108:109], v17 offset:16392
    v_mfma_f32_16x16x32_bf16 v[36:39], v[156:159], a[40:43], v[36:39]
    ds_read_b64_tr_b16 v[110:111], v17 offset:18952
    v_mfma_f32_16x16x32_bf16 v[40:43], v[160:163], a[40:43], v[40:43]
    ds_read_b64_tr_b16 v[112:113], v17 offset:16448
    v_mfma_f32_16x16x32_bf16 v[44:47], v[164:167], a[40:43], v[44:47]
    ds_read_b64_tr_b16 v[114:115], v17 offset:19008
    s_add_u32 m0, s48, 40960
    s_add_u32 s44, s47, 1146880
    buffer_load_dwordx4 v10, s[20:23], s44 offen lds
    v_mfma_f32_16x16x32_bf16 v[48:51], v[168:171], a[40:43], v[48:51]
    ds_read_b64_tr_b16 v[116:117], v17 offset:16456
    v_mfma_f32_16x16x32_bf16 v[52:55], v[172:175], a[40:43], v[52:55]
    ds_read_b64_tr_b16 v[118:119], v17 offset:19016
    v_mfma_f32_16x16x32_bf16 v[56:59], v[176:179], a[40:43], v[56:59]
    ds_read_b64_tr_b16 v[120:121], v17 offset:16512
    v_mfma_f32_16x16x32_bf16 v[60:63], v[180:183], a[40:43], v[60:63]
    ds_read_b64_tr_b16 v[122:123], v17 offset:19072
    s_add_u32 m0, s48, 41984
    s_add_u32 s44, s47, 1146880
    buffer_load_dwordx4 v11, s[20:23], s44 offen lds
    v_mfma_f32_16x16x32_bf16 v[64:67], v[144:147], a[44:47], v[64:67]
    ds_read_b64_tr_b16 v[124:125], v17 offset:16520
    v_mfma_f32_16x16x32_bf16 v[68:71], v[148:151], a[44:47], v[68:71]
    ds_read_b64_tr_b16 v[126:127], v17 offset:19080
    v_mfma_f32_16x16x32_bf16 v[72:75], v[152:155], a[44:47], v[72:75]
    ds_read_b64_tr_b16 v[128:129], v17 offset:16576
    v_mfma_f32_16x16x32_bf16 v[76:79], v[156:159], a[44:47], v[76:79]
    ds_read_b64_tr_b16 v[130:131], v17 offset:19136
    s_add_u32 m0, s48, 43008
    s_add_u32 s44, s47, 1146880
    buffer_load_dwordx4 v12, s[20:23], s44 offen lds
    v_mfma_f32_16x16x32_bf16 v[80:83], v[160:163], a[44:47], v[80:83]
    ds_read_b64_tr_b16 v[132:133], v17 offset:16584
    v_mfma_f32_16x16x32_bf16 v[84:87], v[164:167], a[44:47], v[84:87]
    ds_read_b64_tr_b16 v[134:135], v17 offset:19144
    v_mfma_f32_16x16x32_bf16 v[88:91], v[168:171], a[44:47], v[88:91]
    ds_read_b64_tr_b16 v[136:137], v17 offset:16640
    v_mfma_f32_16x16x32_bf16 v[92:95], v[172:175], a[44:47], v[92:95]
    ds_read_b64_tr_b16 v[138:139], v17 offset:19200
    s_add_u32 m0, s48, 44032
    s_add_u32 s44, s47, 1146880
    buffer_load_dwordx4 v13, s[20:23], s44 offen lds
    v_mfma_f32_16x16x32_bf16 v[96:99], v[176:179], a[44:47], v[96:99]
    ds_read_b64_tr_b16 v[140:141], v17 offset:16648
    v_mfma_f32_16x16x32_bf16 v[100:103], v[180:183], a[44:47], v[100:103]
    ds_read_b64_tr_b16 v[142:143], v17 offset:19208
    s_waitcnt vmcnt(24)
    s_waitcnt lgkmcnt(4)
    v_mfma_f32_16x16x32_bf16 v[24:27], v[104:107], a[48:51], v[24:27]
    ds_read_b64_tr_b16 v[144:145], v17 offset:26624
    v_mfma_f32_16x16x32_bf16 v[28:31], v[108:111], a[48:51], v[28:31]
    ds_read_b64_tr_b16 v[146:147], v17 offset:29184
    s_add_u32 s45, s46, 53248
    buffer_load_dwordx4 a[40:43], v3, s[16:19], s45 offen
    buffer_load_dwordx4 a[44:47], v3, s[16:19], s45 offen offset:256
    v_mfma_f32_16x16x32_bf16 v[32:35], v[112:115], a[48:51], v[32:35]
    ds_read_b64_tr_b16 v[148:149], v17 offset:26632
    v_mfma_f32_16x16x32_bf16 v[36:39], v[116:119], a[48:51], v[36:39]
    ds_read_b64_tr_b16 v[150:151], v17 offset:29192
    v_mfma_f32_16x16x32_bf16 v[40:43], v[120:123], a[48:51], v[40:43]
    ds_read_b64_tr_b16 v[152:153], v17 offset:26688
    v_mfma_f32_16x16x32_bf16 v[44:47], v[124:127], a[48:51], v[44:47]
    ds_read_b64_tr_b16 v[154:155], v17 offset:29248
    s_add_u32 m0, s48, 45056
    s_add_u32 s44, s47, 1146880
    buffer_load_dwordx4 v14, s[20:23], s44 offen lds
    v_mfma_f32_16x16x32_bf16 v[48:51], v[128:131], a[48:51], v[48:51]
    ds_read_b64_tr_b16 v[156:157], v17 offset:26696
    v_mfma_f32_16x16x32_bf16 v[52:55], v[132:135], a[48:51], v[52:55]
    ds_read_b64_tr_b16 v[158:159], v17 offset:29256
    s_waitcnt lgkmcnt(4)
    v_mfma_f32_16x16x32_bf16 v[56:59], v[136:139], a[48:51], v[56:59]
    ds_read_b64_tr_b16 v[160:161], v17 offset:26752
    v_mfma_f32_16x16x32_bf16 v[60:63], v[140:143], a[48:51], v[60:63]
    ds_read_b64_tr_b16 v[162:163], v17 offset:29312
    s_add_u32 m0, s48, 46080
    s_add_u32 s44, s47, 1167360
    buffer_load_dwordx4 v10, s[20:23], s44 offen lds
    v_mfma_f32_16x16x32_bf16 v[64:67], v[104:107], a[52:55], v[64:67]
    ds_read_b64_tr_b16 v[164:165], v17 offset:26760
    v_mfma_f32_16x16x32_bf16 v[68:71], v[108:111], a[52:55], v[68:71]
    ds_read_b64_tr_b16 v[166:167], v17 offset:29320
    v_mfma_f32_16x16x32_bf16 v[72:75], v[112:115], a[52:55], v[72:75]
    ds_read_b64_tr_b16 v[168:169], v17 offset:26816
    v_mfma_f32_16x16x32_bf16 v[76:79], v[116:119], a[52:55], v[76:79]
    ds_read_b64_tr_b16 v[170:171], v17 offset:29376
    s_add_u32 m0, s48, 47104
    s_add_u32 s44, s47, 1167360
    buffer_load_dwordx4 v11, s[20:23], s44 offen lds
    v_mfma_f32_16x16x32_bf16 v[80:83], v[120:123], a[52:55], v[80:83]
    ds_read_b64_tr_b16 v[172:173], v17 offset:26824
    v_mfma_f32_16x16x32_bf16 v[84:87], v[124:127], a[52:55], v[84:87]
    ds_read_b64_tr_b16 v[174:175], v17 offset:29384
    v_mfma_f32_16x16x32_bf16 v[88:91], v[128:131], a[52:55], v[88:91]
    ds_read_b64_tr_b16 v[176:177], v17 offset:26880
    v_mfma_f32_16x16x32_bf16 v[92:95], v[132:135], a[52:55], v[92:95]
    ds_read_b64_tr_b16 v[178:179], v17 offset:29440
    s_add_u32 m0, s48, 48128
    s_add_u32 s44, s47, 1167360
    buffer_load_dwordx4 v12, s[20:23], s44 offen lds
    v_mfma_f32_16x16x32_bf16 v[96:99], v[136:139], a[52:55], v[96:99]
    ds_read_b64_tr_b16 v[180:181], v17 offset:26888
    v_mfma_f32_16x16x32_bf16 v[100:103], v[140:143], a[52:55], v[100:103]
    ds_read_b64_tr_b16 v[182:183], v17 offset:29448
    s_waitcnt vmcnt(28)
    v_mfma_f32_16x16x32_bf16 v[24:27], v[144:147], a[0:3], v[24:27]
    ds_read_b64_tr_b16 v[104:105], v17 offset:36864
    v_mfma_f32_16x16x32_bf16 v[28:31], v[148:151], a[0:3], v[28:31]
    ds_read_b64_tr_b16 v[106:107], v17 offset:39424
    s_add_u32 s45, s46, 55296
    buffer_load_dwordx4 a[48:51], v3, s[16:19], s45 offen
    buffer_load_dwordx4 a[52:55], v3, s[16:19], s45 offen offset:256
    s_waitcnt lgkmcnt(4)
    v_mfma_f32_16x16x32_bf16 v[32:35], v[152:155], a[0:3], v[32:35]
    ds_read_b64_tr_b16 v[108:109], v17 offset:36872
    v_mfma_f32_16x16x32_bf16 v[36:39], v[156:159], a[0:3], v[36:39]
    ds_read_b64_tr_b16 v[110:111], v17 offset:39432
    v_mfma_f32_16x16x32_bf16 v[40:43], v[160:163], a[0:3], v[40:43]
    ds_read_b64_tr_b16 v[112:113], v17 offset:36928
    v_mfma_f32_16x16x32_bf16 v[44:47], v[164:167], a[0:3], v[44:47]
    ds_read_b64_tr_b16 v[114:115], v17 offset:39488
    s_add_u32 m0, s48, 49152
    s_add_u32 s44, s47, 1167360
    buffer_load_dwordx4 v13, s[20:23], s44 offen lds
    v_mfma_f32_16x16x32_bf16 v[48:51], v[168:171], a[0:3], v[48:51]
    ds_read_b64_tr_b16 v[116:117], v17 offset:36936
    v_mfma_f32_16x16x32_bf16 v[52:55], v[172:175], a[0:3], v[52:55]
    ds_read_b64_tr_b16 v[118:119], v17 offset:39496
    v_mfma_f32_16x16x32_bf16 v[56:59], v[176:179], a[0:3], v[56:59]
    ds_read_b64_tr_b16 v[120:121], v17 offset:36992
    s_waitcnt lgkmcnt(4)
    v_mfma_f32_16x16x32_bf16 v[60:63], v[180:183], a[0:3], v[60:63]
    ds_read_b64_tr_b16 v[122:123], v17 offset:39552
    s_add_u32 m0, s48, 50176
    s_add_u32 s44, s47, 1167360
    buffer_load_dwordx4 v14, s[20:23], s44 offen lds
    v_mfma_f32_16x16x32_bf16 v[64:67], v[144:147], a[4:7], v[64:67]
    ds_read_b64_tr_b16 v[124:125], v17 offset:37000
    v_mfma_f32_16x16x32_bf16 v[68:71], v[148:151], a[4:7], v[68:71]
    ds_read_b64_tr_b16 v[126:127], v17 offset:39560
    v_mfma_f32_16x16x32_bf16 v[72:75], v[152:155], a[4:7], v[72:75]
    ds_read_b64_tr_b16 v[128:129], v17 offset:37056
    v_mfma_f32_16x16x32_bf16 v[76:79], v[156:159], a[4:7], v[76:79]
    ds_read_b64_tr_b16 v[130:131], v17 offset:39616
    v_mfma_f32_16x16x32_bf16 v[80:83], v[160:163], a[4:7], v[80:83]
    ds_read_b64_tr_b16 v[132:133], v17 offset:37064
    v_mfma_f32_16x16x32_bf16 v[84:87], v[164:167], a[4:7], v[84:87]
    ds_read_b64_tr_b16 v[134:135], v17 offset:39624
    v_mfma_f32_16x16x32_bf16 v[88:91], v[168:171], a[4:7], v[88:91]
    ds_read_b64_tr_b16 v[136:137], v17 offset:37120
    v_mfma_f32_16x16x32_bf16 v[92:95], v[172:175], a[4:7], v[92:95]
    ds_read_b64_tr_b16 v[138:139], v17 offset:39680
    v_mfma_f32_16x16x32_bf16 v[96:99], v[176:179], a[4:7], v[96:99]
    ds_read_b64_tr_b16 v[140:141], v17 offset:37128
    v_mfma_f32_16x16x32_bf16 v[100:103], v[180:183], a[4:7], v[100:103]
    ds_read_b64_tr_b16 v[142:143], v17 offset:39688
    s_waitcnt vmcnt(26)
    v_mfma_f32_16x16x32_bf16 v[24:27], v[104:107], a[8:11], v[24:27]
    ds_read_b64_tr_b16 v[144:145], v17 offset:47104
    v_mfma_f32_16x16x32_bf16 v[28:31], v[108:111], a[8:11], v[28:31]
    ds_read_b64_tr_b16 v[146:147], v17 offset:49664
    s_add_u32 s45, s46, 57344
    buffer_load_dwordx4 a[0:3], v3, s[16:19], s45 offen
    buffer_load_dwordx4 a[4:7], v3, s[16:19], s45 offen offset:256
    s_waitcnt lgkmcnt(4)
    v_mfma_f32_16x16x32_bf16 v[32:35], v[112:115], a[8:11], v[32:35]
    ds_read_b64_tr_b16 v[148:149], v17 offset:47112
    v_mfma_f32_16x16x32_bf16 v[36:39], v[116:119], a[8:11], v[36:39]
    ds_read_b64_tr_b16 v[150:151], v17 offset:49672
    v_mfma_f32_16x16x32_bf16 v[40:43], v[120:123], a[8:11], v[40:43]
    ds_read_b64_tr_b16 v[152:153], v17 offset:47168
    v_mfma_f32_16x16x32_bf16 v[44:47], v[124:127], a[8:11], v[44:47]
    ds_read_b64_tr_b16 v[154:155], v17 offset:49728
    v_mfma_f32_16x16x32_bf16 v[48:51], v[128:131], a[8:11], v[48:51]
    ds_read_b64_tr_b16 v[156:157], v17 offset:47176
    v_mfma_f32_16x16x32_bf16 v[52:55], v[132:135], a[8:11], v[52:55]
    ds_read_b64_tr_b16 v[158:159], v17 offset:49736
    v_mfma_f32_16x16x32_bf16 v[56:59], v[136:139], a[8:11], v[56:59]
    ds_read_b64_tr_b16 v[160:161], v17 offset:47232
    s_waitcnt lgkmcnt(4)
    v_mfma_f32_16x16x32_bf16 v[60:63], v[140:143], a[8:11], v[60:63]
    ds_read_b64_tr_b16 v[162:163], v17 offset:49792
    v_mfma_f32_16x16x32_bf16 v[64:67], v[104:107], a[12:15], v[64:67]
    ds_read_b64_tr_b16 v[164:165], v17 offset:47240
    v_mfma_f32_16x16x32_bf16 v[68:71], v[108:111], a[12:15], v[68:71]
    ds_read_b64_tr_b16 v[166:167], v17 offset:49800
    v_mfma_f32_16x16x32_bf16 v[72:75], v[112:115], a[12:15], v[72:75]
    ds_read_b64_tr_b16 v[168:169], v17 offset:47296
    v_mfma_f32_16x16x32_bf16 v[76:79], v[116:119], a[12:15], v[76:79]
    ds_read_b64_tr_b16 v[170:171], v17 offset:49856
    v_mfma_f32_16x16x32_bf16 v[80:83], v[120:123], a[12:15], v[80:83]
    ds_read_b64_tr_b16 v[172:173], v17 offset:47304
    v_mfma_f32_16x16x32_bf16 v[84:87], v[124:127], a[12:15], v[84:87]
    ds_read_b64_tr_b16 v[174:175], v17 offset:49864
    v_mfma_f32_16x16x32_bf16 v[88:91], v[128:131], a[12:15], v[88:91]
    ds_read_b64_tr_b16 v[176:177], v17 offset:47360
    v_mfma_f32_16x16x32_bf16 v[92:95], v[132:135], a[12:15], v[92:95]
    ds_read_b64_tr_b16 v[178:179], v17 offset:49920
    v_mfma_f32_16x16x32_bf16 v[96:99], v[136:139], a[12:15], v[96:99]
    ds_read_b64_tr_b16 v[180:181], v17 offset:47368
    v_mfma_f32_16x16x32_bf16 v[100:103], v[140:143], a[12:15], v[100:103]
    ds_read_b64_tr_b16 v[182:183], v17 offset:49928
    s_waitcnt lgkmcnt(0)
    s_waitcnt vmcnt(20)
    s_barrier
    s_waitcnt vmcnt(22)
    v_mfma_f32_16x16x32_bf16 v[24:27], v[144:147], a[16:19], v[24:27]
    ds_read_b64_tr_b16 v[104:105], v16 offset:0
    v_mfma_f32_16x16x32_bf16 v[28:31], v[148:151], a[16:19], v[28:31]
    ds_read_b64_tr_b16 v[106:107], v16 offset:2560
    s_add_u32 s45, s46, 59392
    buffer_load_dwordx4 a[8:11], v3, s[16:19], s45 offen
    buffer_load_dwordx4 a[12:15], v3, s[16:19], s45 offen offset:256
    v_mfma_f32_16x16x32_bf16 v[32:35], v[152:155], a[16:19], v[32:35]
    ds_read_b64_tr_b16 v[108:109], v16 offset:8
    v_mfma_f32_16x16x32_bf16 v[36:39], v[156:159], a[16:19], v[36:39]
    ds_read_b64_tr_b16 v[110:111], v16 offset:2568
    v_mfma_f32_16x16x32_bf16 v[40:43], v[160:163], a[16:19], v[40:43]
    ds_read_b64_tr_b16 v[112:113], v16 offset:64
    v_mfma_f32_16x16x32_bf16 v[44:47], v[164:167], a[16:19], v[44:47]
    ds_read_b64_tr_b16 v[114:115], v16 offset:2624
    v_mfma_f32_16x16x32_bf16 v[48:51], v[168:171], a[16:19], v[48:51]
    ds_read_b64_tr_b16 v[116:117], v16 offset:72
    v_mfma_f32_16x16x32_bf16 v[52:55], v[172:175], a[16:19], v[52:55]
    ds_read_b64_tr_b16 v[118:119], v16 offset:2632
    v_mfma_f32_16x16x32_bf16 v[56:59], v[176:179], a[16:19], v[56:59]
    ds_read_b64_tr_b16 v[120:121], v16 offset:128
    v_mfma_f32_16x16x32_bf16 v[60:63], v[180:183], a[16:19], v[60:63]
    ds_read_b64_tr_b16 v[122:123], v16 offset:2688
    v_mfma_f32_16x16x32_bf16 v[64:67], v[144:147], a[20:23], v[64:67]
    ds_read_b64_tr_b16 v[124:125], v16 offset:136
    v_mfma_f32_16x16x32_bf16 v[68:71], v[148:151], a[20:23], v[68:71]
    ds_read_b64_tr_b16 v[126:127], v16 offset:2696
    v_mfma_f32_16x16x32_bf16 v[72:75], v[152:155], a[20:23], v[72:75]
    ds_read_b64_tr_b16 v[128:129], v16 offset:192
    v_mfma_f32_16x16x32_bf16 v[76:79], v[156:159], a[20:23], v[76:79]
    ds_read_b64_tr_b16 v[130:131], v16 offset:2752
    v_mfma_f32_16x16x32_bf16 v[80:83], v[160:163], a[20:23], v[80:83]
    ds_read_b64_tr_b16 v[132:133], v16 offset:200
    v_mfma_f32_16x16x32_bf16 v[84:87], v[164:167], a[20:23], v[84:87]
    ds_read_b64_tr_b16 v[134:135], v16 offset:2760
    v_mfma_f32_16x16x32_bf16 v[88:91], v[168:171], a[20:23], v[88:91]
    ds_read_b64_tr_b16 v[136:137], v16 offset:256
    v_mfma_f32_16x16x32_bf16 v[92:95], v[172:175], a[20:23], v[92:95]
    ds_read_b64_tr_b16 v[138:139], v16 offset:2816
    v_mfma_f32_16x16x32_bf16 v[96:99], v[176:179], a[20:23], v[96:99]
    ds_read_b64_tr_b16 v[140:141], v16 offset:264
    v_mfma_f32_16x16x32_bf16 v[100:103], v[180:183], a[20:23], v[100:103]
    ds_read_b64_tr_b16 v[142:143], v16 offset:2824
    s_waitcnt vmcnt(20)
    s_waitcnt lgkmcnt(4)
    v_mfma_f32_16x16x32_bf16 v[24:27], v[104:107], a[24:27], v[24:27]
    ds_read_b64_tr_b16 v[144:145], v16 offset:10240
    v_mfma_f32_16x16x32_bf16 v[28:31], v[108:111], a[24:27], v[28:31]
    ds_read_b64_tr_b16 v[146:147], v16 offset:12800
    s_add_u32 s45, s46, 61440
    buffer_load_dwordx4 a[16:19], v3, s[16:19], s45 offen
    buffer_load_dwordx4 a[20:23], v3, s[16:19], s45 offen offset:256
    v_mfma_f32_16x16x32_bf16 v[32:35], v[112:115], a[24:27], v[32:35]
    ds_read_b64_tr_b16 v[148:149], v16 offset:10248
    v_mfma_f32_16x16x32_bf16 v[36:39], v[116:119], a[24:27], v[36:39]
    ds_read_b64_tr_b16 v[150:151], v16 offset:12808
    v_mfma_f32_16x16x32_bf16 v[40:43], v[120:123], a[24:27], v[40:43]
    ds_read_b64_tr_b16 v[152:153], v16 offset:10304
    v_mfma_f32_16x16x32_bf16 v[44:47], v[124:127], a[24:27], v[44:47]
    ds_read_b64_tr_b16 v[154:155], v16 offset:12864
    v_mfma_f32_16x16x32_bf16 v[48:51], v[128:131], a[24:27], v[48:51]
    ds_read_b64_tr_b16 v[156:157], v16 offset:10312
    v_mfma_f32_16x16x32_bf16 v[52:55], v[132:135], a[24:27], v[52:55]
    ds_read_b64_tr_b16 v[158:159], v16 offset:12872
    s_waitcnt lgkmcnt(4)
    v_mfma_f32_16x16x32_bf16 v[56:59], v[136:139], a[24:27], v[56:59]
    ds_read_b64_tr_b16 v[160:161], v16 offset:10368
    v_mfma_f32_16x16x32_bf16 v[60:63], v[140:143], a[24:27], v[60:63]
    ds_read_b64_tr_b16 v[162:163], v16 offset:12928
    v_mfma_f32_16x16x32_bf16 v[64:67], v[104:107], a[28:31], v[64:67]
    ds_read_b64_tr_b16 v[164:165], v16 offset:10376
    v_mfma_f32_16x16x32_bf16 v[68:71], v[108:111], a[28:31], v[68:71]
    ds_read_b64_tr_b16 v[166:167], v16 offset:12936
    v_mfma_f32_16x16x32_bf16 v[72:75], v[112:115], a[28:31], v[72:75]
    ds_read_b64_tr_b16 v[168:169], v16 offset:10432
    v_mfma_f32_16x16x32_bf16 v[76:79], v[116:119], a[28:31], v[76:79]
    ds_read_b64_tr_b16 v[170:171], v16 offset:12992
    v_mfma_f32_16x16x32_bf16 v[80:83], v[120:123], a[28:31], v[80:83]
    ds_read_b64_tr_b16 v[172:173], v16 offset:10440
    v_mfma_f32_16x16x32_bf16 v[84:87], v[124:127], a[28:31], v[84:87]
    ds_read_b64_tr_b16 v[174:175], v16 offset:13000
    v_mfma_f32_16x16x32_bf16 v[88:91], v[128:131], a[28:31], v[88:91]
    ds_read_b64_tr_b16 v[176:177], v16 offset:10496
    v_mfma_f32_16x16x32_bf16 v[92:95], v[132:135], a[28:31], v[92:95]
    ds_read_b64_tr_b16 v[178:179], v16 offset:13056
    v_mfma_f32_16x16x32_bf16 v[96:99], v[136:139], a[28:31], v[96:99]
    ds_read_b64_tr_b16 v[180:181], v16 offset:10504
    v_mfma_f32_16x16x32_bf16 v[100:103], v[140:143], a[28:31], v[100:103]
    ds_read_b64_tr_b16 v[182:183], v16 offset:13064
    s_waitcnt vmcnt(20)
    v_mfma_f32_16x16x32_bf16 v[24:27], v[144:147], a[32:35], v[24:27]
    ds_read_b64_tr_b16 v[104:105], v16 offset:20480
    v_mfma_f32_16x16x32_bf16 v[28:31], v[148:151], a[32:35], v[28:31]
    ds_read_b64_tr_b16 v[106:107], v16 offset:23040
    s_add_u32 s45, s46, 63488
    buffer_load_dwordx4 a[24:27], v3, s[16:19], s45 offen
    buffer_load_dwordx4 a[28:31], v3, s[16:19], s45 offen offset:256
    s_waitcnt lgkmcnt(4)
    v_mfma_f32_16x16x32_bf16 v[32:35], v[152:155], a[32:35], v[32:35]
    ds_read_b64_tr_b16 v[108:109], v16 offset:20488
    v_mfma_f32_16x16x32_bf16 v[36:39], v[156:159], a[32:35], v[36:39]
    ds_read_b64_tr_b16 v[110:111], v16 offset:23048
    v_mfma_f32_16x16x32_bf16 v[40:43], v[160:163], a[32:35], v[40:43]
    ds_read_b64_tr_b16 v[112:113], v16 offset:20544
    v_mfma_f32_16x16x32_bf16 v[44:47], v[164:167], a[32:35], v[44:47]
    ds_read_b64_tr_b16 v[114:115], v16 offset:23104
    v_mfma_f32_16x16x32_bf16 v[48:51], v[168:171], a[32:35], v[48:51]
    ds_read_b64_tr_b16 v[116:117], v16 offset:20552
    v_mfma_f32_16x16x32_bf16 v[52:55], v[172:175], a[32:35], v[52:55]
    ds_read_b64_tr_b16 v[118:119], v16 offset:23112
    v_mfma_f32_16x16x32_bf16 v[56:59], v[176:179], a[32:35], v[56:59]
    ds_read_b64_tr_b16 v[120:121], v16 offset:20608
    s_waitcnt lgkmcnt(4)
    v_mfma_f32_16x16x32_bf16 v[60:63], v[180:183], a[32:35], v[60:63]
    ds_read_b64_tr_b16 v[122:123], v16 offset:23168
    v_mfma_f32_16x16x32_bf16 v[64:67], v[144:147], a[36:39], v[64:67]
    ds_read_b64_tr_b16 v[124:125], v16 offset:20616
    v_mfma_f32_16x16x32_bf16 v[68:71], v[148:151], a[36:39], v[68:71]
    ds_read_b64_tr_b16 v[126:127], v16 offset:23176
    v_mfma_f32_16x16x32_bf16 v[72:75], v[152:155], a[36:39], v[72:75]
    ds_read_b64_tr_b16 v[128:129], v16 offset:20672
    v_mfma_f32_16x16x32_bf16 v[76:79], v[156:159], a[36:39], v[76:79]
    ds_read_b64_tr_b16 v[130:131], v16 offset:23232
    v_mfma_f32_16x16x32_bf16 v[80:83], v[160:163], a[36:39], v[80:83]
    ds_read_b64_tr_b16 v[132:133], v16 offset:20680
    v_mfma_f32_16x16x32_bf16 v[84:87], v[164:167], a[36:39], v[84:87]
    ds_read_b64_tr_b16 v[134:135], v16 offset:23240
    v_mfma_f32_16x16x32_bf16 v[88:91], v[168:171], a[36:39], v[88:91]
    ds_read_b64_tr_b16 v[136:137], v16 offset:20736
    v_mfma_f32_16x16x32_bf16 v[92:95], v[172:175], a[36:39], v[92:95]
    ds_read_b64_tr_b16 v[138:139], v16 offset:23296
    v_mfma_f32_16x16x32_bf16 v[96:99], v[176:179], a[36:39], v[96:99]
    ds_read_b64_tr_b16 v[140:141], v16 offset:20744
    v_mfma_f32_16x16x32_bf16 v[100:103], v[180:183], a[36:39], v[100:103]
    ds_read_b64_tr_b16 v[142:143], v16 offset:23304
    s_waitcnt vmcnt(16)
    v_mfma_f32_16x16x32_bf16 v[24:27], v[104:107], a[40:43], v[24:27]
    ds_read_b64_tr_b16 v[144:145], v16 offset:30720
    v_mfma_f32_16x16x32_bf16 v[28:31], v[108:111], a[40:43], v[28:31]
    ds_read_b64_tr_b16 v[146:147], v16 offset:33280
    s_waitcnt lgkmcnt(4)
    v_mfma_f32_16x16x32_bf16 v[32:35], v[112:115], a[40:43], v[32:35]
    ds_read_b64_tr_b16 v[148:149], v16 offset:30728
    v_mfma_f32_16x16x32_bf16 v[36:39], v[116:119], a[40:43], v[36:39]
    ds_read_b64_tr_b16 v[150:151], v16 offset:33288
    v_mfma_f32_16x16x32_bf16 v[40:43], v[120:123], a[40:43], v[40:43]
    ds_read_b64_tr_b16 v[152:153], v16 offset:30784
    v_mfma_f32_16x16x32_bf16 v[44:47], v[124:127], a[40:43], v[44:47]
    ds_read_b64_tr_b16 v[154:155], v16 offset:33344
    v_mfma_f32_16x16x32_bf16 v[48:51], v[128:131], a[40:43], v[48:51]
    ds_read_b64_tr_b16 v[156:157], v16 offset:30792
    v_mfma_f32_16x16x32_bf16 v[52:55], v[132:135], a[40:43], v[52:55]
    ds_read_b64_tr_b16 v[158:159], v16 offset:33352
    v_mfma_f32_16x16x32_bf16 v[56:59], v[136:139], a[40:43], v[56:59]
    ds_read_b64_tr_b16 v[160:161], v16 offset:30848
    s_waitcnt lgkmcnt(4)
    v_mfma_f32_16x16x32_bf16 v[60:63], v[140:143], a[40:43], v[60:63]
    ds_read_b64_tr_b16 v[162:163], v16 offset:33408
    v_mfma_f32_16x16x32_bf16 v[64:67], v[104:107], a[44:47], v[64:67]
    ds_read_b64_tr_b16 v[164:165], v16 offset:30856
    v_mfma_f32_16x16x32_bf16 v[68:71], v[108:111], a[44:47], v[68:71]
    ds_read_b64_tr_b16 v[166:167], v16 offset:33416
    v_mfma_f32_16x16x32_bf16 v[72:75], v[112:115], a[44:47], v[72:75]
    ds_read_b64_tr_b16 v[168:169], v16 offset:30912
    v_mfma_f32_16x16x32_bf16 v[76:79], v[116:119], a[44:47], v[76:79]
    ds_read_b64_tr_b16 v[170:171], v16 offset:33472
    v_mfma_f32_16x16x32_bf16 v[80:83], v[120:123], a[44:47], v[80:83]
    ds_read_b64_tr_b16 v[172:173], v16 offset:30920
    v_mfma_f32_16x16x32_bf16 v[84:87], v[124:127], a[44:47], v[84:87]
    ds_read_b64_tr_b16 v[174:175], v16 offset:33480
    v_mfma_f32_16x16x32_bf16 v[88:91], v[128:131], a[44:47], v[88:91]
    ds_read_b64_tr_b16 v[176:177], v16 offset:30976
    v_mfma_f32_16x16x32_bf16 v[92:95], v[132:135], a[44:47], v[92:95]
    ds_read_b64_tr_b16 v[178:179], v16 offset:33536
    v_mfma_f32_16x16x32_bf16 v[96:99], v[136:139], a[44:47], v[96:99]
    ds_read_b64_tr_b16 v[180:181], v16 offset:30984
    v_mfma_f32_16x16x32_bf16 v[100:103], v[140:143], a[44:47], v[100:103]
    ds_read_b64_tr_b16 v[182:183], v16 offset:33544
    s_waitcnt lgkmcnt(0)
    s_waitcnt vmcnt(8)
    s_barrier
    s_waitcnt vmcnt(10)
    v_mfma_f32_16x16x32_bf16 v[24:27], v[144:147], a[48:51], v[24:27]
    ds_read_b64_tr_b16 v[104:105], v16 offset:40960
    v_mfma_f32_16x16x32_bf16 v[28:31], v[148:151], a[48:51], v[28:31]
    ds_read_b64_tr_b16 v[106:107], v16 offset:43520
    v_mfma_f32_16x16x32_bf16 v[32:35], v[152:155], a[48:51], v[32:35]
    ds_read_b64_tr_b16 v[108:109], v16 offset:40968
    v_mfma_f32_16x16x32_bf16 v[36:39], v[156:159], a[48:51], v[36:39]
    ds_read_b64_tr_b16 v[110:111], v16 offset:43528
    v_mfma_f32_16x16x32_bf16 v[40:43], v[160:163], a[48:51], v[40:43]
    ds_read_b64_tr_b16 v[112:113], v16 offset:41024
    v_mfma_f32_16x16x32_bf16 v[44:47], v[164:167], a[48:51], v[44:47]
    ds_read_b64_tr_b16 v[114:115], v16 offset:43584
    v_mfma_f32_16x16x32_bf16 v[48:51], v[168:171], a[48:51], v[48:51]
    ds_read_b64_tr_b16 v[116:117], v16 offset:41032
    v_mfma_f32_16x16x32_bf16 v[52:55], v[172:175], a[48:51], v[52:55]
    ds_read_b64_tr_b16 v[118:119], v16 offset:43592
    v_mfma_f32_16x16x32_bf16 v[56:59], v[176:179], a[48:51], v[56:59]
    ds_read_b64_tr_b16 v[120:121], v16 offset:41088
    v_mfma_f32_16x16x32_bf16 v[60:63], v[180:183], a[48:51], v[60:63]
    ds_read_b64_tr_b16 v[122:123], v16 offset:43648
    v_mfma_f32_16x16x32_bf16 v[64:67], v[144:147], a[52:55], v[64:67]
    ds_read_b64_tr_b16 v[124:125], v16 offset:41096
    v_mfma_f32_16x16x32_bf16 v[68:71], v[148:151], a[52:55], v[68:71]
    ds_read_b64_tr_b16 v[126:127], v16 offset:43656
    v_mfma_f32_16x16x32_bf16 v[72:75], v[152:155], a[52:55], v[72:75]
    ds_read_b64_tr_b16 v[128:129], v16 offset:41152
    v_mfma_f32_16x16x32_bf16 v[76:79], v[156:159], a[52:55], v[76:79]
    ds_read_b64_tr_b16 v[130:131], v16 offset:43712
    v_mfma_f32_16x16x32_bf16 v[80:83], v[160:163], a[52:55], v[80:83]
    ds_read_b64_tr_b16 v[132:133], v16 offset:41160
    v_mfma_f32_16x16x32_bf16 v[84:87], v[164:167], a[52:55], v[84:87]
    ds_read_b64_tr_b16 v[134:135], v16 offset:43720
    v_mfma_f32_16x16x32_bf16 v[88:91], v[168:171], a[52:55], v[88:91]
    ds_read_b64_tr_b16 v[136:137], v16 offset:41216
    v_mfma_f32_16x16x32_bf16 v[92:95], v[172:175], a[52:55], v[92:95]
    ds_read_b64_tr_b16 v[138:139], v16 offset:43776
    v_mfma_f32_16x16x32_bf16 v[96:99], v[176:179], a[52:55], v[96:99]
    ds_read_b64_tr_b16 v[140:141], v16 offset:41224
    v_mfma_f32_16x16x32_bf16 v[100:103], v[180:183], a[52:55], v[100:103]
    ds_read_b64_tr_b16 v[142:143], v16 offset:43784
    s_waitcnt vmcnt(6)
    s_waitcnt lgkmcnt(4)
    v_mfma_f32_16x16x32_bf16 v[24:27], v[104:107], a[0:3], v[24:27]
    ds_read_b64_tr_b16 v[144:145], v16 offset:51200
    v_mfma_f32_16x16x32_bf16 v[28:31], v[108:111], a[0:3], v[28:31]
    ds_read_b64_tr_b16 v[146:147], v16 offset:53760
    v_mfma_f32_16x16x32_bf16 v[32:35], v[112:115], a[0:3], v[32:35]
    ds_read_b64_tr_b16 v[148:149], v16 offset:51208
    v_mfma_f32_16x16x32_bf16 v[36:39], v[116:119], a[0:3], v[36:39]
    ds_read_b64_tr_b16 v[150:151], v16 offset:53768
    v_mfma_f32_16x16x32_bf16 v[40:43], v[120:123], a[0:3], v[40:43]
    ds_read_b64_tr_b16 v[152:153], v16 offset:51264
    v_mfma_f32_16x16x32_bf16 v[44:47], v[124:127], a[0:3], v[44:47]
    ds_read_b64_tr_b16 v[154:155], v16 offset:53824
    v_mfma_f32_16x16x32_bf16 v[48:51], v[128:131], a[0:3], v[48:51]
    ds_read_b64_tr_b16 v[156:157], v16 offset:51272
    v_mfma_f32_16x16x32_bf16 v[52:55], v[132:135], a[0:3], v[52:55]
    ds_read_b64_tr_b16 v[158:159], v16 offset:53832
    s_waitcnt lgkmcnt(4)
    v_mfma_f32_16x16x32_bf16 v[56:59], v[136:139], a[0:3], v[56:59]
    ds_read_b64_tr_b16 v[160:161], v16 offset:51328
    v_mfma_f32_16x16x32_bf16 v[60:63], v[140:143], a[0:3], v[60:63]
    ds_read_b64_tr_b16 v[162:163], v16 offset:53888
    v_mfma_f32_16x16x32_bf16 v[64:67], v[104:107], a[4:7], v[64:67]
    ds_read_b64_tr_b16 v[164:165], v16 offset:51336
    v_mfma_f32_16x16x32_bf16 v[68:71], v[108:111], a[4:7], v[68:71]
    ds_read_b64_tr_b16 v[166:167], v16 offset:53896
    v_mfma_f32_16x16x32_bf16 v[72:75], v[112:115], a[4:7], v[72:75]
    ds_read_b64_tr_b16 v[168:169], v16 offset:51392
    v_mfma_f32_16x16x32_bf16 v[76:79], v[116:119], a[4:7], v[76:79]
    ds_read_b64_tr_b16 v[170:171], v16 offset:53952
    v_mfma_f32_16x16x32_bf16 v[80:83], v[120:123], a[4:7], v[80:83]
    ds_read_b64_tr_b16 v[172:173], v16 offset:51400
    v_mfma_f32_16x16x32_bf16 v[84:87], v[124:127], a[4:7], v[84:87]
    ds_read_b64_tr_b16 v[174:175], v16 offset:53960
    v_mfma_f32_16x16x32_bf16 v[88:91], v[128:131], a[4:7], v[88:91]
    ds_read_b64_tr_b16 v[176:177], v16 offset:51456
    v_mfma_f32_16x16x32_bf16 v[92:95], v[132:135], a[4:7], v[92:95]
    ds_read_b64_tr_b16 v[178:179], v16 offset:54016
    v_mfma_f32_16x16x32_bf16 v[96:99], v[136:139], a[4:7], v[96:99]
    ds_read_b64_tr_b16 v[180:181], v16 offset:51464
    v_mfma_f32_16x16x32_bf16 v[100:103], v[140:143], a[4:7], v[100:103]
    ds_read_b64_tr_b16 v[182:183], v16 offset:54024
    s_waitcnt vmcnt(4)
    v_mfma_f32_16x16x32_bf16 v[24:27], v[144:147], a[8:11], v[24:27]
    ds_read_b64_tr_b16 v[104:105], v16 offset:61440
    v_mfma_f32_16x16x32_bf16 v[28:31], v[148:151], a[8:11], v[28:31]
    ds_read_b64_tr_b16 v[106:107], v16 offset:64000
    s_waitcnt lgkmcnt(4)
    v_mfma_f32_16x16x32_bf16 v[32:35], v[152:155], a[8:11], v[32:35]
    ds_read_b64_tr_b16 v[108:109], v16 offset:61448
    v_mfma_f32_16x16x32_bf16 v[36:39], v[156:159], a[8:11], v[36:39]
    ds_read_b64_tr_b16 v[110:111], v16 offset:64008
    v_mfma_f32_16x16x32_bf16 v[40:43], v[160:163], a[8:11], v[40:43]
    ds_read_b64_tr_b16 v[112:113], v16 offset:61504
    v_mfma_f32_16x16x32_bf16 v[44:47], v[164:167], a[8:11], v[44:47]
    ds_read_b64_tr_b16 v[114:115], v16 offset:64064
    v_mfma_f32_16x16x32_bf16 v[48:51], v[168:171], a[8:11], v[48:51]
    ds_read_b64_tr_b16 v[116:117], v16 offset:61512
    v_mfma_f32_16x16x32_bf16 v[52:55], v[172:175], a[8:11], v[52:55]
    ds_read_b64_tr_b16 v[118:119], v16 offset:64072
    v_mfma_f32_16x16x32_bf16 v[56:59], v[176:179], a[8:11], v[56:59]
    ds_read_b64_tr_b16 v[120:121], v16 offset:61568
    s_waitcnt lgkmcnt(4)
    v_mfma_f32_16x16x32_bf16 v[60:63], v[180:183], a[8:11], v[60:63]
    ds_read_b64_tr_b16 v[122:123], v16 offset:64128
    v_mfma_f32_16x16x32_bf16 v[64:67], v[144:147], a[12:15], v[64:67]
    ds_read_b64_tr_b16 v[124:125], v16 offset:61576
    v_mfma_f32_16x16x32_bf16 v[68:71], v[148:151], a[12:15], v[68:71]
    ds_read_b64_tr_b16 v[126:127], v16 offset:64136
    v_mfma_f32_16x16x32_bf16 v[72:75], v[152:155], a[12:15], v[72:75]
    ds_read_b64_tr_b16 v[128:129], v16 offset:61632
    v_mfma_f32_16x16x32_bf16 v[76:79], v[156:159], a[12:15], v[76:79]
    ds_read_b64_tr_b16 v[130:131], v16 offset:64192
    v_mfma_f32_16x16x32_bf16 v[80:83], v[160:163], a[12:15], v[80:83]
    ds_read_b64_tr_b16 v[132:133], v16 offset:61640
    v_mfma_f32_16x16x32_bf16 v[84:87], v[164:167], a[12:15], v[84:87]
    ds_read_b64_tr_b16 v[134:135], v16 offset:64200
    v_mfma_f32_16x16x32_bf16 v[88:91], v[168:171], a[12:15], v[88:91]
    ds_read_b64_tr_b16 v[136:137], v16 offset:61696
    v_mfma_f32_16x16x32_bf16 v[92:95], v[172:175], a[12:15], v[92:95]
    ds_read_b64_tr_b16 v[138:139], v16 offset:64256
    v_mfma_f32_16x16x32_bf16 v[96:99], v[176:179], a[12:15], v[96:99]
    ds_read_b64_tr_b16 v[140:141], v16 offset:61704
    v_mfma_f32_16x16x32_bf16 v[100:103], v[180:183], a[12:15], v[100:103]
    ds_read_b64_tr_b16 v[142:143], v16 offset:64264
    s_waitcnt vmcnt(2)
    v_mfma_f32_16x16x32_bf16 v[24:27], v[104:107], a[16:19], v[24:27]
    ds_read_b64_tr_b16 v[144:145], v17 offset:6144
    v_mfma_f32_16x16x32_bf16 v[28:31], v[108:111], a[16:19], v[28:31]
    ds_read_b64_tr_b16 v[146:147], v17 offset:8704
    s_waitcnt lgkmcnt(4)
    v_mfma_f32_16x16x32_bf16 v[32:35], v[112:115], a[16:19], v[32:35]
    ds_read_b64_tr_b16 v[148:149], v17 offset:6152
    v_mfma_f32_16x16x32_bf16 v[36:39], v[116:119], a[16:19], v[36:39]
    ds_read_b64_tr_b16 v[150:151], v17 offset:8712
    v_mfma_f32_16x16x32_bf16 v[40:43], v[120:123], a[16:19], v[40:43]
    ds_read_b64_tr_b16 v[152:153], v17 offset:6208
    v_mfma_f32_16x16x32_bf16 v[44:47], v[124:127], a[16:19], v[44:47]
    ds_read_b64_tr_b16 v[154:155], v17 offset:8768
    v_mfma_f32_16x16x32_bf16 v[48:51], v[128:131], a[16:19], v[48:51]
    ds_read_b64_tr_b16 v[156:157], v17 offset:6216
    v_mfma_f32_16x16x32_bf16 v[52:55], v[132:135], a[16:19], v[52:55]
    ds_read_b64_tr_b16 v[158:159], v17 offset:8776
    v_mfma_f32_16x16x32_bf16 v[56:59], v[136:139], a[16:19], v[56:59]
    ds_read_b64_tr_b16 v[160:161], v17 offset:6272
    s_waitcnt lgkmcnt(4)
    v_mfma_f32_16x16x32_bf16 v[60:63], v[140:143], a[16:19], v[60:63]
    ds_read_b64_tr_b16 v[162:163], v17 offset:8832
    v_mfma_f32_16x16x32_bf16 v[64:67], v[104:107], a[20:23], v[64:67]
    ds_read_b64_tr_b16 v[164:165], v17 offset:6280
    v_mfma_f32_16x16x32_bf16 v[68:71], v[108:111], a[20:23], v[68:71]
    ds_read_b64_tr_b16 v[166:167], v17 offset:8840
    v_mfma_f32_16x16x32_bf16 v[72:75], v[112:115], a[20:23], v[72:75]
    ds_read_b64_tr_b16 v[168:169], v17 offset:6336
    v_mfma_f32_16x16x32_bf16 v[76:79], v[116:119], a[20:23], v[76:79]
    ds_read_b64_tr_b16 v[170:171], v17 offset:8896
    v_mfma_f32_16x16x32_bf16 v[80:83], v[120:123], a[20:23], v[80:83]
    ds_read_b64_tr_b16 v[172:173], v17 offset:6344
    v_mfma_f32_16x16x32_bf16 v[84:87], v[124:127], a[20:23], v[84:87]
    ds_read_b64_tr_b16 v[174:175], v17 offset:8904
    v_mfma_f32_16x16x32_bf16 v[88:91], v[128:131], a[20:23], v[88:91]
    ds_read_b64_tr_b16 v[176:177], v17 offset:6400
    v_mfma_f32_16x16x32_bf16 v[92:95], v[132:135], a[20:23], v[92:95]
    ds_read_b64_tr_b16 v[178:179], v17 offset:8960
    v_mfma_f32_16x16x32_bf16 v[96:99], v[136:139], a[20:23], v[96:99]
    ds_read_b64_tr_b16 v[180:181], v17 offset:6408
    v_mfma_f32_16x16x32_bf16 v[100:103], v[140:143], a[20:23], v[100:103]
    ds_read_b64_tr_b16 v[182:183], v17 offset:8968
    s_waitcnt vmcnt(0)
    v_mfma_f32_16x16x32_bf16 v[24:27], v[144:147], a[24:27], v[24:27]
    v_mfma_f32_16x16x32_bf16 v[28:31], v[148:151], a[24:27], v[28:31]
    s_waitcnt lgkmcnt(2)
    v_mfma_f32_16x16x32_bf16 v[32:35], v[152:155], a[24:27], v[32:35]
    v_mfma_f32_16x16x32_bf16 v[36:39], v[156:159], a[24:27], v[36:39]
    v_mfma_f32_16x16x32_bf16 v[40:43], v[160:163], a[24:27], v[40:43]
    v_mfma_f32_16x16x32_bf16 v[44:47], v[164:167], a[24:27], v[44:47]
    v_mfma_f32_16x16x32_bf16 v[48:51], v[168:171], a[24:27], v[48:51]
    v_mfma_f32_16x16x32_bf16 v[52:55], v[172:175], a[24:27], v[52:55]
    v_mfma_f32_16x16x32_bf16 v[56:59], v[176:179], a[24:27], v[56:59]
    s_waitcnt lgkmcnt(0)
    v_mfma_f32_16x16x32_bf16 v[60:63], v[180:183], a[24:27], v[60:63]
    v_mfma_f32_16x16x32_bf16 v[64:67], v[144:147], a[28:31], v[64:67]
    v_mfma_f32_16x16x32_bf16 v[68:71], v[148:151], a[28:31], v[68:71]
    v_mfma_f32_16x16x32_bf16 v[72:75], v[152:155], a[28:31], v[72:75]
    v_mfma_f32_16x16x32_bf16 v[76:79], v[156:159], a[28:31], v[76:79]
    v_mfma_f32_16x16x32_bf16 v[80:83], v[160:163], a[28:31], v[80:83]
    v_mfma_f32_16x16x32_bf16 v[84:87], v[164:167], a[28:31], v[84:87]
    v_mfma_f32_16x16x32_bf16 v[88:91], v[168:171], a[28:31], v[88:91]
    v_mfma_f32_16x16x32_bf16 v[92:95], v[172:175], a[28:31], v[92:95]
    v_mfma_f32_16x16x32_bf16 v[96:99], v[176:179], a[28:31], v[96:99]
    v_mfma_f32_16x16x32_bf16 v[100:103], v[180:183], a[28:31], v[100:103]
    s_lshl_b32 s49, s42, 2
    s_add_u32 s49, s49, s43
    s_mov_b32 s51, s49
    s_lshl_b32 s49, s49, 4
    s_lshl_b32 s44, s40, 2
    s_add_u32 s44, s44, s41
    s_add_u32 s44, s44, s49
    s_mul_i32 s45, s44, 10240
    v_cvt_pk_bf16_f32 v104, v24, v25
    v_cvt_pk_bf16_f32 v105, v26, v27
    v_cvt_pk_bf16_f32 v106, v28, v29
    v_cvt_pk_bf16_f32 v107, v30, v31
    s_add_u32 s44, s45, 0
    buffer_store_dwordx4 v[104:107], v4, s[24:27], s44 offen sc1
    v_cvt_pk_bf16_f32 v108, v32, v33
    v_cvt_pk_bf16_f32 v109, v34, v35
    v_cvt_pk_bf16_f32 v110, v36, v37
    v_cvt_pk_bf16_f32 v111, v38, v39
    s_add_u32 s44, s45, 1024
    buffer_store_dwordx4 v[108:111], v4, s[24:27], s44 offen sc1
    v_cvt_pk_bf16_f32 v112, v40, v41
    v_cvt_pk_bf16_f32 v113, v42, v43
    v_cvt_pk_bf16_f32 v114, v44, v45
    v_cvt_pk_bf16_f32 v115, v46, v47
    s_add_u32 s44, s45, 2048
    buffer_store_dwordx4 v[112:115], v4, s[24:27], s44 offen sc1
    v_cvt_pk_bf16_f32 v116, v48, v49
    v_cvt_pk_bf16_f32 v117, v50, v51
    v_cvt_pk_bf16_f32 v118, v52, v53
    v_cvt_pk_bf16_f32 v119, v54, v55
    s_add_u32 s44, s45, 3072
    buffer_store_dwordx4 v[116:119], v4, s[24:27], s44 offen sc1
    v_cvt_pk_bf16_f32 v104, v56, v57
    v_cvt_pk_bf16_f32 v105, v58, v59
    v_cvt_pk_bf16_f32 v106, v60, v61
    v_cvt_pk_bf16_f32 v107, v62, v63
    s_add_u32 s44, s45, 4096
    buffer_store_dwordx4 v[104:107], v4, s[24:27], s44 offen sc1
    v_cvt_pk_bf16_f32 v108, v64, v65
    v_cvt_pk_bf16_f32 v109, v66, v67
    v_cvt_pk_bf16_f32 v110, v68, v69
    v_cvt_pk_bf16_f32 v111, v70, v71
    s_add_u32 s44, s45, 5120
    buffer_store_dwordx4 v[108:111], v4, s[24:27], s44 offen sc1
    v_cvt_pk_bf16_f32 v112, v72, v73
    v_cvt_pk_bf16_f32 v113, v74, v75
    v_cvt_pk_bf16_f32 v114, v76, v77
    v_cvt_pk_bf16_f32 v115, v78, v79
    s_add_u32 s44, s45, 6144
    buffer_store_dwordx4 v[112:115], v4, s[24:27], s44 offen sc1
    v_cvt_pk_bf16_f32 v116, v80, v81
    v_cvt_pk_bf16_f32 v117, v82, v83
    v_cvt_pk_bf16_f32 v118, v84, v85
    v_cvt_pk_bf16_f32 v119, v86, v87
    s_add_u32 s44, s45, 7168
    buffer_store_dwordx4 v[116:119], v4, s[24:27], s44 offen sc1
    v_cvt_pk_bf16_f32 v104, v88, v89
    v_cvt_pk_bf16_f32 v105, v90, v91
    v_cvt_pk_bf16_f32 v106, v92, v93
    v_cvt_pk_bf16_f32 v107, v94, v95
    s_add_u32 s44, s45, 8192
    buffer_store_dwordx4 v[104:107], v4, s[24:27], s44 offen sc1
    v_cvt_pk_bf16_f32 v108, v96, v97
    v_cvt_pk_bf16_f32 v109, v98, v99
    v_cvt_pk_bf16_f32 v110, v100, v101
    v_cvt_pk_bf16_f32 v111, v102, v103
    s_add_u32 s44, s45, 9216
    buffer_store_dwordx4 v[108:111], v4, s[24:27], s44 offen sc1
    s_load_dwordx2 s[4:5], s[0:1], 56
    s_load_dwordx2 s[6:7], s[0:1], 88
    s_load_dwordx4 s[8:11], s[0:1], 64
    s_load_dwordx2 s[12:13], s[0:1], 80
    s_load_dwordx2 s[62:63], s[0:1], 0
    s_add_u32 s56, s14, 68288512
    s_addc_u32 s57, s15, 0
    s_mov_b32 s58, 38912
    s_mov_b32 s59, 0x20000
    s_add_u32 s32, s14, 79691776
    s_addc_u32 s33, s15, 0
    s_mov_b32 s34, 10485760
    s_mov_b32 s35, 0x20000
    v_mov_b32 v3, s100
    v_mov_b32 v5, 0x100000
    v_mov_b32 v6, 0
    v_cmp_eq_u32 vcc, 0, v0
    s_nop 1
    v_cndmask_b32 v4, v5, v6, vcc
    s_lshr_b32 s44, s2, 5
    s_sub_u32 s44, 7, s44
    s_lshl_b32 s101, s44, 5
    s_and_b32 s44, s2, 1
    s_lshl_b32 s44, s44, 4
    s_add_u32 s101, s101, s44
    s_lshl_b32 s44, s41, 2
    s_add_u32 s101, s101, s44
    s_add_u32 s101, s101, s43
    s_lshl_b32 s51, s42, 4
    s_lshl_b32 s44, s41, 2
    s_add_u32 s51, s51, s44
    s_add_u32 s51, s51, s43
    s_waitcnt lgkmcnt(0)
    s_mov_b32 s36, s62
    s_mov_b32 s37, s63
    s_mov_b32 s38, 2621440
    s_mov_b32 s39, 0x20000
    s_mov_b32 s24, s4
    s_mov_b32 s25, s5
    s_mov_b32 s26, 1280
    s_mov_b32 s27, 0x20000
    s_mov_b32 s20, s6
    s_mov_b32 s21, s7
    s_mov_b32 s22, 2621440
    s_mov_b32 s23, 0x20000
    s_add_u32 s16, s14, 62914560
    s_addc_u32 s17, s15, 0
    s_mov_b32 s18, 2621440
    s_mov_b32 s19, 0x20000
    s_add_u32 s28, s14, 68354048
    s_addc_u32 s29, s15, 0
    s_mov_b32 s30, 32768
    s_mov_b32 s31, 0x20000
    s_mov_b32 s46, 0x3727c5ac
    v_and_b32 v5, 7, v2
    s_lshl_b32 s44, s51, 3
    v_add_u32 v9, s44, v5
    v_bfe_u32 v6, v2, 3, 2
    v_lshrrev_b32 v7, 5, v2
    v_lshlrev_b32 v11, 4, v6
    v_lshl_add_u32 v11, v7, 6, v11
    s_mul_i32 s44, s40, 320
    v_add_u32 v11, s44, v11
    v_mul_u32_u24 v10, 1280, v9
    v_add_u32 v10, v10, v11
    v_lshlrev_b32 v12, 10, v7
    v_lshl_add_u32 v12, v6, 8, v12
    s_and_b32 s44, s51, 1
    s_lshl_b32 s44, s44, 3
    v_add_u32 v5, s44, v5
    v_lshl_add_u32 v12, v5, 4, v12
    v_mov_b32 v8, 0x4000000
    v_cmp_gt_u32 vcc, 32, v2
    s_nop 1
    v_cndmask_b32 v13, v8, v10, vcc
    v_cndmask_b32 v14, v8, v11, vcc
    v_cndmask_b32 v15, v8, v12, vcc
    v_cndmask_b32 v16, 0, 1.0, vcc
    buffer_load_dwordx4 v[100:103], v10, s[36:39], 0 offen offset:0
    buffer_load_dwordx4 v[112:115], v11, s[24:27], 0 offen offset:0
    buffer_load_dwordx4 v[104:107], v10, s[36:39], 0 offen offset:128
    buffer_load_dwordx4 v[116:119], v11, s[24:27], 0 offen offset:128
    buffer_load_dwordx4 v[108:111], v13, s[36:39], 0 offen offset:256
    buffer_load_dwordx4 v[120:123], v14, s[24:27], 0 offen offset:256
    s_add_u32 s44, s42, 224
    s_lshl_b32 s44, s44, 7
    s_lshl_b32 s45, s43, 2
    s_add_u32 s45, s45, s41
    s_lshl_b32 s45, s45, 2
    s_add_u32 s45, s45, s44
    v_mov_b32 v5, 162560
    s_cmp_lg_u32 s40, 0
    s_cbranch_scc1 Lt_nn
    ds_write_b32 v5, v3
Lt_nn:
    s_waitcnt vmcnt(6) lgkmcnt(0)
    s_barrier
    ds_read_b32 v3, v5
    s_waitcnt lgkmcnt(0)
    buffer_store_dword v3, v4, s[56:59], s45 offen sc1
    s_add_u32 s44, s42, 224
    s_lshl_b32 s44, s44, 7
    v_lshlrev_b32 v5, 2, v2
    v_mov_b32 v6, 0x100000
    v_cmp_gt_u32 vcc, 16, v0
    s_nop 1
    v_cndmask_b32 v5, v6, v5, vcc
    s_cmp_lg_u32 s40, 0
    s_cbranch_scc1 Lt_h_ok
    s_mov_b32 s47, 2097152
Lt_h_spin:
    buffer_load_dword v20, v5, s[56:59], s44 offen sc1
    s_waitcnt vmcnt(0)
    v_cmp_eq_u32 vcc, v3, v20
    s_sub_u32 s47, s47, 1
    s_cbranch_scc1 Lt_h_ok
    s_and_b32 s48, vcc_lo, 0xffff
    s_and_b32 s49, vcc_hi, 0x0
    s_cmp_eq_u32 s48, 0xffff
    s_cbranch_scc0 Lt_h_spin
    s_cmp_eq_u32 s49, 0x0
    s_cbranch_scc0 Lt_h_spin
Lt_h_ok:
    s_barrier
    s_lshl_b32 s44, s42, 2
    s_add_u32 s44, s44, s40
    s_lshl_b32 s44, s44, 4
    s_lshr_b32 s45, s51, 2
    s_and_b32 s45, s45, 3
    s_lshl_b32 s45, s45, 2
    s_add_u32 s44, s44, s45
    s_mul_i32 s44, s44, 10240
    s_lshr_b32 s45, s51, 1
    s_and_b32 s45, s45, 1
    s_mul_i32 s45, s45, 5120
    s_add_u32 s44, s44, s45
    s_add_u32 s45, s44, 0
    buffer_load_dwordx4 v[24:27], v12, s[32:35], s45 offen
    s_add_u32 s45, s44, 2048
    buffer_load_dwordx4 v[28:31], v12, s[32:35], s45 offen
    s_add_u32 s45, s44, 4096
    buffer_load_dwordx4 v[32:35], v15, s[32:35], s45 offen
    s_add_u32 s45, s44, 10240
    buffer_load_dwordx4 v[36:39], v12, s[32:35], s45 offen
    s_add_u32 s45, s44, 12288
    buffer_load_dwordx4 v[40:43], v12, s[32:35], s45 offen
    s_add_u32 s45, s44, 14336
    buffer_load_dwordx4 v[44:47], v15, s[32:35], s45 offen
    s_add_u32 s45, s44, 20480
    buffer_load_dwordx4 v[48:51], v12, s[32:35], s45 offen
    s_add_u32 s45, s44, 22528
    buffer_load_dwordx4 v[52:55], v12, s[32:35], s45 offen
    s_add_u32 s45, s44, 24576
    buffer_load_dwordx4 v[56:59], v15, s[32:35], s45 offen
    s_add_u32 s45, s44, 30720
    buffer_load_dwordx4 v[60:63], v12, s[32:35], s45 offen
    s_add_u32 s45, s44, 32768
    buffer_load_dwordx4 v[64:67], v12, s[32:35], s45 offen
    s_add_u32 s45, s44, 34816
    buffer_load_dwordx4 v[68:71], v15, s[32:35], s45 offen
    v_lshrrev_b32 v7, 2, v2
    v_mul_u32_u24 v23, 3456, v7
    v_and_b32 v7, 3, v2
    v_lshl_add_u32 v23, v7, 4, v23
    v_lshlrev_b32 v7, 4, v2
    s_cmp_eq_u32 s40, 3
    s_cselect_b64 vcc, -1, 0
    v_cndmask_b32 v23, v23, v7, vcc
    s_cmp_eq_u32 s40, 1
    s_cselect_b32 s64, s8, s10
    s_cselect_b32 s65, s9, s11
    s_cmp_eq_u32 s40, 3
    s_cselect_b32 s64, s12, s64
    s_cselect_b32 s65, s13, s65
    s_movk_i32 s53, 1024
    s_cselect_b32 s53, s53, 55296
    s_lshl_b32 s52, s101, 6
    s_mul_i32 s54, s101, 40960
    s_cmp_eq_u32 s40, 3
    s_cselect_b32 s52, s54, s52
    s_mov_b32 s66, 2211840
    s_mov_b32 s67, 0x20000
    s_cmp_ge_u32 s101, 54
    s_cselect_b32 s66, 0, s66
    s_cmp_eq_u32 s40, 0
    s_cselect_b32 s66, 0, s66
    s_cselect_b32 s54, 0, 1024
    s_sub_u32 s45, s40, 1
    s_mul_i32 s45, s45, 40960
    s_cmp_eq_u32 s40, 0
    s_cselect_b32 s45, 122880, s45
    s_mov_b32 m0, s45
    s_waitcnt vmcnt(0)
    v_lshlrev_b32 v124, 16, v24
    v_and_b32 v125, 0xffff0000, v24
    v_lshlrev_b32 v17, 16, v36
    v_and_b32 v18, 0xffff0000, v36
    v_add_f32 v124, v124, v17
    v_add_f32 v125, v125, v18
    v_lshlrev_b32 v17, 16, v48
    v_and_b32 v18, 0xffff0000, v48
    v_add_f32 v124, v124, v17
    v_add_f32 v125, v125, v18
    v_lshlrev_b32 v17, 16, v60
    v_and_b32 v18, 0xffff0000, v60
    buffer_load_dwordx4 v23, s[64:67], s52 offen lds
    s_add_u32 m0, m0, s54
    s_add_u32 s52, s52, s53
    v_add_f32 v124, v124, v17
    v_add_f32 v125, v125, v18
    v_cvt_pk_bf16_f32 v17, v124, v125
    v_lshlrev_b32 v124, 16, v17
    v_and_b32 v125, 0xffff0000, v17
    v_lshlrev_b32 v17, 16, v100
    v_and_b32 v18, 0xffff0000, v100
    v_add_f32 v124, v124, v17
    v_add_f32 v125, v125, v18
    v_cvt_pk_bf16_f32 v72, v124, v125
    v_lshlrev_b32 v148, 16, v72
    v_and_b32 v149, 0xffff0000, v72
    buffer_load_dwordx4 v23, s[64:67], s52 offen lds
    s_add_u32 m0, m0, s54
    s_add_u32 s52, s52, s53
    v_lshlrev_b32 v126, 16, v25
    v_and_b32 v127, 0xffff0000, v25
    v_lshlrev_b32 v17, 16, v37
    v_and_b32 v18, 0xffff0000, v37
    v_add_f32 v126, v126, v17
    v_add_f32 v127, v127, v18
    v_lshlrev_b32 v17, 16, v49
    v_and_b32 v18, 0xffff0000, v49
    v_add_f32 v126, v126, v17
    v_add_f32 v127, v127, v18
    v_lshlrev_b32 v17, 16, v61
    v_and_b32 v18, 0xffff0000, v61
    buffer_load_dwordx4 v23, s[64:67], s52 offen lds
    s_add_u32 m0, m0, s54
    s_add_u32 s52, s52, s53
    v_add_f32 v126, v126, v17
    v_add_f32 v127, v127, v18
    v_cvt_pk_bf16_f32 v17, v126, v127
    v_lshlrev_b32 v126, 16, v17
    v_and_b32 v127, 0xffff0000, v17
    v_lshlrev_b32 v17, 16, v101
    v_and_b32 v18, 0xffff0000, v101
    v_add_f32 v126, v126, v17
    v_add_f32 v127, v127, v18
    v_cvt_pk_bf16_f32 v73, v126, v127
    v_lshlrev_b32 v150, 16, v73
    v_and_b32 v151, 0xffff0000, v73
    buffer_load_dwordx4 v23, s[64:67], s52 offen lds
    s_add_u32 m0, m0, s54
    s_add_u32 s52, s52, s53
    v_lshlrev_b32 v128, 16, v26
    v_and_b32 v129, 0xffff0000, v26
    v_lshlrev_b32 v17, 16, v38
    v_and_b32 v18, 0xffff0000, v38
    v_add_f32 v128, v128, v17
    v_add_f32 v129, v129, v18
    v_lshlrev_b32 v17, 16, v50
    v_and_b32 v18, 0xffff0000, v50
    v_add_f32 v128, v128, v17
    v_add_f32 v129, v129, v18
    v_lshlrev_b32 v17, 16, v62
    v_and_b32 v18, 0xffff0000, v62
    buffer_load_dwordx4 v23, s[64:67], s52 offen lds
    s_add_u32 m0, m0, s54
    s_add_u32 s52, s52, s53
    v_add_f32 v128, v128, v17
    v_add_f32 v129, v129, v18
    v_cvt_pk_bf16_f32 v17, v128, v129
    v_lshlrev_b32 v128, 16, v17
    v_and_b32 v129, 0xffff0000, v17
    v_lshlrev_b32 v17, 16, v102
    v_and_b32 v18, 0xffff0000, v102
    v_add_f32 v128, v128, v17
    v_add_f32 v129, v129, v18
    v_cvt_pk_bf16_f32 v74, v128, v129
    v_lshlrev_b32 v152, 16, v74
    v_and_b32 v153, 0xffff0000, v74
    buffer_load_dwordx4 v23, s[64:67], s52 offen lds
    s_add_u32 m0, m0, s54
    s_add_u32 s52, s52, s53
    v_lshlrev_b32 v130, 16, v27
    v_and_b32 v131, 0xffff0000, v27
    v_lshlrev_b32 v17, 16, v39
    v_and_b32 v18, 0xffff0000, v39
    v_add_f32 v130, v130, v17
    v_add_f32 v131, v131, v18
    v_lshlrev_b32 v17, 16, v51
    v_and_b32 v18, 0xffff0000, v51
    v_add_f32 v130, v130, v17
    v_add_f32 v131, v131, v18
    v_lshlrev_b32 v17, 16, v63
    v_and_b32 v18, 0xffff0000, v63
    buffer_load_dwordx4 v23, s[64:67], s52 offen lds
    s_add_u32 m0, m0, s54
    s_add_u32 s52, s52, s53
    v_add_f32 v130, v130, v17
    v_add_f32 v131, v131, v18
    v_cvt_pk_bf16_f32 v17, v130, v131
    v_lshlrev_b32 v130, 16, v17
    v_and_b32 v131, 0xffff0000, v17
    v_lshlrev_b32 v17, 16, v103
    v_and_b32 v18, 0xffff0000, v103
    v_add_f32 v130, v130, v17
    v_add_f32 v131, v131, v18
    v_cvt_pk_bf16_f32 v75, v130, v131
    v_lshlrev_b32 v154, 16, v75
    v_and_b32 v155, 0xffff0000, v75
    buffer_load_dwordx4 v23, s[64:67], s52 offen lds
    s_add_u32 m0, m0, s54
    s_add_u32 s52, s52, s53
    buffer_store_dwordx4 v[72:75], v10, s[16:19], 0 offen offset:0 sc1
    v_lshlrev_b32 v132, 16, v28
    v_and_b32 v133, 0xffff0000, v28
    v_lshlrev_b32 v17, 16, v40
    v_and_b32 v18, 0xffff0000, v40
    v_add_f32 v132, v132, v17
    v_add_f32 v133, v133, v18
    v_lshlrev_b32 v17, 16, v52
    v_and_b32 v18, 0xffff0000, v52
    v_add_f32 v132, v132, v17
    v_add_f32 v133, v133, v18
    v_lshlrev_b32 v17, 16, v64
    v_and_b32 v18, 0xffff0000, v64
    buffer_load_dwordx4 v23, s[64:67], s52 offen lds
    s_add_u32 m0, m0, s54
    s_add_u32 s52, s52, s53
    v_add_f32 v132, v132, v17
    v_add_f32 v133, v133, v18
    v_cvt_pk_bf16_f32 v17, v132, v133
    v_lshlrev_b32 v132, 16, v17
    v_and_b32 v133, 0xffff0000, v17
    v_lshlrev_b32 v17, 16, v104
    v_and_b32 v18, 0xffff0000, v104
    v_add_f32 v132, v132, v17
    v_add_f32 v133, v133, v18
    v_cvt_pk_bf16_f32 v76, v132, v133
    v_lshlrev_b32 v156, 16, v76
    v_and_b32 v157, 0xffff0000, v76
    buffer_load_dwordx4 v23, s[64:67], s52 offen lds
    s_add_u32 m0, m0, s54
    s_add_u32 s52, s52, s53
    v_lshlrev_b32 v134, 16, v29
    v_and_b32 v135, 0xffff0000, v29
    v_lshlrev_b32 v17, 16, v41
    v_and_b32 v18, 0xffff0000, v41
    v_add_f32 v134, v134, v17
    v_add_f32 v135, v135, v18
    v_lshlrev_b32 v17, 16, v53
    v_and_b32 v18, 0xffff0000, v53
    v_add_f32 v134, v134, v17
    v_add_f32 v135, v135, v18
    v_lshlrev_b32 v17, 16, v65
    v_and_b32 v18, 0xffff0000, v65
    buffer_load_dwordx4 v23, s[64:67], s52 offen lds
    s_add_u32 m0, m0, s54
    s_add_u32 s52, s52, s53
    v_add_f32 v134, v134, v17
    v_add_f32 v135, v135, v18
    v_cvt_pk_bf16_f32 v17, v134, v135
    v_lshlrev_b32 v134, 16, v17
    v_and_b32 v135, 0xffff0000, v17
    v_lshlrev_b32 v17, 16, v105
    v_and_b32 v18, 0xffff0000, v105
    v_add_f32 v134, v134, v17
    v_add_f32 v135, v135, v18
    v_cvt_pk_bf16_f32 v77, v134, v135
    v_lshlrev_b32 v158, 16, v77
    v_and_b32 v159, 0xffff0000, v77
    buffer_load_dwordx4 v23, s[64:67], s52 offen lds
    s_add_u32 m0, m0, s54
    s_add_u32 s52, s52, s53
    v_lshlrev_b32 v136, 16, v30
    v_and_b32 v137, 0xffff0000, v30
    v_lshlrev_b32 v17, 16, v42
    v_and_b32 v18, 0xffff0000, v42
    v_add_f32 v136, v136, v17
    v_add_f32 v137, v137, v18
    v_lshlrev_b32 v17, 16, v54
    v_and_b32 v18, 0xffff0000, v54
    v_add_f32 v136, v136, v17
    v_add_f32 v137, v137, v18
    v_lshlrev_b32 v17, 16, v66
    v_and_b32 v18, 0xffff0000, v66
    buffer_load_dwordx4 v23, s[64:67], s52 offen lds
    s_add_u32 m0, m0, s54
    s_add_u32 s52, s52, s53
    v_add_f32 v136, v136, v17
    v_add_f32 v137, v137, v18
    v_cvt_pk_bf16_f32 v17, v136, v137
    v_lshlrev_b32 v136, 16, v17
    v_and_b32 v137, 0xffff0000, v17
    v_lshlrev_b32 v17, 16, v106
    v_and_b32 v18, 0xffff0000, v106
    v_add_f32 v136, v136, v17
    v_add_f32 v137, v137, v18
    v_cvt_pk_bf16_f32 v78, v136, v137
    v_lshlrev_b32 v160, 16, v78
    v_and_b32 v161, 0xffff0000, v78
    buffer_load_dwordx4 v23, s[64:67], s52 offen lds
    s_add_u32 m0, m0, s54
    s_add_u32 s52, s52, s53
    v_lshlrev_b32 v138, 16, v31
    v_and_b32 v139, 0xffff0000, v31
    v_lshlrev_b32 v17, 16, v43
    v_and_b32 v18, 0xffff0000, v43
    v_add_f32 v138, v138, v17
    v_add_f32 v139, v139, v18
    v_lshlrev_b32 v17, 16, v55
    v_and_b32 v18, 0xffff0000, v55
    v_add_f32 v138, v138, v17
    v_add_f32 v139, v139, v18
    v_lshlrev_b32 v17, 16, v67
    v_and_b32 v18, 0xffff0000, v67
    buffer_load_dwordx4 v23, s[64:67], s52 offen lds
    s_add_u32 m0, m0, s54
    s_add_u32 s52, s52, s53
    v_add_f32 v138, v138, v17
    v_add_f32 v139, v139, v18
    v_cvt_pk_bf16_f32 v17, v138, v139
    v_lshlrev_b32 v138, 16, v17
    v_and_b32 v139, 0xffff0000, v17
    v_lshlrev_b32 v17, 16, v107
    v_and_b32 v18, 0xffff0000, v107
    v_add_f32 v138, v138, v17
    v_add_f32 v139, v139, v18
    v_cvt_pk_bf16_f32 v79, v138, v139
    v_lshlrev_b32 v162, 16, v79
    v_and_b32 v163, 0xffff0000, v79
    buffer_load_dwordx4 v23, s[64:67], s52 offen lds
    s_add_u32 m0, m0, s54
    s_add_u32 s52, s52, s53
    buffer_store_dwordx4 v[76:79], v10, s[16:19], 0 offen offset:128 sc1
    v_lshlrev_b32 v140, 16, v32
    v_and_b32 v141, 0xffff0000, v32
    v_lshlrev_b32 v17, 16, v44
    v_and_b32 v18, 0xffff0000, v44
    v_add_f32 v140, v140, v17
    v_add_f32 v141, v141, v18
    v_lshlrev_b32 v17, 16, v56
    v_and_b32 v18, 0xffff0000, v56
    v_add_f32 v140, v140, v17
    v_add_f32 v141, v141, v18
    v_lshlrev_b32 v17, 16, v68
    v_and_b32 v18, 0xffff0000, v68
    buffer_load_dwordx4 v23, s[64:67], s52 offen lds
    s_add_u32 m0, m0, s54
    s_add_u32 s52, s52, s53
    v_add_f32 v140, v140, v17
    v_add_f32 v141, v141, v18
    v_cvt_pk_bf16_f32 v17, v140, v141
    v_lshlrev_b32 v140, 16, v17
    v_and_b32 v141, 0xffff0000, v17
    v_lshlrev_b32 v17, 16, v108
    v_and_b32 v18, 0xffff0000, v108
    v_add_f32 v140, v140, v17
    v_add_f32 v141, v141, v18
    v_cvt_pk_bf16_f32 v80, v140, v141
    v_lshlrev_b32 v164, 16, v80
    v_and_b32 v165, 0xffff0000, v80
    buffer_load_dwordx4 v23, s[64:67], s52 offen lds
    s_add_u32 m0, m0, s54
    s_add_u32 s52, s52, s53
    v_lshlrev_b32 v142, 16, v33
    v_and_b32 v143, 0xffff0000, v33
    v_lshlrev_b32 v17, 16, v45
    v_and_b32 v18, 0xffff0000, v45
    v_add_f32 v142, v142, v17
    v_add_f32 v143, v143, v18
    v_lshlrev_b32 v17, 16, v57
    v_and_b32 v18, 0xffff0000, v57
    v_add_f32 v142, v142, v17
    v_add_f32 v143, v143, v18
    v_lshlrev_b32 v17, 16, v69
    v_and_b32 v18, 0xffff0000, v69
    buffer_load_dwordx4 v23, s[64:67], s52 offen lds
    s_add_u32 m0, m0, s54
    s_add_u32 s52, s52, s53
    v_add_f32 v142, v142, v17
    v_add_f32 v143, v143, v18
    v_cvt_pk_bf16_f32 v17, v142, v143
    v_lshlrev_b32 v142, 16, v17
    v_and_b32 v143, 0xffff0000, v17
    v_lshlrev_b32 v17, 16, v109
    v_and_b32 v18, 0xffff0000, v109
    v_add_f32 v142, v142, v17
    v_add_f32 v143, v143, v18
    v_cvt_pk_bf16_f32 v81, v142, v143
    v_lshlrev_b32 v166, 16, v81
    v_and_b32 v167, 0xffff0000, v81
    buffer_load_dwordx4 v23, s[64:67], s52 offen lds
    s_add_u32 m0, m0, s54
    s_add_u32 s52, s52, s53
    v_lshlrev_b32 v144, 16, v34
    v_and_b32 v145, 0xffff0000, v34
    v_lshlrev_b32 v17, 16, v46
    v_and_b32 v18, 0xffff0000, v46
    v_add_f32 v144, v144, v17
    v_add_f32 v145, v145, v18
    v_lshlrev_b32 v17, 16, v58
    v_and_b32 v18, 0xffff0000, v58
    v_add_f32 v144, v144, v17
    v_add_f32 v145, v145, v18
    v_lshlrev_b32 v17, 16, v70
    v_and_b32 v18, 0xffff0000, v70
    buffer_load_dwordx4 v23, s[64:67], s52 offen lds
    s_add_u32 m0, m0, s54
    s_add_u32 s52, s52, s53
    v_add_f32 v144, v144, v17
    v_add_f32 v145, v145, v18
    v_cvt_pk_bf16_f32 v17, v144, v145
    v_lshlrev_b32 v144, 16, v17
    v_and_b32 v145, 0xffff0000, v17
    v_lshlrev_b32 v17, 16, v110
    v_and_b32 v18, 0xffff0000, v110
    v_add_f32 v144, v144, v17
    v_add_f32 v145, v145, v18
    v_cvt_pk_bf16_f32 v82, v144, v145
    v_lshlrev_b32 v168, 16, v82
    v_and_b32 v169, 0xffff0000, v82
    buffer_load_dwordx4 v23, s[64:67], s52 offen lds
    s_add_u32 m0, m0, s54
    s_add_u32 s52, s52, s53
    v_lshlrev_b32 v146, 16, v35
    v_and_b32 v147, 0xffff0000, v35
    v_lshlrev_b32 v17, 16, v47
    v_and_b32 v18, 0xffff0000, v47
    v_add_f32 v146, v146, v17
    v_add_f32 v147, v147, v18
    v_lshlrev_b32 v17, 16, v59
    v_and_b32 v18, 0xffff0000, v59
    v_add_f32 v146, v146, v17
    v_add_f32 v147, v147, v18
    v_lshlrev_b32 v17, 16, v71
    v_and_b32 v18, 0xffff0000, v71
    buffer_load_dwordx4 v23, s[64:67], s52 offen lds
    s_add_u32 m0, m0, s54
    s_add_u32 s52, s52, s53
    v_add_f32 v146, v146, v17
    v_add_f32 v147, v147, v18
    v_cvt_pk_bf16_f32 v17, v146, v147
    v_lshlrev_b32 v146, 16, v17
    v_and_b32 v147, 0xffff0000, v17
    v_lshlrev_b32 v17, 16, v111
    v_and_b32 v18, 0xffff0000, v111
    v_add_f32 v146, v146, v17
    v_add_f32 v147, v147, v18
    v_cvt_pk_bf16_f32 v83, v146, v147
    v_lshlrev_b32 v170, 16, v83
    v_and_b32 v171, 0xffff0000, v83
    buffer_load_dwordx4 v23, s[64:67], s52 offen lds
    s_add_u32 m0, m0, s54
    s_add_u32 s52, s52, s53
    buffer_store_dwordx4 v[80:83], v13, s[16:19], 0 offen offset:256 sc1
    v_add_f32 v20, v148, v149
    v_add_f32 v21, v150, v151
    v_add_f32 v20, v20, v152
    v_add_f32 v21, v21, v153
    v_add_f32 v20, v20, v154
    v_add_f32 v21, v21, v155
    v_add_f32 v20, v20, v156
    v_add_f32 v21, v21, v157
    v_add_f32 v20, v20, v158
    v_add_f32 v21, v21, v159
    v_add_f32 v20, v20, v160
    v_add_f32 v21, v21, v161
    buffer_load_dwordx4 v23, s[64:67], s52 offen lds
    s_add_u32 m0, m0, s54
    s_add_u32 s52, s52, s53
    v_add_f32 v20, v20, v162
    v_add_f32 v21, v21, v163
    v_add_f32 v20, v20, v164
    v_add_f32 v21, v21, v165
    v_add_f32 v20, v20, v166
    v_add_f32 v21, v21, v167
    v_add_f32 v20, v20, v168
    v_add_f32 v21, v21, v169
    v_add_f32 v20, v20, v170
    v_add_f32 v21, v21, v171
    v_add_f32 v20, v20, v21
    s_nop 1
    v_add_f32 v20, v20, v20 row_ror:8
    buffer_load_dwordx4 v23, s[64:67], s52 offen lds
    s_add_u32 m0, m0, s54
    s_add_u32 s52, s52, s53
    v_mov_b32 v18, v20
    s_nop 1
    v_permlane16_swap_b32 v20, v18
    v_add_f32 v20, v20, v18
    v_mov_b32 v18, v20
    s_nop 1
    v_permlane32_swap_b32 v20, v18
    v_add_f32 v20, v20, v18
    v_mul_f32 v19, 0x3bcccccd, v20
    v_sub_f32 v17, v148, v19
    v_mul_f32 v21, v17, v17
    v_sub_f32 v17, v149, v19
    v_fmac_f32 v21, v17, v17
    v_sub_f32 v17, v150, v19
    buffer_load_dwordx4 v23, s[64:67], s52 offen lds
    s_add_u32 m0, m0, s54
    s_add_u32 s52, s52, s53
    v_fmac_f32 v21, v17, v17
    v_sub_f32 v17, v151, v19
    v_fmac_f32 v21, v17, v17
    v_sub_f32 v17, v152, v19
    v_fmac_f32 v21, v17, v17
    v_sub_f32 v17, v153, v19
    v_fmac_f32 v21, v17, v17
    v_sub_f32 v17, v154, v19
    v_fmac_f32 v21, v17, v17
    v_sub_f32 v17, v155, v19
    v_fmac_f32 v21, v17, v17
    v_sub_f32 v17, v156, v19
    buffer_load_dwordx4 v23, s[64:67], s52 offen lds
    s_add_u32 m0, m0, s54
    s_add_u32 s52, s52, s53
    v_fmac_f32 v21, v17, v17
    v_sub_f32 v17, v157, v19
    v_fmac_f32 v21, v17, v17
    v_sub_f32 v17, v158, v19
    v_fmac_f32 v21, v17, v17
    v_sub_f32 v17, v159, v19
    v_fmac_f32 v21, v17, v17
    v_sub_f32 v17, v160, v19
    v_fmac_f32 v21, v17, v17
    v_sub_f32 v17, v161, v19
    v_fmac_f32 v21, v17, v17
    v_sub_f32 v17, v162, v19
    buffer_load_dwordx4 v23, s[64:67], s52 offen lds
    s_add_u32 m0, m0, s54
    s_add_u32 s52, s52, s53
    v_fmac_f32 v21, v17, v17
    v_sub_f32 v17, v163, v19
    v_fmac_f32 v21, v17, v17
    v_sub_f32 v17, v164, v19
    v_mul_f32 v17, v17, v16
    v_fmac_f32 v21, v17, v17
    v_sub_f32 v17, v165, v19
    v_mul_f32 v17, v17, v16
    v_fmac_f32 v21, v17, v17
    v_sub_f32 v17, v166, v19
    v_mul_f32 v17, v17, v16
    v_fmac_f32 v21, v17, v17
    buffer_load_dwordx4 v23, s[64:67], s52 offen lds
    s_add_u32 m0, m0, s54
    s_add_u32 s52, s52, s53
    v_sub_f32 v17, v167, v19
    v_mul_f32 v17, v17, v16
    v_fmac_f32 v21, v17, v17
    v_sub_f32 v17, v168, v19
    v_mul_f32 v17, v17, v16
    v_fmac_f32 v21, v17, v17
    v_sub_f32 v17, v169, v19
    v_mul_f32 v17, v17, v16
    v_fmac_f32 v21, v17, v17
    v_sub_f32 v17, v170, v19
    v_mul_f32 v17, v17, v16
    v_fmac_f32 v21, v17, v17
    buffer_load_dwordx4 v23, s[64:67], s52 offen lds
    s_add_u32 m0, m0, s54
    s_add_u32 s52, s52, s53
    v_sub_f32 v17, v171, v19
    v_mul_f32 v17, v17, v16
    v_fmac_f32 v21, v17, v17
    s_nop 1
    v_add_f32 v21, v21, v21 row_ror:8
    v_mov_b32 v18, v21
    s_nop 1
    v_permlane16_swap_b32 v21, v18
    v_add_f32 v21, v21, v18
    v_mov_b32 v18, v21
    s_nop 1
    v_permlane32_swap_b32 v21, v18
    v_add_f32 v21, v21, v18
    v_and_b32 v5, 7, v2
    v_lshlrev_b32 v5, 5, v5
    buffer_load_dwordx4 v23, s[64:67], s52 offen lds
    s_add_u32 m0, m0, s54
    s_add_u32 s52, s52, s53
    v_add_u32 v5, 161792, v5
    s_lshl_b32 s44, s40, 3
    v_add_u32 v6, s44, v5
    v_mov_b32 v20, v19
    ds_write_b64 v6, v[20:21]
    s_waitcnt lgkmcnt(0)
    s_barrier
    ds_read_b128 v[84:87], v5
    ds_read_b128 v[88:91], v5 offset:16
    s_waitcnt lgkmcnt(0)
    v_add_f32 v92, v84, v86
    v_add_f32 v17, v88, v90
    buffer_load_dwordx4 v23, s[64:67], s52 offen lds
    s_add_u32 m0, m0, s54
    s_add_u32 s52, s52, s53
    v_add_f32 v92, v92, v17
    v_mul_f32 v92, 0.25, v92
    v_add_f32 v93, v85, v87
    v_add_f32 v17, v89, v91
    v_add_f32 v93, v93, v17
    v_mov_b32 v18, 0
    v_sub_f32 v17, v84, v92
    v_fmac_f32 v18, v17, v17
    v_sub_f32 v17, v86, v92
    v_fmac_f32 v18, v17, v17
    v_sub_f32 v17, v88, v92
    v_fmac_f32 v18, v17, v17
    buffer_load_dwordx4 v23, s[64:67], s52 offen lds
    s_add_u32 m0, m0, s54
    s_add_u32 s52, s52, s53
    v_sub_f32 v17, v90, v92
    v_fmac_f32 v18, v17, v17
    v_mov_b32 v17, 0x43200000
    v_fmac_f32 v93, v18, v17
    v_mul_f32 v93, 0x3acccccd, v93
    v_cvt_pk_bf16_f32 v92, v92, v92
    v_and_b32 v92, 0xffff0000, v92
    v_cvt_pk_bf16_f32 v93, v93, v93
    v_and_b32 v93, 0xffff0000, v93
    v_add_f32 v93, s46, v93
    v_cvt_pk_bf16_f32 v93, v93, v93
    v_and_b32 v93, 0xffff0000, v93
    buffer_load_dwordx4 v23, s[64:67], s52 offen lds
    s_add_u32 m0, m0, s54
    s_add_u32 s52, s52, s53
    v_sqrt_f32 v93, v93
    s_nop 0
    v_cvt_pk_bf16_f32 v93, v93, v93
    v_and_b32 v93, 0xffff0000, v93
    v_rcp_f32 v93, v93
    v_sub_f32 v148, v148, v92
    v_sub_f32 v149, v149, v92
    v_cvt_pk_bf16_f32 v96, v148, v149
    v_lshlrev_b32 v148, 16, v96
    v_and_b32 v149, 0xffff0000, v96
    v_mul_f32 v148, v148, v93
    v_mul_f32 v149, v149, v93
    v_cvt_pk_bf16_f32 v24, v148, v149
    buffer_load_dwordx4 v23, s[64:67], s52 offen lds
    s_add_u32 m0, m0, s54
    s_add_u32 s52, s52, s53
    v_sub_f32 v150, v150, v92
    v_sub_f32 v151, v151, v92
    v_cvt_pk_bf16_f32 v96, v150, v151
    v_lshlrev_b32 v150, 16, v96
    v_and_b32 v151, 0xffff0000, v96
    v_mul_f32 v150, v150, v93
    v_mul_f32 v151, v151, v93
    v_cvt_pk_bf16_f32 v25, v150, v151
    v_sub_f32 v152, v152, v92
    v_sub_f32 v153, v153, v92
    v_cvt_pk_bf16_f32 v96, v152, v153
    v_lshlrev_b32 v152, 16, v96
    buffer_load_dwordx4 v23, s[64:67], s52 offen lds
    s_add_u32 m0, m0, s54
    s_add_u32 s52, s52, s53
    v_and_b32 v153, 0xffff0000, v96
    v_mul_f32 v152, v152, v93
    v_mul_f32 v153, v153, v93
    v_cvt_pk_bf16_f32 v26, v152, v153
    v_sub_f32 v154, v154, v92
    v_sub_f32 v155, v155, v92
    v_cvt_pk_bf16_f32 v96, v154, v155
    v_lshlrev_b32 v154, 16, v96
    v_and_b32 v155, 0xffff0000, v96
    v_mul_f32 v154, v154, v93
    v_mul_f32 v155, v155, v93
    v_cvt_pk_bf16_f32 v27, v154, v155
    buffer_load_dwordx4 v23, s[64:67], s52 offen lds
    s_add_u32 m0, m0, s54
    s_add_u32 s52, s52, s53
    v_sub_f32 v156, v156, v92
    v_sub_f32 v157, v157, v92
    v_cvt_pk_bf16_f32 v96, v156, v157
    v_lshlrev_b32 v156, 16, v96
    v_and_b32 v157, 0xffff0000, v96
    v_mul_f32 v156, v156, v93
    v_mul_f32 v157, v157, v93
    v_cvt_pk_bf16_f32 v28, v156, v157
    v_sub_f32 v158, v158, v92
    v_sub_f32 v159, v159, v92
    v_cvt_pk_bf16_f32 v96, v158, v159
    v_lshlrev_b32 v158, 16, v96
    buffer_load_dwordx4 v23, s[64:67], s52 offen lds
    s_add_u32 m0, m0, s54
    s_add_u32 s52, s52, s53
    v_and_b32 v159, 0xffff0000, v96
    v_mul_f32 v158, v158, v93
    v_mul_f32 v159, v159, v93
    v_cvt_pk_bf16_f32 v29, v158, v159
    v_sub_f32 v160, v160, v92
    v_sub_f32 v161, v161, v92
    v_cvt_pk_bf16_f32 v96, v160, v161
    v_lshlrev_b32 v160, 16, v96
    v_and_b32 v161, 0xffff0000, v96
    v_mul_f32 v160, v160, v93
    v_mul_f32 v161, v161, v93
    v_cvt_pk_bf16_f32 v30, v160, v161
    buffer_load_dwordx4 v23, s[64:67], s52 offen lds
    s_add_u32 m0, m0, s54
    s_add_u32 s52, s52, s53
    v_sub_f32 v162, v162, v92
    v_sub_f32 v163, v163, v92
    v_cvt_pk_bf16_f32 v96, v162, v163
    v_lshlrev_b32 v162, 16, v96
    v_and_b32 v163, 0xffff0000, v96
    v_mul_f32 v162, v162, v93
    v_mul_f32 v163, v163, v93
    v_cvt_pk_bf16_f32 v31, v162, v163
    v_sub_f32 v164, v164, v92
    v_sub_f32 v165, v165, v92
    v_cvt_pk_bf16_f32 v96, v164, v165
    v_lshlrev_b32 v164, 16, v96
    v_and_b32 v165, 0xffff0000, v96
    v_mul_f32 v164, v164, v93
    v_mul_f32 v165, v165, v93
    v_cvt_pk_bf16_f32 v32, v164, v165
    v_sub_f32 v166, v166, v92
    v_sub_f32 v167, v167, v92
    v_cvt_pk_bf16_f32 v96, v166, v167
    v_lshlrev_b32 v166, 16, v96
    v_and_b32 v167, 0xffff0000, v96
    v_mul_f32 v166, v166, v93
    v_mul_f32 v167, v167, v93
    v_cvt_pk_bf16_f32 v33, v166, v167
    v_sub_f32 v168, v168, v92
    v_sub_f32 v169, v169, v92
    v_cvt_pk_bf16_f32 v96, v168, v169
    v_lshlrev_b32 v168, 16, v96
    v_and_b32 v169, 0xffff0000, v96
    v_mul_f32 v168, v168, v93
    v_mul_f32 v169, v169, v93
    v_cvt_pk_bf16_f32 v34, v168, v169
    v_sub_f32 v170, v170, v92
    v_sub_f32 v171, v171, v92
    v_cvt_pk_bf16_f32 v96, v170, v171
    v_lshlrev_b32 v170, 16, v96
    v_and_b32 v171, 0xffff0000, v96
    v_mul_f32 v170, v170, v93
    v_mul_f32 v171, v171, v93
    v_cvt_pk_bf16_f32 v35, v170, v171
    v_mov_b32 v94, 0
    v_lshlrev_b32 v17, 16, v24
    v_and_b32 v18, 0xffff0000, v24
    v_lshlrev_b32 v48, 16, v112
    v_and_b32 v49, 0xffff0000, v112
    v_fmac_f32 v94, v17, v48
    v_fmac_f32 v94, v18, v49
    v_lshlrev_b32 v48, 16, v72
    v_and_b32 v49, 0xffff0000, v72
    v_add_f32 v17, v17, v48
    v_add_f32 v18, v18, v49
    v_cvt_pk_bf16_f32 v36, v17, v18
    v_lshlrev_b32 v17, 16, v25
    v_and_b32 v18, 0xffff0000, v25
    v_lshlrev_b32 v48, 16, v113
    v_and_b32 v49, 0xffff0000, v113
    v_fmac_f32 v94, v17, v48
    v_fmac_f32 v94, v18, v49
    v_lshlrev_b32 v48, 16, v73
    v_and_b32 v49, 0xffff0000, v73
    v_add_f32 v17, v17, v48
    v_add_f32 v18, v18, v49
    v_cvt_pk_bf16_f32 v37, v17, v18
    v_lshlrev_b32 v17, 16, v26
    v_and_b32 v18, 0xffff0000, v26
    v_lshlrev_b32 v48, 16, v114
    v_and_b32 v49, 0xffff0000, v114
    v_fmac_f32 v94, v17, v48
    v_fmac_f32 v94, v18, v49
    v_lshlrev_b32 v48, 16, v74
    v_and_b32 v49, 0xffff0000, v74
    v_add_f32 v17, v17, v48
    v_add_f32 v18, v18, v49
    v_cvt_pk_bf16_f32 v38, v17, v18
    v_lshlrev_b32 v17, 16, v27
    v_and_b32 v18, 0xffff0000, v27
    v_lshlrev_b32 v48, 16, v115
    v_and_b32 v49, 0xffff0000, v115
    v_fmac_f32 v94, v17, v48
    v_fmac_f32 v94, v18, v49
    v_lshlrev_b32 v48, 16, v75
    v_and_b32 v49, 0xffff0000, v75
    v_add_f32 v17, v17, v48
    v_add_f32 v18, v18, v49
    v_cvt_pk_bf16_f32 v39, v17, v18
    v_lshlrev_b32 v17, 16, v28
    v_and_b32 v18, 0xffff0000, v28
    v_lshlrev_b32 v48, 16, v116
    v_and_b32 v49, 0xffff0000, v116
    v_fmac_f32 v94, v17, v48
    v_fmac_f32 v94, v18, v49
    v_lshlrev_b32 v48, 16, v76
    v_and_b32 v49, 0xffff0000, v76
    v_add_f32 v17, v17, v48
    v_add_f32 v18, v18, v49
    v_cvt_pk_bf16_f32 v40, v17, v18
    v_lshlrev_b32 v17, 16, v29
    v_and_b32 v18, 0xffff0000, v29
    v_lshlrev_b32 v48, 16, v117
    v_and_b32 v49, 0xffff0000, v117
    v_fmac_f32 v94, v17, v48
    v_fmac_f32 v94, v18, v49
    v_lshlrev_b32 v48, 16, v77
    v_and_b32 v49, 0xffff0000, v77
    v_add_f32 v17, v17, v48
    v_add_f32 v18, v18, v49
    v_cvt_pk_bf16_f32 v41, v17, v18
    v_lshlrev_b32 v17, 16, v30
    v_and_b32 v18, 0xffff0000, v30
    v_lshlrev_b32 v48, 16, v118
    v_and_b32 v49, 0xffff0000, v118
    v_fmac_f32 v94, v17, v48
    v_fmac_f32 v94, v18, v49
    v_lshlrev_b32 v48, 16, v78
    v_and_b32 v49, 0xffff0000, v78
    v_add_f32 v17, v17, v48
    v_add_f32 v18, v18, v49
    v_cvt_pk_bf16_f32 v42, v17, v18
    v_lshlrev_b32 v17, 16, v31
    v_and_b32 v18, 0xffff0000, v31
    v_lshlrev_b32 v48, 16, v119
    v_and_b32 v49, 0xffff0000, v119
    v_fmac_f32 v94, v17, v48
    v_fmac_f32 v94, v18, v49
    v_lshlrev_b32 v48, 16, v79
    v_and_b32 v49, 0xffff0000, v79
    v_add_f32 v17, v17, v48
    v_add_f32 v18, v18, v49
    v_cvt_pk_bf16_f32 v43, v17, v18
    v_lshlrev_b32 v17, 16, v32
    v_and_b32 v18, 0xffff0000, v32
    v_lshlrev_b32 v48, 16, v120
    v_and_b32 v49, 0xffff0000, v120
    v_fmac_f32 v94, v17, v48
    v_fmac_f32 v94, v18, v49
    v_lshlrev_b32 v48, 16, v80
    v_and_b32 v49, 0xffff0000, v80
    v_add_f32 v17, v17, v48
    v_add_f32 v18, v18, v49
    v_cvt_pk_bf16_f32 v44, v17, v18
    v_lshlrev_b32 v17, 16, v33
    v_and_b32 v18, 0xffff0000, v33
    v_lshlrev_b32 v48, 16, v121
    v_and_b32 v49, 0xffff0000, v121
    v_fmac_f32 v94, v17, v48
    v_fmac_f32 v94, v18, v49
    v_lshlrev_b32 v48, 16, v81
    v_and_b32 v49, 0xffff0000, v81
    v_add_f32 v17, v17, v48
    v_add_f32 v18, v18, v49
    v_cvt_pk_bf16_f32 v45, v17, v18
    v_lshlrev_b32 v17, 16, v34
    v_and_b32 v18, 0xffff0000, v34
    v_lshlrev_b32 v48, 16, v122
    v_and_b32 v49, 0xffff0000, v122
    v_fmac_f32 v94, v17, v48
    v_fmac_f32 v94, v18, v49
    v_lshlrev_b32 v48, 16, v82
    v_and_b32 v49, 0xffff0000, v82
    v_add_f32 v17, v17, v48
    v_add_f32 v18, v18, v49
    v_cvt_pk_bf16_f32 v46, v17, v18
    v_lshlrev_b32 v17, 16, v35
    v_and_b32 v18, 0xffff0000, v35
    v_lshlrev_b32 v48, 16, v123
    v_and_b32 v49, 0xffff0000, v123
    v_fmac_f32 v94, v17, v48
    v_fmac_f32 v94, v18, v49
    v_lshlrev_b32 v48, 16, v83
    v_and_b32 v49, 0xffff0000, v83
    v_add_f32 v17, v17, v48
    v_add_f32 v18, v18, v49
    v_cvt_pk_bf16_f32 v47, v17, v18
    buffer_store_dwordx4 v[36:39], v10, s[20:23], 0 offen offset:0 sc1
    buffer_store_dwordx4 v[40:43], v10, s[20:23], 0 offen offset:128 sc1
    buffer_store_dwordx4 v[44:47], v13, s[20:23], 0 offen offset:256 sc1
    v_add_f32 v94, v94, v94 row_ror:8
    v_mov_b32 v18, v94
    s_nop 1
    v_permlane16_swap_b32 v94, v18
    v_add_f32 v94, v94, v18
    v_mov_b32 v18, v94
    s_nop 1
    v_permlane32_swap_b32 v94, v18
    v_add_f32 v94, v94, v18
    v_and_b32 v5, 7, v2
    v_lshlrev_b32 v5, 4, v5
    v_add_u32 v5, 162304, v5
    s_lshl_b32 s44, s40, 2
    v_add_u32 v6, s44, v5
    ds_write_b32 v6, v94
    s_waitcnt lgkmcnt(0)
    s_waitcnt vmcnt(19)
    s_barrier
    ds_read_b128 v[84:87], v5
    s_waitcnt lgkmcnt(0)
    v_add_f32 v84, v84, v85
    v_add_f32 v86, v86, v87
    v_add_f32 v94, v84, v86
    v_cvt_pk_bf16_f32 v94, v94, v94
    v_and_b32 v94, 0xffff0000, v94
    v_mov_b32 v95, v3
    v_lshlrev_b32 v5, 4, v9
    v_cmp_gt_u32 vcc, 8, v0
    s_nop 1
    v_cndmask_b32 v5, v8, v5, vcc
    buffer_store_dwordx4 v[92:95], v5, s[28:31], 0 offen sc1
    s_waitcnt vmcnt(0)
    s_barrier
    s_lshl_b32 s45, s2, 2
    s_add_u32 s45, s45, 36864
    buffer_store_dword v3, v4, s[56:59], s45 offen sc1
    s_cmp_ge_u32 s101, 54
    s_cbranch_scc1 Lk12_fin
    s_add_u32 s60, s14, 69206016
    s_addc_u32 s61, s15, 0
    s_mov_b32 s62, 552960
    s_mov_b32 s63, 0x20000
    v_lshlrev_b32 v5, 4, v0
    s_mov_b32 s47, 2097152
Lt_rt_spin:
    s_mov_b32 s44, 0
    buffer_load_dwordx4 v[64:67], v5, s[28:31], s44 offen sc1
    s_mov_b32 s44, 4096
    buffer_load_dwordx4 v[68:71], v5, s[28:31], s44 offen sc1
    s_mov_b32 s44, 8192
    buffer_load_dwordx4 v[72:75], v5, s[28:31], s44 offen sc1
    s_mov_b32 s44, 12288
    buffer_load_dwordx4 v[76:79], v5, s[28:31], s44 offen sc1
    s_mov_b32 s44, 16384
    buffer_load_dwordx4 v[80:83], v5, s[28:31], s44 offen sc1
    s_mov_b32 s44, 20480
    buffer_load_dwordx4 v[84:87], v5, s[28:31], s44 offen sc1
    s_mov_b32 s44, 24576
    buffer_load_dwordx4 v[88:91], v5, s[28:31], s44 offen sc1
    s_mov_b32 s44, 28672
    buffer_load_dwordx4 v[92:95], v5, s[28:31], s44 offen sc1
    s_waitcnt vmcnt(0)
    v_cmp_eq_u32 vcc, v3, v67
    v_cmp_eq_u32 s[48:49], v3, v71
    s_nop 3
    s_and_b64 vcc, vcc, s[48:49]
    v_cmp_eq_u32 s[48:49], v3, v75
    s_nop 3
    s_and_b64 vcc, vcc, s[48:49]
    v_cmp_eq_u32 s[48:49], v3, v79
    s_nop 3
    s_and_b64 vcc, vcc, s[48:49]
    v_cmp_eq_u32 s[48:49], v3, v83
    s_nop 3
    s_and_b64 vcc, vcc, s[48:49]
    v_cmp_eq_u32 s[48:49], v3, v87
    s_nop 3
    s_and_b64 vcc, vcc, s[48:49]
    v_cmp_eq_u32 s[48:49], v3, v91
    s_nop 3
    s_and_b64 vcc, vcc, s[48:49]
    v_cmp_eq_u32 s[48:49], v3, v95
    s_nop 3
    s_and_b64 vcc, vcc, s[48:49]
    s_sub_u32 s47, s47, 1
    s_cbranch_scc1 Lt_rt_ok
    s_cmp_eq_u64 vcc, -1
    s_cbranch_scc0 Lt_rt_spin
Lt_rt_ok:
    v_mov_b32 v96, 0
    v_mov_b32 v97, 0
    v_ashrrev_i32 v6, 31, v66
    v_or_b32 v6, 0x80000000, v6
    v_xor_b32 v100, v66, v6
    v_and_b32 v100, 0xfffff800, v100
    v_sub_u32 v6, 2047, v0
    v_or_b32 v100, v100, v6
    v_med3_u32 v97, v96, v97, v100
    v_max_u32 v96, v96, v100
    v_ashrrev_i32 v6, 31, v70
    v_or_b32 v6, 0x80000000, v6
    v_xor_b32 v100, v70, v6
    v_and_b32 v100, 0xfffff800, v100
    v_sub_u32 v6, 1791, v0
    v_or_b32 v100, v100, v6
    v_med3_u32 v97, v96, v97, v100
    v_max_u32 v96, v96, v100
    v_ashrrev_i32 v6, 31, v74
    v_or_b32 v6, 0x80000000, v6
    v_xor_b32 v100, v74, v6
    v_and_b32 v100, 0xfffff800, v100
    v_sub_u32 v6, 1535, v0
    v_or_b32 v100, v100, v6
    v_med3_u32 v97, v96, v97, v100
    v_max_u32 v96, v96, v100
    v_ashrrev_i32 v6, 31, v78
    v_or_b32 v6, 0x80000000, v6
    v_xor_b32 v100, v78, v6
    v_and_b32 v100, 0xfffff800, v100
    v_sub_u32 v6, 1279, v0
    v_or_b32 v100, v100, v6
    v_med3_u32 v97, v96, v97, v100
    v_max_u32 v96, v96, v100
    v_ashrrev_i32 v6, 31, v82
    v_or_b32 v6, 0x80000000, v6
    v_xor_b32 v100, v82, v6
    v_and_b32 v100, 0xfffff800, v100
    v_sub_u32 v6, 1023, v0
    v_or_b32 v100, v100, v6
    v_med3_u32 v97, v96, v97, v100
    v_max_u32 v96, v96, v100
    v_ashrrev_i32 v6, 31, v86
    v_or_b32 v6, 0x80000000, v6
    v_xor_b32 v100, v86, v6
    v_and_b32 v100, 0xfffff800, v100
    v_sub_u32 v6, 767, v0
    v_or_b32 v100, v100, v6
    v_med3_u32 v97, v96, v97, v100
    v_max_u32 v96, v96, v100
    v_ashrrev_i32 v6, 31, v90
    v_or_b32 v6, 0x80000000, v6
    v_xor_b32 v100, v90, v6
    v_and_b32 v100, 0xfffff800, v100
    v_sub_u32 v6, 511, v0
    v_or_b32 v100, v100, v6
    v_med3_u32 v97, v96, v97, v100
    v_max_u32 v96, v96, v100
    v_ashrrev_i32 v6, 31, v94
    v_or_b32 v6, 0x80000000, v6
    v_xor_b32 v100, v94, v6
    v_and_b32 v100, 0xfffff800, v100
    v_sub_u32 v6, 255, v0
    v_or_b32 v100, v100, v6
    v_med3_u32 v97, v96, v97, v100
    v_max_u32 v96, v96, v100
    v_mov_b32 v16, v96
    s_nop 1
    v_max_u32 v16, v16, v16 row_ror:8
    s_nop 1
    v_max_u32 v16, v16, v16 row_ror:4
    s_nop 1
    v_max_u32 v16, v16, v16 row_ror:2
    s_nop 1
    v_max_u32 v16, v16, v16 row_ror:1
    v_mov_b32 v6, v16
    s_nop 1
    v_permlane16_swap_b32 v16, v6
    v_max_u32 v16, v16, v6
    v_mov_b32 v6, v16
    s_nop 1
    v_permlane32_swap_b32 v16, v6
    v_max_u32 v16, v16, v6
    v_cmp_eq_u32 vcc, v16, v96
    s_nop 1
    v_cndmask_b32 v17, v96, v97, vcc
    s_nop 1
    v_max_u32 v17, v17, v17 row_ror:8
    s_nop 1
    v_max_u32 v17, v17, v17 row_ror:4
    s_nop 1
    v_max_u32 v17, v17, v17 row_ror:2
    s_nop 1
    v_max_u32 v17, v17, v17 row_ror:1
    v_mov_b32 v6, v17
    s_nop 1
    v_permlane16_swap_b32 v17, v6
    v_max_u32 v17, v17, v6
    v_mov_b32 v6, v17
    s_nop 1
    v_permlane32_swap_b32 v17, v6
    v_max_u32 v17, v17, v6
    s_lshl_b32 s44, s40, 3
    v_mov_b32 v6, s44
    v_add_u32 v6, 158208, v6
    ds_write_b64 v6, v[16:17]
    s_waitcnt lgkmcnt(0)
    s_barrier
    v_mov_b32 v6, 158208
    ds_read_b128 v[20:23], v6
    ds_read_b128 v[24:27], v6 offset:16
    s_waitcnt lgkmcnt(0)
    v_mov_b32 v96, 0
    v_mov_b32 v97, 0
    v_med3_u32 v97, v96, v97, v20
    v_max_u32 v96, v96, v20
    v_med3_u32 v97, v96, v97, v21
    v_max_u32 v96, v96, v21
    v_med3_u32 v97, v96, v97, v22
    v_max_u32 v96, v96, v22
    v_med3_u32 v97, v96, v97, v23
    v_max_u32 v96, v96, v23
    v_med3_u32 v97, v96, v97, v24
    v_max_u32 v96, v96, v24
    v_med3_u32 v97, v96, v97, v25
    v_max_u32 v96, v96, v25
    v_med3_u32 v97, v96, v97, v26
    v_max_u32 v96, v96, v26
    v_med3_u32 v97, v96, v97, v27
    v_max_u32 v96, v96, v27
    v_and_b32 v96, 0x7ff, v96
    v_sub_u32 v96, 2047, v96
    v_and_b32 v97, 0x7ff, v97
    v_sub_u32 v97, 2047, v97
    v_bfe_u32 v6, v2, 4, 1
    v_cmp_eq_u32 vcc, 0, v6
    s_nop 1
    v_cndmask_b32 v8, v97, v96, vcc
    v_mov_b32 v13, v8
    v_lshlrev_b32 v7, 4, v8
    buffer_load_dwordx4 v[56:59], v7, s[28:31], 0 offen sc1
    v_mul_u32_u24 v8, 1280, v8
    v_and_b32 v5, 15, v2
    v_lshl_add_u32 v8, v5, 4, v8
    buffer_load_dwordx4 v[16:19], v8, s[16:19], 0 offen offset:0
    buffer_load_dwordx4 v[20:23], v8, s[16:19], 0 offen offset:256
    buffer_load_dwordx4 v[24:27], v8, s[16:19], 0 offen offset:512
    buffer_load_dwordx4 v[28:31], v8, s[16:19], 0 offen offset:768
    buffer_load_dwordx4 v[32:35], v8, s[16:19], 0 offen offset:1024
    s_waitcnt vmcnt(0)
    v_lshlrev_b32 v164, 16, v16
    v_and_b32 v165, 0xffff0000, v16
    v_sub_f32 v164, v164, v56
    v_sub_f32 v165, v165, v56
    v_cvt_pk_bf16_f32 v166, v164, v165
    v_lshlrev_b32 v164, 16, v166
    v_and_b32 v165, 0xffff0000, v166
    v_mul_f32 v164, v164, v57
    v_mul_f32 v165, v165, v57
    v_cvt_pk_bf16_f32 v36, v164, v165
    v_lshlrev_b32 v164, 16, v17
    v_and_b32 v165, 0xffff0000, v17
    v_sub_f32 v164, v164, v56
    v_sub_f32 v165, v165, v56
    v_cvt_pk_bf16_f32 v166, v164, v165
    v_lshlrev_b32 v164, 16, v166
    v_and_b32 v165, 0xffff0000, v166
    v_mul_f32 v164, v164, v57
    v_mul_f32 v165, v165, v57
    v_cvt_pk_bf16_f32 v37, v164, v165
    v_lshlrev_b32 v164, 16, v18
    v_and_b32 v165, 0xffff0000, v18
    v_sub_f32 v164, v164, v56
    v_sub_f32 v165, v165, v56
    v_cvt_pk_bf16_f32 v166, v164, v165
    v_lshlrev_b32 v164, 16, v166
    v_and_b32 v165, 0xffff0000, v166
    v_mul_f32 v164, v164, v57
    v_mul_f32 v165, v165, v57
    v_cvt_pk_bf16_f32 v38, v164, v165
    v_lshlrev_b32 v164, 16, v19
    v_and_b32 v165, 0xffff0000, v19
    v_sub_f32 v164, v164, v56
    v_sub_f32 v165, v165, v56
    v_cvt_pk_bf16_f32 v166, v164, v165
    v_lshlrev_b32 v164, 16, v166
    v_and_b32 v165, 0xffff0000, v166
    v_mul_f32 v164, v164, v57
    v_mul_f32 v165, v165, v57
    v_cvt_pk_bf16_f32 v39, v164, v165
    v_lshlrev_b32 v164, 16, v20
    v_and_b32 v165, 0xffff0000, v20
    v_sub_f32 v164, v164, v56
    v_sub_f32 v165, v165, v56
    v_cvt_pk_bf16_f32 v166, v164, v165
    v_lshlrev_b32 v164, 16, v166
    v_and_b32 v165, 0xffff0000, v166
    v_mul_f32 v164, v164, v57
    v_mul_f32 v165, v165, v57
    v_cvt_pk_bf16_f32 v40, v164, v165
    v_lshlrev_b32 v164, 16, v21
    v_and_b32 v165, 0xffff0000, v21
    v_sub_f32 v164, v164, v56
    v_sub_f32 v165, v165, v56
    v_cvt_pk_bf16_f32 v166, v164, v165
    v_lshlrev_b32 v164, 16, v166
    v_and_b32 v165, 0xffff0000, v166
    v_mul_f32 v164, v164, v57
    v_mul_f32 v165, v165, v57
    v_cvt_pk_bf16_f32 v41, v164, v165
    v_lshlrev_b32 v164, 16, v22
    v_and_b32 v165, 0xffff0000, v22
    v_sub_f32 v164, v164, v56
    v_sub_f32 v165, v165, v56
    v_cvt_pk_bf16_f32 v166, v164, v165
    v_lshlrev_b32 v164, 16, v166
    v_and_b32 v165, 0xffff0000, v166
    v_mul_f32 v164, v164, v57
    v_mul_f32 v165, v165, v57
    v_cvt_pk_bf16_f32 v42, v164, v165
    v_lshlrev_b32 v164, 16, v23
    v_and_b32 v165, 0xffff0000, v23
    v_sub_f32 v164, v164, v56
    v_sub_f32 v165, v165, v56
    v_cvt_pk_bf16_f32 v166, v164, v165
    v_lshlrev_b32 v164, 16, v166
    v_and_b32 v165, 0xffff0000, v166
    v_mul_f32 v164, v164, v57
    v_mul_f32 v165, v165, v57
    v_cvt_pk_bf16_f32 v43, v164, v165
    v_lshlrev_b32 v164, 16, v24
    v_and_b32 v165, 0xffff0000, v24
    v_sub_f32 v164, v164, v56
    v_sub_f32 v165, v165, v56
    v_cvt_pk_bf16_f32 v166, v164, v165
    v_lshlrev_b32 v164, 16, v166
    v_and_b32 v165, 0xffff0000, v166
    v_mul_f32 v164, v164, v57
    v_mul_f32 v165, v165, v57
    v_cvt_pk_bf16_f32 v44, v164, v165
    v_lshlrev_b32 v164, 16, v25
    v_and_b32 v165, 0xffff0000, v25
    v_sub_f32 v164, v164, v56
    v_sub_f32 v165, v165, v56
    v_cvt_pk_bf16_f32 v166, v164, v165
    v_lshlrev_b32 v164, 16, v166
    v_and_b32 v165, 0xffff0000, v166
    v_mul_f32 v164, v164, v57
    v_mul_f32 v165, v165, v57
    v_cvt_pk_bf16_f32 v45, v164, v165
    v_lshlrev_b32 v164, 16, v26
    v_and_b32 v165, 0xffff0000, v26
    v_sub_f32 v164, v164, v56
    v_sub_f32 v165, v165, v56
    v_cvt_pk_bf16_f32 v166, v164, v165
    v_lshlrev_b32 v164, 16, v166
    v_and_b32 v165, 0xffff0000, v166
    v_mul_f32 v164, v164, v57
    v_mul_f32 v165, v165, v57
    v_cvt_pk_bf16_f32 v46, v164, v165
    v_lshlrev_b32 v164, 16, v27
    v_and_b32 v165, 0xffff0000, v27
    v_sub_f32 v164, v164, v56
    v_sub_f32 v165, v165, v56
    v_cvt_pk_bf16_f32 v166, v164, v165
    v_lshlrev_b32 v164, 16, v166
    v_and_b32 v165, 0xffff0000, v166
    v_mul_f32 v164, v164, v57
    v_mul_f32 v165, v165, v57
    v_cvt_pk_bf16_f32 v47, v164, v165
    v_lshlrev_b32 v164, 16, v28
    v_and_b32 v165, 0xffff0000, v28
    v_sub_f32 v164, v164, v56
    v_sub_f32 v165, v165, v56
    v_cvt_pk_bf16_f32 v166, v164, v165
    v_lshlrev_b32 v164, 16, v166
    v_and_b32 v165, 0xffff0000, v166
    v_mul_f32 v164, v164, v57
    v_mul_f32 v165, v165, v57
    v_cvt_pk_bf16_f32 v48, v164, v165
    v_lshlrev_b32 v164, 16, v29
    v_and_b32 v165, 0xffff0000, v29
    v_sub_f32 v164, v164, v56
    v_sub_f32 v165, v165, v56
    v_cvt_pk_bf16_f32 v166, v164, v165
    v_lshlrev_b32 v164, 16, v166
    v_and_b32 v165, 0xffff0000, v166
    v_mul_f32 v164, v164, v57
    v_mul_f32 v165, v165, v57
    v_cvt_pk_bf16_f32 v49, v164, v165
    v_lshlrev_b32 v164, 16, v30
    v_and_b32 v165, 0xffff0000, v30
    v_sub_f32 v164, v164, v56
    v_sub_f32 v165, v165, v56
    v_cvt_pk_bf16_f32 v166, v164, v165
    v_lshlrev_b32 v164, 16, v166
    v_and_b32 v165, 0xffff0000, v166
    v_mul_f32 v164, v164, v57
    v_mul_f32 v165, v165, v57
    v_cvt_pk_bf16_f32 v50, v164, v165
    v_lshlrev_b32 v164, 16, v31
    v_and_b32 v165, 0xffff0000, v31
    v_sub_f32 v164, v164, v56
    v_sub_f32 v165, v165, v56
    v_cvt_pk_bf16_f32 v166, v164, v165
    v_lshlrev_b32 v164, 16, v166
    v_and_b32 v165, 0xffff0000, v166
    v_mul_f32 v164, v164, v57
    v_mul_f32 v165, v165, v57
    v_cvt_pk_bf16_f32 v51, v164, v165
    v_lshlrev_b32 v164, 16, v32
    v_and_b32 v165, 0xffff0000, v32
    v_sub_f32 v164, v164, v56
    v_sub_f32 v165, v165, v56
    v_cvt_pk_bf16_f32 v166, v164, v165
    v_lshlrev_b32 v164, 16, v166
    v_and_b32 v165, 0xffff0000, v166
    v_mul_f32 v164, v164, v57
    v_mul_f32 v165, v165, v57
    v_cvt_pk_bf16_f32 v52, v164, v165
    v_lshlrev_b32 v164, 16, v33
    v_and_b32 v165, 0xffff0000, v33
    v_sub_f32 v164, v164, v56
    v_sub_f32 v165, v165, v56
    v_cvt_pk_bf16_f32 v166, v164, v165
    v_lshlrev_b32 v164, 16, v166
    v_and_b32 v165, 0xffff0000, v166
    v_mul_f32 v164, v164, v57
    v_mul_f32 v165, v165, v57
    v_cvt_pk_bf16_f32 v53, v164, v165
    v_lshlrev_b32 v164, 16, v34
    v_and_b32 v165, 0xffff0000, v34
    v_sub_f32 v164, v164, v56
    v_sub_f32 v165, v165, v56
    v_cvt_pk_bf16_f32 v166, v164, v165
    v_lshlrev_b32 v164, 16, v166
    v_and_b32 v165, 0xffff0000, v166
    v_mul_f32 v164, v164, v57
    v_mul_f32 v165, v165, v57
    v_cvt_pk_bf16_f32 v54, v164, v165
    v_lshlrev_b32 v164, 16, v35
    v_and_b32 v165, 0xffff0000, v35
    v_sub_f32 v164, v164, v56
    v_sub_f32 v165, v165, v56
    v_cvt_pk_bf16_f32 v166, v164, v165
    v_lshlrev_b32 v164, 16, v166
    v_and_b32 v165, 0xffff0000, v166
    v_mul_f32 v164, v164, v57
    v_mul_f32 v165, v165, v57
    v_cvt_pk_bf16_f32 v55, v164, v165
    v_mul_f32 v60, 0xbfb8aa3b, v58
    v_exp_f32 v60, v60
    s_nop 0
    v_add_f32 v60, 1.0, v60
    v_rcp_f32 v60, v60
    s_nop 0
    v_cvt_pk_bf16_f32 v60, v60, v60
    v_and_b32 v60, 0xffff0000, v60
    v_bfe_u32 v6, v2, 4, 1
    v_mul_u32_u24 v6, 1280, v6
    v_lshl_add_u32 v6, v5, 4, v6
    v_add_u32 v7, 155648, v6
    s_cmp_lg_u32 s40, 0
    s_cbranch_scc1 Lt_w0done
    ds_write_b128 v7, v[36:39] offset:0
    ds_write_b128 v7, v[40:43] offset:256
    ds_write_b128 v7, v[44:47] offset:512
    ds_write_b128 v7, v[48:51] offset:768
    ds_write_b128 v7, v[52:55] offset:1024
    v_bfe_u32 v7, v2, 4, 1
    v_lshlrev_b32 v7, 3, v7
    v_add_u32 v7, 158240, v7
    v_mov_b32 v62, v13
    v_mov_b32 v63, v60
    ds_write_b64 v7, v[62:63]
Lt_w0done:
    s_waitcnt vmcnt(0) lgkmcnt(0)
    s_barrier
    s_mul_i32 s51, s40, 10240
    v_and_b32 v5, 1, v2
    v_mul_u32_u24 v5, 1280, v5
    v_lshrrev_b32 v6, 4, v2
    v_lshl_add_u32 v5, v6, 4, v5
    s_mul_i32 s44, s40, 320
    s_add_u32 s44, s44, 155648
    v_add_u32 v5, s44, v5
    v_bfe_u32 v7, v2, 2, 2
    v_lshl_add_u32 v7, v6, 3, v7
    v_lshlrev_b32 v7, 6, v7
    v_and_b32 v8, 3, v2
    v_lshl_add_u32 v7, v8, 3, v7
    v_add_u32 v7, s51, v7
    ds_read_b128 v[16:19], v5 offset:0
    ds_read_b128 v[20:23], v5 offset:64
    ds_read_b128 v[24:27], v5 offset:128
    ds_read_b128 v[28:31], v5 offset:192
    ds_read_b128 v[32:35], v5 offset:256
    ds_read_b64_tr_b16 v[100:101], v7 offset:0
    ds_read_b64_tr_b16 v[102:103], v7 offset:256
    ds_read_b64_tr_b16 v[104:105], v7 offset:2048
    ds_read_b64_tr_b16 v[106:107], v7 offset:2304
    ds_read_b64_tr_b16 v[108:109], v7 offset:4096
    ds_read_b64_tr_b16 v[110:111], v7 offset:4352
    ds_read_b64_tr_b16 v[112:113], v7 offset:6144
    ds_read_b64_tr_b16 v[114:115], v7 offset:6400
    ds_read_b64_tr_b16 v[116:117], v7 offset:8192
    ds_read_b64_tr_b16 v[118:119], v7 offset:8448
    ds_read_b64_tr_b16 v[120:121], v7 offset:32
    ds_read_b64_tr_b16 v[122:123], v7 offset:288
    ds_read_b64_tr_b16 v[124:125], v7 offset:2080
    ds_read_b64_tr_b16 v[126:127], v7 offset:2336
    ds_read_b64_tr_b16 v[128:129], v7 offset:4128
    ds_read_b64_tr_b16 v[130:131], v7 offset:4384
    ds_read_b64_tr_b16 v[132:133], v7 offset:6176
    ds_read_b64_tr_b16 v[134:135], v7 offset:6432
    ds_read_b64_tr_b16 v[136:137], v7 offset:8224
    ds_read_b64_tr_b16 v[138:139], v7 offset:8480
    ds_read_b64_tr_b16 v[140:141], v7 offset:40960
    ds_read_b64_tr_b16 v[142:143], v7 offset:41216
    ds_read_b64_tr_b16 v[144:145], v7 offset:43008
    ds_read_b64_tr_b16 v[146:147], v7 offset:43264
    ds_read_b64_tr_b16 v[148:149], v7 offset:45056
    ds_read_b64_tr_b16 v[150:151], v7 offset:45312
    ds_read_b64_tr_b16 v[152:153], v7 offset:47104
    ds_read_b64_tr_b16 v[154:155], v7 offset:47360
    ds_read_b64_tr_b16 v[156:157], v7 offset:49152
    ds_read_b64_tr_b16 v[158:159], v7 offset:49408
    ds_read_b64_tr_b16 v[160:161], v7 offset:40992
    ds_read_b64_tr_b16 v[162:163], v7 offset:41248
    ds_read_b64_tr_b16 v[164:165], v7 offset:43040
    ds_read_b64_tr_b16 v[166:167], v7 offset:43296
    ds_read_b64_tr_b16 v[168:169], v7 offset:45088
    ds_read_b64_tr_b16 v[170:171], v7 offset:45344
    ds_read_b64_tr_b16 v[172:173], v7 offset:47136
    ds_read_b64_tr_b16 v[174:175], v7 offset:47392
    ds_read_b64_tr_b16 v[176:177], v7 offset:49184
    ds_read_b64_tr_b16 v[178:179], v7 offset:49440
    s_waitcnt lgkmcnt(0)
    v_mfma_f32_16x16x32_bf16 v[72:75], v[16:19], v[100:103], 0
    v_mfma_f32_16x16x32_bf16 v[76:79], v[16:19], v[120:123], 0
    v_mfma_f32_16x16x32_bf16 v[80:83], v[16:19], v[140:143], 0
    v_mfma_f32_16x16x32_bf16 v[84:87], v[16:19], v[160:163], 0
    v_mfma_f32_16x16x32_bf16 v[72:75], v[20:23], v[104:107], v[72:75]
    v_mfma_f32_16x16x32_bf16 v[76:79], v[20:23], v[124:127], v[76:79]
    v_mfma_f32_16x16x32_bf16 v[80:83], v[20:23], v[144:147], v[80:83]
    v_mfma_f32_16x16x32_bf16 v[84:87], v[20:23], v[164:167], v[84:87]
    v_mfma_f32_16x16x32_bf16 v[72:75], v[24:27], v[108:111], v[72:75]
    v_mfma_f32_16x16x32_bf16 v[76:79], v[24:27], v[128:131], v[76:79]
    v_mfma_f32_16x16x32_bf16 v[80:83], v[24:27], v[148:151], v[80:83]
    v_mfma_f32_16x16x32_bf16 v[84:87], v[24:27], v[168:171], v[84:87]
    v_mfma_f32_16x16x32_bf16 v[72:75], v[28:31], v[112:115], v[72:75]
    v_mfma_f32_16x16x32_bf16 v[76:79], v[28:31], v[132:135], v[76:79]
    v_mfma_f32_16x16x32_bf16 v[80:83], v[28:31], v[152:155], v[80:83]
    v_mfma_f32_16x16x32_bf16 v[84:87], v[28:31], v[172:175], v[84:87]
    v_mfma_f32_16x16x32_bf16 v[72:75], v[32:35], v[116:119], v[72:75]
    v_mfma_f32_16x16x32_bf16 v[76:79], v[32:35], v[136:139], v[76:79]
    v_mfma_f32_16x16x32_bf16 v[80:83], v[32:35], v[156:159], v[80:83]
    v_mfma_f32_16x16x32_bf16 v[84:87], v[32:35], v[176:179], v[84:87]
    v_and_b32 v5, 15, v2
    v_lshlrev_b32 v5, 2, v5
    s_lshl_b32 s44, s40, 9
    s_add_u32 s44, s44, 158272
    v_add_u32 v5, s44, v5
    s_mov_b32 exec_lo, 0xffff
    s_mov_b32 exec_hi, 0
    ds_write_b32 v5, v72 offset:0
    ds_write_b32 v5, v73 offset:128
    ds_write_b32 v5, v76 offset:64
    ds_write_b32 v5, v77 offset:192
    ds_write_b32 v5, v80 offset:256
    ds_write_b32 v5, v81 offset:384
    ds_write_b32 v5, v84 offset:320
    ds_write_b32 v5, v85 offset:448
    s_mov_b64 exec, -1
    s_waitcnt lgkmcnt(0)
    s_barrier
    v_lshlrev_b32 v5, 2, v2
    v_add_u32 v5, 158272, v5
    ds_read_b32 v16, v5 offset:0
    ds_read_b32 v20, v5 offset:256
    ds_read_b32 v17, v5 offset:512
    ds_read_b32 v21, v5 offset:768
    ds_read_b32 v18, v5 offset:1024
    ds_read_b32 v22, v5 offset:1280
    ds_read_b32 v19, v5 offset:1536
    ds_read_b32 v23, v5 offset:1792
    s_waitcnt lgkmcnt(0)
    v_add_f32 v16, v16, v17
    v_add_f32 v18, v18, v19
    v_add_f32 v16, v16, v18
    v_cvt_pk_bf16_f32 v16, v16, v16
    v_and_b32 v16, 0xffff0000, v16
    v_add_f32 v20, v20, v21
    v_add_f32 v22, v22, v23
    v_add_f32 v20, v20, v22
    v_cvt_pk_bf16_f32 v20, v20, v20
    v_and_b32 v20, 0xffff0000, v20
    v_mul_f32 v17, 0xbfb8aa3b, v16
    v_exp_f32 v17, v17
    s_nop 0
    v_add_f32 v17, 1.0, v17
    v_rcp_f32 v17, v17
    s_nop 0
    v_mul_f32 v16, v16, v17
    v_cvt_pk_bf16_f32 v16, v16, v16
    v_and_b32 v16, 0xffff0000, v16
    v_mul_f32 v16, v16, v20
    v_cvt_pk_bf16_f32 v16, v16, v16
    v_lshlrev_b32 v6, 1, v2
    v_add_u32 v6, 160320, v6
    ds_write_b16 v6, v16
    s_waitcnt lgkmcnt(0)
    v_and_b32 v5, 1, v2
    v_lshlrev_b32 v5, 6, v5
    v_lshrrev_b32 v6, 4, v2
    v_lshl_add_u32 v5, v6, 4, v5
    v_add_u32 v5, 160320, v5
    ds_read_b128 v[16:19], v5
    v_bfe_u32 v7, v2, 2, 2
    v_lshl_add_u32 v7, v6, 3, v7
    v_mul_u32_u24 v7, 1280, v7
    v_and_b32 v8, 3, v2
    v_lshl_add_u32 v7, v8, 3, v7
    s_mul_i32 s44, s40, 320
    s_add_u32 s44, s44, 81920
    v_add_u32 v7, s44, v7
    ds_read_b64_tr_b16 v[100:101], v7 offset:0
    ds_read_b64_tr_b16 v[102:103], v7 offset:5120
    ds_read_b64_tr_b16 v[104:105], v7 offset:32
    ds_read_b64_tr_b16 v[106:107], v7 offset:5152
    ds_read_b64_tr_b16 v[108:109], v7 offset:64
    ds_read_b64_tr_b16 v[110:111], v7 offset:5184
    ds_read_b64_tr_b16 v[112:113], v7 offset:96
    ds_read_b64_tr_b16 v[114:115], v7 offset:5216
    ds_read_b64_tr_b16 v[116:117], v7 offset:128
    ds_read_b64_tr_b16 v[118:119], v7 offset:5248
    ds_read_b64_tr_b16 v[120:121], v7 offset:160
    ds_read_b64_tr_b16 v[122:123], v7 offset:5280
    ds_read_b64_tr_b16 v[124:125], v7 offset:192
    ds_read_b64_tr_b16 v[126:127], v7 offset:5312
    ds_read_b64_tr_b16 v[128:129], v7 offset:224
    ds_read_b64_tr_b16 v[130:131], v7 offset:5344
    ds_read_b64_tr_b16 v[132:133], v7 offset:256
    ds_read_b64_tr_b16 v[134:135], v7 offset:5376
    ds_read_b64_tr_b16 v[136:137], v7 offset:288
    ds_read_b64_tr_b16 v[138:139], v7 offset:5408
    s_waitcnt lgkmcnt(0)
    v_mfma_f32_16x16x32_bf16 v[140:143], v[16:19], v[100:103], 0
    v_mfma_f32_16x16x32_bf16 v[144:147], v[16:19], v[104:107], 0
    v_mfma_f32_16x16x32_bf16 v[148:151], v[16:19], v[108:111], 0
    v_mfma_f32_16x16x32_bf16 v[152:155], v[16:19], v[112:115], 0
    v_mfma_f32_16x16x32_bf16 v[156:159], v[16:19], v[116:119], 0
    v_mfma_f32_16x16x32_bf16 v[160:163], v[16:19], v[120:123], 0
    v_mfma_f32_16x16x32_bf16 v[164:167], v[16:19], v[124:127], 0
    v_mfma_f32_16x16x32_bf16 v[168:171], v[16:19], v[128:131], 0
    v_mfma_f32_16x16x32_bf16 v[172:175], v[16:19], v[132:135], 0
    v_mfma_f32_16x16x32_bf16 v[176:179], v[16:19], v[136:139], 0
    v_and_b32 v5, 15, v2
    v_lshlrev_b32 v5, 4, v5
    v_mov_b32 v6, 0x4000000
    v_cmp_gt_u32 vcc, 16, v2
    s_nop 1
    v_cndmask_b32 v5, v6, v5, vcc
    s_mul_i32 s44, s101, 10240
    s_mul_i32 s45, s40, 2560
    s_add_u32 s44, s44, s45
    v_mov_b32 v142, v3
    v_mov_b32 v143, v3
    v_mov_b32 v146, v3
    v_mov_b32 v147, v3
    v_mov_b32 v150, v3
    v_mov_b32 v151, v3
    v_mov_b32 v154, v3
    v_mov_b32 v155, v3
    v_mov_b32 v158, v3
    v_mov_b32 v159, v3
    v_mov_b32 v162, v3
    v_mov_b32 v163, v3
    v_mov_b32 v166, v3
    v_mov_b32 v167, v3
    v_mov_b32 v170, v3
    v_mov_b32 v171, v3
    v_mov_b32 v174, v3
    v_mov_b32 v175, v3
    v_mov_b32 v178, v3
    v_mov_b32 v179, v3
    buffer_store_dwordx4 v[140:143], v5, s[60:63], s44 offen offset:0 sc1
    buffer_store_dwordx4 v[144:147], v5, s[60:63], s44 offen offset:256 sc1
    buffer_store_dwordx4 v[148:151], v5, s[60:63], s44 offen offset:512 sc1
    buffer_store_dwordx4 v[152:155], v5, s[60:63], s44 offen offset:768 sc1
    buffer_store_dwordx4 v[156:159], v5, s[60:63], s44 offen offset:1024 sc1
    buffer_store_dwordx4 v[160:163], v5, s[60:63], s44 offen offset:1280 sc1
    buffer_store_dwordx4 v[164:167], v5, s[60:63], s44 offen offset:1536 sc1
    buffer_store_dwordx4 v[168:171], v5, s[60:63], s44 offen offset:1792 sc1
    buffer_store_dwordx4 v[172:175], v5, s[60:63], s44 offen offset:2048 sc1
    buffer_store_dwordx4 v[176:179], v5, s[60:63], s44 offen offset:2304 sc1
    s_cmp_ge_u32 s101, 20
    s_cbranch_scc1 Lk12_fin
    s_cmp_ge_u32 s101, 10
    s_cselect_b32 s51, 1, 0
    s_mul_i32 s44, s51, 10
    s_sub_u32 s52, s101, s44
    s_lshl_b32 s44, s52, 6
    v_add_u32 v16, s44, v2
    s_lshl_b32 s44, s51, 3
    s_add_u32 s44, s44, 158240
    v_mov_b32 v17, s44
    ds_read_b64 v[18:19], v17
    s_mul_i32 s44, s51, 1280
    s_add_u32 s44, s44, 155648
    v_lshlrev_b32 v20, 1, v16
    v_add_u32 v21, s44, v20
    ds_read_u16 v22, v21
    s_waitcnt lgkmcnt(0)
    v_mul_u32_u24 v23, 1280, v18
    v_add_u32 v23, v23, v20
    buffer_load_ushort v24, v23, s[16:19], 0 offen
    v_lshlrev_b32 v5, 4, v2
    s_mov_b32 s44, 36864
    s_cmp_lg_u32 s40, 0
    s_cbranch_scc1 Lt_rtf_ok
    s_mov_b32 s47, 2097152
Lt_rtf_spin:
    buffer_load_dwordx4 v[28:31], v5, s[56:59], s44 offen sc1
    s_waitcnt vmcnt(0)
    v_cmp_eq_u32 vcc, v3, v28
    v_cmp_eq_u32 s[48:49], v3, v29
    s_nop 3
    s_and_b64 vcc, vcc, s[48:49]
    v_cmp_eq_u32 s[48:49], v3, v30
    s_nop 3
    s_and_b64 vcc, vcc, s[48:49]
    v_cmp_eq_u32 s[48:49], v3, v31
    s_nop 3
    s_and_b64 vcc, vcc, s[48:49]
    s_sub_u32 s47, s47, 1
    s_cbranch_scc1 Lt_rtf_ok
    s_and_b32 s48, vcc_lo, 0xffffffff
    s_and_b32 s49, vcc_hi, 0xffffffff
    s_cmp_eq_u32 s48, 0xffffffff
    s_cbranch_scc0 Lt_rtf_spin
    s_cmp_eq_u32 s49, 0xffffffff
    s_cbranch_scc0 Lt_rtf_spin
Lt_rtf_ok:
    s_barrier
    v_lshlrev_b32 v26, 4, v16
    s_mul_i32 s45, s40, 143360
    s_mov_b32 s47, 2097152
Lt_y_spin:
    s_add_u32 s44, s45, 0
    buffer_load_dwordx4 v[100:103], v26, s[60:63], s44 offen sc1
    s_add_u32 s44, s45, 10240
    buffer_load_dwordx4 v[104:107], v26, s[60:63], s44 offen sc1
    s_add_u32 s44, s45, 20480
    buffer_load_dwordx4 v[108:111], v26, s[60:63], s44 offen sc1
    s_add_u32 s44, s45, 30720
    buffer_load_dwordx4 v[112:115], v26, s[60:63], s44 offen sc1
    s_add_u32 s44, s45, 40960
    buffer_load_dwordx4 v[116:119], v26, s[60:63], s44 offen sc1
    s_add_u32 s44, s45, 51200
    buffer_load_dwordx4 v[120:123], v26, s[60:63], s44 offen sc1
    s_add_u32 s44, s45, 61440
    buffer_load_dwordx4 v[124:127], v26, s[60:63], s44 offen sc1
    s_add_u32 s44, s45, 71680
    buffer_load_dwordx4 v[128:131], v26, s[60:63], s44 offen sc1
    s_add_u32 s44, s45, 81920
    buffer_load_dwordx4 v[132:135], v26, s[60:63], s44 offen sc1
    s_add_u32 s44, s45, 92160
    buffer_load_dwordx4 v[136:139], v26, s[60:63], s44 offen sc1
    s_add_u32 s44, s45, 102400
    buffer_load_dwordx4 v[140:143], v26, s[60:63], s44 offen sc1
    s_add_u32 s44, s45, 112640
    buffer_load_dwordx4 v[144:147], v26, s[60:63], s44 offen sc1
    s_add_u32 s44, s45, 122880
    buffer_load_dwordx4 v[148:151], v26, s[60:63], s44 offen sc1
    s_add_u32 s44, s45, 133120
    buffer_load_dwordx4 v[152:155], v26, s[60:63], s44 offen sc1
    s_waitcnt vmcnt(0)
    v_cmp_eq_u32 vcc, v3, v102
    v_cmp_eq_u32 s[48:49], v3, v106
    s_nop 3
    s_and_b64 vcc, vcc, s[48:49]
    v_cmp_eq_u32 s[48:49], v3, v110
    s_nop 3
    s_and_b64 vcc, vcc, s[48:49]
    v_cmp_eq_u32 s[48:49], v3, v114
    s_nop 3
    s_and_b64 vcc, vcc, s[48:49]
    v_cmp_eq_u32 s[48:49], v3, v118
    s_nop 3
    s_and_b64 vcc, vcc, s[48:49]
    v_cmp_eq_u32 s[48:49], v3, v122
    s_nop 3
    s_and_b64 vcc, vcc, s[48:49]
    v_cmp_eq_u32 s[48:49], v3, v126
    s_nop 3
    s_and_b64 vcc, vcc, s[48:49]
    v_cmp_eq_u32 s[48:49], v3, v130
    s_nop 3
    s_and_b64 vcc, vcc, s[48:49]
    v_cmp_eq_u32 s[48:49], v3, v134
    s_nop 3
    s_and_b64 vcc, vcc, s[48:49]
    v_cmp_eq_u32 s[48:49], v3, v138
    s_nop 3
    s_and_b64 vcc, vcc, s[48:49]
    v_cmp_eq_u32 s[48:49], v3, v142
    s_nop 3
    s_and_b64 vcc, vcc, s[48:49]
    v_cmp_eq_u32 s[48:49], v3, v146
    s_nop 3
    s_and_b64 vcc, vcc, s[48:49]
    s_cmp_eq_u32 s40, 3
    s_cbranch_scc1 Lt_y_chk
    v_cmp_eq_u32 s[48:49], v3, v150
    s_nop 3
    s_and_b64 vcc, vcc, s[48:49]
    v_cmp_eq_u32 s[48:49], v3, v154
    s_nop 3
    s_and_b64 vcc, vcc, s[48:49]
Lt_y_chk:
    s_sub_u32 s47, s47, 1
    s_cbranch_scc1 Lt_y_ok
    s_cmp_eq_u64 vcc, -1
    s_cbranch_scc0 Lt_y_spin
Lt_y_ok:
    s_cmp_eq_u32 s51, 0
    s_cselect_b64 vcc, -1, 0
    v_cndmask_b32 v32, v101, v100, vcc
    v_cndmask_b32 v33, v105, v104, vcc
    v_cndmask_b32 v34, v109, v108, vcc
    v_cndmask_b32 v35, v113, v112, vcc
    v_cndmask_b32 v36, v117, v116, vcc
    v_cndmask_b32 v37, v121, v120, vcc
    v_cndmask_b32 v38, v125, v124, vcc
    v_cndmask_b32 v39, v129, v128, vcc
    v_cndmask_b32 v40, v133, v132, vcc
    v_cndmask_b32 v41, v137, v136, vcc
    v_cndmask_b32 v42, v141, v140, vcc
    v_cndmask_b32 v43, v145, v144, vcc
    v_cndmask_b32 v44, v149, v148, vcc
    v_cndmask_b32 v45, v153, v152, vcc
    v_add_f32 v32, v32, v33
    v_add_f32 v32, v32, v34
    v_add_f32 v32, v32, v35
    v_add_f32 v32, v32, v36
    v_add_f32 v32, v32, v37
    v_add_f32 v32, v32, v38
    v_add_f32 v32, v32, v39
    v_add_f32 v32, v32, v40
    v_add_f32 v32, v32, v41
    v_add_f32 v32, v32, v42
    v_add_f32 v32, v32, v43
    v_add_f32 v32, v32, v44
    v_add_f32 v32, v32, v45
    v_lshlrev_b32 v27, 2, v0
    v_add_u32 v27, 158272, v27
    ds_write_b32 v27, v32
    s_waitcnt lgkmcnt(0)
    s_barrier
    s_cmp_lg_u32 s40, 0
    s_cbranch_scc1 Lk12_fin
    v_lshlrev_b32 v27, 2, v2
    v_add_u32 v27, 158272, v27
    ds_read_b32 v32, v27 offset:0
    ds_read_b32 v33, v27 offset:256
    ds_read_b32 v34, v27 offset:512
    ds_read_b32 v35, v27 offset:768
    s_waitcnt lgkmcnt(0)
    v_add_f32 v32, v32, v33
    v_add_f32 v34, v34, v35
    v_add_f32 v32, v32, v34
    v_cvt_pk_bf16_f32 v32, v32, v32
    v_and_b32 v32, 0xffff0000, v32
    v_mul_f32 v32, v32, v19
    v_cvt_pk_bf16_f32 v32, v32, v32
    v_and_b32 v32, 0xffff0000, v32
    v_lshlrev_b32 v22, 16, v22
    v_add_f32 v32, v32, v22
    v_cvt_pk_bf16_f32 v32, v32, v32
    v_and_b32 v32, 0xffff0000, v32
    v_lshlrev_b32 v24, 16, v24
    v_add_f32 v32, v32, v24
    v_cvt_pk_bf16_f32 v32, v32, v32
    buffer_store_short v32, v23, s[20:23], 0 offen sc1
Lk12_fin:
Lk12_end:
    s_endpgm
Lcode_end:
    s_endpgm
.section .rodata,"a"
.p2align 6
.amdhsa_kernel k12_kernel
  .amdhsa_next_free_vgpr 512
  .amdhsa_next_free_sgpr 102
  .amdhsa_accum_offset 256
  .amdhsa_group_segment_fixed_size 0
  .amdhsa_kernarg_size 112
  .amdhsa_user_sgpr_count 2
  .amdhsa_user_sgpr_kernarg_segment_ptr 1
  .amdhsa_system_sgpr_workgroup_id_x 1
  .amdhsa_float_denorm_mode_32 3
.end_amdhsa_kernel
```
